```python
import torch

def _softmax(x, axis=-1):
    return torch.softmax(x, dim=axis)

def _gelu(x):
    return torch.nn.functional.gelu(x, approximate='tanh')

def _silu(x):
    return torch.nn.functional.silu(x)

def _sigmoid(x):
    return torch.sigmoid(x)

def _layernorm(x, axis=-1, eps=1e-05):
    m = x.mean(dim=axis, keepdim=True)
    v = x.var(dim=axis, keepdim=True, unbiased=False)
    return (x - m) / torch.sqrt(v + eps)

def _scatter_add(tgt, idx, src, axis=0):
    return tgt.clone().index_add_(axis, idx, src)

def _segment_sum(src, seg, n):
    out = torch.zeros((n,) + src.shape[1:], dtype=src.dtype)
    return out.index_add_(0, seg, src)

def _pad(x, pw):
    flat = tuple((v for pair in reversed(pw) for v in pair))
    return torch.nn.functional.pad(x, flat)
kernel_name = 'adaLN_cond__memory_aug_recurrent_mem_tr__mixer_gmlp__prompt'

def setup_inputs():

    _w = lambda a: (lambda t: t.to(torch.bfloat16) if t.is_floating_point() else t)(torch.as_tensor(a))

    def _A_setup():
        B, S, Dm = (1, 2048, 512)
        H, Dh = (32, 128)
        M, seg = (8, 32)
        seg = min(seg, S)
        S = S // seg * seg
        return {'x': _w((lambda *s: torch.randn(*s, dtype=torch.bfloat16) * 0.05)(B, S, Dm)), 'mem0': _w((lambda *s: torch.randn(*s, dtype=torch.bfloat16) * 0.4)(B, M, Dm)), 'Wq': _w((lambda *s: torch.randn(*s, dtype=torch.bfloat16) * 3.2)(Dm, H, Dh) * Dm ** (-0.5)), 'Wk': _w((lambda *s: torch.randn(*s, dtype=torch.bfloat16) * 3.2)(Dm, H, Dh) * Dm ** (-0.5)), 'Wv': _w((lambda *s: torch.randn(*s, dtype=torch.bfloat16) * 0.4)(Dm, H, Dh) * Dm ** (-0.5)), 'Wo': _w((lambda *s: torch.randn(*s, dtype=torch.bfloat16) * 0.4)(H, Dh, Dm) * (H * Dh) ** (-0.5)), 'seg_len': seg}
    _A_in = _A_setup()

    def _B_setup():
        B, S, D, F = (1, 2048, 512, 1376)
        Fh = F // 2
        return {'x': _w((lambda *s: torch.randn(*s, dtype=torch.bfloat16) * 0.05)(B, S, D)), 'w_in': _w((lambda *s: torch.randn(*s, dtype=torch.bfloat16) * 0.8)(D, 2 * Fh)), 'w_sp': _w(0.01 * (lambda *s: torch.randn(*s, dtype=torch.bfloat16) * 0.8)(S, S)), 'b_sp': _w(1.0 + 0.01 * (lambda *s: torch.randn(*s, dtype=torch.bfloat16) * 0.05)(S)), 'w_out': _w((lambda *s: torch.randn(*s, dtype=torch.bfloat16) * 0.05)(Fh, D))}
    _B_in = _B_setup()
    return {'A_x': _A_in['x'], 'A_mem0': _A_in['mem0'], 'A_Wq': _A_in['Wq'], 'A_Wk': _A_in['Wk'], 'A_Wv': _A_in['Wv'], 'A_Wo': _A_in['Wo'], 'A_seg_len': _A_in['seg_len'], 'B_x': _B_in['x'], 'B_w_in': _B_in['w_in'], 'B_w_sp': _B_in['w_sp'], 'B_b_sp': _B_in['b_sp'], 'B_w_out': _B_in['w_out'], 'c': _w((lambda *s: torch.randn(*s, dtype=torch.bfloat16) * 0.1)(1, 512) * 8.0), 'w_mod': _w((lambda *s: torch.randn(*s, dtype=torch.bfloat16) * 0.1)(512, 6 * 512) * 512 ** (-0.5) * 8.0)}

def reference(A_x, A_mem0, A_Wq, A_Wk, A_Wv, A_Wo, A_seg_len, B_x, B_w_in, B_w_sp, B_b_sp, B_w_out, c, w_mod):

    def _A_ref(x, mem0, Wq, Wk, Wv, Wo, seg_len):
        B, S, Dm = x.shape
        H, Dh = (Wq.shape[1], Wq.shape[2])
        M = mem0.shape[1]
        scale = Dh ** (-0.5)
        n_seg = S // seg_len
        L = M + seg_len
        idx = torch.arange(L)
        mask = (idx[:, None] < M) | (idx[:, None] >= idx[None, :])
        mem = mem0
        outs = []
        for s in range(n_seg):
            xs = x[:, s * seg_len:(s + 1) * seg_len, :].clone()
            h = torch.concatenate([mem, xs], axis=1)
            q = torch.einsum('btd,dhe->bhte', h, Wq)
            k = torch.einsum('btd,dhe->bhte', h, Wk)
            v = torch.einsum('btd,dhe->bhte', h, Wv)
            scores = torch.einsum('bhqe,bhke->bhqk', q, k) * scale
            scores = torch.where(mask[None, None], scores, -1000000000.0)
            p = _softmax(scores, axis=-1)
            o = torch.einsum('bhqk,bhke->bhqe', p, v)
            o = torch.einsum('bhte,hed->btd', o, Wo)
            mem = o[:, :M, :].clone()
            outs.append(o[:, M:, :])
        return torch.concatenate(outs, axis=1)

    def _B_ref(x, w_in, w_sp, b_sp, w_out):
        B, S, D = x.shape
        F = w_in.shape[-1]
        Fh = F // 2
        z = _gelu(torch.einsum('bsd,df->bsf', x, w_in))
        z1 = z[..., :Fh].clone()
        z2 = _layernorm(z[..., Fh:], axis=-1)
        g = torch.einsum('ts,bsf->btf', w_sp, z2) + b_sp[None, :, None]
        return torch.einsum('bsf,fd->bsd', z1 * g, w_out)
    x = A_x
    mod = (_silu(c) @ w_mod).reshape(c.shape[0], 6, 1, -1)
    sa, ca, ga, sb, cb, gb = (mod[:, 0].clone(), mod[:, 1].clone(), mod[:, 2].clone(), mod[:, 3].clone(), mod[:, 4].clone(), mod[:, 5].clone())
    h = _layernorm(x, axis=-1) * (1 + ca) + sa
    x = x + ga * _A_ref(h, A_mem0, A_Wq, A_Wk, A_Wv, A_Wo, A_seg_len)
    h = _layernorm(x, axis=-1) * (1 + cb) + sb
    x = x + gb * _B_ref(h, B_w_in, B_w_sp, B_b_sp, B_w_out)
    return x
```

```asm
; @launch grid=(256,1,1) block=(256,1,1) lds=163840
.amdgcn_target "amdgcn-amd-amdhsa--gfx950"
.text
.globl adaLN_cond__memory_aug_recurrent_mem_tr__mixer_gmlp__prompt_kernel
.p2align 8
.type adaLN_cond__memory_aug_recurrent_mem_tr__mixer_gmlp__prompt_kernel,@function
adaLN_cond__memory_aug_recurrent_mem_tr__mixer_gmlp__prompt_kernel:
    s_cmp_ge_u32 s2, 256
    s_cbranch_scc1 Ldone
    s_load_dwordx2 s[4:5], s[0:1], 128
    s_load_dwordx2 s[6:7], s[0:1], 120
    v_lshrrev_b32 v1, 6, v0
    s_nop 0
    v_readfirstlane_b32 s9, v1
    s_waitcnt lgkmcnt(0)
    s_getreg_b32 s100, hwreg(HW_REG_XCC_ID)
    s_and_b32 s100, s100, 7
    s_cmp_lg_u32 s9, 0
    s_cbranch_scc1 Lreg_1
    s_cmp_lg_u32 s100, 0
    s_cbranch_scc1 Lreg_1
    s_memtime s[40:41]
    s_memrealtime s[42:43]
    s_waitcnt lgkmcnt(0)
    s_lshr_b32 s41, s40, 4
    s_xor_b32 s40, s40, s41
    s_lshr_b32 s41, s40, 9
    s_xor_b32 s40, s40, s41
    s_xor_b32 s40, s40, s42
    s_lshr_b32 s41, s42, 5
    s_xor_b32 s40, s40, s41
    s_and_b32 s40, s40, 15
    s_lshl_b32 s40, s40, 3
    s_or_b32 s40, s40, s100
    s_or_b32 s40, s40, 0x80
    v_mov_b32 v2, s2
    v_mov_b32 v3, s40
    s_mov_b64 exec, 1
    global_store_byte v2, v3, s[6:7] sc1
    s_mov_b64 exec, -1
Lreg_1:
    s_sub_u32 s40, s2, s100
    s_and_b32 s40, s40, 7
    s_add_u32 s41, s2, 7
    s_sub_u32 s41, s41, s40
    s_lshr_b32 s41, s41, 3
    s_sub_u32 s42, s2, s41
    s_add_u32 s42, s42, 32
    s_cmp_eq_u32 s100, 0
    s_cselect_b32 s99, s41, s42
    s_min_u32 s99, s99, 255
    s_mov_b32 s98, 0
Lstart:
    v_mbcnt_lo_u32_b32 v0, -1, 0
    v_mbcnt_hi_u32_b32 v0, -1, v0
    s_lshl_b32 s40, s9, 6
    v_add_u32 v0, s40, v0
    s_cmp_ge_u32 s99, 32
    s_cbranch_scc1 Lworker
    s_mov_b32 s8, s99
    s_getpc_b64 s[62:63]
Lpc_2:
    s_sub_u32 s62, s62, Lpc_2-Lstart
    s_subb_u32 s63, s63, 0
    v_lshlrev_b32 v120, 6, v0
    global_load_dword v121, v120, s[62:63]
    v_and_b32 v16, 63, v0
    v_and_b32 v17, 15, v16
    v_lshrrev_b32 v18, 4, v16
    s_load_dwordx4 s[40:43], s[0:1], 16
    s_load_dwordx4 s[44:47], s[0:1], 32
    s_load_dwordx2 s[48:49], s[0:1], 8
    v_lshrrev_b32 v22, 3, v16
    v_bfe_u32 v19, v16, 1, 2
    v_lshrrev_b32 v20, 5, v16
    v_xor_b32 v19, v19, v20
    v_lshlrev_b32 v19, 5, v19
    v_and_b32 v20, 1, v16
    v_lshl_add_u32 v19, v20, 4, v19
    v_lshl_add_u32 v24, v22, 13, v19
    v_xor_b32 v25, 64, v24
    v_lshl_add_u32 v30, v22, 10, v19
    v_xor_b32 v31, 64, v30
    v_bfe_u32 v19, v16, 5, 1
    v_lshlrev_b32 v19, 11, v19
    v_bfe_u32 v20, v16, 3, 1
    v_lshl_add_u32 v19, v20, 10, v19
    v_bfe_u32 v21, v16, 4, 1
    v_lshl_add_u32 v19, v21, 9, v19
    v_lshl_add_u32 v21, v20, 1, v21
    v_bfe_u32 v20, v16, 2, 1
    v_lshl_add_u32 v19, v20, 7, v19
    v_and_b32 v20, 3, v16
    v_lshl_add_u32 v19, v20, 3, v19
    s_lshl_b32 s50, s9, 15
    s_add_u32 s50, s50, 32768
    v_add_u32 v19, s50, v19
    v_xor_b32 v20, 0, v21
    v_lshl_add_u32 v32, v20, 5, v19
    v_xor_b32 v20, 1, v21
    v_lshl_add_u32 v33, v20, 5, v19
    v_xor_b32 v20, 2, v21
    v_lshl_add_u32 v34, v20, 5, v19
    v_xor_b32 v20, 3, v21
    v_lshl_add_u32 v35, v20, 5, v19
    s_and_b32 s51, s9, 1
    s_lshl_b32 s51, s51, 6
    v_xor_b32 v36, s51, v32
    v_xor_b32 v37, s51, v33
    v_subrev_u32 v19, s50, v19
    v_and_b32 v20, 24, v19
    v_lshrrev_b32 v19, 7, v19
    v_lshl_add_u32 v19, v19, 6, v20
    v_add_u32 v36, s50, v19
    v_lshrrev_b32 v19, 2, v16
    v_lshlrev_b32 v19, 13, v19
    v_and_b32 v20, 3, v16
    v_lshl_add_u32 v37, v20, 4, v19
    s_waitcnt lgkmcnt(0)
    s_cmp_lt_u32 s9, 2
    s_cselect_b64 s[40:41], s[40:41], s[42:43]
    s_lshl_b32 s52, s8, 8
    s_lshl_b32 s51, s51, 1
    s_add_u32 s51, s51, s52
    s_add_u32 s40, s40, s51
    s_addc_u32 s41, s41, 0
    s_lshl_b32 s51, s9, 6
    s_add_u32 s51, s51, s52
    s_add_u32 s44, s44, s51
    s_addc_u32 s45, s45, 0
    s_lshl_b32 s51, s8, 17
    s_lshl_b32 s52, s9, 7
    s_add_u32 s51, s51, s52
    s_add_u32 s46, s46, s51
    s_addc_u32 s47, s47, 0
    s_add_u32 s52, s9, 0
    s_and_b32 s52, s52, 3
    s_lshl_b32 s52, s52, 19
    s_add_u32 s53, s9, 1
    s_and_b32 s53, s53, 3
    s_lshl_b32 s53, s53, 19
    s_add_u32 s54, s9, 2
    s_and_b32 s54, s54, 3
    s_lshl_b32 s54, s54, 19
    s_add_u32 s55, s9, 3
    s_and_b32 s55, s55, 3
    s_lshl_b32 s55, s55, 19
    s_add_u32 m0, s50, 0
    s_add_u32 s56, s52, 0
    v_add_u32 v26, s56, v24
    global_load_lds_dwordx4 v26, s[40:41]
    s_add_u32 m0, s50, 1024
    s_add_u32 s56, s52, 65536
    v_add_u32 v27, s56, v25
    global_load_lds_dwordx4 v27, s[40:41]
    s_add_u32 m0, s50, 2048
    s_add_u32 s56, s52, 131072
    v_add_u32 v26, s56, v24
    global_load_lds_dwordx4 v26, s[40:41]
    s_add_u32 m0, s50, 3072
    s_add_u32 s56, s52, 196608
    v_add_u32 v27, s56, v25
    global_load_lds_dwordx4 v27, s[40:41]
    s_add_u32 m0, s50, 4096
    s_add_u32 s56, s52, 262144
    v_add_u32 v26, s56, v24
    global_load_lds_dwordx4 v26, s[40:41]
    s_add_u32 m0, s50, 5120
    s_add_u32 s56, s52, 327680
    v_add_u32 v27, s56, v25
    global_load_lds_dwordx4 v27, s[40:41]
    s_add_u32 m0, s50, 6144
    s_add_u32 s56, s52, 393216
    v_add_u32 v26, s56, v24
    global_load_lds_dwordx4 v26, s[40:41]
    s_add_u32 m0, s50, 7168
    s_add_u32 s56, s52, 458752
    v_add_u32 v27, s56, v25
    global_load_lds_dwordx4 v27, s[40:41]
    s_add_u32 m0, s50, 8192
    s_add_u32 s56, s55, 0
    v_add_u32 v26, s56, v24
    global_load_lds_dwordx4 v26, s[40:41]
    s_add_u32 m0, s50, 9216
    s_add_u32 s56, s55, 65536
    v_add_u32 v27, s56, v25
    global_load_lds_dwordx4 v27, s[40:41]
    s_add_u32 m0, s50, 10240
    s_add_u32 s56, s55, 131072
    v_add_u32 v26, s56, v24
    global_load_lds_dwordx4 v26, s[40:41]
    s_add_u32 m0, s50, 11264
    s_add_u32 s56, s55, 196608
    v_add_u32 v27, s56, v25
    global_load_lds_dwordx4 v27, s[40:41]
    s_add_u32 m0, s50, 12288
    s_add_u32 s56, s55, 262144
    v_add_u32 v26, s56, v24
    global_load_lds_dwordx4 v26, s[40:41]
    s_add_u32 m0, s50, 13312
    s_add_u32 s56, s55, 327680
    v_add_u32 v27, s56, v25
    global_load_lds_dwordx4 v27, s[40:41]
    s_add_u32 m0, s50, 14336
    s_add_u32 s56, s55, 393216
    v_add_u32 v26, s56, v24
    global_load_lds_dwordx4 v26, s[40:41]
    s_add_u32 m0, s50, 15360
    s_add_u32 s56, s55, 458752
    v_add_u32 v27, s56, v25
    global_load_lds_dwordx4 v27, s[40:41]
    s_add_u32 m0, s50, 16384
    s_add_u32 s56, s52, 2097152
    v_add_u32 v26, s56, v24
    global_load_lds_dwordx4 v26, s[40:41]
    s_add_u32 m0, s50, 17408
    s_add_u32 s56, s52, 2162688
    v_add_u32 v27, s56, v25
    global_load_lds_dwordx4 v27, s[40:41]
    s_add_u32 m0, s50, 18432
    s_add_u32 s56, s52, 2228224
    v_add_u32 v26, s56, v24
    global_load_lds_dwordx4 v26, s[40:41]
    s_add_u32 m0, s50, 19456
    s_add_u32 s56, s52, 2293760
    v_add_u32 v27, s56, v25
    global_load_lds_dwordx4 v27, s[40:41]
    s_add_u32 m0, s50, 20480
    s_add_u32 s56, s52, 2359296
    v_add_u32 v26, s56, v24
    global_load_lds_dwordx4 v26, s[40:41]
    s_add_u32 m0, s50, 21504
    s_add_u32 s56, s52, 2424832
    v_add_u32 v27, s56, v25
    global_load_lds_dwordx4 v27, s[40:41]
    s_add_u32 m0, s50, 22528
    s_add_u32 s56, s52, 2490368
    v_add_u32 v26, s56, v24
    global_load_lds_dwordx4 v26, s[40:41]
    s_add_u32 m0, s50, 23552
    s_add_u32 s56, s52, 2555904
    v_add_u32 v27, s56, v25
    global_load_lds_dwordx4 v27, s[40:41]
    v_lshlrev_b32 v1, 4, v16
    s_lshl_b32 s56, s9, 10
    v_add_u32 v2, s56, v1
    s_lshr_b32 s57, s53, 9
    v_add_u32 v3, s57, v1
    s_lshr_b32 s57, s54, 9
    v_add_u32 v4, s57, v1
    s_lshr_b32 s57, s55, 9
    v_add_u32 v5, s57, v1
    v_bfe_u32 v19, v16, 1, 1
    v_mul_u32_u24 v19, 0xAAAA, v19
    v_add_u32 v0, 0x4444, v19
    v_lshrrev_b32 v19, 2, v17
    v_xor_b32 v19, v19, v18
    v_lshlrev_b32 v19, 3, v19
    v_lshl_add_u32 v19, v17, 5, v19
    s_and_b32 s57, s9, 1
    s_lshl_b32 s57, s57, 11
    s_add_u32 s57, s57, 24576
    s_cmp_lt_u32 s9, 2
    s_cselect_b32 s58, 4, 0
    s_add_u32 s57, s57, s58
    v_add_u32 v6, s57, v19
    v_bfe_u32 v19, v16, 5, 1
    v_lshlrev_b32 v19, 4, v19
    v_bfe_u32 v20, v16, 4, 1
    v_lshl_add_u32 v19, v20, 2, v19
    v_lshrrev_b32 v21, 2, v17
    v_add_u32 v19, v19, v21
    v_and_b32 v21, 3, v16
    v_xor_b32 v21, v21, v20
    v_lshlrev_b32 v21, 3, v21
    v_lshl_add_u32 v19, v19, 5, v21
    v_add_u32 v7, 24576, v19
    v_xor_b32 v19, 16, v19
    v_add_u32 v8, 24832, v19
    v_lshrrev_b32 v19, 2, v17
    v_and_b32 v20, 1, v17
    v_lshl_add_u32 v19, v19, 1, v20
    v_mul_u32_u24 v20, 288, v19
    v_lshl_add_u32 v21, v18, 3, v20
    s_lshl_b32 s57, s9, 6
    s_add_u32 s57, s57, 28672
    v_add_u32 v9, s57, v21
    v_bfe_u32 v22, v16, 1, 1
    v_cmp_eq_u32 vcc, 0, v22
    v_lshlrev_b32 v22, 2, v16
    v_add_u32 v22, 31296, v22
    v_and_b32 v22, -8, v22
    v_cndmask_b32 v9, v9, v22, vcc
    v_lshl_add_u32 v21, v18, 5, v20
    v_bfe_u32 v22, v16, 1, 1
    v_lshl_add_u32 v21, v22, 4, v21
    v_add_u32 v10, 28672, v21
    v_lshlrev_b32 v19, 10, v19
    v_lshl_add_u32 v19, v18, 5, v19
    v_lshl_add_u32 v19, v22, 4, v19
    s_lshl_b32 s57, s9, 7
    v_add_u32 v28, s57, v19
    v_lshlrev_b32 v19, 13, v18
    v_lshl_add_u32 v19, v17, 4, v19
    s_lshl_b32 s57, s9, 15
    s_lshl_b32 s58, s8, 8
    s_add_u32 s57, s57, s58
    v_add_u32 v13, s57, v19
    v_and_b32 v19, 7, v16
    v_lshlrev_b32 v19, 5, v19
    v_lshl_add_u32 v19, v18, 3, v19
    s_lshl_b32 s57, s8, 8
    v_add_u32 v14, s57, v19
    v_lshrrev_b32 v19, 2, v17
    v_lshlrev_b32 v19, 8, v19
    v_lshl_add_u32 v19, v18, 6, v19
    v_and_b32 v20, 1, v16
    v_lshl_add_u32 v19, v20, 5, v19
    v_bfe_u32 v20, v16, 1, 1
    v_lshl_add_u32 v19, v20, 4, v19
    v_add_u32 v15, s56, v19
    s_add_u32 s12, s4, 0
    s_addc_u32 s13, s5, 0
    s_add_u32 s14, s4, 131072
    s_addc_u32 s15, s5, 0
    s_add_u32 s16, s4, 0
    s_addc_u32 s17, s5, 0
    s_lshl_b32 s57, s8, 13
    s_add_u32 s16, s16, s57
    s_addc_u32 s17, s17, 0
    s_add_u32 s18, s4, 4096
    s_addc_u32 s19, s5, 0
    s_lshl_b32 s57, s8, 13
    s_add_u32 s18, s18, s57
    s_addc_u32 s19, s19, 0
    s_add_u32 s20, s4, 262144
    s_addc_u32 s21, s5, 0
    s_add_u32 s22, s4, 266240
    s_addc_u32 s23, s5, 0
    s_add_u32 s24, s4, 4194304
    s_addc_u32 s25, s5, 0
    s_lshl_b32 s57, s8, 21
    s_add_u32 s24, s24, s57
    s_addc_u32 s25, s25, 0
    s_add_u32 s26, s4, 4202496
    s_addc_u32 s27, s5, 0
    s_lshl_b32 s57, s8, 21
    s_add_u32 s26, s26, s57
    s_addc_u32 s27, s27, 0
    s_add_u32 s28, s4, 4218880
    s_addc_u32 s29, s5, 0
    s_lshl_b32 s57, s8, 21
    s_add_u32 s28, s28, s57
    s_addc_u32 s29, s29, 0
    s_add_u32 s30, s4, 4222976
    s_addc_u32 s31, s5, 0
    s_lshl_b32 s57, s8, 21
    s_add_u32 s30, s30, s57
    s_addc_u32 s31, s31, 0
    s_lshl_b32 s58, s8, 9
    s_add_u32 s36, s4, 327680
    s_addc_u32 s37, s5, 0
    s_lshl_b32 s57, s58, 2
    s_add_u32 s36, s36, s57
    s_addc_u32 s37, s37, 0
    s_add_u32 s38, s4, 127533056
    s_addc_u32 s39, s5, 0
    s_lshl_b32 s57, s8, 10
    s_add_u32 s38, s38, s57
    s_addc_u32 s39, s39, 0
    s_lshl_b32 s57, s9, 11
    s_add_u32 s24, s24, s57
    s_addc_u32 s25, s25, 0
    s_add_u32 s26, s26, s57
    s_addc_u32 s27, s27, 0
    s_lshl_b32 s57, s9, 10
    s_add_u32 s28, s28, s57
    s_addc_u32 s29, s29, 0
    v_add_u32 v11, s50, v1
    v_lshlrev_b32 v12, 1, v1
    v_add_u32 v12, 65536, v12
    v_and_b32 v19, 7, v16
    v_cmp_eq_u32 vcc, 0, v19
    v_mov_b32 v20, 0x3f80
    s_nop 0
    v_cndmask_b32 v52, 0, v20, vcc
    v_cmp_eq_u32 vcc, 1, v19
    v_mov_b32 v20, 0x3f800000
    s_nop 0
    v_cndmask_b32 v52, v52, v20, vcc
    v_cmp_eq_u32 vcc, 2, v19
    v_mov_b32 v20, 0x3f80
    s_nop 0
    v_cndmask_b32 v53, 0, v20, vcc
    v_cmp_eq_u32 vcc, 3, v19
    v_mov_b32 v20, 0x3f800000
    s_nop 0
    v_cndmask_b32 v53, v53, v20, vcc
    v_cmp_eq_u32 vcc, 4, v19
    v_mov_b32 v20, 0x3f80
    s_nop 0
    v_cndmask_b32 v54, 0, v20, vcc
    v_cmp_eq_u32 vcc, 5, v19
    v_mov_b32 v20, 0x3f800000
    s_nop 0
    v_cndmask_b32 v54, v54, v20, vcc
    v_cmp_eq_u32 vcc, 6, v19
    v_mov_b32 v20, 0x3f80
    s_nop 0
    v_cndmask_b32 v55, 0, v20, vcc
    v_cmp_eq_u32 vcc, 7, v19
    v_mov_b32 v20, 0x3f800000
    s_nop 0
    v_cndmask_b32 v55, v55, v20, vcc
    ds_write_b128 v1, v[52:55] offset:31744
    s_lshl_b32 s57, s9, 10
    s_add_u32 s30, s30, s57
    s_addc_u32 s31, s31, 0
    s_mov_b32 s32, 0x3e0293ee
    s_mov_b32 s33, 0x3e0293ee
    s_mov_b32 s34, 0x00ff00ff
    s_mov_b32 s35, 0x00ff00ff
    v_mov_b32 v48, 0
    v_mov_b32 v49, 0
    v_mov_b32 v50, 0
    v_mov_b32 v51, 0
    s_waitcnt vmcnt(16)
    ds_read_b64_tr_b16 v[128:129], v32 offset:0
    ds_read_b64_tr_b16 v[130:131], v32 offset:256
    ds_read_b64_tr_b16 v[132:133], v32 offset:4096
    ds_read_b64_tr_b16 v[134:135], v32 offset:4352
    ds_read_b64_tr_b16 v[136:137], v33 offset:0
    ds_read_b64_tr_b16 v[138:139], v33 offset:256
    ds_read_b64_tr_b16 v[140:141], v33 offset:4096
    ds_read_b64_tr_b16 v[142:143], v33 offset:4352
    ds_read_b64_tr_b16 v[144:145], v34 offset:0
    ds_read_b64_tr_b16 v[146:147], v34 offset:256
    ds_read_b64_tr_b16 v[148:149], v34 offset:4096
    ds_read_b64_tr_b16 v[150:151], v34 offset:4352
    ds_read_b64_tr_b16 v[152:153], v35 offset:0
    ds_read_b64_tr_b16 v[154:155], v35 offset:256
    ds_read_b64_tr_b16 v[156:157], v35 offset:4096
    ds_read_b64_tr_b16 v[158:159], v35 offset:4352
    s_waitcnt lgkmcnt(15)
    s_cmp_lg_u32 s98, 0
    s_cbranch_scc1 Lcf_3
    s_cmp_lg_u32 s9, 0
    s_cbranch_scc1 Lcf_4
    s_mov_b32 s60, 0
    s_lshr_b32 s94, s2, 2
    s_and_b32 s95, s2, 3
Lcf_5:
    v_mbcnt_lo_u32_b32 v56, -1, 0
    v_mbcnt_hi_u32_b32 v56, -1, v56
    v_lshlrev_b32 v56, 2, v56
    global_load_dword v57, v56, s[6:7] sc1
    s_add_u32 s60, s60, 1
    s_cmp_gt_u32 s60, 300000
    s_cbranch_scc1 Lfail
    s_cmp_lg_u32 s60, 64
    s_cbranch_scc1 Lcf_8
    s_cmp_eq_u32 s100, 0
    s_cbranch_scc1 Lcf_8
    s_memtime s[88:89]
    s_memrealtime s[90:91]
    s_waitcnt lgkmcnt(0)
    s_lshr_b32 s89, s88, 4
    s_xor_b32 s88, s88, s89
    s_lshr_b32 s89, s88, 9
    s_xor_b32 s88, s88, s89
    s_xor_b32 s88, s88, s90
    s_lshr_b32 s89, s90, 5
    s_xor_b32 s88, s88, s89
    s_and_b32 s88, s88, 15
    s_lshl_b32 s88, s88, 3
    s_or_b32 s88, s88, s100
    s_or_b32 s88, s88, 0x80
    v_mov_b32 v58, s2
    v_mov_b32 v59, s88
    s_mov_b64 exec, 1
    global_store_byte v58, v59, s[6:7] sc1
    s_mov_b64 exec, -1
Lcf_8:
    s_waitcnt vmcnt(0)
    v_and_b32 v58, 0x80808080, v57
    v_cmp_ne_u32 vcc, 0x80808080, v58
    s_nop 0
    s_cmp_eq_u64 vcc, 0
    s_cselect_b32 s93, 8, 1
    s_mov_b32 s85, 0x80
Lcf_6:
    s_mov_b32 s86, 0
    s_mov_b32 s87, 0
    s_mov_b32 s84, 0
    v_bfe_u32 v58, v57, 0, 8
    v_and_b32 v59, 0x87, v58
    v_cmp_eq_u32 vcc, s85, v59
    s_nop 0
    s_bcnt1_i32_b64 s88, vcc
    s_add_u32 s86, s86, s88
    s_cmp_gt_u32 s95, 0
    s_cselect_b32 s88, 1, 0
    s_add_u32 s88, s88, s94
    s_bfm_b64 s[90:91], s88, 0
    s_cmp_eq_u32 s88, 64
    s_cselect_b64 s[90:91], -1, s[90:91]
    s_and_b64 s[90:91], s[90:91], vcc
    s_bcnt1_i32_b64 s88, s[90:91]
    s_add_u32 s87, s87, s88
    v_cndmask_b32 v58, 0, v58, vcc
    v_bfe_u32 v59, v58, 3, 1
    v_cmp_ne_u32 s[90:91], 0, v59
    s_mul_i32 s84, s84, 0x9e3779b1
    s_xor_b32 s84, s84, s90
    s_mul_i32 s84, s84, 0x85ebca6b
    s_add_u32 s84, s84, s91
    v_bfe_u32 v59, v58, 4, 1
    v_cmp_ne_u32 s[90:91], 0, v59
    s_mul_i32 s84, s84, 0x9e3779b1
    s_xor_b32 s84, s84, s90
    s_mul_i32 s84, s84, 0x85ebca6b
    s_add_u32 s84, s84, s91
    v_bfe_u32 v59, v58, 5, 1
    v_cmp_ne_u32 s[90:91], 0, v59
    s_mul_i32 s84, s84, 0x9e3779b1
    s_xor_b32 s84, s84, s90
    s_mul_i32 s84, s84, 0x85ebca6b
    s_add_u32 s84, s84, s91
    v_bfe_u32 v59, v58, 6, 1
    v_cmp_ne_u32 s[90:91], 0, v59
    s_mul_i32 s84, s84, 0x9e3779b1
    s_xor_b32 s84, s84, s90
    s_mul_i32 s84, s84, 0x85ebca6b
    s_add_u32 s84, s84, s91
    v_bfe_u32 v58, v57, 8, 8
    v_and_b32 v59, 0x87, v58
    v_cmp_eq_u32 vcc, s85, v59
    s_nop 0
    s_bcnt1_i32_b64 s88, vcc
    s_add_u32 s86, s86, s88
    s_cmp_gt_u32 s95, 1
    s_cselect_b32 s88, 1, 0
    s_add_u32 s88, s88, s94
    s_bfm_b64 s[90:91], s88, 0
    s_cmp_eq_u32 s88, 64
    s_cselect_b64 s[90:91], -1, s[90:91]
    s_and_b64 s[90:91], s[90:91], vcc
    s_bcnt1_i32_b64 s88, s[90:91]
    s_add_u32 s87, s87, s88
    v_cndmask_b32 v58, 0, v58, vcc
    v_bfe_u32 v59, v58, 3, 1
    v_cmp_ne_u32 s[90:91], 0, v59
    s_mul_i32 s84, s84, 0x9e3779b1
    s_xor_b32 s84, s84, s90
    s_mul_i32 s84, s84, 0x85ebca6b
    s_add_u32 s84, s84, s91
    v_bfe_u32 v59, v58, 4, 1
    v_cmp_ne_u32 s[90:91], 0, v59
    s_mul_i32 s84, s84, 0x9e3779b1
    s_xor_b32 s84, s84, s90
    s_mul_i32 s84, s84, 0x85ebca6b
    s_add_u32 s84, s84, s91
    v_bfe_u32 v59, v58, 5, 1
    v_cmp_ne_u32 s[90:91], 0, v59
    s_mul_i32 s84, s84, 0x9e3779b1
    s_xor_b32 s84, s84, s90
    s_mul_i32 s84, s84, 0x85ebca6b
    s_add_u32 s84, s84, s91
    v_bfe_u32 v59, v58, 6, 1
    v_cmp_ne_u32 s[90:91], 0, v59
    s_mul_i32 s84, s84, 0x9e3779b1
    s_xor_b32 s84, s84, s90
    s_mul_i32 s84, s84, 0x85ebca6b
    s_add_u32 s84, s84, s91
    v_bfe_u32 v58, v57, 16, 8
    v_and_b32 v59, 0x87, v58
    v_cmp_eq_u32 vcc, s85, v59
    s_nop 0
    s_bcnt1_i32_b64 s88, vcc
    s_add_u32 s86, s86, s88
    s_cmp_gt_u32 s95, 2
    s_cselect_b32 s88, 1, 0
    s_add_u32 s88, s88, s94
    s_bfm_b64 s[90:91], s88, 0
    s_cmp_eq_u32 s88, 64
    s_cselect_b64 s[90:91], -1, s[90:91]
    s_and_b64 s[90:91], s[90:91], vcc
    s_bcnt1_i32_b64 s88, s[90:91]
    s_add_u32 s87, s87, s88
    v_cndmask_b32 v58, 0, v58, vcc
    v_bfe_u32 v59, v58, 3, 1
    v_cmp_ne_u32 s[90:91], 0, v59
    s_mul_i32 s84, s84, 0x9e3779b1
    s_xor_b32 s84, s84, s90
    s_mul_i32 s84, s84, 0x85ebca6b
    s_add_u32 s84, s84, s91
    v_bfe_u32 v59, v58, 4, 1
    v_cmp_ne_u32 s[90:91], 0, v59
    s_mul_i32 s84, s84, 0x9e3779b1
    s_xor_b32 s84, s84, s90
    s_mul_i32 s84, s84, 0x85ebca6b
    s_add_u32 s84, s84, s91
    v_bfe_u32 v59, v58, 5, 1
    v_cmp_ne_u32 s[90:91], 0, v59
    s_mul_i32 s84, s84, 0x9e3779b1
    s_xor_b32 s84, s84, s90
    s_mul_i32 s84, s84, 0x85ebca6b
    s_add_u32 s84, s84, s91
    v_bfe_u32 v59, v58, 6, 1
    v_cmp_ne_u32 s[90:91], 0, v59
    s_mul_i32 s84, s84, 0x9e3779b1
    s_xor_b32 s84, s84, s90
    s_mul_i32 s84, s84, 0x85ebca6b
    s_add_u32 s84, s84, s91
    v_bfe_u32 v58, v57, 24, 8
    v_and_b32 v59, 0x87, v58
    v_cmp_eq_u32 vcc, s85, v59
    s_nop 0
    s_bcnt1_i32_b64 s88, vcc
    s_add_u32 s86, s86, s88
    s_cmp_gt_u32 s95, 3
    s_cselect_b32 s88, 1, 0
    s_add_u32 s88, s88, s94
    s_bfm_b64 s[90:91], s88, 0
    s_cmp_eq_u32 s88, 64
    s_cselect_b64 s[90:91], -1, s[90:91]
    s_and_b64 s[90:91], s[90:91], vcc
    s_bcnt1_i32_b64 s88, s[90:91]
    s_add_u32 s87, s87, s88
    v_cndmask_b32 v58, 0, v58, vcc
    v_bfe_u32 v59, v58, 3, 1
    v_cmp_ne_u32 s[90:91], 0, v59
    s_mul_i32 s84, s84, 0x9e3779b1
    s_xor_b32 s84, s84, s90
    s_mul_i32 s84, s84, 0x85ebca6b
    s_add_u32 s84, s84, s91
    v_bfe_u32 v59, v58, 4, 1
    v_cmp_ne_u32 s[90:91], 0, v59
    s_mul_i32 s84, s84, 0x9e3779b1
    s_xor_b32 s84, s84, s90
    s_mul_i32 s84, s84, 0x85ebca6b
    s_add_u32 s84, s84, s91
    v_bfe_u32 v59, v58, 5, 1
    v_cmp_ne_u32 s[90:91], 0, v59
    s_mul_i32 s84, s84, 0x9e3779b1
    s_xor_b32 s84, s84, s90
    s_mul_i32 s84, s84, 0x85ebca6b
    s_add_u32 s84, s84, s91
    v_bfe_u32 v59, v58, 6, 1
    v_cmp_ne_u32 s[90:91], 0, v59
    s_mul_i32 s84, s84, 0x9e3779b1
    s_xor_b32 s84, s84, s90
    s_mul_i32 s84, s84, 0x85ebca6b
    s_add_u32 s84, s84, s91
    s_cmp_ge_u32 s86, 32
    s_cbranch_scc1 Lcf_7
    s_add_u32 s85, s85, 1
    s_and_b32 s88, s85, 15
    s_cmp_lt_u32 s88, s93
    s_cbranch_scc1 Lcf_6
    s_branch Lcf_5
Lcf_7:
    s_or_b32 s84, s84, 1
    s_and_b32 s85, s85, 7
    s_min_u32 s88, s87, 32
    s_sub_u32 s88, s2, s88
    s_add_u32 s88, s88, 32
    s_cmp_lt_u32 s87, 32
    s_cselect_b32 s89, s87, s88
    s_cmp_eq_u32 s85, s100
    s_cselect_b32 s89, s89, s88
    v_mov_b32 v58, s84
    v_mov_b32 v59, s89
    v_mov_b32 v56, 31232
    ds_write_b64 v56, v[58:59]
    s_waitcnt lgkmcnt(0)
Lcf_4:
    s_barrier
    v_mov_b32 v56, 31232
    ds_read_b64 v[58:59], v56
    s_waitcnt lgkmcnt(0)
    v_readfirstlane_b32 s97, v58
    v_readfirstlane_b32 s89, v59
    s_mov_b32 s98, 1
    s_nop 3
    s_cmp_eq_u32 s89, s99
    s_cbranch_scc1 Lcf_3
    s_mov_b32 s99, s89
    s_waitcnt vmcnt(0)
    s_barrier
    s_branch Lstart
Lcf_3:
    global_store_dwordx4 v2, v[48:51], s[16:17]
    global_store_dwordx4 v2, v[48:51], s[18:19]
    global_store_dwordx2 v14, v[48:49], s[20:21]
    s_add_u32 m0, s50, 24576
    s_add_u32 s56, s53, 2097152
    v_add_u32 v26, s56, v24
    global_load_lds_dwordx4 v26, s[40:41]
    s_add_u32 m0, s50, 25600
    s_add_u32 s56, s53, 2162688
    v_add_u32 v27, s56, v25
    global_load_lds_dwordx4 v27, s[40:41]
    s_add_u32 m0, s50, 26624
    s_add_u32 s56, s53, 2228224
    v_add_u32 v26, s56, v24
    global_load_lds_dwordx4 v26, s[40:41]
    s_add_u32 m0, s50, 27648
    s_add_u32 s56, s53, 2293760
    v_add_u32 v27, s56, v25
    global_load_lds_dwordx4 v27, s[40:41]
    s_add_u32 m0, s50, 28672
    s_add_u32 s56, s53, 2359296
    v_add_u32 v26, s56, v24
    global_load_lds_dwordx4 v26, s[40:41]
    s_add_u32 m0, s50, 29696
    s_add_u32 s56, s53, 2424832
    v_add_u32 v27, s56, v25
    global_load_lds_dwordx4 v27, s[40:41]
    s_add_u32 m0, s50, 30720
    s_add_u32 s56, s53, 2490368
    v_add_u32 v26, s56, v24
    global_load_lds_dwordx4 v26, s[40:41]
    s_add_u32 m0, s50, 31744
    s_add_u32 s56, s53, 2555904
    v_add_u32 v27, s56, v25
    global_load_lds_dwordx4 v27, s[40:41]
    s_waitcnt vmcnt(16)
    ds_read_b64_tr_b16 v[160:161], v32 offset:8192
    ds_read_b64_tr_b16 v[162:163], v32 offset:8448
    ds_read_b64_tr_b16 v[164:165], v32 offset:12288
    ds_read_b64_tr_b16 v[166:167], v32 offset:12544
    ds_read_b64_tr_b16 v[168:169], v33 offset:8192
    ds_read_b64_tr_b16 v[170:171], v33 offset:8448
    ds_read_b64_tr_b16 v[172:173], v33 offset:12288
    ds_read_b64_tr_b16 v[174:175], v33 offset:12544
    ds_read_b64_tr_b16 v[176:177], v34 offset:8192
    ds_read_b64_tr_b16 v[178:179], v34 offset:8448
    ds_read_b64_tr_b16 v[180:181], v34 offset:12288
    ds_read_b64_tr_b16 v[182:183], v34 offset:12544
    ds_read_b64_tr_b16 v[184:185], v35 offset:8192
    ds_read_b64_tr_b16 v[186:187], v35 offset:8448
    ds_read_b64_tr_b16 v[188:189], v35 offset:12288
    ds_read_b64_tr_b16 v[190:191], v35 offset:12544
    s_waitcnt lgkmcnt(15)
    s_add_u32 m0, s50, 0
    s_add_u32 s56, s54, 2097152
    v_add_u32 v26, s56, v24
    global_load_lds_dwordx4 v26, s[40:41]
    s_add_u32 m0, s50, 1024
    s_add_u32 s56, s54, 2162688
    v_add_u32 v27, s56, v25
    global_load_lds_dwordx4 v27, s[40:41]
    s_add_u32 m0, s50, 2048
    s_add_u32 s56, s54, 2228224
    v_add_u32 v26, s56, v24
    global_load_lds_dwordx4 v26, s[40:41]
    s_add_u32 m0, s50, 3072
    s_add_u32 s56, s54, 2293760
    v_add_u32 v27, s56, v25
    global_load_lds_dwordx4 v27, s[40:41]
    s_add_u32 m0, s50, 4096
    s_add_u32 s56, s54, 2359296
    v_add_u32 v26, s56, v24
    global_load_lds_dwordx4 v26, s[40:41]
    s_add_u32 m0, s50, 5120
    s_add_u32 s56, s54, 2424832
    v_add_u32 v27, s56, v25
    global_load_lds_dwordx4 v27, s[40:41]
    s_add_u32 m0, s50, 6144
    s_add_u32 s56, s54, 2490368
    v_add_u32 v26, s56, v24
    global_load_lds_dwordx4 v26, s[40:41]
    s_add_u32 m0, s50, 7168
    s_add_u32 s56, s54, 2555904
    v_add_u32 v27, s56, v25
    global_load_lds_dwordx4 v27, s[40:41]
    s_waitcnt vmcnt(16)
    ds_read_b64_tr_b16 v[192:193], v32 offset:16384
    ds_read_b64_tr_b16 v[194:195], v32 offset:16640
    ds_read_b64_tr_b16 v[196:197], v32 offset:20480
    ds_read_b64_tr_b16 v[198:199], v32 offset:20736
    ds_read_b64_tr_b16 v[200:201], v33 offset:16384
    ds_read_b64_tr_b16 v[202:203], v33 offset:16640
    ds_read_b64_tr_b16 v[204:205], v33 offset:20480
    ds_read_b64_tr_b16 v[206:207], v33 offset:20736
    ds_read_b64_tr_b16 v[208:209], v34 offset:16384
    ds_read_b64_tr_b16 v[210:211], v34 offset:16640
    ds_read_b64_tr_b16 v[212:213], v34 offset:20480
    ds_read_b64_tr_b16 v[214:215], v34 offset:20736
    ds_read_b64_tr_b16 v[216:217], v35 offset:16384
    ds_read_b64_tr_b16 v[218:219], v35 offset:16640
    ds_read_b64_tr_b16 v[220:221], v35 offset:20480
    ds_read_b64_tr_b16 v[222:223], v35 offset:20736
    s_waitcnt lgkmcnt(15)
    s_add_u32 m0, s50, 8192
    s_add_u32 s56, s55, 2097152
    v_add_u32 v26, s56, v24
    global_load_lds_dwordx4 v26, s[40:41]
    s_add_u32 m0, s50, 9216
    s_add_u32 s56, s55, 2162688
    v_add_u32 v27, s56, v25
    global_load_lds_dwordx4 v27, s[40:41]
    s_add_u32 m0, s50, 10240
    s_add_u32 s56, s55, 2228224
    v_add_u32 v26, s56, v24
    global_load_lds_dwordx4 v26, s[40:41]
    s_add_u32 m0, s50, 11264
    s_add_u32 s56, s55, 2293760
    v_add_u32 v27, s56, v25
    global_load_lds_dwordx4 v27, s[40:41]
    s_add_u32 m0, s50, 12288
    s_add_u32 s56, s55, 2359296
    v_add_u32 v26, s56, v24
    global_load_lds_dwordx4 v26, s[40:41]
    s_add_u32 m0, s50, 13312
    s_add_u32 s56, s55, 2424832
    v_add_u32 v27, s56, v25
    global_load_lds_dwordx4 v27, s[40:41]
    s_add_u32 m0, s50, 14336
    s_add_u32 s56, s55, 2490368
    v_add_u32 v26, s56, v24
    global_load_lds_dwordx4 v26, s[40:41]
    s_add_u32 m0, s50, 15360
    s_add_u32 s56, s55, 2555904
    v_add_u32 v27, s56, v25
    global_load_lds_dwordx4 v27, s[40:41]
    s_waitcnt vmcnt(16)
    ds_read_b64_tr_b16 v[224:225], v32 offset:24576
    ds_read_b64_tr_b16 v[226:227], v32 offset:24832
    ds_read_b64_tr_b16 v[228:229], v32 offset:28672
    ds_read_b64_tr_b16 v[230:231], v32 offset:28928
    ds_read_b64_tr_b16 v[232:233], v33 offset:24576
    ds_read_b64_tr_b16 v[234:235], v33 offset:24832
    ds_read_b64_tr_b16 v[236:237], v33 offset:28672
    ds_read_b64_tr_b16 v[238:239], v33 offset:28928
    ds_read_b64_tr_b16 v[240:241], v34 offset:24576
    ds_read_b64_tr_b16 v[242:243], v34 offset:24832
    ds_read_b64_tr_b16 v[244:245], v34 offset:28672
    ds_read_b64_tr_b16 v[246:247], v34 offset:28928
    ds_read_b64_tr_b16 v[248:249], v35 offset:24576
    ds_read_b64_tr_b16 v[250:251], v35 offset:24832
    ds_read_b64_tr_b16 v[252:253], v35 offset:28672
    ds_read_b64_tr_b16 v[254:255], v35 offset:28928
    s_waitcnt lgkmcnt(15)
    s_add_u32 m0, s50, 16384
    s_add_u32 s56, s52, 0
    v_add_u32 v26, s56, v37
    global_load_lds_dwordx4 v26, s[44:45]
    s_add_u32 m0, s50, 17408
    s_add_u32 s56, s52, 131072
    v_add_u32 v27, s56, v37
    global_load_lds_dwordx4 v27, s[44:45]
    s_add_u32 m0, s50, 18432
    s_add_u32 s56, s52, 262144
    v_add_u32 v26, s56, v37
    global_load_lds_dwordx4 v26, s[44:45]
    s_add_u32 m0, s50, 19456
    s_add_u32 s56, s52, 393216
    v_add_u32 v27, s56, v37
    global_load_lds_dwordx4 v27, s[44:45]
    s_lshl_b32 s57, s8, 4
    s_lshl_b32 s58, s9, 2
    s_add_u32 s57, s57, s58
    s_add_u32 s57, s57, 436224
    v_mov_b32 v20, s57
    v_mov_b32 v19, s97
    s_nop 0
    s_mov_b64 exec, 0x1
    global_store_dword v20, v19, s[4:5] offset:0 sc1
    s_mov_b64 exec, -1
    s_waitcnt vmcnt(12)
    ds_read_b64_tr_b16 a[0:1], v32 offset:0
    ds_read_b64_tr_b16 a[2:3], v32 offset:256
    ds_read_b64_tr_b16 a[4:5], v32 offset:4096
    ds_read_b64_tr_b16 a[6:7], v32 offset:4352
    ds_read_b64_tr_b16 a[8:9], v33 offset:0
    ds_read_b64_tr_b16 a[10:11], v33 offset:256
    ds_read_b64_tr_b16 a[12:13], v33 offset:4096
    ds_read_b64_tr_b16 a[14:15], v33 offset:4352
    ds_read_b64_tr_b16 a[16:17], v34 offset:0
    ds_read_b64_tr_b16 a[18:19], v34 offset:256
    ds_read_b64_tr_b16 a[20:21], v34 offset:4096
    ds_read_b64_tr_b16 a[22:23], v34 offset:4352
    ds_read_b64_tr_b16 a[24:25], v35 offset:0
    ds_read_b64_tr_b16 a[26:27], v35 offset:256
    ds_read_b64_tr_b16 a[28:29], v35 offset:4096
    ds_read_b64_tr_b16 a[30:31], v35 offset:4352
    s_waitcnt lgkmcnt(15)
    s_add_u32 m0, s50, 24576
    s_add_u32 s56, s53, 0
    v_add_u32 v26, s56, v37
    global_load_lds_dwordx4 v26, s[44:45]
    s_add_u32 m0, s50, 25600
    s_add_u32 s56, s53, 131072
    v_add_u32 v27, s56, v37
    global_load_lds_dwordx4 v27, s[44:45]
    s_add_u32 m0, s50, 26624
    s_add_u32 s56, s53, 262144
    v_add_u32 v26, s56, v37
    global_load_lds_dwordx4 v26, s[44:45]
    s_add_u32 m0, s50, 27648
    s_add_u32 s56, s53, 393216
    v_add_u32 v27, s56, v37
    global_load_lds_dwordx4 v27, s[44:45]
    s_waitcnt vmcnt(8)
    ds_read_b64_tr_b16 a[32:33], v32 offset:8192
    ds_read_b64_tr_b16 a[34:35], v32 offset:8448
    ds_read_b64_tr_b16 a[36:37], v32 offset:12288
    ds_read_b64_tr_b16 a[38:39], v32 offset:12544
    ds_read_b64_tr_b16 a[40:41], v33 offset:8192
    ds_read_b64_tr_b16 a[42:43], v33 offset:8448
    ds_read_b64_tr_b16 a[44:45], v33 offset:12288
    ds_read_b64_tr_b16 a[46:47], v33 offset:12544
    ds_read_b64_tr_b16 a[48:49], v34 offset:8192
    ds_read_b64_tr_b16 a[50:51], v34 offset:8448
    ds_read_b64_tr_b16 a[52:53], v34 offset:12288
    ds_read_b64_tr_b16 a[54:55], v34 offset:12544
    ds_read_b64_tr_b16 a[56:57], v35 offset:8192
    ds_read_b64_tr_b16 a[58:59], v35 offset:8448
    ds_read_b64_tr_b16 a[60:61], v35 offset:12288
    ds_read_b64_tr_b16 a[62:63], v35 offset:12544
    s_waitcnt lgkmcnt(15)
    s_add_u32 m0, s50, 0
    s_add_u32 s56, s54, 0
    v_add_u32 v26, s56, v37
    global_load_lds_dwordx4 v26, s[44:45]
    s_add_u32 m0, s50, 1024
    s_add_u32 s56, s54, 131072
    v_add_u32 v27, s56, v37
    global_load_lds_dwordx4 v27, s[44:45]
    s_add_u32 m0, s50, 2048
    s_add_u32 s56, s54, 262144
    v_add_u32 v26, s56, v37
    global_load_lds_dwordx4 v26, s[44:45]
    s_add_u32 m0, s50, 3072
    s_add_u32 s56, s54, 393216
    v_add_u32 v27, s56, v37
    global_load_lds_dwordx4 v27, s[44:45]
    s_waitcnt vmcnt(8)
    ds_read_b64_tr_b16 a[64:65], v36 offset:16384
    ds_read_b64_tr_b16 a[66:67], v36 offset:16512
    ds_read_b64_tr_b16 a[68:69], v36 offset:18432
    ds_read_b64_tr_b16 a[70:71], v36 offset:18560
    ds_read_b64_tr_b16 a[72:73], v36 offset:16416
    ds_read_b64_tr_b16 a[74:75], v36 offset:16544
    ds_read_b64_tr_b16 a[76:77], v36 offset:18464
    ds_read_b64_tr_b16 a[78:79], v36 offset:18592
    s_waitcnt lgkmcnt(8)
    s_add_u32 m0, s50, 8192
    s_add_u32 s56, s55, 0
    v_add_u32 v26, s56, v37
    global_load_lds_dwordx4 v26, s[44:45]
    s_add_u32 m0, s50, 9216
    s_add_u32 s56, s55, 131072
    v_add_u32 v27, s56, v37
    global_load_lds_dwordx4 v27, s[44:45]
    s_add_u32 m0, s50, 10240
    s_add_u32 s56, s55, 262144
    v_add_u32 v26, s56, v37
    global_load_lds_dwordx4 v26, s[44:45]
    s_add_u32 m0, s50, 11264
    s_add_u32 s56, s55, 393216
    v_add_u32 v27, s56, v37
    global_load_lds_dwordx4 v27, s[44:45]
    s_waitcnt vmcnt(8)
    ds_read_b64_tr_b16 a[80:81], v36 offset:24576
    ds_read_b64_tr_b16 a[82:83], v36 offset:24704
    ds_read_b64_tr_b16 a[84:85], v36 offset:26624
    ds_read_b64_tr_b16 a[86:87], v36 offset:26752
    ds_read_b64_tr_b16 a[88:89], v36 offset:24608
    ds_read_b64_tr_b16 a[90:91], v36 offset:24736
    ds_read_b64_tr_b16 a[92:93], v36 offset:26656
    ds_read_b64_tr_b16 a[94:95], v36 offset:26784
    s_waitcnt lgkmcnt(8)
    s_add_u32 m0, s50, 16384
    s_add_u32 s56, s52, 2097152
    v_add_u32 v26, s56, v37
    global_load_lds_dwordx4 v26, s[44:45]
    s_add_u32 m0, s50, 17408
    s_add_u32 s56, s52, 2228224
    v_add_u32 v27, s56, v37
    global_load_lds_dwordx4 v27, s[44:45]
    s_add_u32 m0, s50, 18432
    s_add_u32 s56, s52, 2359296
    v_add_u32 v26, s56, v37
    global_load_lds_dwordx4 v26, s[44:45]
    s_add_u32 m0, s50, 19456
    s_add_u32 s56, s52, 2490368
    v_add_u32 v27, s56, v37
    global_load_lds_dwordx4 v27, s[44:45]
    s_waitcnt vmcnt(8)
    ds_read_b64_tr_b16 a[96:97], v36 offset:0
    ds_read_b64_tr_b16 a[98:99], v36 offset:128
    ds_read_b64_tr_b16 a[100:101], v36 offset:2048
    ds_read_b64_tr_b16 a[102:103], v36 offset:2176
    ds_read_b64_tr_b16 a[104:105], v36 offset:32
    ds_read_b64_tr_b16 a[106:107], v36 offset:160
    ds_read_b64_tr_b16 a[108:109], v36 offset:2080
    ds_read_b64_tr_b16 a[110:111], v36 offset:2208
    s_waitcnt lgkmcnt(8)
    s_add_u32 m0, s50, 24576
    s_add_u32 s56, s53, 2097152
    v_add_u32 v26, s56, v37
    global_load_lds_dwordx4 v26, s[44:45]
    s_add_u32 m0, s50, 25600
    s_add_u32 s56, s53, 2228224
    v_add_u32 v27, s56, v37
    global_load_lds_dwordx4 v27, s[44:45]
    s_add_u32 m0, s50, 26624
    s_add_u32 s56, s53, 2359296
    v_add_u32 v26, s56, v37
    global_load_lds_dwordx4 v26, s[44:45]
    s_add_u32 m0, s50, 27648
    s_add_u32 s56, s53, 2490368
    v_add_u32 v27, s56, v37
    global_load_lds_dwordx4 v27, s[44:45]
    s_waitcnt vmcnt(8)
    ds_read_b64_tr_b16 a[112:113], v36 offset:8192
    ds_read_b64_tr_b16 a[114:115], v36 offset:8320
    ds_read_b64_tr_b16 a[116:117], v36 offset:10240
    ds_read_b64_tr_b16 a[118:119], v36 offset:10368
    ds_read_b64_tr_b16 a[120:121], v36 offset:8224
    ds_read_b64_tr_b16 a[122:123], v36 offset:8352
    ds_read_b64_tr_b16 a[124:125], v36 offset:10272
    ds_read_b64_tr_b16 a[126:127], v36 offset:10400
    s_waitcnt lgkmcnt(8)
    s_add_u32 m0, s50, 0
    s_add_u32 s56, s54, 2097152
    v_add_u32 v26, s56, v37
    global_load_lds_dwordx4 v26, s[44:45]
    s_add_u32 m0, s50, 1024
    s_add_u32 s56, s54, 2228224
    v_add_u32 v27, s56, v37
    global_load_lds_dwordx4 v27, s[44:45]
    s_add_u32 m0, s50, 2048
    s_add_u32 s56, s54, 2359296
    v_add_u32 v26, s56, v37
    global_load_lds_dwordx4 v26, s[44:45]
    s_add_u32 m0, s50, 3072
    s_add_u32 s56, s54, 2490368
    v_add_u32 v27, s56, v37
    global_load_lds_dwordx4 v27, s[44:45]
    s_waitcnt vmcnt(8)
    ds_read_b64_tr_b16 a[128:129], v36 offset:16384
    ds_read_b64_tr_b16 a[130:131], v36 offset:16512
    ds_read_b64_tr_b16 a[132:133], v36 offset:18432
    ds_read_b64_tr_b16 a[134:135], v36 offset:18560
    ds_read_b64_tr_b16 a[136:137], v36 offset:16416
    ds_read_b64_tr_b16 a[138:139], v36 offset:16544
    ds_read_b64_tr_b16 a[140:141], v36 offset:18464
    ds_read_b64_tr_b16 a[142:143], v36 offset:18592
    s_waitcnt lgkmcnt(8)
    s_add_u32 m0, s50, 8192
    s_add_u32 s56, s55, 2097152
    v_add_u32 v26, s56, v37
    global_load_lds_dwordx4 v26, s[44:45]
    s_add_u32 m0, s50, 9216
    s_add_u32 s56, s55, 2228224
    v_add_u32 v27, s56, v37
    global_load_lds_dwordx4 v27, s[44:45]
    s_add_u32 m0, s50, 10240
    s_add_u32 s56, s55, 2359296
    v_add_u32 v26, s56, v37
    global_load_lds_dwordx4 v26, s[44:45]
    s_add_u32 m0, s50, 11264
    s_add_u32 s56, s55, 2490368
    v_add_u32 v27, s56, v37
    global_load_lds_dwordx4 v27, s[44:45]
    s_waitcnt vmcnt(8)
    ds_read_b64_tr_b16 a[144:145], v36 offset:24576
    ds_read_b64_tr_b16 a[146:147], v36 offset:24704
    ds_read_b64_tr_b16 a[148:149], v36 offset:26624
    ds_read_b64_tr_b16 a[150:151], v36 offset:26752
    ds_read_b64_tr_b16 a[152:153], v36 offset:24608
    ds_read_b64_tr_b16 a[154:155], v36 offset:24736
    ds_read_b64_tr_b16 a[156:157], v36 offset:26656
    ds_read_b64_tr_b16 a[158:159], v36 offset:26784
    s_waitcnt lgkmcnt(8)
    s_add_u32 m0, s50, 16384
    v_add_u32 v26, 0, v30
    global_load_lds_dwordx4 v26, s[46:47]
    s_add_u32 m0, s50, 17408
    v_add_u32 v27, 8192, v31
    global_load_lds_dwordx4 v27, s[46:47]
    s_add_u32 m0, s50, 18432
    v_add_u32 v26, 16384, v30
    global_load_lds_dwordx4 v26, s[46:47]
    s_add_u32 m0, s50, 19456
    v_add_u32 v27, 24576, v31
    global_load_lds_dwordx4 v27, s[46:47]
    s_add_u32 m0, s50, 20480
    v_add_u32 v26, 32768, v30
    global_load_lds_dwordx4 v26, s[46:47]
    s_add_u32 m0, s50, 21504
    v_add_u32 v27, 40960, v31
    global_load_lds_dwordx4 v27, s[46:47]
    s_add_u32 m0, s50, 22528
    v_add_u32 v26, 49152, v30
    global_load_lds_dwordx4 v26, s[46:47]
    s_add_u32 m0, s50, 23552
    v_add_u32 v27, 57344, v31
    global_load_lds_dwordx4 v27, s[46:47]
    s_waitcnt vmcnt(12)
    ds_read_b64_tr_b16 a[160:161], v36 offset:0
    ds_read_b64_tr_b16 a[162:163], v36 offset:128
    ds_read_b64_tr_b16 a[164:165], v36 offset:2048
    ds_read_b64_tr_b16 a[166:167], v36 offset:2176
    ds_read_b64_tr_b16 a[168:169], v36 offset:32
    ds_read_b64_tr_b16 a[170:171], v36 offset:160
    ds_read_b64_tr_b16 a[172:173], v36 offset:2080
    ds_read_b64_tr_b16 a[174:175], v36 offset:2208
    s_waitcnt lgkmcnt(8)
    s_add_u32 m0, s50, 24576
    v_add_u32 v26, 65536, v30
    global_load_lds_dwordx4 v26, s[46:47]
    s_add_u32 m0, s50, 25600
    v_add_u32 v27, 73728, v31
    global_load_lds_dwordx4 v27, s[46:47]
    s_add_u32 m0, s50, 26624
    v_add_u32 v26, 81920, v30
    global_load_lds_dwordx4 v26, s[46:47]
    s_add_u32 m0, s50, 27648
    v_add_u32 v27, 90112, v31
    global_load_lds_dwordx4 v27, s[46:47]
    s_add_u32 m0, s50, 28672
    v_add_u32 v26, 98304, v30
    global_load_lds_dwordx4 v26, s[46:47]
    s_add_u32 m0, s50, 29696
    v_add_u32 v27, 106496, v31
    global_load_lds_dwordx4 v27, s[46:47]
    s_add_u32 m0, s50, 30720
    v_add_u32 v26, 114688, v30
    global_load_lds_dwordx4 v26, s[46:47]
    s_add_u32 m0, s50, 31744
    v_add_u32 v27, 122880, v31
    global_load_lds_dwordx4 v27, s[46:47]
    s_waitcnt vmcnt(16)
    ds_read_b64_tr_b16 a[176:177], v36 offset:8192
    ds_read_b64_tr_b16 a[178:179], v36 offset:8320
    ds_read_b64_tr_b16 a[180:181], v36 offset:10240
    ds_read_b64_tr_b16 a[182:183], v36 offset:10368
    ds_read_b64_tr_b16 a[184:185], v36 offset:8224
    ds_read_b64_tr_b16 a[186:187], v36 offset:8352
    ds_read_b64_tr_b16 a[188:189], v36 offset:10272
    ds_read_b64_tr_b16 a[190:191], v36 offset:10400
    s_waitcnt lgkmcnt(8)
    s_add_u32 m0, s50, 0
    s_add_u32 s56, s53, 0
    v_add_u32 v26, s56, v24
    global_load_lds_dwordx4 v26, s[40:41]
    s_add_u32 m0, s50, 1024
    s_add_u32 s56, s53, 65536
    v_add_u32 v27, s56, v25
    global_load_lds_dwordx4 v27, s[40:41]
    s_add_u32 m0, s50, 2048
    s_add_u32 s56, s53, 131072
    v_add_u32 v26, s56, v24
    global_load_lds_dwordx4 v26, s[40:41]
    s_add_u32 m0, s50, 3072
    s_add_u32 s56, s53, 196608
    v_add_u32 v27, s56, v25
    global_load_lds_dwordx4 v27, s[40:41]
    s_add_u32 m0, s50, 4096
    s_add_u32 s56, s53, 262144
    v_add_u32 v26, s56, v24
    global_load_lds_dwordx4 v26, s[40:41]
    s_add_u32 m0, s50, 5120
    s_add_u32 s56, s53, 327680
    v_add_u32 v27, s56, v25
    global_load_lds_dwordx4 v27, s[40:41]
    s_add_u32 m0, s50, 6144
    s_add_u32 s56, s53, 393216
    v_add_u32 v26, s56, v24
    global_load_lds_dwordx4 v26, s[40:41]
    s_add_u32 m0, s50, 7168
    s_add_u32 s56, s53, 458752
    v_add_u32 v27, s56, v25
    global_load_lds_dwordx4 v27, s[40:41]
    s_waitcnt vmcnt(16)
    ds_read_b64_tr_b16 a[192:193], v32 offset:16384
    ds_read_b64_tr_b16 a[194:195], v32 offset:16640
    ds_read_b64_tr_b16 a[196:197], v32 offset:20480
    ds_read_b64_tr_b16 a[198:199], v32 offset:20736
    ds_read_b64_tr_b16 a[200:201], v33 offset:16384
    ds_read_b64_tr_b16 a[202:203], v33 offset:16640
    ds_read_b64_tr_b16 a[204:205], v33 offset:20480
    ds_read_b64_tr_b16 a[206:207], v33 offset:20736
    ds_read_b64_tr_b16 a[208:209], v34 offset:16384
    ds_read_b64_tr_b16 a[210:211], v34 offset:16640
    ds_read_b64_tr_b16 a[212:213], v34 offset:20480
    ds_read_b64_tr_b16 a[214:215], v34 offset:20736
    ds_read_b64_tr_b16 a[216:217], v35 offset:16384
    ds_read_b64_tr_b16 a[218:219], v35 offset:16640
    ds_read_b64_tr_b16 a[220:221], v35 offset:20480
    ds_read_b64_tr_b16 a[222:223], v35 offset:20736
    s_waitcnt lgkmcnt(15)
    s_add_u32 m0, s50, 8192
    s_add_u32 s56, s54, 0
    v_add_u32 v26, s56, v24
    global_load_lds_dwordx4 v26, s[40:41]
    s_add_u32 m0, s50, 9216
    s_add_u32 s56, s54, 65536
    v_add_u32 v27, s56, v25
    global_load_lds_dwordx4 v27, s[40:41]
    s_add_u32 m0, s50, 10240
    s_add_u32 s56, s54, 131072
    v_add_u32 v26, s56, v24
    global_load_lds_dwordx4 v26, s[40:41]
    s_add_u32 m0, s50, 11264
    s_add_u32 s56, s54, 196608
    v_add_u32 v27, s56, v25
    global_load_lds_dwordx4 v27, s[40:41]
    s_add_u32 m0, s50, 12288
    s_add_u32 s56, s54, 262144
    v_add_u32 v26, s56, v24
    global_load_lds_dwordx4 v26, s[40:41]
    s_add_u32 m0, s50, 13312
    s_add_u32 s56, s54, 327680
    v_add_u32 v27, s56, v25
    global_load_lds_dwordx4 v27, s[40:41]
    s_add_u32 m0, s50, 14336
    s_add_u32 s56, s54, 393216
    v_add_u32 v26, s56, v24
    global_load_lds_dwordx4 v26, s[40:41]
    s_add_u32 m0, s50, 15360
    s_add_u32 s56, s54, 458752
    v_add_u32 v27, s56, v25
    global_load_lds_dwordx4 v27, s[40:41]
    s_waitcnt vmcnt(16)
    ds_read_b64_tr_b16 a[224:225], v32 offset:24576
    ds_read_b64_tr_b16 a[226:227], v32 offset:24832
    ds_read_b64_tr_b16 a[228:229], v32 offset:28672
    ds_read_b64_tr_b16 a[230:231], v32 offset:28928
    ds_read_b64_tr_b16 a[232:233], v33 offset:24576
    ds_read_b64_tr_b16 a[234:235], v33 offset:24832
    ds_read_b64_tr_b16 a[236:237], v33 offset:28672
    ds_read_b64_tr_b16 a[238:239], v33 offset:28928
    ds_read_b64_tr_b16 a[240:241], v34 offset:24576
    ds_read_b64_tr_b16 a[242:243], v34 offset:24832
    ds_read_b64_tr_b16 a[244:245], v34 offset:28672
    ds_read_b64_tr_b16 a[246:247], v34 offset:28928
    ds_read_b64_tr_b16 a[248:249], v35 offset:24576
    ds_read_b64_tr_b16 a[250:251], v35 offset:24832
    ds_read_b64_tr_b16 a[252:253], v35 offset:28672
    ds_read_b64_tr_b16 a[254:255], v35 offset:28928
    s_waitcnt lgkmcnt(15)
    s_add_u32 m0, s50, 16384
    v_add_u32 v26, 512, v30
    global_load_lds_dwordx4 v26, s[46:47]
    s_add_u32 m0, s50, 17408
    v_add_u32 v27, 8704, v31
    global_load_lds_dwordx4 v27, s[46:47]
    s_add_u32 m0, s50, 18432
    v_add_u32 v26, 16896, v30
    global_load_lds_dwordx4 v26, s[46:47]
    s_add_u32 m0, s50, 19456
    v_add_u32 v27, 25088, v31
    global_load_lds_dwordx4 v27, s[46:47]
    s_add_u32 m0, s50, 20480
    v_add_u32 v26, 33280, v30
    global_load_lds_dwordx4 v26, s[46:47]
    s_add_u32 m0, s50, 21504
    v_add_u32 v27, 41472, v31
    global_load_lds_dwordx4 v27, s[46:47]
    s_add_u32 m0, s50, 22528
    v_add_u32 v26, 49664, v30
    global_load_lds_dwordx4 v26, s[46:47]
    s_add_u32 m0, s50, 23552
    v_add_u32 v27, 57856, v31
    global_load_lds_dwordx4 v27, s[46:47]
    s_waitcnt lgkmcnt(0)
    s_add_u32 m0, s50, 24576
    v_add_u32 v26, 66048, v30
    global_load_lds_dwordx4 v26, s[46:47]
    s_add_u32 m0, s50, 25600
    v_add_u32 v27, 74240, v31
    global_load_lds_dwordx4 v27, s[46:47]
    s_add_u32 m0, s50, 26624
    v_add_u32 v26, 82432, v30
    global_load_lds_dwordx4 v26, s[46:47]
    s_add_u32 m0, s50, 27648
    v_add_u32 v27, 90624, v31
    global_load_lds_dwordx4 v27, s[46:47]
    s_add_u32 m0, s50, 28672
    v_add_u32 v26, 98816, v30
    global_load_lds_dwordx4 v26, s[46:47]
    s_add_u32 m0, s50, 29696
    v_add_u32 v27, 107008, v31
    global_load_lds_dwordx4 v27, s[46:47]
    s_add_u32 m0, s50, 30720
    v_add_u32 v26, 115200, v30
    global_load_lds_dwordx4 v26, s[46:47]
    s_add_u32 m0, s50, 31744
    v_add_u32 v27, 123392, v31
    global_load_lds_dwordx4 v27, s[46:47]
    v_lshrrev_b32 v20, 2, v16
    v_lshlrev_b32 v20, 8, v20
    v_and_b32 v21, 3, v16
    v_lshl_add_u32 v20, v21, 2, v20
    s_mov_b32 s60, 0
    s_mov_b64 exec, 0xff
    global_load_dword v19, v20, s[38:39] sc1
    s_waitcnt vmcnt(0)
    v_cmp_ne_u32 vcc, s97, v19
    s_cbranch_vccz Lwf_11
    global_load_dword v19, v20, s[38:39] sc1
    s_sleep 2
Lwf_10:
    global_load_dword v19, v20, s[38:39] sc1
    s_add_u32 s60, s60, 1
    s_cmp_gt_u32 s60, 1000000
    s_cbranch_scc1 Lfail
    s_waitcnt vmcnt(1)
    v_cmp_ne_u32 vcc, s97, v19
    s_cbranch_vccz Lwf_11
    s_branch Lwf_10
Lwf_11:
    s_mov_b64 exec, -1
    s_lshl_b32 s57, s9, 11
    s_add_u32 s61, s57, 8192
    s_mov_b32 m0, s61
    s_nop 0
    global_load_lds_dwordx4 v1, s[24:25] sc1
    global_load_lds_dwordx4 v1, s[24:25] offset:1024 sc1
    global_load_dwordx4 v[120:123], v1, s[26:27] sc1
    global_load_dwordx4 v[124:127], v1, s[26:27] offset:1024 sc1
    global_load_dwordx4 v[80:83], v28, s[48:49]
    global_load_dwordx4 v[84:87], v28, s[48:49] offset:512
    v_lshrrev_b32 v20, 1, v1
    v_add_u32 v20, 436224, v20
    global_load_dwordx2 v[96:97], v20, s[4:5] sc1
    s_waitcnt vmcnt(7)
    ds_read_b64_tr_b16 v[48:49], v32 offset:0
    ds_read_b64_tr_b16 v[50:51], v32 offset:256
    ds_read_b64_tr_b16 v[52:53], v32 offset:4096
    ds_read_b64_tr_b16 v[54:55], v32 offset:4352
    ds_read_b64_tr_b16 v[56:57], v33 offset:0
    ds_read_b64_tr_b16 v[58:59], v33 offset:256
    ds_read_b64_tr_b16 v[60:61], v33 offset:4096
    ds_read_b64_tr_b16 v[62:63], v33 offset:4352
    ds_read_b64_tr_b16 v[64:65], v34 offset:0
    ds_read_b64_tr_b16 v[66:67], v34 offset:256
    ds_read_b64_tr_b16 v[68:69], v34 offset:4096
    ds_read_b64_tr_b16 v[70:71], v34 offset:4352
    ds_read_b64_tr_b16 v[72:73], v35 offset:0
    ds_read_b64_tr_b16 v[74:75], v35 offset:256
    ds_read_b64_tr_b16 v[76:77], v35 offset:4096
    ds_read_b64_tr_b16 v[78:79], v35 offset:4352
    s_waitcnt lgkmcnt(0)
    ds_write_b128 v11, v[48:51] offset:0
    ds_write_b128 v11, v[52:55] offset:1024
    ds_write_b128 v11, v[56:59] offset:2048
    ds_write_b128 v11, v[60:63] offset:3072
    ds_write_b128 v11, v[64:67] offset:4096
    ds_write_b128 v11, v[68:71] offset:5120
    ds_write_b128 v11, v[72:75] offset:6144
    ds_write_b128 v11, v[76:79] offset:7168
    ds_read_b64_tr_b16 v[48:49], v32 offset:8192
    ds_read_b64_tr_b16 v[50:51], v32 offset:8448
    ds_read_b64_tr_b16 v[52:53], v32 offset:12288
    ds_read_b64_tr_b16 v[54:55], v32 offset:12544
    ds_read_b64_tr_b16 v[56:57], v33 offset:8192
    ds_read_b64_tr_b16 v[58:59], v33 offset:8448
    ds_read_b64_tr_b16 v[60:61], v33 offset:12288
    ds_read_b64_tr_b16 v[62:63], v33 offset:12544
    ds_read_b64_tr_b16 v[64:65], v34 offset:8192
    ds_read_b64_tr_b16 v[66:67], v34 offset:8448
    ds_read_b64_tr_b16 v[68:69], v34 offset:12288
    ds_read_b64_tr_b16 v[70:71], v34 offset:12544
    ds_read_b64_tr_b16 v[72:73], v35 offset:8192
    ds_read_b64_tr_b16 v[74:75], v35 offset:8448
    ds_read_b64_tr_b16 v[76:77], v35 offset:12288
    ds_read_b64_tr_b16 v[78:79], v35 offset:12544
    s_waitcnt lgkmcnt(0)
    ds_write_b128 v11, v[48:51] offset:8192
    ds_write_b128 v11, v[52:55] offset:9216
    ds_write_b128 v11, v[56:59] offset:10240
    ds_write_b128 v11, v[60:63] offset:11264
    ds_write_b128 v11, v[64:67] offset:12288
    ds_write_b128 v11, v[68:71] offset:13312
    ds_write_b128 v11, v[72:75] offset:14336
    ds_write_b128 v11, v[76:79] offset:15360
    ds_read_b64_tr_b16 v[48:49], v32 offset:16384
    ds_read_b64_tr_b16 v[50:51], v32 offset:16640
    ds_read_b64_tr_b16 v[52:53], v32 offset:20480
    ds_read_b64_tr_b16 v[54:55], v32 offset:20736
    ds_read_b64_tr_b16 v[56:57], v33 offset:16384
    ds_read_b64_tr_b16 v[58:59], v33 offset:16640
    ds_read_b64_tr_b16 v[60:61], v33 offset:20480
    ds_read_b64_tr_b16 v[62:63], v33 offset:20736
    ds_read_b64_tr_b16 v[64:65], v34 offset:16384
    ds_read_b64_tr_b16 v[66:67], v34 offset:16640
    ds_read_b64_tr_b16 v[68:69], v34 offset:20480
    ds_read_b64_tr_b16 v[70:71], v34 offset:20736
    ds_read_b64_tr_b16 v[72:73], v35 offset:16384
    ds_read_b64_tr_b16 v[74:75], v35 offset:16640
    ds_read_b64_tr_b16 v[76:77], v35 offset:20480
    ds_read_b64_tr_b16 v[78:79], v35 offset:20736
    s_waitcnt lgkmcnt(0)
    ds_write_b128 v11, v[48:51] offset:16384
    ds_write_b128 v11, v[52:55] offset:17408
    ds_write_b128 v11, v[56:59] offset:18432
    ds_write_b128 v11, v[60:63] offset:19456
    ds_write_b128 v11, v[64:67] offset:20480
    ds_write_b128 v11, v[68:71] offset:21504
    ds_write_b128 v11, v[72:75] offset:22528
    ds_write_b128 v11, v[76:79] offset:23552
    ds_read_b64_tr_b16 v[48:49], v32 offset:24576
    ds_read_b64_tr_b16 v[50:51], v32 offset:24832
    ds_read_b64_tr_b16 v[52:53], v32 offset:28672
    ds_read_b64_tr_b16 v[54:55], v32 offset:28928
    ds_read_b64_tr_b16 v[56:57], v33 offset:24576
    ds_read_b64_tr_b16 v[58:59], v33 offset:24832
    ds_read_b64_tr_b16 v[60:61], v33 offset:28672
    ds_read_b64_tr_b16 v[62:63], v33 offset:28928
    ds_read_b64_tr_b16 v[64:65], v34 offset:24576
    ds_read_b64_tr_b16 v[66:67], v34 offset:24832
    ds_read_b64_tr_b16 v[68:69], v34 offset:28672
    ds_read_b64_tr_b16 v[70:71], v34 offset:28928
    ds_read_b64_tr_b16 v[72:73], v35 offset:24576
    ds_read_b64_tr_b16 v[74:75], v35 offset:24832
    ds_read_b64_tr_b16 v[76:77], v35 offset:28672
    ds_read_b64_tr_b16 v[78:79], v35 offset:28928
    s_waitcnt lgkmcnt(0)
    ds_write_b128 v11, v[48:51] offset:24576
    ds_write_b128 v11, v[52:55] offset:25600
    ds_write_b128 v11, v[56:59] offset:26624
    ds_write_b128 v11, v[60:63] offset:27648
    ds_write_b128 v11, v[64:67] offset:28672
    ds_write_b128 v11, v[68:71] offset:29696
    ds_write_b128 v11, v[72:75] offset:30720
    ds_write_b128 v11, v[76:79] offset:31744
    s_waitcnt vmcnt(0)
    v_cmp_ne_u32 vcc, s97, v96
    v_cmp_ne_u32 s[58:59], s97, v97
    s_nop 0
    s_or_b64 vcc, vcc, s[58:59]
    s_cbranch_scc0 Lti_12
    v_lshrrev_b32 v20, 2, v1
    v_add_u32 v20, 436224, v20
    s_mov_b32 s60, 0
    s_mov_b64 exec, -1
    global_load_dword v19, v20, s[4:5] sc1
    s_waitcnt vmcnt(0)
    v_cmp_ne_u32 vcc, s97, v19
    s_cbranch_vccz Lwf_14
    global_load_dword v19, v20, s[4:5] sc1
    s_sleep 2
Lwf_13:
    global_load_dword v19, v20, s[4:5] sc1
    s_add_u32 s60, s60, 1
    s_cmp_gt_u32 s60, 1000000
    s_cbranch_scc1 Lfail
    s_waitcnt vmcnt(1)
    v_cmp_ne_u32 vcc, s97, v19
    s_cbranch_vccz Lwf_14
    s_sleep 1
    s_branch Lwf_13
Lwf_14:
    s_mov_b64 exec, -1
    v_add_u32 v20, 256, v20
    s_mov_b32 s60, 0
    s_mov_b64 exec, -1
    global_load_dword v19, v20, s[4:5] sc1
    s_waitcnt vmcnt(0)
    v_cmp_ne_u32 vcc, s97, v19
    s_cbranch_vccz Lwf_16
    global_load_dword v19, v20, s[4:5] sc1
    s_sleep 2
Lwf_15:
    global_load_dword v19, v20, s[4:5] sc1
    s_add_u32 s60, s60, 1
    s_cmp_gt_u32 s60, 1000000
    s_cbranch_scc1 Lfail
    s_waitcnt vmcnt(1)
    v_cmp_ne_u32 vcc, s97, v19
    s_cbranch_vccz Lwf_16
    s_sleep 1
    s_branch Lwf_15
Lwf_16:
    s_mov_b64 exec, -1
Lti_12:
    s_waitcnt vmcnt(0) lgkmcnt(0)
    v_mov_b32 v16, v80
    v_mov_b32 v32, v84
    v_mov_b32 v17, v81
    v_mov_b32 v33, v85
    v_mov_b32 v18, v82
    v_mov_b32 v34, v86
    v_mov_b32 v19, v83
    v_mov_b32 v35, v87
    s_mov_b32 s10, 0
    s_mov_b32 s60, 0
    s_mov_b32 s11, 0
    s_mov_b32 s58, 0
    s_mov_b64 s[54:55], 0
    s_cmp_eq_u32 s9, 1
    s_cselect_b32 s52, 1, 0
    s_mov_b32 s56, 8192
    s_lshr_b32 s57, s53, 9
    s_mov_b32 s59, 0
    ds_read_b128 v[48:51], v11 offset:0
    ds_read_b128 v[52:55], v11 offset:1024
    ds_read_b128 v[56:59], v11 offset:2048
    ds_read_b128 v[60:63], v11 offset:3072
    ds_read_b128 v[64:67], v11 offset:8192
    ds_read_b128 v[68:71], v11 offset:9216
    ds_read_b128 v[72:75], v11 offset:10240
    ds_read_b128 v[76:79], v11 offset:11264
    ds_read_b128 v[112:115], v11 offset:4096
    ds_read_b128 v[116:119], v11 offset:5120
    ds_read_b128 v[104:107], v11 offset:6144
    ds_read_b128 v[108:111], v11 offset:7168
    v_mov_b64 v[80:81], 0
    v_mov_b64 v[82:83], 0
    v_mov_b64 v[84:85], 0
    v_mov_b64 v[86:87], 0
    v_mov_b64 v[88:89], 0
    v_mov_b64 v[90:91], 0
    v_mov_b64 v[92:93], 0
    v_mov_b64 v[94:95], 0
    v_mov_b64 v[96:97], 0
    v_mov_b64 v[98:99], 0
    v_mov_b64 v[100:101], 0
    v_mov_b64 v[102:103], 0
    s_barrier
    s_branch Lent_19
Lretry_20:
    s_nop 5
    v_mov_b64 v[80:81], 0
    v_mov_b64 v[82:83], 0
    v_mov_b64 v[84:85], 0
    v_mov_b64 v[86:87], 0
    s_add_u32 s60, s60, 1
    s_cmp_gt_u32 s60, 200000
    s_cbranch_scc1 Lfail
.p2align 3
Lteam_17:
    global_load_dwordx4 v[16:19], v15, s[20:21] sc1
    s_add_u32 s60, s60, 1
    s_cmp_gt_u32 s60, 400000
    s_cbranch_scc1 Lfail
    s_waitcnt vmcnt(2)
    v_bitop3_b32 v28, v16, v18, s11 bitop3:0x7e
    v_and_b32 v28, 1, v28
    v_cmp_ne_u32 vcc, 0, v28
    s_cbranch_vccnz Lteam_17
    global_load_dwordx4 v[32:35], v15, s[22:23] sc1
Lent_19:
    ds_write_b128 v2, v[16:19] offset:0
    v_smfmac_f32_16x16x64_bf16 v[80:83], v[16:19], v[128:135], v0
    v_smfmac_f32_16x16x64_bf16 v[84:87], v[16:19], v[136:143], v0
    s_waitcnt lgkmcnt(0)
    s_barrier
    ds_read_b128 v[20:23], v3 offset:0
    s_mov_b64 exec, s[54:55]
    global_load_dwordx4 v[32:35], v15, s[22:23] sc1
    s_mov_b64 exec, -1
    v_smfmac_f32_16x16x64_bf16 v[88:91], v[16:19], v[144:151], v0
    ds_read_b128 v[24:27], v4 offset:0
    v_smfmac_f32_16x16x64_bf16 v[92:95], v[16:19], v[152:159], v0
    ds_read_b128 v[28:31], v5 offset:0
    v_smfmac_f32_16x16x64_bf16 v[96:99], v[16:19], a[64:71], v0
    s_add_u32 s24, s24, 32768
    s_addc_u32 s25, s25, 0
    v_smfmac_f32_16x16x64_bf16 v[100:103], v[16:19], a[72:79], v0
    s_waitcnt lgkmcnt(2)
    v_smfmac_f32_16x16x64_bf16 v[80:83], v[20:23], v[48:55], v0
    ds_read_b128 v[48:51], v11 offset:12288
    v_smfmac_f32_16x16x64_bf16 v[84:87], v[20:23], v[56:63], v0
    ds_read_b128 v[52:55], v11 offset:13312
    v_smfmac_f32_16x16x64_bf16 v[88:91], v[20:23], v[112:119], v0
    ds_read_b128 v[56:59], v11 offset:14336
    v_smfmac_f32_16x16x64_bf16 v[92:95], v[20:23], v[104:111], v0
    ds_read_b128 v[60:63], v11 offset:15360
    s_waitcnt lgkmcnt(5)
    v_smfmac_f32_16x16x64_bf16 v[80:83], v[24:27], v[64:71], v0
    v_smfmac_f32_16x16x64_bf16 v[84:87], v[24:27], v[72:79], v0
    s_waitcnt lgkmcnt(4)
    v_smfmac_f32_16x16x64_bf16 v[80:83], v[28:31], v[160:167], v0
    s_waitcnt vmcnt(1)
    v_bitop3_b32 v44, v32, v34, s11 bitop3:0x7e
    v_smfmac_f32_16x16x64_bf16 v[84:87], v[28:31], v[168:175], v0
    v_and_b32 v44, s58, v44
    v_smfmac_f32_16x16x64_bf16 v[88:91], v[28:31], v[176:183], v0
    v_cmp_ne_u32 vcc, 0, v44
    s_cbranch_vccnz Lretb_21
Lokb_22:
    ds_write_b128 v2, v[32:35] offset:4096
    v_smfmac_f32_16x16x64_bf16 v[92:95], v[28:31], v[184:191], v0
    s_waitcnt lgkmcnt(1)
    v_smfmac_f32_16x16x64_bf16 v[88:91], v[24:27], v[48:55], v0
    v_smfmac_f32_16x16x64_bf16 v[92:95], v[24:27], v[56:63], v0
    s_xor_b32 s11, s11, 1
    s_waitcnt lgkmcnt(0)
    s_barrier
    ds_read_b128 v[36:39], v3 offset:4096
    v_smfmac_f32_16x16x64_bf16 v[80:83], v[32:35], v[192:199], v0
    ds_read_b128 v[40:43], v4 offset:4096
    s_mov_b32 s58, 1
    s_mov_b64 s[54:55], -1
    v_smfmac_f32_16x16x64_bf16 v[84:87], v[32:35], v[200:207], v0
    ds_read_b128 v[44:47], v5 offset:4096
    v_smfmac_f32_16x16x64_bf16 v[88:91], v[32:35], v[208:215], v0
    v_add_u32 v3, s56, v1
    v_smfmac_f32_16x16x64_bf16 v[92:95], v[32:35], v[216:223], v0
    s_xor_b32 m0, s61, 0x6000
    v_smfmac_f32_16x16x64_bf16 v[96:99], v[32:35], a[128:135], v0
    global_load_lds_dwordx4 v1, s[24:25] sc1
    v_smfmac_f32_16x16x64_bf16 v[100:103], v[32:35], a[136:143], v0
    global_load_lds_dwordx4 v1, s[24:25] offset:1024 sc1
    s_waitcnt lgkmcnt(2)
    v_smfmac_f32_16x16x64_bf16 v[80:83], v[36:39], v[224:231], v0
    ds_read_b128 v[48:51], v3 offset:0
    v_smfmac_f32_16x16x64_bf16 v[84:87], v[36:39], v[232:239], v0
    ds_read_b128 v[52:55], v3 offset:1024
    s_waitcnt lgkmcnt(3)
    v_smfmac_f32_16x16x64_bf16 v[80:83], v[40:43], a[0:7], v0
    ds_read_b128 v[56:59], v3 offset:2048
    v_smfmac_f32_16x16x64_bf16 v[84:87], v[40:43], a[8:15], v0
    ds_read_b128 v[60:63], v3 offset:3072
    s_waitcnt lgkmcnt(4)
    v_smfmac_f32_16x16x64_bf16 v[80:83], v[44:47], a[32:39], v0
    ds_read_b128 v[64:67], v3 offset:4096
    v_smfmac_f32_16x16x64_bf16 v[84:87], v[44:47], a[40:47], v0
    ds_read_b128 v[68:71], v3 offset:5120
    v_smfmac_f32_16x16x64_bf16 v[88:91], v[36:39], v[240:247], v0
    s_mov_b32 m0, 31296
    s_nop 0
    global_load_lds_dword v12, s[26:27] sc1
    v_smfmac_f32_16x16x64_bf16 v[92:95], v[36:39], v[248:255], v0
    ds_read_b128 v[72:75], v3 offset:6144
    s_add_u32 s26, s26, 32768
    s_addc_u32 s27, s27, 0
    v_smfmac_f32_16x16x64_bf16 v[88:91], v[40:43], a[16:23], v0
    ds_read_b128 v[76:79], v3 offset:7168
    v_add_f32 v80, v80, v82
    v_smfmac_f32_16x16x64_bf16 v[92:95], v[40:43], a[24:31], v0
    v_add_f32 v81, v81, v83
    v_add_f32 v84, v84, v86
    v_smfmac_f32_16x16x64_bf16 v[88:91], v[44:47], a[48:55], v0
    v_add_f32 v85, v85, v87
    v_cvt_pk_bf16_f32 v104, v80, v81
    v_smfmac_f32_16x16x64_bf16 v[92:95], v[44:47], a[56:63], v0
    v_cvt_pk_bf16_f32 v105, v84, v85
    ds_write2st64_b32 v6, v104, v105 offset0:0 offset1:2
    v_smfmac_f32_16x16x64_bf16 v[96:99], v[20:23], a[80:87], v0
    v_smfmac_f32_16x16x64_bf16 v[100:103], v[20:23], a[88:95], v0
    s_nop 0
    v_add_f32 v88, v88, v90
    v_add_f32 v89, v89, v91
    s_nop 0
    v_add_f32 v92, v92, v94
    v_add_f32 v93, v93, v95
    v_cvt_pk_bf16_f32 v106, v88, v89
    v_cvt_pk_bf16_f32 v107, v92, v93
    ds_write2st64_b32 v6, v106, v107 offset0:4 offset1:6
    v_smfmac_f32_16x16x64_bf16 v[96:99], v[24:27], a[96:103], v0
    s_cmp_lt_u32 s9, 2
    s_cbranch_scc1 Lnk_23
    global_store_dwordx4 v1, v[104:107], s[28:29] sc1
Lnk_23:
    v_smfmac_f32_16x16x64_bf16 v[100:103], v[24:27], a[104:111], v0
    s_waitcnt lgkmcnt(0)
    s_barrier
    ds_read_b64_tr_b16 v[104:105], v7 offset:0
    ds_read_b64_tr_b16 v[106:107], v8 offset:0
    ds_read_b64_tr_b16 v[108:109], v7 offset:1024
    ds_read_b64_tr_b16 v[110:111], v8 offset:1024
    ds_read_b64_tr_b16 v[112:113], v7 offset:2048
    ds_read_b64_tr_b16 v[114:115], v8 offset:2048
    ds_read_b64_tr_b16 v[116:117], v7 offset:3072
    ds_read_b64_tr_b16 v[118:119], v8 offset:3072
    v_smfmac_f32_16x16x64_bf16 v[96:99], v[28:31], a[112:119], v0
    v_mov_b32 v95, s97
    v_smfmac_f32_16x16x64_bf16 v[100:103], v[28:31], a[120:127], v0
    s_cmp_eq_u32 s52, 0
    s_cbranch_scc1 Lnf_24
    s_mov_b64 exec, 1
    global_store_dword v1, v95, s[36:37] sc1
    s_mov_b64 exec, -1
Lnf_24:
    v_smfmac_f32_16x16x64_bf16 v[96:99], v[36:39], a[144:151], v0
    v_smfmac_f32_16x16x64_bf16 v[100:103], v[36:39], a[152:159], v0
    v_smfmac_f32_16x16x64_bf16 v[96:99], v[40:43], a[160:167], v0
    v_smfmac_f32_16x16x64_bf16 v[100:103], v[40:43], a[168:175], v0
    v_smfmac_f32_16x16x64_bf16 v[96:99], v[44:47], a[176:183], v0
    v_smfmac_f32_16x16x64_bf16 v[100:103], v[44:47], a[184:191], v0
    s_cmp_eq_u32 s10, 63
    s_cbranch_scc1 Lfin_18
    s_waitcnt lgkmcnt(6)
    v_mfma_f32_16x16x32_bf16 v[80:83], v[104:107], v[104:107], 0
    s_waitcnt lgkmcnt(4)
    v_mfma_f32_16x16x32_bf16 v[80:83], v[108:111], v[108:111], v[80:83]
    s_waitcnt lgkmcnt(2)
    v_mfma_f32_16x16x32_bf16 v[80:83], v[112:115], v[112:115], v[80:83]
    s_waitcnt lgkmcnt(0)
    v_mfma_f32_16x16x32_bf16 v[80:83], v[116:119], v[116:119], v[80:83]
    v_mfma_f32_16x16x32_bf16 v[84:87], v[48:51], v[104:107], 0
    v_cvt_pk_bf16_f32 v96, v96, v97
    v_cvt_pk_bf16_f32 v97, v98, v99
    v_mfma_f32_16x16x32_bf16 v[84:87], v[52:55], v[108:111], v[84:87]
    v_cvt_pk_bf16_f32 v98, v100, v101
    v_cvt_pk_bf16_f32 v99, v102, v103
    v_mfma_f32_16x16x32_bf16 v[84:87], v[56:59], v[112:115], v[84:87]
    global_store_dwordx4 v1, v[96:99], s[30:31] sc1
    v_mfma_f32_16x16x32_bf16 v[84:87], v[60:63], v[116:119], v[84:87]
    v_mfma_f32_16x16x32_bf16 v[88:91], v[64:67], v[104:107], 0
    v_mov_b32 v48, 0x3f803f80
    v_mov_b32 v49, 0x3f803f80
    v_mfma_f32_16x16x32_bf16 v[88:91], v[68:71], v[108:111], v[88:91]
    v_mov_b32 v50, 0x3f803f80
    v_mov_b32 v51, 0x3f803f80
    v_mfma_f32_16x16x32_bf16 v[88:91], v[72:75], v[112:115], v[88:91]
    v_mov_b64 v[56:57], 0
    v_mov_b64 v[58:59], 0
    v_mfma_f32_16x16x32_bf16 v[88:91], v[76:79], v[116:119], v[88:91]
    v_mov_b64 v[60:61], 0
    v_max3_f32 v92, v80, v81, v84
    v_max3_f32 v92, v92, v85, v86
    v_mov_b64 v[62:63], 0
    v_mov_b64 v[64:65], 0
    v_mov_b64 v[66:67], 0
    s_nop 1
    v_max3_f32 v92, v92, v87, v88
    v_max3_f32 v92, v92, v89, v90
    v_max_f32 v93, v92, v91
    v_max_f32 v92, v92, v91
    ds_read_b128 v[16:19], v11 offset:16384
    ds_read_b128 v[20:23], v11 offset:17408
    v_permlane32_swap_b32 v92, v93
    v_max_f32 v94, v92, v93
    v_max_f32 v92, v92, v93
    ds_read_b128 v[24:27], v11 offset:18432
    ds_read_b128 v[28:31], v11 offset:19456
    v_permlane16_swap_b32 v92, v94
    v_max_f32 v92, v92, v94
    v_mul_f32 v92, s32, v92
    v_pk_fma_f32 v[84:85], v[84:85], s[32:33], v[92:93] op_sel_hi:[1,0,0] neg_lo:[0,0,1] neg_hi:[0,0,1]
    v_pk_fma_f32 v[86:87], v[86:87], s[32:33], v[92:93] op_sel_hi:[1,0,0] neg_lo:[0,0,1] neg_hi:[0,0,1]
    v_pk_fma_f32 v[88:89], v[88:89], s[32:33], v[92:93] op_sel_hi:[1,0,0] neg_lo:[0,0,1] neg_hi:[0,0,1]
    v_pk_fma_f32 v[90:91], v[90:91], s[32:33], v[92:93] op_sel_hi:[1,0,0] neg_lo:[0,0,1] neg_hi:[0,0,1]
    v_pk_fma_f32 v[80:81], v[80:81], s[32:33], v[92:93] op_sel_hi:[1,0,0] neg_lo:[0,0,1] neg_hi:[0,0,1]
    v_exp_f32 v84, v84
    v_exp_f32 v85, v85
    v_exp_f32 v86, v86
    v_exp_f32 v87, v87
    v_exp_f32 v88, v88
    v_exp_f32 v89, v89
    v_exp_f32 v90, v90
    v_exp_f32 v91, v91
    v_cvt_pk_bf16_f32 v104, v84, v85
    v_cvt_pk_bf16_f32 v105, v86, v87
    v_cvt_pk_bf16_f32 v106, v88, v89
    v_cvt_pk_bf16_f32 v107, v90, v91
    v_exp_f32 v80, v80
    v_exp_f32 v81, v81
    v_mfma_f32_16x16x32_bf16 v[52:55], v[48:51], v[104:107], 0
    v_cvt_pk_bf16_f32 v108, v80, v81
    v_cvt_pk_bf16_f32 v109, v80, v81
    v_mfma_f32_16x16x32_bf16 v[112:115], v[120:123], v[104:107], 0
    v_mov_b32 v49, 0
    ds_read_b128 v[32:35], v11 offset:20480
    v_mfma_f32_16x16x32_bf16 v[116:119], v[124:127], v[104:107], 0
    ds_read_b128 v[40:43], v11 offset:22528
    v_mfma_f32_16x16x16_bf16 v[52:55], v[48:49], v[108:109], v[52:55]
    ds_read_b128 v[36:39], v11 offset:21504
    v_mov_b64 v[68:69], 0
    v_mfma_f32_16x16x16_bf16 v[112:115], v[96:97], v[108:109], v[112:115]
    ds_read_b128 v[80:83], v11 offset:28672
    v_mov_b64 v[70:71], 0
    v_mfma_f32_16x16x16_bf16 v[116:119], v[98:99], v[108:109], v[116:119]
    ds_read_b128 v[84:87], v11 offset:29696
    ds_read_b128 v[44:47], v11 offset:23552
    v_rcp_f32 v52, v52
    global_load_dwordx4 v[120:123], v1, s[26:27] sc1
    global_load_dwordx4 v[124:127], v1, s[26:27] offset:1024 sc1
    v_pk_mul_f32 v[112:113], v[112:113], v[52:53] op_sel_hi:[1,0]
    v_pk_mul_f32 v[114:115], v[114:115], v[52:53] op_sel_hi:[1,0]
    v_cvt_pk_bf16_f32 v112, v112, v113
    v_cvt_pk_bf16_f32 v113, v114, v115
    ds_write_b64 v9, v[112:113]
    v_pk_mul_f32 v[116:117], v[116:117], v[52:53] op_sel_hi:[1,0]
    v_pk_mul_f32 v[118:119], v[118:119], v[52:53] op_sel_hi:[1,0]
    v_cvt_pk_bf16_f32 v114, v116, v117
    v_cvt_pk_bf16_f32 v115, v118, v119
    ds_write_b64 v9, v[114:115] offset:32
    v_mov_b64 v[48:49], 0
    v_mov_b64 v[50:51], 0
    v_mov_b64 v[52:53], 0
    v_mov_b64 v[54:55], 0
    s_waitcnt lgkmcnt(0)
    s_barrier
    ds_read_b128 v[104:107], v10
    ds_read_b128 v[108:111], v10 offset:128
    v_mov_b64 v[72:73], 0
    v_mov_b64 v[74:75], 0
    v_mov_b64 v[76:77], 0
    v_mov_b64 v[78:79], 0
    s_waitcnt lgkmcnt(1)
    v_smfmac_f32_16x16x64_bf16 v[48:51], v[104:107], a[192:199], v0
    s_waitcnt lgkmcnt(0)
    ds_read_b128 v[88:91], v11 offset:30720
    v_smfmac_f32_16x16x64_bf16 v[48:51], v[108:111], a[224:231], v0
    ds_read_b128 v[92:95], v11 offset:31744
    v_smfmac_f32_16x16x64_bf16 v[52:55], v[104:107], a[200:207], v0
    ds_read_b128 v[96:99], v11 offset:24576
    v_smfmac_f32_16x16x64_bf16 v[52:55], v[108:111], a[232:239], v0
    ds_read_b128 v[100:103], v11 offset:25600
    v_smfmac_f32_16x16x64_bf16 v[56:59], v[104:107], a[208:215], v0
    v_smfmac_f32_16x16x64_bf16 v[56:59], v[108:111], a[240:247], v0
    s_nop 0
    v_add_f32 v48, v48, v50
    v_add_f32 v49, v49, v51
    v_smfmac_f32_16x16x64_bf16 v[60:63], v[104:107], a[216:223], v0
    v_cvt_pk_bf16_f32 v112, v48, v49
    v_add_f32 v52, v52, v54
    v_smfmac_f32_16x16x64_bf16 v[60:63], v[108:111], a[248:255], v0
    v_add_f32 v53, v53, v55
    v_cvt_pk_bf16_f32 v113, v52, v53
    v_and_or_b32 v112, v112, -2, s11
    v_smfmac_f32_16x16x64_bf16 v[72:75], v[104:107], v[32:39], v0
    v_add_f32 v56, v56, v58
    ds_read_b128 v[32:35], v11 offset:26624
    v_add_f32 v57, v57, v59
    v_cvt_pk_bf16_f32 v114, v56, v57
    ds_read_b128 v[36:39], v11 offset:27648
    v_add_f32 v60, v60, v62
    v_add_f32 v61, v61, v63
    v_cvt_pk_bf16_f32 v115, v60, v61
    global_store_dwordx4 v13, v[112:115], s[12:13]
    s_waitcnt lgkmcnt(2)
    v_smfmac_f32_16x16x64_bf16 v[72:75], v[108:111], v[80:87], v0
    v_smfmac_f32_16x16x64_bf16 v[76:79], v[104:107], v[40:47], v0
    v_smfmac_f32_16x16x64_bf16 v[76:79], v[108:111], v[88:95], v0
    v_smfmac_f32_16x16x64_bf16 v[64:67], v[104:107], v[16:23], v0
    v_smfmac_f32_16x16x64_bf16 v[64:67], v[108:111], v[96:103], v0
    s_nop 3
    v_add_f32 v72, v72, v74
    v_add_f32 v73, v73, v75
    v_smfmac_f32_16x16x64_bf16 v[68:71], v[104:107], v[24:31], v0
    v_cvt_pk_bf16_f32 v118, v72, v73
    v_add_f32 v76, v76, v78
    s_waitcnt lgkmcnt(0)
    v_smfmac_f32_16x16x64_bf16 v[68:71], v[108:111], v[32:39], v0
    v_add_f32 v77, v77, v79
    v_cvt_pk_bf16_f32 v119, v76, v77
    v_add_f32 v64, v64, v66
    v_add_f32 v65, v65, v67
    v_cvt_pk_bf16_f32 v116, v64, v65
    v_and_or_b32 v116, v116, -2, s11
    s_nop 1
    v_add_f32 v68, v68, v70
    v_add_f32 v69, v69, v71
    v_cvt_pk_bf16_f32 v117, v68, v69
    global_store_dwordx4 v13, v[116:119], s[14:15]
    s_cmp_lg_u32 s9, 0
    s_cbranch_scc1 Lnr_25
    ds_read_b128 v[20:23], v1 offset:31744
    ds_read_b128 v[112:115], v11 offset:4096
    ds_read_b128 v[116:119], v11 offset:5120
    ds_read_b128 v[104:107], v11 offset:6144
    ds_read_b128 v[108:111], v11 offset:7168
    v_mov_b64 v[80:81], 0
    v_mov_b64 v[82:83], 0
    v_mov_b64 v[84:85], 0
    v_mov_b64 v[86:87], 0
    v_mov_b64 v[88:89], 0
    v_mov_b64 v[90:91], 0
    v_mov_b64 v[92:93], 0
    v_mov_b64 v[94:95], 0
    v_mov_b64 v[96:97], 0
    v_mov_b64 v[98:99], 0
    v_mov_b64 v[100:101], 0
    v_mov_b64 v[102:103], 0
    s_xor_b32 s61, s61, 0x6000
    s_xor_b32 s56, s56, 0x6000
    v_add_u32 v3, s57, v1
    s_add_u32 s28, s28, 32768
    s_addc_u32 s29, s29, 0
    s_add_u32 s30, s30, 32768
    s_addc_u32 s31, s31, 0
    s_cmp_lt_u32 s8, 16
    s_cbranch_scc1 Lrd_26
    s_sleep 3
Lrd_26:
    s_mov_b32 s60, 0
    global_load_dwordx4 v[48:51], v1, s[16:17] offset:0 sc1
    global_load_dwordx4 v[52:55], v1, s[16:17] offset:1024 sc1
    global_load_dwordx4 v[56:59], v1, s[16:17] offset:2048 sc1
    global_load_dwordx4 v[60:63], v1, s[16:17] offset:3072 sc1
    global_load_dwordx4 v[64:67], v1, s[18:19] offset:0 sc1
    global_load_dwordx4 v[68:71], v1, s[18:19] offset:1024 sc1
    global_load_dwordx4 v[72:75], v1, s[18:19] offset:2048 sc1
    global_load_dwordx4 v[76:79], v1, s[18:19] offset:3072 sc1
    s_sleep 1
Lp_27:
    global_load_dwordx4 v[48:51], v1, s[16:17] offset:0 sc1
    global_load_dwordx4 v[52:55], v1, s[16:17] offset:1024 sc1
    global_load_dwordx4 v[56:59], v1, s[16:17] offset:2048 sc1
    global_load_dwordx4 v[60:63], v1, s[16:17] offset:3072 sc1
    global_load_dwordx4 v[64:67], v1, s[18:19] offset:0 sc1
    global_load_dwordx4 v[68:71], v1, s[18:19] offset:1024 sc1
    global_load_dwordx4 v[72:75], v1, s[18:19] offset:2048 sc1
    global_load_dwordx4 v[76:79], v1, s[18:19] offset:3072 sc1
    s_add_u32 s60, s60, 1
    s_cmp_gt_u32 s60, 200000
    s_cbranch_scc1 Lfail
    s_waitcnt lgkmcnt(0)
    s_waitcnt vmcnt(14)
    v_bitop3_b32 v28, v48, v52, s11 bitop3:0x7e
    v_mfma_f32_16x16x32_bf16 v[24:27], v[48:51], v[20:23], 0
    v_mfma_f32_16x16x32_bf16 v[24:27], v[52:55], v[20:23], v[24:27]
    s_waitcnt vmcnt(12)
    v_bitop3_b32 v29, v56, v60, s11 bitop3:0x7e
    v_mfma_f32_16x16x32_bf16 v[24:27], v[56:59], v[20:23], v[24:27]
    v_or_b32 v28, v28, v29
    v_mfma_f32_16x16x32_bf16 v[24:27], v[60:63], v[20:23], v[24:27]
    s_waitcnt vmcnt(10)
    v_bitop3_b32 v29, v64, v68, s11 bitop3:0x7e
    v_mfma_f32_16x16x32_bf16 v[24:27], v[64:67], v[20:23], v[24:27]
    v_or_b32 v28, v28, v29
    v_mfma_f32_16x16x32_bf16 v[24:27], v[68:71], v[20:23], v[24:27]
    s_waitcnt vmcnt(9)
    v_bitop3_b32 v29, v28, v72, s11 bitop3:0xf6
    v_mfma_f32_16x16x32_bf16 v[24:27], v[72:75], v[20:23], v[24:27]
    s_waitcnt vmcnt(8)
    v_bitop3_b32 v28, v29, v76, s11 bitop3:0xf6
    v_mfma_f32_16x16x32_bf16 v[24:27], v[76:79], v[20:23], v[24:27]
    v_and_b32 v28, 1, v28
    v_cmp_ne_u32 vcc, 0, v28
    s_cbranch_vccnz Lp_27
    s_nop 4
    v_cvt_pk_bf16_f32 v24, v24, v25
    v_cvt_pk_bf16_f32 v25, v26, v27
    v_and_or_b32 v24, v24, -2, s11
    s_mov_b64 exec, s[34:35]
    global_store_dwordx2 v14, v[24:25], s[20:21]
    s_mov_b64 exec, -1
    s_barrier
    global_load_dwordx4 v[16:19], v15, s[20:21] sc1
    s_waitcnt vmcnt(2)
    ds_read_b128 v[48:51], v11 offset:0
    ds_read_b128 v[52:55], v11 offset:1024
    ds_read_b128 v[56:59], v11 offset:2048
    ds_read_b128 v[60:63], v11 offset:3072
    ds_read_b128 v[64:67], v11 offset:8192
    ds_read_b128 v[68:71], v11 offset:9216
    ds_read_b128 v[72:75], v11 offset:10240
    ds_read_b128 v[76:79], v11 offset:11264
    s_add_u32 s10, s10, 1
    s_add_u32 s36, s36, 16
    s_addc_u32 s37, s37, 0
    s_mov_b32 s60, 0
    global_load_dwordx4 v[16:19], v15, s[20:21] sc1
    s_sleep 1
    s_branch Lteam_17
Lnr_25:
    ds_read_b128 v[112:115], v11 offset:4096
    ds_read_b128 v[116:119], v11 offset:5120
    ds_read_b128 v[104:107], v11 offset:6144
    ds_read_b128 v[108:111], v11 offset:7168
    v_mov_b64 v[80:81], 0
    v_mov_b64 v[82:83], 0
    v_mov_b64 v[84:85], 0
    v_mov_b64 v[86:87], 0
    v_mov_b64 v[88:89], 0
    v_mov_b64 v[90:91], 0
    v_mov_b64 v[92:93], 0
    v_mov_b64 v[94:95], 0
    v_mov_b64 v[96:97], 0
    v_mov_b64 v[98:99], 0
    v_mov_b64 v[100:101], 0
    v_mov_b64 v[102:103], 0
    s_xor_b32 s61, s61, 0x6000
    s_xor_b32 s56, s56, 0x6000
    v_add_u32 v3, s57, v1
    s_add_u32 s28, s28, 32768
    s_addc_u32 s29, s29, 0
    s_add_u32 s30, s30, 32768
    s_addc_u32 s31, s31, 0
    ds_read_b128 v[48:51], v11 offset:0
    ds_read_b128 v[52:55], v11 offset:1024
    ds_read_b128 v[56:59], v11 offset:2048
    ds_read_b128 v[60:63], v11 offset:3072
    ds_read_b128 v[64:67], v11 offset:8192
    ds_read_b128 v[68:71], v11 offset:9216
    ds_read_b128 v[72:75], v11 offset:10240
    ds_read_b128 v[76:79], v11 offset:11264
    s_add_u32 s10, s10, 1
    s_add_u32 s36, s36, 16
    s_addc_u32 s37, s37, 0
    s_mov_b32 s60, 0
    s_add_u32 s40, s10, 2
    s_min_u32 s40, s40, 63
    s_lshl_b32 s40, s40, 2
    v_lshlrev_b32 v20, 4, v1
    v_add_u32 v20, s40, v20
    s_mov_b32 s60, 0
    s_mov_b64 exec, 0x3
    global_load_dword v21, v20, s[38:39] sc1
    s_waitcnt vmcnt(0)
    v_cmp_ne_u32 vcc, s97, v21
    s_cbranch_vccz Lwf_29
    global_load_dword v21, v20, s[38:39] sc1
    s_sleep 2
Lwf_28:
    global_load_dword v21, v20, s[38:39] sc1
    s_add_u32 s60, s60, 1
    s_cmp_gt_u32 s60, 1000000
    s_cbranch_scc1 Lfail
    s_waitcnt vmcnt(1)
    v_cmp_ne_u32 vcc, s97, v21
    s_cbranch_vccz Lwf_29
    s_sleep 1
    s_branch Lwf_28
Lwf_29:
    s_mov_b64 exec, -1
    s_mov_b32 s60, 0
    s_barrier
    s_cmp_lg_u32 s10, 63
    s_cbranch_scc1 Lef_30
    s_cmp_eq_u32 s52, 0
    s_cbranch_scc1 Lef_30
    v_mov_b32 v28, s97
    s_nop 0
    s_mov_b64 exec, 0x1
    global_store_dword v1, v28, s[36:37] offset:0 sc1
    s_mov_b64 exec, -1
Lef_30:
    s_cmp_lt_u32 s8, 16
    s_cbranch_scc0 Lrd_31
    s_sleep 1
Lrd_31:
    global_load_dwordx4 v[16:19], v15, s[20:21] sc1
    s_sleep 1
    global_load_dwordx4 v[16:19], v15, s[20:21] sc1
    s_sleep 1
    s_branch Lteam_17
Lretb_21:
    global_load_dwordx4 v[32:35], v15, s[22:23] sc1
    s_add_u32 s60, s60, 1
    s_cmp_gt_u32 s60, 400000
    s_cbranch_scc1 Lfail
    s_waitcnt vmcnt(1)
    v_bitop3_b32 v44, v32, v34, s11 bitop3:0x7e
    v_and_b32 v44, 1, v44
    v_cmp_ne_u32 vcc, 0, v44
    s_cbranch_vccnz Lretb_21
    s_branch Lokb_22
Lfin_18:
    s_nop 7
    v_cvt_pk_bf16_f32 v96, v96, v97
    v_cvt_pk_bf16_f32 v97, v98, v99
    v_cvt_pk_bf16_f32 v98, v100, v101
    v_cvt_pk_bf16_f32 v99, v102, v103
    global_store_dwordx4 v1, v[96:99], s[30:31] sc1
    s_waitcnt vmcnt(0)
    s_barrier
    s_cmp_eq_u32 s52, 0
    s_cbranch_scc1 Lff_32
    v_mov_b32 v95, s97
    s_nop 0
    s_mov_b64 exec, 0x1
    global_store_dword v1, v95, s[36:37] offset:16 sc1
    s_mov_b64 exec, -1
Lff_32:
    s_waitcnt vmcnt(0)
    s_branch Lteamdone
Lteamdone:
    v_mbcnt_lo_u32_b32 v0, -1, 0
    v_mbcnt_hi_u32_b32 v0, -1, v0
    s_lshl_b32 s40, s9, 6
    v_add_u32 v0, s40, v0
    s_lshr_b32 s94, s99, 2
    s_and_b32 s95, s99, 3
    s_branch Low
Lworker:
    s_getpc_b64 s[62:63]
Lpc_33:
    s_sub_u32 s62, s62, Lpc_33-Lworker
    s_subb_u32 s63, s63, 0
    v_lshlrev_b32 v250, 6, v0
    global_load_dword v251, v250, s[62:63]
    v_add_u32 v250, 16384, v250
    global_load_dword v251, v250, s[62:63]
    s_sub_u32 s96, s99, 32
    s_mul_i32 s40, s96, 9363
    s_lshr_b32 s40, s40, 16
    s_mul_i32 s41, s40, 7
    s_sub_u32 s41, s96, s41
    s_lshl_b32 s41, s41, 5
    s_add_u32 s40, s40, s41
    s_mul_i32 s8, s40, 9363
    s_lshr_b32 s8, s8, 16
    s_mul_i32 s41, s8, 7
    s_sub_u32 s96, s40, s41
    s_cmp_lt_u32 s96, 2
    s_cbranch_scc1 Lp1
    s_mul_i32 s3, s8, 5
    s_add_u32 s3, s3, s96
    s_sub_u32 s3, s3, 2
    s_cmp_lt_u32 s3, 96
    s_cbranch_scc0 Lln1
    s_load_dwordx2 s[40:41], s[0:1], 96
    s_load_dwordx2 s[42:43], s[0:1], 104
    v_lshrrev_b32 v1, 2, v0
    v_and_b32 v2, 3, v0
    v_lshlrev_b32 v3, 4, v1
    s_mov_b32 s44, 49152
    v_mul_lo_u32 v4, v1, s44
    v_lshl_add_u32 v4, v2, 4, v4
    s_lshl_b32 s45, s3, 6
    v_add_u32 v4, s45, v4
    s_waitcnt lgkmcnt(0)
    global_load_dwordx4 v[8:11], v3, s[40:41]
    global_load_dwordx4 v[16:19], v4, s[42:43]
    v_add_u32 v4, 6144, v4
    global_load_dwordx4 v[20:23], v4, s[42:43]
    v_add_u32 v4, 6144, v4
    global_load_dwordx4 v[24:27], v4, s[42:43]
    v_add_u32 v4, 6144, v4
    global_load_dwordx4 v[28:31], v4, s[42:43]
    v_add_u32 v4, 6144, v4
    global_load_dwordx4 v[32:35], v4, s[42:43]
    v_add_u32 v4, 6144, v4
    global_load_dwordx4 v[36:39], v4, s[42:43]
    v_add_u32 v4, 6144, v4
    global_load_dwordx4 v[40:43], v4, s[42:43]
    v_add_u32 v4, 6144, v4
    global_load_dwordx4 v[44:47], v4, s[42:43]
    s_waitcnt vmcnt(8)
    v_lshlrev_b32 v48, 16, v8
    v_and_b32 v49, 0xffff0000, v8
    v_lshlrev_b32 v50, 16, v9
    v_and_b32 v51, 0xffff0000, v9
    v_lshlrev_b32 v52, 16, v10
    v_and_b32 v53, 0xffff0000, v10
    v_lshlrev_b32 v54, 16, v11
    v_and_b32 v55, 0xffff0000, v11
    v_mul_f32 v56, 0xbfb8aa3b, v48
    v_exp_f32 v56, v56
    s_nop 0
    v_add_f32 v56, 1.0, v56
    v_rcp_f32 v56, v56
    s_nop 0
    v_mul_f32 v48, v48, v56
    v_mul_f32 v57, 0xbfb8aa3b, v49
    v_exp_f32 v57, v57
    s_nop 0
    v_add_f32 v57, 1.0, v57
    v_rcp_f32 v57, v57
    s_nop 0
    v_mul_f32 v49, v49, v57
    v_mul_f32 v58, 0xbfb8aa3b, v50
    v_exp_f32 v58, v58
    s_nop 0
    v_add_f32 v58, 1.0, v58
    v_rcp_f32 v58, v58
    s_nop 0
    v_mul_f32 v50, v50, v58
    v_mul_f32 v59, 0xbfb8aa3b, v51
    v_exp_f32 v59, v59
    s_nop 0
    v_add_f32 v59, 1.0, v59
    v_rcp_f32 v59, v59
    s_nop 0
    v_mul_f32 v51, v51, v59
    v_mul_f32 v60, 0xbfb8aa3b, v52
    v_exp_f32 v60, v60
    s_nop 0
    v_add_f32 v60, 1.0, v60
    v_rcp_f32 v60, v60
    s_nop 0
    v_mul_f32 v52, v52, v60
    v_mul_f32 v61, 0xbfb8aa3b, v53
    v_exp_f32 v61, v61
    s_nop 0
    v_add_f32 v61, 1.0, v61
    v_rcp_f32 v61, v61
    s_nop 0
    v_mul_f32 v53, v53, v61
    v_mul_f32 v62, 0xbfb8aa3b, v54
    v_exp_f32 v62, v62
    s_nop 0
    v_add_f32 v62, 1.0, v62
    v_rcp_f32 v62, v62
    s_nop 0
    v_mul_f32 v54, v54, v62
    v_mul_f32 v63, 0xbfb8aa3b, v55
    v_exp_f32 v63, v63
    s_nop 0
    v_add_f32 v63, 1.0, v63
    v_rcp_f32 v63, v63
    s_nop 0
    v_mul_f32 v55, v55, v63
    v_cvt_pk_bf16_f32 v8, v48, v49
    v_cvt_pk_bf16_f32 v9, v50, v51
    v_cvt_pk_bf16_f32 v10, v52, v53
    v_cvt_pk_bf16_f32 v11, v54, v55
    v_lshlrev_b32 v48, 16, v8
    v_and_b32 v49, 0xffff0000, v8
    v_lshlrev_b32 v50, 16, v9
    v_and_b32 v51, 0xffff0000, v9
    v_lshlrev_b32 v52, 16, v10
    v_and_b32 v53, 0xffff0000, v10
    v_lshlrev_b32 v54, 16, v11
    v_and_b32 v55, 0xffff0000, v11
    v_mov_b32 v64, 0
    v_mov_b32 v65, 0
    v_mov_b32 v66, 0
    v_mov_b32 v67, 0
    v_mov_b32 v68, 0
    v_mov_b32 v69, 0
    v_mov_b32 v70, 0
    v_mov_b32 v71, 0
    s_waitcnt vmcnt(7)
    v_lshlrev_b32 v56, 16, v16
    v_and_b32 v57, 0xffff0000, v16
    v_lshlrev_b32 v58, 16, v17
    v_and_b32 v59, 0xffff0000, v17
    v_lshlrev_b32 v60, 16, v18
    v_and_b32 v61, 0xffff0000, v18
    v_lshlrev_b32 v62, 16, v19
    v_and_b32 v63, 0xffff0000, v19
    v_fmac_f32 v64, v48, v56
    v_fmac_f32 v65, v48, v57
    v_fmac_f32 v66, v48, v58
    v_fmac_f32 v67, v48, v59
    v_fmac_f32 v68, v48, v60
    v_fmac_f32 v69, v48, v61
    v_fmac_f32 v70, v48, v62
    v_fmac_f32 v71, v48, v63
    s_waitcnt vmcnt(6)
    v_lshlrev_b32 v56, 16, v20
    v_and_b32 v57, 0xffff0000, v20
    v_lshlrev_b32 v58, 16, v21
    v_and_b32 v59, 0xffff0000, v21
    v_lshlrev_b32 v60, 16, v22
    v_and_b32 v61, 0xffff0000, v22
    v_lshlrev_b32 v62, 16, v23
    v_and_b32 v63, 0xffff0000, v23
    v_fmac_f32 v64, v49, v56
    v_fmac_f32 v65, v49, v57
    v_fmac_f32 v66, v49, v58
    v_fmac_f32 v67, v49, v59
    v_fmac_f32 v68, v49, v60
    v_fmac_f32 v69, v49, v61
    v_fmac_f32 v70, v49, v62
    v_fmac_f32 v71, v49, v63
    s_waitcnt vmcnt(5)
    v_lshlrev_b32 v56, 16, v24
    v_and_b32 v57, 0xffff0000, v24
    v_lshlrev_b32 v58, 16, v25
    v_and_b32 v59, 0xffff0000, v25
    v_lshlrev_b32 v60, 16, v26
    v_and_b32 v61, 0xffff0000, v26
    v_lshlrev_b32 v62, 16, v27
    v_and_b32 v63, 0xffff0000, v27
    v_fmac_f32 v64, v50, v56
    v_fmac_f32 v65, v50, v57
    v_fmac_f32 v66, v50, v58
    v_fmac_f32 v67, v50, v59
    v_fmac_f32 v68, v50, v60
    v_fmac_f32 v69, v50, v61
    v_fmac_f32 v70, v50, v62
    v_fmac_f32 v71, v50, v63
    s_waitcnt vmcnt(4)
    v_lshlrev_b32 v56, 16, v28
    v_and_b32 v57, 0xffff0000, v28
    v_lshlrev_b32 v58, 16, v29
    v_and_b32 v59, 0xffff0000, v29
    v_lshlrev_b32 v60, 16, v30
    v_and_b32 v61, 0xffff0000, v30
    v_lshlrev_b32 v62, 16, v31
    v_and_b32 v63, 0xffff0000, v31
    v_fmac_f32 v64, v51, v56
    v_fmac_f32 v65, v51, v57
    v_fmac_f32 v66, v51, v58
    v_fmac_f32 v67, v51, v59
    v_fmac_f32 v68, v51, v60
    v_fmac_f32 v69, v51, v61
    v_fmac_f32 v70, v51, v62
    v_fmac_f32 v71, v51, v63
    s_waitcnt vmcnt(3)
    v_lshlrev_b32 v56, 16, v32
    v_and_b32 v57, 0xffff0000, v32
    v_lshlrev_b32 v58, 16, v33
    v_and_b32 v59, 0xffff0000, v33
    v_lshlrev_b32 v60, 16, v34
    v_and_b32 v61, 0xffff0000, v34
    v_lshlrev_b32 v62, 16, v35
    v_and_b32 v63, 0xffff0000, v35
    v_fmac_f32 v64, v52, v56
    v_fmac_f32 v65, v52, v57
    v_fmac_f32 v66, v52, v58
    v_fmac_f32 v67, v52, v59
    v_fmac_f32 v68, v52, v60
    v_fmac_f32 v69, v52, v61
    v_fmac_f32 v70, v52, v62
    v_fmac_f32 v71, v52, v63
    s_waitcnt vmcnt(2)
    v_lshlrev_b32 v56, 16, v36
    v_and_b32 v57, 0xffff0000, v36
    v_lshlrev_b32 v58, 16, v37
    v_and_b32 v59, 0xffff0000, v37
    v_lshlrev_b32 v60, 16, v38
    v_and_b32 v61, 0xffff0000, v38
    v_lshlrev_b32 v62, 16, v39
    v_and_b32 v63, 0xffff0000, v39
    v_fmac_f32 v64, v53, v56
    v_fmac_f32 v65, v53, v57
    v_fmac_f32 v66, v53, v58
    v_fmac_f32 v67, v53, v59
    v_fmac_f32 v68, v53, v60
    v_fmac_f32 v69, v53, v61
    v_fmac_f32 v70, v53, v62
    v_fmac_f32 v71, v53, v63
    s_waitcnt vmcnt(1)
    v_lshlrev_b32 v56, 16, v40
    v_and_b32 v57, 0xffff0000, v40
    v_lshlrev_b32 v58, 16, v41
    v_and_b32 v59, 0xffff0000, v41
    v_lshlrev_b32 v60, 16, v42
    v_and_b32 v61, 0xffff0000, v42
    v_lshlrev_b32 v62, 16, v43
    v_and_b32 v63, 0xffff0000, v43
    v_fmac_f32 v64, v54, v56
    v_fmac_f32 v65, v54, v57
    v_fmac_f32 v66, v54, v58
    v_fmac_f32 v67, v54, v59
    v_fmac_f32 v68, v54, v60
    v_fmac_f32 v69, v54, v61
    v_fmac_f32 v70, v54, v62
    v_fmac_f32 v71, v54, v63
    s_waitcnt vmcnt(0)
    v_lshlrev_b32 v56, 16, v44
    v_and_b32 v57, 0xffff0000, v44
    v_lshlrev_b32 v58, 16, v45
    v_and_b32 v59, 0xffff0000, v45
    v_lshlrev_b32 v60, 16, v46
    v_and_b32 v61, 0xffff0000, v46
    v_lshlrev_b32 v62, 16, v47
    v_and_b32 v63, 0xffff0000, v47
    v_fmac_f32 v64, v55, v56
    v_fmac_f32 v65, v55, v57
    v_fmac_f32 v66, v55, v58
    v_fmac_f32 v67, v55, v59
    v_fmac_f32 v68, v55, v60
    v_fmac_f32 v69, v55, v61
    v_fmac_f32 v70, v55, v62
    v_fmac_f32 v71, v55, v63
    v_lshlrev_b32 v5, 5, v0
    ds_write_b128 v5, v[64:67]
    ds_write_b128 v5, v[68:71] offset:16
    s_waitcnt lgkmcnt(0)
    s_barrier
    v_and_b32 v6, 31, v0
    v_lshrrev_b32 v7, 5, v0
    v_lshlrev_b32 v5, 10, v7
    v_lshl_add_u32 v5, v6, 2, v5
    ds_read_b32 v16, v5 offset:0
    ds_read_b32 v17, v5 offset:128
    ds_read_b32 v18, v5 offset:256
    ds_read_b32 v19, v5 offset:384
    ds_read_b32 v20, v5 offset:512
    ds_read_b32 v21, v5 offset:640
    ds_read_b32 v22, v5 offset:768
    ds_read_b32 v23, v5 offset:896
    s_waitcnt lgkmcnt(0)
    v_add_f32 v16, v16, v17
    v_add_f32 v16, v16, v18
    v_add_f32 v16, v16, v19
    v_add_f32 v16, v16, v20
    v_add_f32 v16, v16, v21
    v_add_f32 v16, v16, v22
    v_add_f32 v16, v16, v23
    v_lshlrev_b32 v5, 2, v0
    ds_write_b32 v5, v16 offset:8192
    s_waitcnt lgkmcnt(0)
    s_barrier
    s_cmp_lg_u32 s98, 0
    s_cbranch_scc1 Lcf_34
    s_cmp_lg_u32 s9, 0
    s_cbranch_scc1 Lcf_35
    s_mov_b32 s60, 0
    s_lshr_b32 s94, s2, 2
    s_and_b32 s95, s2, 3
Lcf_36:
    v_mbcnt_lo_u32_b32 v24, -1, 0
    v_mbcnt_hi_u32_b32 v24, -1, v24
    v_lshlrev_b32 v24, 2, v24
    global_load_dword v25, v24, s[6:7] sc1
    s_add_u32 s60, s60, 1
    s_cmp_gt_u32 s60, 300000
    s_cbranch_scc1 Lfail
    s_cmp_lg_u32 s60, 64
    s_cbranch_scc1 Lcf_39
    s_cmp_eq_u32 s100, 0
    s_cbranch_scc1 Lcf_39
    s_memtime s[88:89]
    s_memrealtime s[90:91]
    s_waitcnt lgkmcnt(0)
    s_lshr_b32 s89, s88, 4
    s_xor_b32 s88, s88, s89
    s_lshr_b32 s89, s88, 9
    s_xor_b32 s88, s88, s89
    s_xor_b32 s88, s88, s90
    s_lshr_b32 s89, s90, 5
    s_xor_b32 s88, s88, s89
    s_and_b32 s88, s88, 15
    s_lshl_b32 s88, s88, 3
    s_or_b32 s88, s88, s100
    s_or_b32 s88, s88, 0x80
    v_mov_b32 v26, s2
    v_mov_b32 v27, s88
    s_mov_b64 exec, 1
    global_store_byte v26, v27, s[6:7] sc1
    s_mov_b64 exec, -1
Lcf_39:
    s_waitcnt vmcnt(0)
    v_and_b32 v26, 0x80808080, v25
    v_cmp_ne_u32 vcc, 0x80808080, v26
    s_nop 0
    s_cmp_eq_u64 vcc, 0
    s_cselect_b32 s93, 8, 1
    s_mov_b32 s85, 0x80
Lcf_37:
    s_mov_b32 s86, 0
    s_mov_b32 s87, 0
    s_mov_b32 s84, 0
    v_bfe_u32 v26, v25, 0, 8
    v_and_b32 v27, 0x87, v26
    v_cmp_eq_u32 vcc, s85, v27
    s_nop 0
    s_bcnt1_i32_b64 s88, vcc
    s_add_u32 s86, s86, s88
    s_cmp_gt_u32 s95, 0
    s_cselect_b32 s88, 1, 0
    s_add_u32 s88, s88, s94
    s_bfm_b64 s[90:91], s88, 0
    s_cmp_eq_u32 s88, 64
    s_cselect_b64 s[90:91], -1, s[90:91]
    s_and_b64 s[90:91], s[90:91], vcc
    s_bcnt1_i32_b64 s88, s[90:91]
    s_add_u32 s87, s87, s88
    v_cndmask_b32 v26, 0, v26, vcc
    v_bfe_u32 v27, v26, 3, 1
    v_cmp_ne_u32 s[90:91], 0, v27
    s_mul_i32 s84, s84, 0x9e3779b1
    s_xor_b32 s84, s84, s90
    s_mul_i32 s84, s84, 0x85ebca6b
    s_add_u32 s84, s84, s91
    v_bfe_u32 v27, v26, 4, 1
    v_cmp_ne_u32 s[90:91], 0, v27
    s_mul_i32 s84, s84, 0x9e3779b1
    s_xor_b32 s84, s84, s90
    s_mul_i32 s84, s84, 0x85ebca6b
    s_add_u32 s84, s84, s91
    v_bfe_u32 v27, v26, 5, 1
    v_cmp_ne_u32 s[90:91], 0, v27
    s_mul_i32 s84, s84, 0x9e3779b1
    s_xor_b32 s84, s84, s90
    s_mul_i32 s84, s84, 0x85ebca6b
    s_add_u32 s84, s84, s91
    v_bfe_u32 v27, v26, 6, 1
    v_cmp_ne_u32 s[90:91], 0, v27
    s_mul_i32 s84, s84, 0x9e3779b1
    s_xor_b32 s84, s84, s90
    s_mul_i32 s84, s84, 0x85ebca6b
    s_add_u32 s84, s84, s91
    v_bfe_u32 v26, v25, 8, 8
    v_and_b32 v27, 0x87, v26
    v_cmp_eq_u32 vcc, s85, v27
    s_nop 0
    s_bcnt1_i32_b64 s88, vcc
    s_add_u32 s86, s86, s88
    s_cmp_gt_u32 s95, 1
    s_cselect_b32 s88, 1, 0
    s_add_u32 s88, s88, s94
    s_bfm_b64 s[90:91], s88, 0
    s_cmp_eq_u32 s88, 64
    s_cselect_b64 s[90:91], -1, s[90:91]
    s_and_b64 s[90:91], s[90:91], vcc
    s_bcnt1_i32_b64 s88, s[90:91]
    s_add_u32 s87, s87, s88
    v_cndmask_b32 v26, 0, v26, vcc
    v_bfe_u32 v27, v26, 3, 1
    v_cmp_ne_u32 s[90:91], 0, v27
    s_mul_i32 s84, s84, 0x9e3779b1
    s_xor_b32 s84, s84, s90
    s_mul_i32 s84, s84, 0x85ebca6b
    s_add_u32 s84, s84, s91
    v_bfe_u32 v27, v26, 4, 1
    v_cmp_ne_u32 s[90:91], 0, v27
    s_mul_i32 s84, s84, 0x9e3779b1
    s_xor_b32 s84, s84, s90
    s_mul_i32 s84, s84, 0x85ebca6b
    s_add_u32 s84, s84, s91
    v_bfe_u32 v27, v26, 5, 1
    v_cmp_ne_u32 s[90:91], 0, v27
    s_mul_i32 s84, s84, 0x9e3779b1
    s_xor_b32 s84, s84, s90
    s_mul_i32 s84, s84, 0x85ebca6b
    s_add_u32 s84, s84, s91
    v_bfe_u32 v27, v26, 6, 1
    v_cmp_ne_u32 s[90:91], 0, v27
    s_mul_i32 s84, s84, 0x9e3779b1
    s_xor_b32 s84, s84, s90
    s_mul_i32 s84, s84, 0x85ebca6b
    s_add_u32 s84, s84, s91
    v_bfe_u32 v26, v25, 16, 8
    v_and_b32 v27, 0x87, v26
    v_cmp_eq_u32 vcc, s85, v27
    s_nop 0
    s_bcnt1_i32_b64 s88, vcc
    s_add_u32 s86, s86, s88
    s_cmp_gt_u32 s95, 2
    s_cselect_b32 s88, 1, 0
    s_add_u32 s88, s88, s94
    s_bfm_b64 s[90:91], s88, 0
    s_cmp_eq_u32 s88, 64
    s_cselect_b64 s[90:91], -1, s[90:91]
    s_and_b64 s[90:91], s[90:91], vcc
    s_bcnt1_i32_b64 s88, s[90:91]
    s_add_u32 s87, s87, s88
    v_cndmask_b32 v26, 0, v26, vcc
    v_bfe_u32 v27, v26, 3, 1
    v_cmp_ne_u32 s[90:91], 0, v27
    s_mul_i32 s84, s84, 0x9e3779b1
    s_xor_b32 s84, s84, s90
    s_mul_i32 s84, s84, 0x85ebca6b
    s_add_u32 s84, s84, s91
    v_bfe_u32 v27, v26, 4, 1
    v_cmp_ne_u32 s[90:91], 0, v27
    s_mul_i32 s84, s84, 0x9e3779b1
    s_xor_b32 s84, s84, s90
    s_mul_i32 s84, s84, 0x85ebca6b
    s_add_u32 s84, s84, s91
    v_bfe_u32 v27, v26, 5, 1
    v_cmp_ne_u32 s[90:91], 0, v27
    s_mul_i32 s84, s84, 0x9e3779b1
    s_xor_b32 s84, s84, s90
    s_mul_i32 s84, s84, 0x85ebca6b
    s_add_u32 s84, s84, s91
    v_bfe_u32 v27, v26, 6, 1
    v_cmp_ne_u32 s[90:91], 0, v27
    s_mul_i32 s84, s84, 0x9e3779b1
    s_xor_b32 s84, s84, s90
    s_mul_i32 s84, s84, 0x85ebca6b
    s_add_u32 s84, s84, s91
    v_bfe_u32 v26, v25, 24, 8
    v_and_b32 v27, 0x87, v26
    v_cmp_eq_u32 vcc, s85, v27
    s_nop 0
    s_bcnt1_i32_b64 s88, vcc
    s_add_u32 s86, s86, s88
    s_cmp_gt_u32 s95, 3
    s_cselect_b32 s88, 1, 0
    s_add_u32 s88, s88, s94
    s_bfm_b64 s[90:91], s88, 0
    s_cmp_eq_u32 s88, 64
    s_cselect_b64 s[90:91], -1, s[90:91]
    s_and_b64 s[90:91], s[90:91], vcc
    s_bcnt1_i32_b64 s88, s[90:91]
    s_add_u32 s87, s87, s88
    v_cndmask_b32 v26, 0, v26, vcc
    v_bfe_u32 v27, v26, 3, 1
    v_cmp_ne_u32 s[90:91], 0, v27
    s_mul_i32 s84, s84, 0x9e3779b1
    s_xor_b32 s84, s84, s90
    s_mul_i32 s84, s84, 0x85ebca6b
    s_add_u32 s84, s84, s91
    v_bfe_u32 v27, v26, 4, 1
    v_cmp_ne_u32 s[90:91], 0, v27
    s_mul_i32 s84, s84, 0x9e3779b1
    s_xor_b32 s84, s84, s90
    s_mul_i32 s84, s84, 0x85ebca6b
    s_add_u32 s84, s84, s91
    v_bfe_u32 v27, v26, 5, 1
    v_cmp_ne_u32 s[90:91], 0, v27
    s_mul_i32 s84, s84, 0x9e3779b1
    s_xor_b32 s84, s84, s90
    s_mul_i32 s84, s84, 0x85ebca6b
    s_add_u32 s84, s84, s91
    v_bfe_u32 v27, v26, 6, 1
    v_cmp_ne_u32 s[90:91], 0, v27
    s_mul_i32 s84, s84, 0x9e3779b1
    s_xor_b32 s84, s84, s90
    s_mul_i32 s84, s84, 0x85ebca6b
    s_add_u32 s84, s84, s91
    s_cmp_ge_u32 s86, 32
    s_cbranch_scc1 Lcf_38
    s_add_u32 s85, s85, 1
    s_and_b32 s88, s85, 15
    s_cmp_lt_u32 s88, s93
    s_cbranch_scc1 Lcf_37
    s_branch Lcf_36
Lcf_38:
    s_or_b32 s84, s84, 1
    s_and_b32 s85, s85, 7
    s_min_u32 s88, s87, 32
    s_sub_u32 s88, s2, s88
    s_add_u32 s88, s88, 32
    s_cmp_lt_u32 s87, 32
    s_cselect_b32 s89, s87, s88
    s_cmp_eq_u32 s85, s100
    s_cselect_b32 s89, s89, s88
    v_mov_b32 v26, s84
    v_mov_b32 v27, s89
    v_mov_b32 v24, 163824
    ds_write_b64 v24, v[26:27]
    s_waitcnt lgkmcnt(0)
Lcf_35:
    s_barrier
    v_mov_b32 v24, 163824
    ds_read_b64 v[26:27], v24
    s_waitcnt lgkmcnt(0)
    v_readfirstlane_b32 s97, v26
    v_readfirstlane_b32 s89, v27
    s_mov_b32 s98, 1
    s_nop 3
    s_cmp_eq_u32 s89, s99
    s_cbranch_scc1 Lcf_34
    s_mov_b32 s99, s89
    s_waitcnt vmcnt(0)
    s_barrier
    s_branch Lstart
Lcf_34:
    s_cmp_lg_u32 s9, 0
    s_cbranch_scc1 Lmod_41
    v_lshlrev_b32 v5, 2, v6
    ds_read_b32 v16, v5 offset:8192
    ds_read_b32 v17, v5 offset:8320
    ds_read_b32 v18, v5 offset:8448
    ds_read_b32 v19, v5 offset:8576
    ds_read_b32 v20, v5 offset:8704
    ds_read_b32 v21, v5 offset:8832
    ds_read_b32 v22, v5 offset:8960
    ds_read_b32 v23, v5 offset:9088
    s_waitcnt lgkmcnt(0)
    v_add_f32 v16, v16, v17
    v_add_f32 v16, v16, v18
    v_add_f32 v16, v16, v19
    v_add_f32 v16, v16, v20
    v_add_f32 v16, v16, v21
    v_add_f32 v16, v16, v22
    v_add_f32 v16, v16, v23
    v_cvt_pk_bf16_f32 v16, v16, v16
    s_lshr_b32 s46, s3, 4
    s_cmp_eq_u32 s46, 1
    s_cselect_b32 s47, 1.0, 0
    s_cmp_eq_u32 s46, 4
    s_cselect_b32 s47, 1.0, s47
    v_and_b32 v16, 0xffff0000, v16
    v_add_f32 v16, s47, v16
    v_cvt_pk_bf16_f32 v16, v16, v16
    s_nop 1
    v_mov_b32_dpp v17, v16 quad_perm:[1,1,3,3] row_mask:0xf bank_mask:0xf
    v_and_b32 v16, 0xffff, v16
    v_and_b32 v17, 0xffff0000, v17
    v_or_b32 v16, v16, v17
    v_mov_b32 v17, s97
    v_and_b32 v18, 63, v0
    v_cmp_le_u32 vcc, 32, v18
    s_nop 1
    v_cndmask_b32 v16, v16, v17, vcc
    v_and_b32 v5, 15, v18
    v_lshlrev_b32 v5, 1, v5
    v_bfe_u32 v19, v18, 4, 1
    v_lshl_add_u32 v5, v19, 6, v5
    v_and_b32 v19, 2, v18
    v_lshlrev_b32 v19, 5, v19
    v_add_u32 v19, 32, v19
    v_cndmask_b32 v5, v5, v19, vcc
    s_lshl_b32 s45, s45, 1
    s_add_u32 s45, s45, 491520
    v_add_u32 v5, s45, v5
    s_mov_b32 exec_lo, 0x55555555
    s_mov_b32 exec_hi, 5
    global_store_dword v5, v16, s[4:5] sc1
    s_mov_b64 exec, -1
Lmod_41:
    s_branch Lp1
Lln1:
    s_sub_u32 s3, s3, 96
    s_lshl_b32 s3, s3, 2
    s_add_u32 s3, s3, s9
    s_load_dwordx2 s[40:41], s[0:1], 0
    v_and_b32 v1, 63, v0
    v_and_b32 v2, 7, v1
    v_lshrrev_b32 v3, 3, v1
    v_lshlrev_b32 v4, 10, v2
    v_lshl_add_u32 v4, v3, 4, v4
    s_lshl_b32 s42, s3, 13
    v_add_u32 v4, s42, v4
    s_waitcnt lgkmcnt(0)
    global_load_dwordx4 v[16:19], v4, s[40:41] offset:0
    global_load_dwordx4 v[20:23], v4, s[40:41] offset:128
    global_load_dwordx4 v[24:27], v4, s[40:41] offset:256
    global_load_dwordx4 v[28:31], v4, s[40:41] offset:384
    global_load_dwordx4 v[32:35], v4, s[40:41] offset:512
    global_load_dwordx4 v[36:39], v4, s[40:41] offset:640
    global_load_dwordx4 v[40:43], v4, s[40:41] offset:768
    global_load_dwordx4 v[44:47], v4, s[40:41] offset:896
    v_lshrrev_b32 v5, 1, v3
    v_lshlrev_b32 v5, 10, v5
    v_and_b32 v6, 1, v3
    v_lshl_add_u32 v5, v6, 9, v5
    v_lshl_add_u32 v5, v2, 4, v5
    s_lshr_b32 s43, s3, 2
    s_lshl_b32 s43, s43, 15
    s_and_b32 s44, s3, 3
    s_lshl_b32 s44, s44, 7
    s_add_u32 s43, s43, s44
    s_add_u32 s43, s43, 1048576
    v_add_u32 v5, s43, v5
    v_lshrrev_b32 v6, 1, v3
    v_lshlrev_b32 v6, 6, v6
    v_and_b32 v7, 1, v3
    v_lshl_add_u32 v6, v7, 4, v6
    v_add_u32 v6, 491520, v6
    s_waitcnt vmcnt(7)
    v_lshlrev_b32 v64, 16, v16
    v_and_b32 v65, 0xffff0000, v16
    v_lshlrev_b32 v66, 16, v17
    v_and_b32 v67, 0xffff0000, v17
    v_lshlrev_b32 v68, 16, v18
    v_and_b32 v69, 0xffff0000, v18
    v_lshlrev_b32 v70, 16, v19
    v_and_b32 v71, 0xffff0000, v19
    s_waitcnt vmcnt(6)
    v_lshlrev_b32 v72, 16, v20
    v_and_b32 v73, 0xffff0000, v20
    v_lshlrev_b32 v74, 16, v21
    v_and_b32 v75, 0xffff0000, v21
    v_lshlrev_b32 v76, 16, v22
    v_and_b32 v77, 0xffff0000, v22
    v_lshlrev_b32 v78, 16, v23
    v_and_b32 v79, 0xffff0000, v23
    s_waitcnt vmcnt(5)
    v_lshlrev_b32 v80, 16, v24
    v_and_b32 v81, 0xffff0000, v24
    v_lshlrev_b32 v82, 16, v25
    v_and_b32 v83, 0xffff0000, v25
    v_lshlrev_b32 v84, 16, v26
    v_and_b32 v85, 0xffff0000, v26
    v_lshlrev_b32 v86, 16, v27
    v_and_b32 v87, 0xffff0000, v27
    s_waitcnt vmcnt(4)
    v_lshlrev_b32 v88, 16, v28
    v_and_b32 v89, 0xffff0000, v28
    v_lshlrev_b32 v90, 16, v29
    v_and_b32 v91, 0xffff0000, v29
    v_lshlrev_b32 v92, 16, v30
    v_and_b32 v93, 0xffff0000, v30
    v_lshlrev_b32 v94, 16, v31
    v_and_b32 v95, 0xffff0000, v31
    s_waitcnt vmcnt(3)
    v_lshlrev_b32 v96, 16, v32
    v_and_b32 v97, 0xffff0000, v32
    v_lshlrev_b32 v98, 16, v33
    v_and_b32 v99, 0xffff0000, v33
    v_lshlrev_b32 v100, 16, v34
    v_and_b32 v101, 0xffff0000, v34
    v_lshlrev_b32 v102, 16, v35
    v_and_b32 v103, 0xffff0000, v35
    s_waitcnt vmcnt(2)
    v_lshlrev_b32 v104, 16, v36
    v_and_b32 v105, 0xffff0000, v36
    v_lshlrev_b32 v106, 16, v37
    v_and_b32 v107, 0xffff0000, v37
    v_lshlrev_b32 v108, 16, v38
    v_and_b32 v109, 0xffff0000, v38
    v_lshlrev_b32 v110, 16, v39
    v_and_b32 v111, 0xffff0000, v39
    s_waitcnt vmcnt(1)
    v_lshlrev_b32 v112, 16, v40
    v_and_b32 v113, 0xffff0000, v40
    v_lshlrev_b32 v114, 16, v41
    v_and_b32 v115, 0xffff0000, v41
    v_lshlrev_b32 v116, 16, v42
    v_and_b32 v117, 0xffff0000, v42
    v_lshlrev_b32 v118, 16, v43
    v_and_b32 v119, 0xffff0000, v43
    s_waitcnt vmcnt(0)
    v_lshlrev_b32 v120, 16, v44
    v_and_b32 v121, 0xffff0000, v44
    v_lshlrev_b32 v122, 16, v45
    v_and_b32 v123, 0xffff0000, v45
    v_lshlrev_b32 v124, 16, v46
    v_and_b32 v125, 0xffff0000, v46
    v_lshlrev_b32 v126, 16, v47
    v_and_b32 v127, 0xffff0000, v47
    v_add_f32 v8, v64, v65
    v_add_f32 v9, v66, v67
    v_add_f32 v8, v8, v68
    v_add_f32 v9, v9, v69
    v_add_f32 v8, v8, v70
    v_add_f32 v9, v9, v71
    v_add_f32 v8, v8, v72
    v_add_f32 v9, v9, v73
    v_add_f32 v8, v8, v74
    v_add_f32 v9, v9, v75
    v_add_f32 v8, v8, v76
    v_add_f32 v9, v9, v77
    v_add_f32 v8, v8, v78
    v_add_f32 v9, v9, v79
    v_add_f32 v8, v8, v80
    v_add_f32 v9, v9, v81
    v_add_f32 v8, v8, v82
    v_add_f32 v9, v9, v83
    v_add_f32 v8, v8, v84
    v_add_f32 v9, v9, v85
    v_add_f32 v8, v8, v86
    v_add_f32 v9, v9, v87
    v_add_f32 v8, v8, v88
    v_add_f32 v9, v9, v89
    v_add_f32 v8, v8, v90
    v_add_f32 v9, v9, v91
    v_add_f32 v8, v8, v92
    v_add_f32 v9, v9, v93
    v_add_f32 v8, v8, v94
    v_add_f32 v9, v9, v95
    v_add_f32 v8, v8, v96
    v_add_f32 v9, v9, v97
    v_add_f32 v8, v8, v98
    v_add_f32 v9, v9, v99
    v_add_f32 v8, v8, v100
    v_add_f32 v9, v9, v101
    v_add_f32 v8, v8, v102
    v_add_f32 v9, v9, v103
    v_add_f32 v8, v8, v104
    v_add_f32 v9, v9, v105
    v_add_f32 v8, v8, v106
    v_add_f32 v9, v9, v107
    v_add_f32 v8, v8, v108
    v_add_f32 v9, v9, v109
    v_add_f32 v8, v8, v110
    v_add_f32 v9, v9, v111
    v_add_f32 v8, v8, v112
    v_add_f32 v9, v9, v113
    v_add_f32 v8, v8, v114
    v_add_f32 v9, v9, v115
    v_add_f32 v8, v8, v116
    v_add_f32 v9, v9, v117
    v_add_f32 v8, v8, v118
    v_add_f32 v9, v9, v119
    v_add_f32 v8, v8, v120
    v_add_f32 v9, v9, v121
    v_add_f32 v8, v8, v122
    v_add_f32 v9, v9, v123
    v_add_f32 v8, v8, v124
    v_add_f32 v9, v9, v125
    v_add_f32 v8, v8, v126
    v_add_f32 v9, v9, v127
    v_add_f32 v8, v8, v9
    s_nop 1
    v_add_f32_dpp v8, v8, v8 row_ror:8 row_mask:0xf bank_mask:0xf
    v_mov_b32 v9, v8
    s_nop 1
    v_permlane16_swap_b32 v8, v9
    v_add_f32 v8, v8, v9
    v_mov_b32 v9, v8
    s_nop 1
    v_permlane32_swap_b32 v8, v9
    v_add_f32 v8, v8, v9
    v_mul_f32 v8, 0x3b000000, v8
    v_sub_f32 v64, v64, v8
    v_sub_f32 v65, v65, v8
    v_sub_f32 v66, v66, v8
    v_sub_f32 v67, v67, v8
    v_sub_f32 v68, v68, v8
    v_sub_f32 v69, v69, v8
    v_sub_f32 v70, v70, v8
    v_sub_f32 v71, v71, v8
    v_sub_f32 v72, v72, v8
    v_sub_f32 v73, v73, v8
    v_sub_f32 v74, v74, v8
    v_sub_f32 v75, v75, v8
    v_sub_f32 v76, v76, v8
    v_sub_f32 v77, v77, v8
    v_sub_f32 v78, v78, v8
    v_sub_f32 v79, v79, v8
    v_sub_f32 v80, v80, v8
    v_sub_f32 v81, v81, v8
    v_sub_f32 v82, v82, v8
    v_sub_f32 v83, v83, v8
    v_sub_f32 v84, v84, v8
    v_sub_f32 v85, v85, v8
    v_sub_f32 v86, v86, v8
    v_sub_f32 v87, v87, v8
    v_sub_f32 v88, v88, v8
    v_sub_f32 v89, v89, v8
    v_sub_f32 v90, v90, v8
    v_sub_f32 v91, v91, v8
    v_sub_f32 v92, v92, v8
    v_sub_f32 v93, v93, v8
    v_sub_f32 v94, v94, v8
    v_sub_f32 v95, v95, v8
    v_sub_f32 v96, v96, v8
    v_sub_f32 v97, v97, v8
    v_sub_f32 v98, v98, v8
    v_sub_f32 v99, v99, v8
    v_sub_f32 v100, v100, v8
    v_sub_f32 v101, v101, v8
    v_sub_f32 v102, v102, v8
    v_sub_f32 v103, v103, v8
    v_sub_f32 v104, v104, v8
    v_sub_f32 v105, v105, v8
    v_sub_f32 v106, v106, v8
    v_sub_f32 v107, v107, v8
    v_sub_f32 v108, v108, v8
    v_sub_f32 v109, v109, v8
    v_sub_f32 v110, v110, v8
    v_sub_f32 v111, v111, v8
    v_sub_f32 v112, v112, v8
    v_sub_f32 v113, v113, v8
    v_sub_f32 v114, v114, v8
    v_sub_f32 v115, v115, v8
    v_sub_f32 v116, v116, v8
    v_sub_f32 v117, v117, v8
    v_sub_f32 v118, v118, v8
    v_sub_f32 v119, v119, v8
    v_sub_f32 v120, v120, v8
    v_sub_f32 v121, v121, v8
    v_sub_f32 v122, v122, v8
    v_sub_f32 v123, v123, v8
    v_sub_f32 v124, v124, v8
    v_sub_f32 v125, v125, v8
    v_sub_f32 v126, v126, v8
    v_sub_f32 v127, v127, v8
    v_mul_f32 v8, v64, v64
    v_mul_f32 v9, v65, v65
    v_fmac_f32 v8, v66, v66
    v_fmac_f32 v9, v67, v67
    v_fmac_f32 v8, v68, v68
    v_fmac_f32 v9, v69, v69
    v_fmac_f32 v8, v70, v70
    v_fmac_f32 v9, v71, v71
    v_fmac_f32 v8, v72, v72
    v_fmac_f32 v9, v73, v73
    v_fmac_f32 v8, v74, v74
    v_fmac_f32 v9, v75, v75
    v_fmac_f32 v8, v76, v76
    v_fmac_f32 v9, v77, v77
    v_fmac_f32 v8, v78, v78
    v_fmac_f32 v9, v79, v79
    v_fmac_f32 v8, v80, v80
    v_fmac_f32 v9, v81, v81
    v_fmac_f32 v8, v82, v82
    v_fmac_f32 v9, v83, v83
    v_fmac_f32 v8, v84, v84
    v_fmac_f32 v9, v85, v85
    v_fmac_f32 v8, v86, v86
    v_fmac_f32 v9, v87, v87
    v_fmac_f32 v8, v88, v88
    v_fmac_f32 v9, v89, v89
    v_fmac_f32 v8, v90, v90
    v_fmac_f32 v9, v91, v91
    v_fmac_f32 v8, v92, v92
    v_fmac_f32 v9, v93, v93
    v_fmac_f32 v8, v94, v94
    v_fmac_f32 v9, v95, v95
    v_fmac_f32 v8, v96, v96
    v_fmac_f32 v9, v97, v97
    v_fmac_f32 v8, v98, v98
    v_fmac_f32 v9, v99, v99
    v_fmac_f32 v8, v100, v100
    v_fmac_f32 v9, v101, v101
    v_fmac_f32 v8, v102, v102
    v_fmac_f32 v9, v103, v103
    v_fmac_f32 v8, v104, v104
    v_fmac_f32 v9, v105, v105
    v_fmac_f32 v8, v106, v106
    v_fmac_f32 v9, v107, v107
    v_fmac_f32 v8, v108, v108
    v_fmac_f32 v9, v109, v109
    v_fmac_f32 v8, v110, v110
    v_fmac_f32 v9, v111, v111
    v_fmac_f32 v8, v112, v112
    v_fmac_f32 v9, v113, v113
    v_fmac_f32 v8, v114, v114
    v_fmac_f32 v9, v115, v115
    v_fmac_f32 v8, v116, v116
    v_fmac_f32 v9, v117, v117
    v_fmac_f32 v8, v118, v118
    v_fmac_f32 v9, v119, v119
    v_fmac_f32 v8, v120, v120
    v_fmac_f32 v9, v121, v121
    v_fmac_f32 v8, v122, v122
    v_fmac_f32 v9, v123, v123
    v_fmac_f32 v8, v124, v124
    v_fmac_f32 v9, v125, v125
    v_fmac_f32 v8, v126, v126
    v_fmac_f32 v9, v127, v127
    v_add_f32 v8, v8, v9
    s_nop 1
    v_add_f32_dpp v8, v8, v8 row_ror:8 row_mask:0xf bank_mask:0xf
    v_mov_b32 v9, v8
    s_nop 1
    v_permlane16_swap_b32 v8, v9
    v_add_f32 v8, v8, v9
    v_mov_b32 v9, v8
    s_nop 1
    v_permlane32_swap_b32 v8, v9
    v_add_f32 v8, v8, v9
    v_mov_b32 v9, 0x3727c5ac
    v_fmac_f32 v9, 0x3b000000, v8
    v_rsq_f32 v8, v9
    s_cmp_lg_u32 s98, 0
    s_cbranch_scc1 Lcf_42
    s_cmp_lg_u32 s9, 0
    s_cbranch_scc1 Lcf_43
    s_mov_b32 s60, 0
    s_lshr_b32 s94, s2, 2
    s_and_b32 s95, s2, 3
Lcf_44:
    v_mbcnt_lo_u32_b32 v12, -1, 0
    v_mbcnt_hi_u32_b32 v12, -1, v12
    v_lshlrev_b32 v12, 2, v12
    global_load_dword v13, v12, s[6:7] sc1
    s_add_u32 s60, s60, 1
    s_cmp_gt_u32 s60, 300000
    s_cbranch_scc1 Lfail
    s_cmp_lg_u32 s60, 64
    s_cbranch_scc1 Lcf_47
    s_cmp_eq_u32 s100, 0
    s_cbranch_scc1 Lcf_47
    s_memtime s[88:89]
    s_memrealtime s[90:91]
    s_waitcnt lgkmcnt(0)
    s_lshr_b32 s89, s88, 4
    s_xor_b32 s88, s88, s89
    s_lshr_b32 s89, s88, 9
    s_xor_b32 s88, s88, s89
    s_xor_b32 s88, s88, s90
    s_lshr_b32 s89, s90, 5
    s_xor_b32 s88, s88, s89
    s_and_b32 s88, s88, 15
    s_lshl_b32 s88, s88, 3
    s_or_b32 s88, s88, s100
    s_or_b32 s88, s88, 0x80
    v_mov_b32 v14, s2
    v_mov_b32 v15, s88
    s_mov_b64 exec, 1
    global_store_byte v14, v15, s[6:7] sc1
    s_mov_b64 exec, -1
Lcf_47:
    s_waitcnt vmcnt(0)
    v_and_b32 v14, 0x80808080, v13
    v_cmp_ne_u32 vcc, 0x80808080, v14
    s_nop 0
    s_cmp_eq_u64 vcc, 0
    s_cselect_b32 s93, 8, 1
    s_mov_b32 s85, 0x80
Lcf_45:
    s_mov_b32 s86, 0
    s_mov_b32 s87, 0
    s_mov_b32 s84, 0
    v_bfe_u32 v14, v13, 0, 8
    v_and_b32 v15, 0x87, v14
    v_cmp_eq_u32 vcc, s85, v15
    s_nop 0
    s_bcnt1_i32_b64 s88, vcc
    s_add_u32 s86, s86, s88
    s_cmp_gt_u32 s95, 0
    s_cselect_b32 s88, 1, 0
    s_add_u32 s88, s88, s94
    s_bfm_b64 s[90:91], s88, 0
    s_cmp_eq_u32 s88, 64
    s_cselect_b64 s[90:91], -1, s[90:91]
    s_and_b64 s[90:91], s[90:91], vcc
    s_bcnt1_i32_b64 s88, s[90:91]
    s_add_u32 s87, s87, s88
    v_cndmask_b32 v14, 0, v14, vcc
    v_bfe_u32 v15, v14, 3, 1
    v_cmp_ne_u32 s[90:91], 0, v15
    s_mul_i32 s84, s84, 0x9e3779b1
    s_xor_b32 s84, s84, s90
    s_mul_i32 s84, s84, 0x85ebca6b
    s_add_u32 s84, s84, s91
    v_bfe_u32 v15, v14, 4, 1
    v_cmp_ne_u32 s[90:91], 0, v15
    s_mul_i32 s84, s84, 0x9e3779b1
    s_xor_b32 s84, s84, s90
    s_mul_i32 s84, s84, 0x85ebca6b
    s_add_u32 s84, s84, s91
    v_bfe_u32 v15, v14, 5, 1
    v_cmp_ne_u32 s[90:91], 0, v15
    s_mul_i32 s84, s84, 0x9e3779b1
    s_xor_b32 s84, s84, s90
    s_mul_i32 s84, s84, 0x85ebca6b
    s_add_u32 s84, s84, s91
    v_bfe_u32 v15, v14, 6, 1
    v_cmp_ne_u32 s[90:91], 0, v15
    s_mul_i32 s84, s84, 0x9e3779b1
    s_xor_b32 s84, s84, s90
    s_mul_i32 s84, s84, 0x85ebca6b
    s_add_u32 s84, s84, s91
    v_bfe_u32 v14, v13, 8, 8
    v_and_b32 v15, 0x87, v14
    v_cmp_eq_u32 vcc, s85, v15
    s_nop 0
    s_bcnt1_i32_b64 s88, vcc
    s_add_u32 s86, s86, s88
    s_cmp_gt_u32 s95, 1
    s_cselect_b32 s88, 1, 0
    s_add_u32 s88, s88, s94
    s_bfm_b64 s[90:91], s88, 0
    s_cmp_eq_u32 s88, 64
    s_cselect_b64 s[90:91], -1, s[90:91]
    s_and_b64 s[90:91], s[90:91], vcc
    s_bcnt1_i32_b64 s88, s[90:91]
    s_add_u32 s87, s87, s88
    v_cndmask_b32 v14, 0, v14, vcc
    v_bfe_u32 v15, v14, 3, 1
    v_cmp_ne_u32 s[90:91], 0, v15
    s_mul_i32 s84, s84, 0x9e3779b1
    s_xor_b32 s84, s84, s90
    s_mul_i32 s84, s84, 0x85ebca6b
    s_add_u32 s84, s84, s91
    v_bfe_u32 v15, v14, 4, 1
    v_cmp_ne_u32 s[90:91], 0, v15
    s_mul_i32 s84, s84, 0x9e3779b1
    s_xor_b32 s84, s84, s90
    s_mul_i32 s84, s84, 0x85ebca6b
    s_add_u32 s84, s84, s91
    v_bfe_u32 v15, v14, 5, 1
    v_cmp_ne_u32 s[90:91], 0, v15
    s_mul_i32 s84, s84, 0x9e3779b1
    s_xor_b32 s84, s84, s90
    s_mul_i32 s84, s84, 0x85ebca6b
    s_add_u32 s84, s84, s91
    v_bfe_u32 v15, v14, 6, 1
    v_cmp_ne_u32 s[90:91], 0, v15
    s_mul_i32 s84, s84, 0x9e3779b1
    s_xor_b32 s84, s84, s90
    s_mul_i32 s84, s84, 0x85ebca6b
    s_add_u32 s84, s84, s91
    v_bfe_u32 v14, v13, 16, 8
    v_and_b32 v15, 0x87, v14
    v_cmp_eq_u32 vcc, s85, v15
    s_nop 0
    s_bcnt1_i32_b64 s88, vcc
    s_add_u32 s86, s86, s88
    s_cmp_gt_u32 s95, 2
    s_cselect_b32 s88, 1, 0
    s_add_u32 s88, s88, s94
    s_bfm_b64 s[90:91], s88, 0
    s_cmp_eq_u32 s88, 64
    s_cselect_b64 s[90:91], -1, s[90:91]
    s_and_b64 s[90:91], s[90:91], vcc
    s_bcnt1_i32_b64 s88, s[90:91]
    s_add_u32 s87, s87, s88
    v_cndmask_b32 v14, 0, v14, vcc
    v_bfe_u32 v15, v14, 3, 1
    v_cmp_ne_u32 s[90:91], 0, v15
    s_mul_i32 s84, s84, 0x9e3779b1
    s_xor_b32 s84, s84, s90
    s_mul_i32 s84, s84, 0x85ebca6b
    s_add_u32 s84, s84, s91
    v_bfe_u32 v15, v14, 4, 1
    v_cmp_ne_u32 s[90:91], 0, v15
    s_mul_i32 s84, s84, 0x9e3779b1
    s_xor_b32 s84, s84, s90
    s_mul_i32 s84, s84, 0x85ebca6b
    s_add_u32 s84, s84, s91
    v_bfe_u32 v15, v14, 5, 1
    v_cmp_ne_u32 s[90:91], 0, v15
    s_mul_i32 s84, s84, 0x9e3779b1
    s_xor_b32 s84, s84, s90
    s_mul_i32 s84, s84, 0x85ebca6b
    s_add_u32 s84, s84, s91
    v_bfe_u32 v15, v14, 6, 1
    v_cmp_ne_u32 s[90:91], 0, v15
    s_mul_i32 s84, s84, 0x9e3779b1
    s_xor_b32 s84, s84, s90
    s_mul_i32 s84, s84, 0x85ebca6b
    s_add_u32 s84, s84, s91
    v_bfe_u32 v14, v13, 24, 8
    v_and_b32 v15, 0x87, v14
    v_cmp_eq_u32 vcc, s85, v15
    s_nop 0
    s_bcnt1_i32_b64 s88, vcc
    s_add_u32 s86, s86, s88
    s_cmp_gt_u32 s95, 3
    s_cselect_b32 s88, 1, 0
    s_add_u32 s88, s88, s94
    s_bfm_b64 s[90:91], s88, 0
    s_cmp_eq_u32 s88, 64
    s_cselect_b64 s[90:91], -1, s[90:91]
    s_and_b64 s[90:91], s[90:91], vcc
    s_bcnt1_i32_b64 s88, s[90:91]
    s_add_u32 s87, s87, s88
    v_cndmask_b32 v14, 0, v14, vcc
    v_bfe_u32 v15, v14, 3, 1
    v_cmp_ne_u32 s[90:91], 0, v15
    s_mul_i32 s84, s84, 0x9e3779b1
    s_xor_b32 s84, s84, s90
    s_mul_i32 s84, s84, 0x85ebca6b
    s_add_u32 s84, s84, s91
    v_bfe_u32 v15, v14, 4, 1
    v_cmp_ne_u32 s[90:91], 0, v15
    s_mul_i32 s84, s84, 0x9e3779b1
    s_xor_b32 s84, s84, s90
    s_mul_i32 s84, s84, 0x85ebca6b
    s_add_u32 s84, s84, s91
    v_bfe_u32 v15, v14, 5, 1
    v_cmp_ne_u32 s[90:91], 0, v15
    s_mul_i32 s84, s84, 0x9e3779b1
    s_xor_b32 s84, s84, s90
    s_mul_i32 s84, s84, 0x85ebca6b
    s_add_u32 s84, s84, s91
    v_bfe_u32 v15, v14, 6, 1
    v_cmp_ne_u32 s[90:91], 0, v15
    s_mul_i32 s84, s84, 0x9e3779b1
    s_xor_b32 s84, s84, s90
    s_mul_i32 s84, s84, 0x85ebca6b
    s_add_u32 s84, s84, s91
    s_cmp_ge_u32 s86, 32
    s_cbranch_scc1 Lcf_46
    s_add_u32 s85, s85, 1
    s_and_b32 s88, s85, 15
    s_cmp_lt_u32 s88, s93
    s_cbranch_scc1 Lcf_45
    s_branch Lcf_44
Lcf_46:
    s_or_b32 s84, s84, 1
    s_and_b32 s85, s85, 7
    s_min_u32 s88, s87, 32
    s_sub_u32 s88, s2, s88
    s_add_u32 s88, s88, 32
    s_cmp_lt_u32 s87, 32
    s_cselect_b32 s89, s87, s88
    s_cmp_eq_u32 s85, s100
    s_cselect_b32 s89, s89, s88
    v_mov_b32 v14, s84
    v_mov_b32 v15, s89
    v_mov_b32 v12, 163824
    ds_write_b64 v12, v[14:15]
    s_waitcnt lgkmcnt(0)
Lcf_43:
    s_barrier
    v_mov_b32 v12, 163824
    ds_read_b64 v[14:15], v12
    s_waitcnt lgkmcnt(0)
    v_readfirstlane_b32 s97, v14
    v_readfirstlane_b32 s89, v15
    s_mov_b32 s98, 1
    s_nop 3
    s_cmp_eq_u32 s89, s99
    s_cbranch_scc1 Lcf_42
    s_mov_b32 s99, s89
    s_waitcnt vmcnt(0)
    s_barrier
    s_branch Lstart
Lcf_42:
    v_and_b32 v12, 63, v0
    v_lshlrev_b32 v12, 6, v12
    v_add_u32 v12, 491552, v12
    s_mov_b32 s60, 0
    s_mov_b64 exec, -1
    global_load_dword v13, v12, s[4:5] sc1
    s_waitcnt vmcnt(0)
    v_cmp_ne_u32 vcc, s97, v13
    s_cbranch_vccz Lwf_50
    global_load_dword v13, v12, s[4:5] sc1
    s_sleep 2
Lwf_49:
    global_load_dword v13, v12, s[4:5] sc1
    s_add_u32 s60, s60, 1
    s_cmp_gt_u32 s60, 1000000
    s_cbranch_scc1 Lfail
    s_waitcnt vmcnt(1)
    v_cmp_ne_u32 vcc, s97, v13
    s_cbranch_vccz Lwf_50
    s_sleep 1
    s_branch Lwf_49
Lwf_50:
    s_mov_b64 exec, -1
    global_load_dwordx4 v[160:163], v6, s[4:5] offset:0 sc1
    global_load_dwordx4 v[128:131], v6, s[4:5] offset:2048 sc1
    global_load_dwordx4 v[164:167], v6, s[4:5] offset:256 sc1
    global_load_dwordx4 v[132:135], v6, s[4:5] offset:2304 sc1
    global_load_dwordx4 v[168:171], v6, s[4:5] offset:512 sc1
    global_load_dwordx4 v[136:139], v6, s[4:5] offset:2560 sc1
    global_load_dwordx4 v[172:175], v6, s[4:5] offset:768 sc1
    global_load_dwordx4 v[140:143], v6, s[4:5] offset:2816 sc1
    global_load_dwordx4 v[176:179], v6, s[4:5] offset:1024 sc1
    global_load_dwordx4 v[144:147], v6, s[4:5] offset:3072 sc1
    global_load_dwordx4 v[180:183], v6, s[4:5] offset:1280 sc1
    global_load_dwordx4 v[148:151], v6, s[4:5] offset:3328 sc1
    global_load_dwordx4 v[184:187], v6, s[4:5] offset:1536 sc1
    global_load_dwordx4 v[152:155], v6, s[4:5] offset:3584 sc1
    global_load_dwordx4 v[188:191], v6, s[4:5] offset:1792 sc1
    global_load_dwordx4 v[156:159], v6, s[4:5] offset:3840 sc1
    v_mul_f32 v64, v64, v8
    v_mul_f32 v65, v65, v8
    v_mul_f32 v66, v66, v8
    v_mul_f32 v67, v67, v8
    v_mul_f32 v68, v68, v8
    v_mul_f32 v69, v69, v8
    v_mul_f32 v70, v70, v8
    v_mul_f32 v71, v71, v8
    v_mul_f32 v72, v72, v8
    v_mul_f32 v73, v73, v8
    v_mul_f32 v74, v74, v8
    v_mul_f32 v75, v75, v8
    v_mul_f32 v76, v76, v8
    v_mul_f32 v77, v77, v8
    v_mul_f32 v78, v78, v8
    v_mul_f32 v79, v79, v8
    v_mul_f32 v80, v80, v8
    v_mul_f32 v81, v81, v8
    v_mul_f32 v82, v82, v8
    v_mul_f32 v83, v83, v8
    v_mul_f32 v84, v84, v8
    v_mul_f32 v85, v85, v8
    v_mul_f32 v86, v86, v8
    v_mul_f32 v87, v87, v8
    v_mul_f32 v88, v88, v8
    v_mul_f32 v89, v89, v8
    v_mul_f32 v90, v90, v8
    v_mul_f32 v91, v91, v8
    v_mul_f32 v92, v92, v8
    v_mul_f32 v93, v93, v8
    v_mul_f32 v94, v94, v8
    v_mul_f32 v95, v95, v8
    v_mul_f32 v96, v96, v8
    v_mul_f32 v97, v97, v8
    v_mul_f32 v98, v98, v8
    v_mul_f32 v99, v99, v8
    v_mul_f32 v100, v100, v8
    v_mul_f32 v101, v101, v8
    v_mul_f32 v102, v102, v8
    v_mul_f32 v103, v103, v8
    v_mul_f32 v104, v104, v8
    v_mul_f32 v105, v105, v8
    v_mul_f32 v106, v106, v8
    v_mul_f32 v107, v107, v8
    v_mul_f32 v108, v108, v8
    v_mul_f32 v109, v109, v8
    v_mul_f32 v110, v110, v8
    v_mul_f32 v111, v111, v8
    v_mul_f32 v112, v112, v8
    v_mul_f32 v113, v113, v8
    v_mul_f32 v114, v114, v8
    v_mul_f32 v115, v115, v8
    v_mul_f32 v116, v116, v8
    v_mul_f32 v117, v117, v8
    v_mul_f32 v118, v118, v8
    v_mul_f32 v119, v119, v8
    v_mul_f32 v120, v120, v8
    v_mul_f32 v121, v121, v8
    v_mul_f32 v122, v122, v8
    v_mul_f32 v123, v123, v8
    v_mul_f32 v124, v124, v8
    v_mul_f32 v125, v125, v8
    v_mul_f32 v126, v126, v8
    v_mul_f32 v127, v127, v8
    s_waitcnt vmcnt(14)
    v_lshlrev_b32 v16, 16, v160
    v_and_b32 v17, 0xffff0000, v160
    v_lshlrev_b32 v18, 16, v161
    v_and_b32 v19, 0xffff0000, v161
    v_lshlrev_b32 v20, 16, v162
    v_and_b32 v21, 0xffff0000, v162
    v_lshlrev_b32 v22, 16, v163
    v_and_b32 v23, 0xffff0000, v163
    v_lshlrev_b32 v24, 16, v128
    v_and_b32 v25, 0xffff0000, v128
    v_lshlrev_b32 v26, 16, v129
    v_and_b32 v27, 0xffff0000, v129
    v_lshlrev_b32 v28, 16, v130
    v_and_b32 v29, 0xffff0000, v130
    v_lshlrev_b32 v30, 16, v131
    v_and_b32 v31, 0xffff0000, v131
    v_fma_f32 v64, v64, v24, v16
    v_fma_f32 v65, v65, v25, v17
    v_fma_f32 v66, v66, v26, v18
    v_fma_f32 v67, v67, v27, v19
    v_fma_f32 v68, v68, v28, v20
    v_fma_f32 v69, v69, v29, v21
    v_fma_f32 v70, v70, v30, v22
    v_fma_f32 v71, v71, v31, v23
    v_cvt_pk_bf16_f32 v160, v64, v65
    v_cvt_pk_bf16_f32 v161, v66, v67
    v_cvt_pk_bf16_f32 v162, v68, v69
    v_cvt_pk_bf16_f32 v163, v70, v71
    global_store_dwordx4 v5, v[160:163], s[4:5] sc1
    v_add_u32 v5, 4096, v5
    s_waitcnt vmcnt(13)
    v_lshlrev_b32 v16, 16, v164
    v_and_b32 v17, 0xffff0000, v164
    v_lshlrev_b32 v18, 16, v165
    v_and_b32 v19, 0xffff0000, v165
    v_lshlrev_b32 v20, 16, v166
    v_and_b32 v21, 0xffff0000, v166
    v_lshlrev_b32 v22, 16, v167
    v_and_b32 v23, 0xffff0000, v167
    v_lshlrev_b32 v24, 16, v132
    v_and_b32 v25, 0xffff0000, v132
    v_lshlrev_b32 v26, 16, v133
    v_and_b32 v27, 0xffff0000, v133
    v_lshlrev_b32 v28, 16, v134
    v_and_b32 v29, 0xffff0000, v134
    v_lshlrev_b32 v30, 16, v135
    v_and_b32 v31, 0xffff0000, v135
    v_fma_f32 v72, v72, v24, v16
    v_fma_f32 v73, v73, v25, v17
    v_fma_f32 v74, v74, v26, v18
    v_fma_f32 v75, v75, v27, v19
    v_fma_f32 v76, v76, v28, v20
    v_fma_f32 v77, v77, v29, v21
    v_fma_f32 v78, v78, v30, v22
    v_fma_f32 v79, v79, v31, v23
    v_cvt_pk_bf16_f32 v164, v72, v73
    v_cvt_pk_bf16_f32 v165, v74, v75
    v_cvt_pk_bf16_f32 v166, v76, v77
    v_cvt_pk_bf16_f32 v167, v78, v79
    global_store_dwordx4 v5, v[164:167], s[4:5] sc1
    v_add_u32 v5, 4096, v5
    s_waitcnt vmcnt(12)
    v_lshlrev_b32 v16, 16, v168
    v_and_b32 v17, 0xffff0000, v168
    v_lshlrev_b32 v18, 16, v169
    v_and_b32 v19, 0xffff0000, v169
    v_lshlrev_b32 v20, 16, v170
    v_and_b32 v21, 0xffff0000, v170
    v_lshlrev_b32 v22, 16, v171
    v_and_b32 v23, 0xffff0000, v171
    v_lshlrev_b32 v24, 16, v136
    v_and_b32 v25, 0xffff0000, v136
    v_lshlrev_b32 v26, 16, v137
    v_and_b32 v27, 0xffff0000, v137
    v_lshlrev_b32 v28, 16, v138
    v_and_b32 v29, 0xffff0000, v138
    v_lshlrev_b32 v30, 16, v139
    v_and_b32 v31, 0xffff0000, v139
    v_fma_f32 v80, v80, v24, v16
    v_fma_f32 v81, v81, v25, v17
    v_fma_f32 v82, v82, v26, v18
    v_fma_f32 v83, v83, v27, v19
    v_fma_f32 v84, v84, v28, v20
    v_fma_f32 v85, v85, v29, v21
    v_fma_f32 v86, v86, v30, v22
    v_fma_f32 v87, v87, v31, v23
    v_cvt_pk_bf16_f32 v168, v80, v81
    v_cvt_pk_bf16_f32 v169, v82, v83
    v_cvt_pk_bf16_f32 v170, v84, v85
    v_cvt_pk_bf16_f32 v171, v86, v87
    global_store_dwordx4 v5, v[168:171], s[4:5] sc1
    v_add_u32 v5, 4096, v5
    s_waitcnt vmcnt(11)
    v_lshlrev_b32 v16, 16, v172
    v_and_b32 v17, 0xffff0000, v172
    v_lshlrev_b32 v18, 16, v173
    v_and_b32 v19, 0xffff0000, v173
    v_lshlrev_b32 v20, 16, v174
    v_and_b32 v21, 0xffff0000, v174
    v_lshlrev_b32 v22, 16, v175
    v_and_b32 v23, 0xffff0000, v175
    v_lshlrev_b32 v24, 16, v140
    v_and_b32 v25, 0xffff0000, v140
    v_lshlrev_b32 v26, 16, v141
    v_and_b32 v27, 0xffff0000, v141
    v_lshlrev_b32 v28, 16, v142
    v_and_b32 v29, 0xffff0000, v142
    v_lshlrev_b32 v30, 16, v143
    v_and_b32 v31, 0xffff0000, v143
    v_fma_f32 v88, v88, v24, v16
    v_fma_f32 v89, v89, v25, v17
    v_fma_f32 v90, v90, v26, v18
    v_fma_f32 v91, v91, v27, v19
    v_fma_f32 v92, v92, v28, v20
    v_fma_f32 v93, v93, v29, v21
    v_fma_f32 v94, v94, v30, v22
    v_fma_f32 v95, v95, v31, v23
    v_cvt_pk_bf16_f32 v172, v88, v89
    v_cvt_pk_bf16_f32 v173, v90, v91
    v_cvt_pk_bf16_f32 v174, v92, v93
    v_cvt_pk_bf16_f32 v175, v94, v95
    global_store_dwordx4 v5, v[172:175], s[4:5] sc1
    v_add_u32 v5, 4096, v5
    s_waitcnt vmcnt(10)
    v_lshlrev_b32 v16, 16, v176
    v_and_b32 v17, 0xffff0000, v176
    v_lshlrev_b32 v18, 16, v177
    v_and_b32 v19, 0xffff0000, v177
    v_lshlrev_b32 v20, 16, v178
    v_and_b32 v21, 0xffff0000, v178
    v_lshlrev_b32 v22, 16, v179
    v_and_b32 v23, 0xffff0000, v179
    v_lshlrev_b32 v24, 16, v144
    v_and_b32 v25, 0xffff0000, v144
    v_lshlrev_b32 v26, 16, v145
    v_and_b32 v27, 0xffff0000, v145
    v_lshlrev_b32 v28, 16, v146
    v_and_b32 v29, 0xffff0000, v146
    v_lshlrev_b32 v30, 16, v147
    v_and_b32 v31, 0xffff0000, v147
    v_fma_f32 v96, v96, v24, v16
    v_fma_f32 v97, v97, v25, v17
    v_fma_f32 v98, v98, v26, v18
    v_fma_f32 v99, v99, v27, v19
    v_fma_f32 v100, v100, v28, v20
    v_fma_f32 v101, v101, v29, v21
    v_fma_f32 v102, v102, v30, v22
    v_fma_f32 v103, v103, v31, v23
    v_cvt_pk_bf16_f32 v176, v96, v97
    v_cvt_pk_bf16_f32 v177, v98, v99
    v_cvt_pk_bf16_f32 v178, v100, v101
    v_cvt_pk_bf16_f32 v179, v102, v103
    global_store_dwordx4 v5, v[176:179], s[4:5] sc1
    v_add_u32 v5, 4096, v5
    s_waitcnt vmcnt(9)
    v_lshlrev_b32 v16, 16, v180
    v_and_b32 v17, 0xffff0000, v180
    v_lshlrev_b32 v18, 16, v181
    v_and_b32 v19, 0xffff0000, v181
    v_lshlrev_b32 v20, 16, v182
    v_and_b32 v21, 0xffff0000, v182
    v_lshlrev_b32 v22, 16, v183
    v_and_b32 v23, 0xffff0000, v183
    v_lshlrev_b32 v24, 16, v148
    v_and_b32 v25, 0xffff0000, v148
    v_lshlrev_b32 v26, 16, v149
    v_and_b32 v27, 0xffff0000, v149
    v_lshlrev_b32 v28, 16, v150
    v_and_b32 v29, 0xffff0000, v150
    v_lshlrev_b32 v30, 16, v151
    v_and_b32 v31, 0xffff0000, v151
    v_fma_f32 v104, v104, v24, v16
    v_fma_f32 v105, v105, v25, v17
    v_fma_f32 v106, v106, v26, v18
    v_fma_f32 v107, v107, v27, v19
    v_fma_f32 v108, v108, v28, v20
    v_fma_f32 v109, v109, v29, v21
    v_fma_f32 v110, v110, v30, v22
    v_fma_f32 v111, v111, v31, v23
    v_cvt_pk_bf16_f32 v180, v104, v105
    v_cvt_pk_bf16_f32 v181, v106, v107
    v_cvt_pk_bf16_f32 v182, v108, v109
    v_cvt_pk_bf16_f32 v183, v110, v111
    global_store_dwordx4 v5, v[180:183], s[4:5] sc1
    v_add_u32 v5, 4096, v5
    s_waitcnt vmcnt(8)
    v_lshlrev_b32 v16, 16, v184
    v_and_b32 v17, 0xffff0000, v184
    v_lshlrev_b32 v18, 16, v185
    v_and_b32 v19, 0xffff0000, v185
    v_lshlrev_b32 v20, 16, v186
    v_and_b32 v21, 0xffff0000, v186
    v_lshlrev_b32 v22, 16, v187
    v_and_b32 v23, 0xffff0000, v187
    v_lshlrev_b32 v24, 16, v152
    v_and_b32 v25, 0xffff0000, v152
    v_lshlrev_b32 v26, 16, v153
    v_and_b32 v27, 0xffff0000, v153
    v_lshlrev_b32 v28, 16, v154
    v_and_b32 v29, 0xffff0000, v154
    v_lshlrev_b32 v30, 16, v155
    v_and_b32 v31, 0xffff0000, v155
    v_fma_f32 v112, v112, v24, v16
    v_fma_f32 v113, v113, v25, v17
    v_fma_f32 v114, v114, v26, v18
    v_fma_f32 v115, v115, v27, v19
    v_fma_f32 v116, v116, v28, v20
    v_fma_f32 v117, v117, v29, v21
    v_fma_f32 v118, v118, v30, v22
    v_fma_f32 v119, v119, v31, v23
    v_cvt_pk_bf16_f32 v184, v112, v113
    v_cvt_pk_bf16_f32 v185, v114, v115
    v_cvt_pk_bf16_f32 v186, v116, v117
    v_cvt_pk_bf16_f32 v187, v118, v119
    global_store_dwordx4 v5, v[184:187], s[4:5] sc1
    v_add_u32 v5, 4096, v5
    s_waitcnt vmcnt(7)
    v_lshlrev_b32 v16, 16, v188
    v_and_b32 v17, 0xffff0000, v188
    v_lshlrev_b32 v18, 16, v189
    v_and_b32 v19, 0xffff0000, v189
    v_lshlrev_b32 v20, 16, v190
    v_and_b32 v21, 0xffff0000, v190
    v_lshlrev_b32 v22, 16, v191
    v_and_b32 v23, 0xffff0000, v191
    v_lshlrev_b32 v24, 16, v156
    v_and_b32 v25, 0xffff0000, v156
    v_lshlrev_b32 v26, 16, v157
    v_and_b32 v27, 0xffff0000, v157
    v_lshlrev_b32 v28, 16, v158
    v_and_b32 v29, 0xffff0000, v158
    v_lshlrev_b32 v30, 16, v159
    v_and_b32 v31, 0xffff0000, v159
    v_fma_f32 v120, v120, v24, v16
    v_fma_f32 v121, v121, v25, v17
    v_fma_f32 v122, v122, v26, v18
    v_fma_f32 v123, v123, v27, v19
    v_fma_f32 v124, v124, v28, v20
    v_fma_f32 v125, v125, v29, v21
    v_fma_f32 v126, v126, v30, v22
    v_fma_f32 v127, v127, v31, v23
    v_cvt_pk_bf16_f32 v188, v120, v121
    v_cvt_pk_bf16_f32 v189, v122, v123
    v_cvt_pk_bf16_f32 v190, v124, v125
    v_cvt_pk_bf16_f32 v191, v126, v127
    global_store_dwordx4 v5, v[188:191], s[4:5] sc1
    s_waitcnt vmcnt(0)
    s_barrier
    s_cmp_lg_u32 s9, 0
    s_cbranch_scc1 Lln_51
    s_lshl_b32 s45, s3, 5
    s_add_u32 s45, s45, 127598592
    v_mov_b32 v5, s45
    v_mov_b32 v6, s97
    s_nop 0
    s_mov_b64 exec, 0x1
    global_store_dword v5, v6, s[4:5] offset:0 sc1
    s_mov_b64 exec, -1
Lln_51:
Lp1:
    v_and_b32 v1, 63, v0
    v_lshrrev_b32 v2, 5, v1
    v_lshlrev_b32 v2, 11, v2
    v_bfe_u32 v3, v1, 2, 2
    v_lshl_add_u32 v2, v3, 8, v2
    v_bfe_u32 v4, v1, 4, 1
    v_lshl_add_u32 v2, v4, 5, v2
    v_and_b32 v4, 3, v1
    v_lshl_add_u32 v2, v4, 3, v2
    v_xor_b32 v4, 0, v3
    v_lshl_add_u32 v8, v4, 6, v2
    v_xor_b32 v4, 1, v3
    v_lshl_add_u32 v9, v4, 6, v2
    v_xor_b32 v4, 2, v3
    v_lshl_add_u32 v10, v4, 6, v2
    v_xor_b32 v4, 3, v3
    v_lshl_add_u32 v11, v4, 6, v2
    v_lshrrev_b32 v2, 4, v1
    v_xor_b32 v4, v3, v2
    v_lshlrev_b32 v2, 13, v2
    v_lshl_add_u32 v2, v4, 6, v2
    v_and_b32 v4, 3, v1
    v_lshl_add_u32 v2, v4, 4, v2
    s_lshl_b32 s40, s9, 15
    v_add_u32 v12, s40, v2
    s_lshl_b32 s70, s9, 10
    v_lshlrev_b32 v2, 4, v1
    s_lshl_b32 s40, s9, 15
    v_add_u32 v13, s40, v2
    v_lshlrev_b32 v17, 4, v1
    v_bfe_u32 v2, v1, 3, 1
    v_lshlrev_b32 v2, 12, v2
    v_lshrrev_b32 v3, 5, v1
    v_lshl_add_u32 v2, v3, 8, v2
    v_bfe_u32 v4, v1, 4, 1
    v_lshl_add_u32 v2, v4, 7, v2
    v_and_b32 v4, 7, v1
    v_lshl_add_u32 v14, v4, 4, v2
    v_and_b32 v4, 15, v1
    v_lshlrev_b32 v4, 4, v4
    v_lshl_add_u32 v15, v3, 8, v4
    v_bfe_u32 v16, v1, 4, 1
    s_cmp_lt_u32 s96, 2
    s_cbranch_scc1 Lnohold
    s_cmp_lg_u32 s96, 4
    s_cbranch_scc1 Lnowarm
    s_load_dwordx2 s[52:53], s[0:1], 40
    v_lshlrev_b32 v2, 6, v0
    s_lshl_b32 s49, s8, 17
    v_add_u32 v2, s49, v2
    s_waitcnt lgkmcnt(0)
    global_load_dword v48, v2, s[52:53]
    v_add_u32 v2, 16384, v2
    global_load_dword v48, v2, s[52:53]
    v_add_u32 v2, 16384, v2
    global_load_dword v48, v2, s[52:53]
    v_add_u32 v2, 16384, v2
    global_load_dword v48, v2, s[52:53]
    v_add_u32 v2, 16384, v2
    global_load_dword v48, v2, s[52:53]
    v_add_u32 v2, 16384, v2
    global_load_dword v48, v2, s[52:53]
    v_add_u32 v2, 16384, v2
    global_load_dword v48, v2, s[52:53]
    v_add_u32 v2, 16384, v2
    global_load_dword v48, v2, s[52:53]
Lnowarm:
    s_lshl_b32 s40, s8, 10
    s_add_u32 s40, s40, 127533056
    v_and_b32 v2, 3, v0
    v_lshlrev_b32 v2, 2, v2
    v_add_u32 v2, s40, v2
    s_mov_b32 s60, 0
    s_mov_b64 exec, 0xf
    global_load_dword v3, v2, s[4:5] sc1
    s_waitcnt vmcnt(0)
    v_cmp_ne_u32 vcc, s97, v3
    s_cbranch_vccz Lwf_53
    global_load_dword v3, v2, s[4:5] sc1
    s_sleep 2
Lwf_52:
    global_load_dword v3, v2, s[4:5] sc1
    s_add_u32 s60, s60, 1
    s_cmp_gt_u32 s60, 1000000
    s_cbranch_scc1 Lfail
    s_waitcnt vmcnt(1)
    v_cmp_ne_u32 vcc, s97, v3
    s_cbranch_vccz Lwf_53
    s_sleep 1
    s_branch Lwf_52
Lwf_53:
    s_waitcnt vmcnt(0)
    s_mov_b64 exec, -1
Lnohold:
    s_cmp_lt_u32 s96, 4
    s_cbranch_scc0 Lp3a
    s_lshr_b32 s3, s96, 1
    s_bitcmp1_b32 s96, 0
    s_cbranch_scc1 Lp2
    s_load_dwordx4 s[40:43], s[0:1], 16
    s_load_dwordx2 s[44:45], s[0:1], 32
    s_lshl_b32 s46, s3, 18
    s_add_u32 s66, s4, 1048576
    s_addc_u32 s67, s5, 0
    s_add_u32 s66, s66, s46
    s_addc_u32 s67, s67, 0
    s_lshl_b32 s47, s8, 21
    s_add_u32 s47, s47, s46
    s_lshl_b32 s48, s9, 15
    s_add_u32 s47, s47, s48
    s_add_u32 s47, s47, 4194304
    s_add_u32 s68, s4, s47
    s_addc_u32 s69, s5, 0
    s_lshl_b32 s48, s8, 8
    s_waitcnt lgkmcnt(0)
    s_add_u32 s40, s40, s48
    s_addc_u32 s41, s41, 0
    s_add_u32 s42, s42, s48
    s_addc_u32 s43, s43, 0
    s_add_u32 s44, s44, s48
    s_addc_u32 s45, s45, 0
    s_barrier
    s_cmp_lg_u32 s98, 0
    s_cbranch_scc1 Lcf_54
    s_cmp_lg_u32 s9, 0
    s_cbranch_scc1 Lcf_55
    s_mov_b32 s60, 0
    s_lshr_b32 s94, s2, 2
    s_and_b32 s95, s2, 3
Lcf_56:
    v_mbcnt_lo_u32_b32 v20, -1, 0
    v_mbcnt_hi_u32_b32 v20, -1, v20
    v_lshlrev_b32 v20, 2, v20
    global_load_dword v21, v20, s[6:7] sc1
    s_add_u32 s60, s60, 1
    s_cmp_gt_u32 s60, 300000
    s_cbranch_scc1 Lfail
    s_cmp_lg_u32 s60, 64
    s_cbranch_scc1 Lcf_59
    s_cmp_eq_u32 s100, 0
    s_cbranch_scc1 Lcf_59
    s_memtime s[88:89]
    s_memrealtime s[90:91]
    s_waitcnt lgkmcnt(0)
    s_lshr_b32 s89, s88, 4
    s_xor_b32 s88, s88, s89
    s_lshr_b32 s89, s88, 9
    s_xor_b32 s88, s88, s89
    s_xor_b32 s88, s88, s90
    s_lshr_b32 s89, s90, 5
    s_xor_b32 s88, s88, s89
    s_and_b32 s88, s88, 15
    s_lshl_b32 s88, s88, 3
    s_or_b32 s88, s88, s100
    s_or_b32 s88, s88, 0x80
    v_mov_b32 v22, s2
    v_mov_b32 v23, s88
    s_mov_b64 exec, 1
    global_store_byte v22, v23, s[6:7] sc1
    s_mov_b64 exec, -1
Lcf_59:
    s_waitcnt vmcnt(0)
    v_and_b32 v22, 0x80808080, v21
    v_cmp_ne_u32 vcc, 0x80808080, v22
    s_nop 0
    s_cmp_eq_u64 vcc, 0
    s_cselect_b32 s93, 8, 1
    s_mov_b32 s85, 0x80
Lcf_57:
    s_mov_b32 s86, 0
    s_mov_b32 s87, 0
    s_mov_b32 s84, 0
    v_bfe_u32 v22, v21, 0, 8
    v_and_b32 v23, 0x87, v22
    v_cmp_eq_u32 vcc, s85, v23
    s_nop 0
    s_bcnt1_i32_b64 s88, vcc
    s_add_u32 s86, s86, s88
    s_cmp_gt_u32 s95, 0
    s_cselect_b32 s88, 1, 0
    s_add_u32 s88, s88, s94
    s_bfm_b64 s[90:91], s88, 0
    s_cmp_eq_u32 s88, 64
    s_cselect_b64 s[90:91], -1, s[90:91]
    s_and_b64 s[90:91], s[90:91], vcc
    s_bcnt1_i32_b64 s88, s[90:91]
    s_add_u32 s87, s87, s88
    v_cndmask_b32 v22, 0, v22, vcc
    v_bfe_u32 v23, v22, 3, 1
    v_cmp_ne_u32 s[90:91], 0, v23
    s_mul_i32 s84, s84, 0x9e3779b1
    s_xor_b32 s84, s84, s90
    s_mul_i32 s84, s84, 0x85ebca6b
    s_add_u32 s84, s84, s91
    v_bfe_u32 v23, v22, 4, 1
    v_cmp_ne_u32 s[90:91], 0, v23
    s_mul_i32 s84, s84, 0x9e3779b1
    s_xor_b32 s84, s84, s90
    s_mul_i32 s84, s84, 0x85ebca6b
    s_add_u32 s84, s84, s91
    v_bfe_u32 v23, v22, 5, 1
    v_cmp_ne_u32 s[90:91], 0, v23
    s_mul_i32 s84, s84, 0x9e3779b1
    s_xor_b32 s84, s84, s90
    s_mul_i32 s84, s84, 0x85ebca6b
    s_add_u32 s84, s84, s91
    v_bfe_u32 v23, v22, 6, 1
    v_cmp_ne_u32 s[90:91], 0, v23
    s_mul_i32 s84, s84, 0x9e3779b1
    s_xor_b32 s84, s84, s90
    s_mul_i32 s84, s84, 0x85ebca6b
    s_add_u32 s84, s84, s91
    v_bfe_u32 v22, v21, 8, 8
    v_and_b32 v23, 0x87, v22
    v_cmp_eq_u32 vcc, s85, v23
    s_nop 0
    s_bcnt1_i32_b64 s88, vcc
    s_add_u32 s86, s86, s88
    s_cmp_gt_u32 s95, 1
    s_cselect_b32 s88, 1, 0
    s_add_u32 s88, s88, s94
    s_bfm_b64 s[90:91], s88, 0
    s_cmp_eq_u32 s88, 64
    s_cselect_b64 s[90:91], -1, s[90:91]
    s_and_b64 s[90:91], s[90:91], vcc
    s_bcnt1_i32_b64 s88, s[90:91]
    s_add_u32 s87, s87, s88
    v_cndmask_b32 v22, 0, v22, vcc
    v_bfe_u32 v23, v22, 3, 1
    v_cmp_ne_u32 s[90:91], 0, v23
    s_mul_i32 s84, s84, 0x9e3779b1
    s_xor_b32 s84, s84, s90
    s_mul_i32 s84, s84, 0x85ebca6b
    s_add_u32 s84, s84, s91
    v_bfe_u32 v23, v22, 4, 1
    v_cmp_ne_u32 s[90:91], 0, v23
    s_mul_i32 s84, s84, 0x9e3779b1
    s_xor_b32 s84, s84, s90
    s_mul_i32 s84, s84, 0x85ebca6b
    s_add_u32 s84, s84, s91
    v_bfe_u32 v23, v22, 5, 1
    v_cmp_ne_u32 s[90:91], 0, v23
    s_mul_i32 s84, s84, 0x9e3779b1
    s_xor_b32 s84, s84, s90
    s_mul_i32 s84, s84, 0x85ebca6b
    s_add_u32 s84, s84, s91
    v_bfe_u32 v23, v22, 6, 1
    v_cmp_ne_u32 s[90:91], 0, v23
    s_mul_i32 s84, s84, 0x9e3779b1
    s_xor_b32 s84, s84, s90
    s_mul_i32 s84, s84, 0x85ebca6b
    s_add_u32 s84, s84, s91
    v_bfe_u32 v22, v21, 16, 8
    v_and_b32 v23, 0x87, v22
    v_cmp_eq_u32 vcc, s85, v23
    s_nop 0
    s_bcnt1_i32_b64 s88, vcc
    s_add_u32 s86, s86, s88
    s_cmp_gt_u32 s95, 2
    s_cselect_b32 s88, 1, 0
    s_add_u32 s88, s88, s94
    s_bfm_b64 s[90:91], s88, 0
    s_cmp_eq_u32 s88, 64
    s_cselect_b64 s[90:91], -1, s[90:91]
    s_and_b64 s[90:91], s[90:91], vcc
    s_bcnt1_i32_b64 s88, s[90:91]
    s_add_u32 s87, s87, s88
    v_cndmask_b32 v22, 0, v22, vcc
    v_bfe_u32 v23, v22, 3, 1
    v_cmp_ne_u32 s[90:91], 0, v23
    s_mul_i32 s84, s84, 0x9e3779b1
    s_xor_b32 s84, s84, s90
    s_mul_i32 s84, s84, 0x85ebca6b
    s_add_u32 s84, s84, s91
    v_bfe_u32 v23, v22, 4, 1
    v_cmp_ne_u32 s[90:91], 0, v23
    s_mul_i32 s84, s84, 0x9e3779b1
    s_xor_b32 s84, s84, s90
    s_mul_i32 s84, s84, 0x85ebca6b
    s_add_u32 s84, s84, s91
    v_bfe_u32 v23, v22, 5, 1
    v_cmp_ne_u32 s[90:91], 0, v23
    s_mul_i32 s84, s84, 0x9e3779b1
    s_xor_b32 s84, s84, s90
    s_mul_i32 s84, s84, 0x85ebca6b
    s_add_u32 s84, s84, s91
    v_bfe_u32 v23, v22, 6, 1
    v_cmp_ne_u32 s[90:91], 0, v23
    s_mul_i32 s84, s84, 0x9e3779b1
    s_xor_b32 s84, s84, s90
    s_mul_i32 s84, s84, 0x85ebca6b
    s_add_u32 s84, s84, s91
    v_bfe_u32 v22, v21, 24, 8
    v_and_b32 v23, 0x87, v22
    v_cmp_eq_u32 vcc, s85, v23
    s_nop 0
    s_bcnt1_i32_b64 s88, vcc
    s_add_u32 s86, s86, s88
    s_cmp_gt_u32 s95, 3
    s_cselect_b32 s88, 1, 0
    s_add_u32 s88, s88, s94
    s_bfm_b64 s[90:91], s88, 0
    s_cmp_eq_u32 s88, 64
    s_cselect_b64 s[90:91], -1, s[90:91]
    s_and_b64 s[90:91], s[90:91], vcc
    s_bcnt1_i32_b64 s88, s[90:91]
    s_add_u32 s87, s87, s88
    v_cndmask_b32 v22, 0, v22, vcc
    v_bfe_u32 v23, v22, 3, 1
    v_cmp_ne_u32 s[90:91], 0, v23
    s_mul_i32 s84, s84, 0x9e3779b1
    s_xor_b32 s84, s84, s90
    s_mul_i32 s84, s84, 0x85ebca6b
    s_add_u32 s84, s84, s91
    v_bfe_u32 v23, v22, 4, 1
    v_cmp_ne_u32 s[90:91], 0, v23
    s_mul_i32 s84, s84, 0x9e3779b1
    s_xor_b32 s84, s84, s90
    s_mul_i32 s84, s84, 0x85ebca6b
    s_add_u32 s84, s84, s91
    v_bfe_u32 v23, v22, 5, 1
    v_cmp_ne_u32 s[90:91], 0, v23
    s_mul_i32 s84, s84, 0x9e3779b1
    s_xor_b32 s84, s84, s90
    s_mul_i32 s84, s84, 0x85ebca6b
    s_add_u32 s84, s84, s91
    v_bfe_u32 v23, v22, 6, 1
    v_cmp_ne_u32 s[90:91], 0, v23
    s_mul_i32 s84, s84, 0x9e3779b1
    s_xor_b32 s84, s84, s90
    s_mul_i32 s84, s84, 0x85ebca6b
    s_add_u32 s84, s84, s91
    s_cmp_ge_u32 s86, 32
    s_cbranch_scc1 Lcf_58
    s_add_u32 s85, s85, 1
    s_and_b32 s88, s85, 15
    s_cmp_lt_u32 s88, s93
    s_cbranch_scc1 Lcf_57
    s_branch Lcf_56
Lcf_58:
    s_or_b32 s84, s84, 1
    s_and_b32 s85, s85, 7
    s_min_u32 s88, s87, 32
    s_sub_u32 s88, s2, s88
    s_add_u32 s88, s88, 32
    s_cmp_lt_u32 s87, 32
    s_cselect_b32 s89, s87, s88
    s_cmp_eq_u32 s85, s100
    s_cselect_b32 s89, s89, s88
    v_mov_b32 v22, s84
    v_mov_b32 v23, s89
    v_mov_b32 v20, 163824
    ds_write_b64 v20, v[22:23]
    s_waitcnt lgkmcnt(0)
Lcf_55:
    s_barrier
    v_mov_b32 v20, 163824
    ds_read_b64 v[22:23], v20
    s_waitcnt lgkmcnt(0)
    v_readfirstlane_b32 s97, v22
    v_readfirstlane_b32 s89, v23
    s_mov_b32 s98, 1
    s_nop 3
    s_cmp_eq_u32 s89, s99
    s_cbranch_scc1 Lcf_54
    s_mov_b32 s99, s89
    s_waitcnt vmcnt(0)
    s_barrier
    s_branch Lstart
Lcf_54:
    s_add_u32 s71, s70, 0
    s_add_u32 m0, s71, 0
    v_add_u32 v2, 0, v12
    global_load_lds_dwordx4 v2, s[42:43]
    s_add_u32 m0, s71, 4096
    v_add_u32 v3, 131072, v12
    global_load_lds_dwordx4 v3, s[42:43]
    s_add_u32 m0, s71, 8192
    v_add_u32 v2, 262144, v12
    global_load_lds_dwordx4 v2, s[42:43]
    s_add_u32 m0, s71, 12288
    v_add_u32 v3, 393216, v12
    global_load_lds_dwordx4 v3, s[42:43]
    s_add_u32 m0, s71, 16384
    v_add_u32 v2, 524288, v12
    global_load_lds_dwordx4 v2, s[42:43]
    s_add_u32 m0, s71, 20480
    v_add_u32 v3, 655360, v12
    global_load_lds_dwordx4 v3, s[42:43]
    s_add_u32 m0, s71, 24576
    v_add_u32 v2, 786432, v12
    global_load_lds_dwordx4 v2, s[42:43]
    s_add_u32 m0, s71, 28672
    v_add_u32 v3, 917504, v12
    global_load_lds_dwordx4 v3, s[42:43]
    s_add_u32 s71, s70, 32768
    s_add_u32 m0, s71, 0
    v_add_u32 v2, 1048576, v12
    global_load_lds_dwordx4 v2, s[42:43]
    s_add_u32 m0, s71, 4096
    v_add_u32 v3, 1179648, v12
    global_load_lds_dwordx4 v3, s[42:43]
    s_add_u32 m0, s71, 8192
    v_add_u32 v2, 1310720, v12
    global_load_lds_dwordx4 v2, s[42:43]
    s_add_u32 m0, s71, 12288
    v_add_u32 v3, 1441792, v12
    global_load_lds_dwordx4 v3, s[42:43]
    s_add_u32 m0, s71, 16384
    v_add_u32 v2, 1572864, v12
    global_load_lds_dwordx4 v2, s[42:43]
    s_add_u32 m0, s71, 20480
    v_add_u32 v3, 1703936, v12
    global_load_lds_dwordx4 v3, s[42:43]
    s_add_u32 m0, s71, 24576
    v_add_u32 v2, 1835008, v12
    global_load_lds_dwordx4 v2, s[42:43]
    s_add_u32 m0, s71, 28672
    v_add_u32 v3, 1966080, v12
    global_load_lds_dwordx4 v3, s[42:43]
    s_add_u32 s71, s70, 65536
    s_add_u32 m0, s71, 0
    v_add_u32 v2, 2097152, v12
    global_load_lds_dwordx4 v2, s[42:43]
    s_add_u32 m0, s71, 4096
    v_add_u32 v3, 2228224, v12
    global_load_lds_dwordx4 v3, s[42:43]
    s_add_u32 m0, s71, 8192
    v_add_u32 v2, 2359296, v12
    global_load_lds_dwordx4 v2, s[42:43]
    s_add_u32 m0, s71, 12288
    v_add_u32 v3, 2490368, v12
    global_load_lds_dwordx4 v3, s[42:43]
    s_add_u32 m0, s71, 16384
    v_add_u32 v2, 2621440, v12
    global_load_lds_dwordx4 v2, s[42:43]
    s_add_u32 m0, s71, 20480
    v_add_u32 v3, 2752512, v12
    global_load_lds_dwordx4 v3, s[42:43]
    s_add_u32 m0, s71, 24576
    v_add_u32 v2, 2883584, v12
    global_load_lds_dwordx4 v2, s[42:43]
    s_add_u32 m0, s71, 28672
    v_add_u32 v3, 3014656, v12
    global_load_lds_dwordx4 v3, s[42:43]
    s_add_u32 s71, s70, 98304
    s_add_u32 m0, s71, 0
    v_add_u32 v2, 3145728, v12
    global_load_lds_dwordx4 v2, s[42:43]
    s_add_u32 m0, s71, 4096
    v_add_u32 v3, 3276800, v12
    global_load_lds_dwordx4 v3, s[42:43]
    s_add_u32 m0, s71, 8192
    v_add_u32 v2, 3407872, v12
    global_load_lds_dwordx4 v2, s[42:43]
    s_add_u32 m0, s71, 12288
    v_add_u32 v3, 3538944, v12
    global_load_lds_dwordx4 v3, s[42:43]
    s_add_u32 m0, s71, 16384
    v_add_u32 v2, 3670016, v12
    global_load_lds_dwordx4 v2, s[42:43]
    s_add_u32 m0, s71, 20480
    v_add_u32 v3, 3801088, v12
    global_load_lds_dwordx4 v3, s[42:43]
    s_add_u32 m0, s71, 24576
    v_add_u32 v2, 3932160, v12
    global_load_lds_dwordx4 v2, s[42:43]
    s_add_u32 m0, s71, 28672
    v_add_u32 v3, 4063232, v12
    global_load_lds_dwordx4 v3, s[42:43]
    s_cmp_lg_u32 s3, 0
    s_cbranch_scc1 Lwm_61
    v_lshrrev_b32 v2, 2, v0
    v_lshlrev_b32 v2, 13, v2
    v_and_b32 v3, 3, v0
    v_lshl_add_u32 v2, v3, 6, v2
    global_load_dword v48, v2, s[40:41]
    v_add_u32 v2, 524288, v2
    global_load_dword v48, v2, s[40:41]
    v_add_u32 v2, 524288, v2
    global_load_dword v48, v2, s[40:41]
    v_add_u32 v2, 524288, v2
    global_load_dword v48, v2, s[40:41]
    v_add_u32 v2, 524288, v2
    global_load_dword v48, v2, s[40:41]
    v_add_u32 v2, 524288, v2
    global_load_dword v48, v2, s[40:41]
    v_add_u32 v2, 524288, v2
    global_load_dword v48, v2, s[40:41]
    v_add_u32 v2, 524288, v2
    global_load_dword v48, v2, s[40:41]
Lwm_61:
    s_lshl_b32 s49, s8, 10
    s_lshl_b32 s50, s3, 5
    s_add_u32 s49, s49, s50
    s_lshl_b32 s50, s9, 2
    s_add_u32 s49, s49, s50
    s_add_u32 s49, s49, 127533056
    s_add_u32 s74, s4, s49
    s_addc_u32 s75, s5, 0
    s_lshl_b32 s49, s3, 10
    s_lshl_b32 s50, s9, 7
    s_add_u32 s49, s49, s50
    s_add_u32 s49, s49, 127598592
    v_and_b32 v2, 1, v0
    v_lshlrev_b32 v2, 9, v2
    v_add_u32 v2, s49, v2
    s_mov_b32 s60, 0
    s_mov_b64 exec, 0x3
    global_load_dword v19, v2, s[4:5] sc1
    s_waitcnt vmcnt(0)
    v_cmp_ne_u32 vcc, s97, v19
    s_cbranch_vccz Lwf_63
    global_load_dword v19, v2, s[4:5] sc1
    s_sleep 2
Lwf_62:
    global_load_dword v19, v2, s[4:5] sc1
    s_add_u32 s60, s60, 1
    s_cmp_gt_u32 s60, 1000000
    s_cbranch_scc1 Lfail
    s_waitcnt vmcnt(1)
    v_cmp_ne_u32 vcc, s97, v19
    s_cbranch_vccz Lwf_63
    s_sleep 1
    s_branch Lwf_62
Lwf_63:
    s_mov_b64 exec, -1
    v_add_u32 v4, 0, v13
    global_load_dwordx4 a[0:3], v4, s[66:67] offset:0 sc1
    global_load_dwordx4 a[8:11], v4, s[66:67] offset:1024 sc1
    global_load_dwordx4 a[16:19], v4, s[66:67] offset:2048 sc1
    global_load_dwordx4 a[24:27], v4, s[66:67] offset:3072 sc1
    v_add_u32 v4, 4096, v13
    global_load_dwordx4 a[32:35], v4, s[66:67] offset:0 sc1
    global_load_dwordx4 a[40:43], v4, s[66:67] offset:1024 sc1
    global_load_dwordx4 a[48:51], v4, s[66:67] offset:2048 sc1
    global_load_dwordx4 a[56:59], v4, s[66:67] offset:3072 sc1
    v_add_u32 v4, 8192, v13
    global_load_dwordx4 a[64:67], v4, s[66:67] offset:0 sc1
    global_load_dwordx4 a[72:75], v4, s[66:67] offset:1024 sc1
    global_load_dwordx4 a[80:83], v4, s[66:67] offset:2048 sc1
    global_load_dwordx4 a[88:91], v4, s[66:67] offset:3072 sc1
    v_add_u32 v4, 12288, v13
    global_load_dwordx4 a[96:99], v4, s[66:67] offset:0 sc1
    global_load_dwordx4 a[104:107], v4, s[66:67] offset:1024 sc1
    global_load_dwordx4 a[112:115], v4, s[66:67] offset:2048 sc1
    global_load_dwordx4 a[120:123], v4, s[66:67] offset:3072 sc1
    v_add_u32 v4, 16384, v13
    global_load_dwordx4 a[128:131], v4, s[66:67] offset:0 sc1
    global_load_dwordx4 a[136:139], v4, s[66:67] offset:1024 sc1
    global_load_dwordx4 a[144:147], v4, s[66:67] offset:2048 sc1
    global_load_dwordx4 a[152:155], v4, s[66:67] offset:3072 sc1
    v_add_u32 v4, 20480, v13
    global_load_dwordx4 a[160:163], v4, s[66:67] offset:0 sc1
    global_load_dwordx4 a[168:171], v4, s[66:67] offset:1024 sc1
    global_load_dwordx4 a[176:179], v4, s[66:67] offset:2048 sc1
    global_load_dwordx4 a[184:187], v4, s[66:67] offset:3072 sc1
    v_add_u32 v4, 24576, v13
    global_load_dwordx4 a[192:195], v4, s[66:67] offset:0 sc1
    global_load_dwordx4 a[200:203], v4, s[66:67] offset:1024 sc1
    global_load_dwordx4 a[208:211], v4, s[66:67] offset:2048 sc1
    global_load_dwordx4 a[216:219], v4, s[66:67] offset:3072 sc1
    v_add_u32 v4, 28672, v13
    global_load_dwordx4 a[224:227], v4, s[66:67] offset:0 sc1
    global_load_dwordx4 a[232:235], v4, s[66:67] offset:1024 sc1
    global_load_dwordx4 a[240:243], v4, s[66:67] offset:2048 sc1
    global_load_dwordx4 a[248:251], v4, s[66:67] offset:3072 sc1
    v_add_u32 v4, 131072, v13
    global_load_dwordx4 a[4:7], v4, s[66:67] offset:0 sc1
    global_load_dwordx4 a[12:15], v4, s[66:67] offset:1024 sc1
    global_load_dwordx4 a[20:23], v4, s[66:67] offset:2048 sc1
    global_load_dwordx4 a[28:31], v4, s[66:67] offset:3072 sc1
    v_add_u32 v4, 135168, v13
    global_load_dwordx4 a[36:39], v4, s[66:67] offset:0 sc1
    global_load_dwordx4 a[44:47], v4, s[66:67] offset:1024 sc1
    global_load_dwordx4 a[52:55], v4, s[66:67] offset:2048 sc1
    global_load_dwordx4 a[60:63], v4, s[66:67] offset:3072 sc1
    v_add_u32 v4, 139264, v13
    global_load_dwordx4 a[68:71], v4, s[66:67] offset:0 sc1
    global_load_dwordx4 a[76:79], v4, s[66:67] offset:1024 sc1
    global_load_dwordx4 a[84:87], v4, s[66:67] offset:2048 sc1
    global_load_dwordx4 a[92:95], v4, s[66:67] offset:3072 sc1
    v_add_u32 v4, 143360, v13
    global_load_dwordx4 a[100:103], v4, s[66:67] offset:0 sc1
    global_load_dwordx4 a[108:111], v4, s[66:67] offset:1024 sc1
    global_load_dwordx4 a[116:119], v4, s[66:67] offset:2048 sc1
    global_load_dwordx4 a[124:127], v4, s[66:67] offset:3072 sc1
    v_add_u32 v4, 147456, v13
    global_load_dwordx4 a[132:135], v4, s[66:67] offset:0 sc1
    global_load_dwordx4 a[140:143], v4, s[66:67] offset:1024 sc1
    global_load_dwordx4 a[148:151], v4, s[66:67] offset:2048 sc1
    global_load_dwordx4 a[156:159], v4, s[66:67] offset:3072 sc1
    v_add_u32 v4, 151552, v13
    global_load_dwordx4 a[164:167], v4, s[66:67] offset:0 sc1
    global_load_dwordx4 a[172:175], v4, s[66:67] offset:1024 sc1
    global_load_dwordx4 a[180:183], v4, s[66:67] offset:2048 sc1
    global_load_dwordx4 a[188:191], v4, s[66:67] offset:3072 sc1
    v_add_u32 v4, 155648, v13
    global_load_dwordx4 a[196:199], v4, s[66:67] offset:0 sc1
    global_load_dwordx4 a[204:207], v4, s[66:67] offset:1024 sc1
    global_load_dwordx4 a[212:215], v4, s[66:67] offset:2048 sc1
    global_load_dwordx4 a[220:223], v4, s[66:67] offset:3072 sc1
    v_add_u32 v4, 159744, v13
    global_load_dwordx4 a[228:231], v4, s[66:67] offset:0 sc1
    s_waitcnt vmcnt(58)
    global_load_dwordx4 a[236:239], v4, s[66:67] offset:1024 sc1
    global_load_dwordx4 a[244:247], v4, s[66:67] offset:2048 sc1
    global_load_dwordx4 a[252:255], v4, s[66:67] offset:3072 sc1
    s_barrier
    v_mov_b32 v19, 0
    v_add_u32 v24, 65536, v8
    v_add_u32 v25, 65536, v9
    v_add_u32 v26, 65536, v10
    v_add_u32 v27, 65536, v11
    ds_read_b64_tr_b16 v[64:65], v8 offset:0
    ds_read_b64_tr_b16 v[66:67], v8 offset:1024
    ds_read_b64_tr_b16 v[68:69], v9 offset:0
    ds_read_b64_tr_b16 v[70:71], v9 offset:1024
    ds_read_b64_tr_b16 v[72:73], v10 offset:0
    ds_read_b64_tr_b16 v[74:75], v10 offset:1024
    ds_read_b64_tr_b16 v[76:77], v11 offset:0
    ds_read_b64_tr_b16 v[78:79], v11 offset:1024
    s_waitcnt vmcnt(60)
    s_waitcnt lgkmcnt(0)
    v_mfma_f32_32x32x16_bf16 v[128:143], v[64:67], a[0:3], 0
    ds_read_b64_tr_b16 v[80:81], v8 offset:4096
    ds_read_b64_tr_b16 v[82:83], v8 offset:5120
    ds_read_b64_tr_b16 v[84:85], v9 offset:4096
    ds_read_b64_tr_b16 v[86:87], v9 offset:5120
    v_mfma_f32_32x32x16_bf16 v[144:159], v[68:71], a[0:3], 0
    ds_read_b64_tr_b16 v[88:89], v10 offset:4096
    ds_read_b64_tr_b16 v[90:91], v10 offset:5120
    ds_read_b64_tr_b16 v[92:93], v11 offset:4096
    ds_read_b64_tr_b16 v[94:95], v11 offset:5120
    v_mfma_f32_32x32x16_bf16 v[160:175], v[72:75], a[0:3], 0
    v_mfma_f32_32x32x16_bf16 v[176:191], v[76:79], a[0:3], 0
    s_waitcnt lgkmcnt(0)
    v_mfma_f32_32x32x16_bf16 v[128:143], v[80:83], a[8:11], v[128:143]
    ds_read_b64_tr_b16 v[64:65], v8 offset:8192
    ds_read_b64_tr_b16 v[66:67], v8 offset:9216
    ds_read_b64_tr_b16 v[68:69], v9 offset:8192
    ds_read_b64_tr_b16 v[70:71], v9 offset:9216
    v_mfma_f32_32x32x16_bf16 v[144:159], v[84:87], a[8:11], v[144:159]
    ds_read_b64_tr_b16 v[72:73], v10 offset:8192
    ds_read_b64_tr_b16 v[74:75], v10 offset:9216
    ds_read_b64_tr_b16 v[76:77], v11 offset:8192
    ds_read_b64_tr_b16 v[78:79], v11 offset:9216
    v_mfma_f32_32x32x16_bf16 v[160:175], v[88:91], a[8:11], v[160:175]
    v_mfma_f32_32x32x16_bf16 v[176:191], v[92:95], a[8:11], v[176:191]
    s_waitcnt lgkmcnt(0)
    v_mfma_f32_32x32x16_bf16 v[128:143], v[64:67], a[16:19], v[128:143]
    ds_read_b64_tr_b16 v[80:81], v8 offset:12288
    ds_read_b64_tr_b16 v[82:83], v8 offset:13312
    ds_read_b64_tr_b16 v[84:85], v9 offset:12288
    ds_read_b64_tr_b16 v[86:87], v9 offset:13312
    v_mfma_f32_32x32x16_bf16 v[144:159], v[68:71], a[16:19], v[144:159]
    ds_read_b64_tr_b16 v[88:89], v10 offset:12288
    ds_read_b64_tr_b16 v[90:91], v10 offset:13312
    ds_read_b64_tr_b16 v[92:93], v11 offset:12288
    ds_read_b64_tr_b16 v[94:95], v11 offset:13312
    v_mfma_f32_32x32x16_bf16 v[160:175], v[72:75], a[16:19], v[160:175]
    v_mfma_f32_32x32x16_bf16 v[176:191], v[76:79], a[16:19], v[176:191]
    s_waitcnt lgkmcnt(0)
    v_mfma_f32_32x32x16_bf16 v[128:143], v[80:83], a[24:27], v[128:143]
    ds_read_b64_tr_b16 v[64:65], v8 offset:16384
    ds_read_b64_tr_b16 v[66:67], v8 offset:17408
    ds_read_b64_tr_b16 v[68:69], v9 offset:16384
    ds_read_b64_tr_b16 v[70:71], v9 offset:17408
    v_mfma_f32_32x32x16_bf16 v[144:159], v[84:87], a[24:27], v[144:159]
    ds_read_b64_tr_b16 v[72:73], v10 offset:16384
    ds_read_b64_tr_b16 v[74:75], v10 offset:17408
    ds_read_b64_tr_b16 v[76:77], v11 offset:16384
    ds_read_b64_tr_b16 v[78:79], v11 offset:17408
    v_mfma_f32_32x32x16_bf16 v[160:175], v[88:91], a[24:27], v[160:175]
    v_mfma_f32_32x32x16_bf16 v[176:191], v[92:95], a[24:27], v[176:191]
    s_waitcnt vmcnt(56)
    s_waitcnt lgkmcnt(0)
    v_mfma_f32_32x32x16_bf16 v[128:143], v[64:67], a[32:35], v[128:143]
    ds_read_b64_tr_b16 v[80:81], v8 offset:20480
    ds_read_b64_tr_b16 v[82:83], v8 offset:21504
    ds_read_b64_tr_b16 v[84:85], v9 offset:20480
    ds_read_b64_tr_b16 v[86:87], v9 offset:21504
    v_mfma_f32_32x32x16_bf16 v[144:159], v[68:71], a[32:35], v[144:159]
    ds_read_b64_tr_b16 v[88:89], v10 offset:20480
    ds_read_b64_tr_b16 v[90:91], v10 offset:21504
    ds_read_b64_tr_b16 v[92:93], v11 offset:20480
    ds_read_b64_tr_b16 v[94:95], v11 offset:21504
    v_mfma_f32_32x32x16_bf16 v[160:175], v[72:75], a[32:35], v[160:175]
    v_mfma_f32_32x32x16_bf16 v[176:191], v[76:79], a[32:35], v[176:191]
    s_waitcnt lgkmcnt(0)
    v_mfma_f32_32x32x16_bf16 v[128:143], v[80:83], a[40:43], v[128:143]
    ds_read_b64_tr_b16 v[64:65], v8 offset:24576
    ds_read_b64_tr_b16 v[66:67], v8 offset:25600
    ds_read_b64_tr_b16 v[68:69], v9 offset:24576
    ds_read_b64_tr_b16 v[70:71], v9 offset:25600
    v_mfma_f32_32x32x16_bf16 v[144:159], v[84:87], a[40:43], v[144:159]
    ds_read_b64_tr_b16 v[72:73], v10 offset:24576
    ds_read_b64_tr_b16 v[74:75], v10 offset:25600
    ds_read_b64_tr_b16 v[76:77], v11 offset:24576
    ds_read_b64_tr_b16 v[78:79], v11 offset:25600
    v_mfma_f32_32x32x16_bf16 v[160:175], v[88:91], a[40:43], v[160:175]
    v_mfma_f32_32x32x16_bf16 v[176:191], v[92:95], a[40:43], v[176:191]
    s_waitcnt lgkmcnt(0)
    v_mfma_f32_32x32x16_bf16 v[128:143], v[64:67], a[48:51], v[128:143]
    ds_read_b64_tr_b16 v[80:81], v8 offset:28672
    ds_read_b64_tr_b16 v[82:83], v8 offset:29696
    ds_read_b64_tr_b16 v[84:85], v9 offset:28672
    ds_read_b64_tr_b16 v[86:87], v9 offset:29696
    v_mfma_f32_32x32x16_bf16 v[144:159], v[68:71], a[48:51], v[144:159]
    ds_read_b64_tr_b16 v[88:89], v10 offset:28672
    ds_read_b64_tr_b16 v[90:91], v10 offset:29696
    ds_read_b64_tr_b16 v[92:93], v11 offset:28672
    ds_read_b64_tr_b16 v[94:95], v11 offset:29696
    v_mfma_f32_32x32x16_bf16 v[160:175], v[72:75], a[48:51], v[160:175]
    v_mfma_f32_32x32x16_bf16 v[176:191], v[76:79], a[48:51], v[176:191]
    s_waitcnt lgkmcnt(0)
    v_mfma_f32_32x32x16_bf16 v[128:143], v[80:83], a[56:59], v[128:143]
    ds_read_b64_tr_b16 v[64:65], v8 offset:32768
    ds_read_b64_tr_b16 v[66:67], v8 offset:33792
    ds_read_b64_tr_b16 v[68:69], v9 offset:32768
    ds_read_b64_tr_b16 v[70:71], v9 offset:33792
    v_mfma_f32_32x32x16_bf16 v[144:159], v[84:87], a[56:59], v[144:159]
    ds_read_b64_tr_b16 v[72:73], v10 offset:32768
    ds_read_b64_tr_b16 v[74:75], v10 offset:33792
    ds_read_b64_tr_b16 v[76:77], v11 offset:32768
    ds_read_b64_tr_b16 v[78:79], v11 offset:33792
    v_mfma_f32_32x32x16_bf16 v[160:175], v[88:91], a[56:59], v[160:175]
    v_mfma_f32_32x32x16_bf16 v[176:191], v[92:95], a[56:59], v[176:191]
    s_waitcnt vmcnt(52)
    s_waitcnt lgkmcnt(0)
    v_mfma_f32_32x32x16_bf16 v[128:143], v[64:67], a[64:67], v[128:143]
    ds_read_b64_tr_b16 v[80:81], v8 offset:36864
    ds_read_b64_tr_b16 v[82:83], v8 offset:37888
    ds_read_b64_tr_b16 v[84:85], v9 offset:36864
    ds_read_b64_tr_b16 v[86:87], v9 offset:37888
    v_mfma_f32_32x32x16_bf16 v[144:159], v[68:71], a[64:67], v[144:159]
    ds_read_b64_tr_b16 v[88:89], v10 offset:36864
    ds_read_b64_tr_b16 v[90:91], v10 offset:37888
    ds_read_b64_tr_b16 v[92:93], v11 offset:36864
    ds_read_b64_tr_b16 v[94:95], v11 offset:37888
    v_mfma_f32_32x32x16_bf16 v[160:175], v[72:75], a[64:67], v[160:175]
    v_mfma_f32_32x32x16_bf16 v[176:191], v[76:79], a[64:67], v[176:191]
    s_waitcnt lgkmcnt(0)
    v_mfma_f32_32x32x16_bf16 v[128:143], v[80:83], a[72:75], v[128:143]
    ds_read_b64_tr_b16 v[64:65], v8 offset:40960
    ds_read_b64_tr_b16 v[66:67], v8 offset:41984
    ds_read_b64_tr_b16 v[68:69], v9 offset:40960
    ds_read_b64_tr_b16 v[70:71], v9 offset:41984
    v_mfma_f32_32x32x16_bf16 v[144:159], v[84:87], a[72:75], v[144:159]
    ds_read_b64_tr_b16 v[72:73], v10 offset:40960
    ds_read_b64_tr_b16 v[74:75], v10 offset:41984
    ds_read_b64_tr_b16 v[76:77], v11 offset:40960
    ds_read_b64_tr_b16 v[78:79], v11 offset:41984
    v_mfma_f32_32x32x16_bf16 v[160:175], v[88:91], a[72:75], v[160:175]
    v_mfma_f32_32x32x16_bf16 v[176:191], v[92:95], a[72:75], v[176:191]
    s_waitcnt lgkmcnt(0)
    v_mfma_f32_32x32x16_bf16 v[128:143], v[64:67], a[80:83], v[128:143]
    ds_read_b64_tr_b16 v[80:81], v8 offset:45056
    ds_read_b64_tr_b16 v[82:83], v8 offset:46080
    ds_read_b64_tr_b16 v[84:85], v9 offset:45056
    ds_read_b64_tr_b16 v[86:87], v9 offset:46080
    v_mfma_f32_32x32x16_bf16 v[144:159], v[68:71], a[80:83], v[144:159]
    ds_read_b64_tr_b16 v[88:89], v10 offset:45056
    ds_read_b64_tr_b16 v[90:91], v10 offset:46080
    ds_read_b64_tr_b16 v[92:93], v11 offset:45056
    ds_read_b64_tr_b16 v[94:95], v11 offset:46080
    v_mfma_f32_32x32x16_bf16 v[160:175], v[72:75], a[80:83], v[160:175]
    v_mfma_f32_32x32x16_bf16 v[176:191], v[76:79], a[80:83], v[176:191]
    s_waitcnt lgkmcnt(0)
    v_mfma_f32_32x32x16_bf16 v[128:143], v[80:83], a[88:91], v[128:143]
    ds_read_b64_tr_b16 v[64:65], v8 offset:49152
    ds_read_b64_tr_b16 v[66:67], v8 offset:50176
    ds_read_b64_tr_b16 v[68:69], v9 offset:49152
    ds_read_b64_tr_b16 v[70:71], v9 offset:50176
    v_mfma_f32_32x32x16_bf16 v[144:159], v[84:87], a[88:91], v[144:159]
    ds_read_b64_tr_b16 v[72:73], v10 offset:49152
    ds_read_b64_tr_b16 v[74:75], v10 offset:50176
    ds_read_b64_tr_b16 v[76:77], v11 offset:49152
    ds_read_b64_tr_b16 v[78:79], v11 offset:50176
    v_mfma_f32_32x32x16_bf16 v[160:175], v[88:91], a[88:91], v[160:175]
    v_mfma_f32_32x32x16_bf16 v[176:191], v[92:95], a[88:91], v[176:191]
    s_waitcnt vmcnt(48)
    s_waitcnt lgkmcnt(0)
    v_mfma_f32_32x32x16_bf16 v[128:143], v[64:67], a[96:99], v[128:143]
    ds_read_b64_tr_b16 v[80:81], v8 offset:53248
    ds_read_b64_tr_b16 v[82:83], v8 offset:54272
    ds_read_b64_tr_b16 v[84:85], v9 offset:53248
    ds_read_b64_tr_b16 v[86:87], v9 offset:54272
    v_mfma_f32_32x32x16_bf16 v[144:159], v[68:71], a[96:99], v[144:159]
    ds_read_b64_tr_b16 v[88:89], v10 offset:53248
    ds_read_b64_tr_b16 v[90:91], v10 offset:54272
    ds_read_b64_tr_b16 v[92:93], v11 offset:53248
    ds_read_b64_tr_b16 v[94:95], v11 offset:54272
    v_mfma_f32_32x32x16_bf16 v[160:175], v[72:75], a[96:99], v[160:175]
    v_mfma_f32_32x32x16_bf16 v[176:191], v[76:79], a[96:99], v[176:191]
    s_waitcnt lgkmcnt(0)
    v_mfma_f32_32x32x16_bf16 v[128:143], v[80:83], a[104:107], v[128:143]
    ds_read_b64_tr_b16 v[64:65], v8 offset:57344
    ds_read_b64_tr_b16 v[66:67], v8 offset:58368
    ds_read_b64_tr_b16 v[68:69], v9 offset:57344
    ds_read_b64_tr_b16 v[70:71], v9 offset:58368
    v_mfma_f32_32x32x16_bf16 v[144:159], v[84:87], a[104:107], v[144:159]
    ds_read_b64_tr_b16 v[72:73], v10 offset:57344
    ds_read_b64_tr_b16 v[74:75], v10 offset:58368
    ds_read_b64_tr_b16 v[76:77], v11 offset:57344
    ds_read_b64_tr_b16 v[78:79], v11 offset:58368
    v_mfma_f32_32x32x16_bf16 v[160:175], v[88:91], a[104:107], v[160:175]
    v_mfma_f32_32x32x16_bf16 v[176:191], v[92:95], a[104:107], v[176:191]
    s_waitcnt lgkmcnt(0)
    v_mfma_f32_32x32x16_bf16 v[128:143], v[64:67], a[112:115], v[128:143]
    ds_read_b64_tr_b16 v[80:81], v8 offset:61440
    ds_read_b64_tr_b16 v[82:83], v8 offset:62464
    ds_read_b64_tr_b16 v[84:85], v9 offset:61440
    ds_read_b64_tr_b16 v[86:87], v9 offset:62464
    v_mfma_f32_32x32x16_bf16 v[144:159], v[68:71], a[112:115], v[144:159]
    ds_read_b64_tr_b16 v[88:89], v10 offset:61440
    ds_read_b64_tr_b16 v[90:91], v10 offset:62464
    ds_read_b64_tr_b16 v[92:93], v11 offset:61440
    ds_read_b64_tr_b16 v[94:95], v11 offset:62464
    v_mfma_f32_32x32x16_bf16 v[160:175], v[72:75], a[112:115], v[160:175]
    v_mfma_f32_32x32x16_bf16 v[176:191], v[76:79], a[112:115], v[176:191]
    s_waitcnt lgkmcnt(0)
    v_mfma_f32_32x32x16_bf16 v[128:143], v[80:83], a[120:123], v[128:143]
    ds_read_b64_tr_b16 v[64:65], v24 offset:0
    ds_read_b64_tr_b16 v[66:67], v24 offset:1024
    ds_read_b64_tr_b16 v[68:69], v25 offset:0
    ds_read_b64_tr_b16 v[70:71], v25 offset:1024
    v_mfma_f32_32x32x16_bf16 v[144:159], v[84:87], a[120:123], v[144:159]
    ds_read_b64_tr_b16 v[72:73], v26 offset:0
    ds_read_b64_tr_b16 v[74:75], v26 offset:1024
    ds_read_b64_tr_b16 v[76:77], v27 offset:0
    ds_read_b64_tr_b16 v[78:79], v27 offset:1024
    v_mfma_f32_32x32x16_bf16 v[160:175], v[88:91], a[120:123], v[160:175]
    v_mfma_f32_32x32x16_bf16 v[176:191], v[92:95], a[120:123], v[176:191]
    s_waitcnt vmcnt(44)
    s_waitcnt lgkmcnt(0)
    v_mfma_f32_32x32x16_bf16 v[128:143], v[64:67], a[128:131], v[128:143]
    ds_read_b64_tr_b16 v[80:81], v24 offset:4096
    ds_read_b64_tr_b16 v[82:83], v24 offset:5120
    ds_read_b64_tr_b16 v[84:85], v25 offset:4096
    ds_read_b64_tr_b16 v[86:87], v25 offset:5120
    v_mfma_f32_32x32x16_bf16 v[144:159], v[68:71], a[128:131], v[144:159]
    ds_read_b64_tr_b16 v[88:89], v26 offset:4096
    ds_read_b64_tr_b16 v[90:91], v26 offset:5120
    ds_read_b64_tr_b16 v[92:93], v27 offset:4096
    ds_read_b64_tr_b16 v[94:95], v27 offset:5120
    v_mfma_f32_32x32x16_bf16 v[160:175], v[72:75], a[128:131], v[160:175]
    v_mfma_f32_32x32x16_bf16 v[176:191], v[76:79], a[128:131], v[176:191]
    s_waitcnt lgkmcnt(0)
    v_mfma_f32_32x32x16_bf16 v[128:143], v[80:83], a[136:139], v[128:143]
    ds_read_b64_tr_b16 v[64:65], v24 offset:8192
    ds_read_b64_tr_b16 v[66:67], v24 offset:9216
    ds_read_b64_tr_b16 v[68:69], v25 offset:8192
    ds_read_b64_tr_b16 v[70:71], v25 offset:9216
    v_mfma_f32_32x32x16_bf16 v[144:159], v[84:87], a[136:139], v[144:159]
    ds_read_b64_tr_b16 v[72:73], v26 offset:8192
    ds_read_b64_tr_b16 v[74:75], v26 offset:9216
    ds_read_b64_tr_b16 v[76:77], v27 offset:8192
    ds_read_b64_tr_b16 v[78:79], v27 offset:9216
    v_mfma_f32_32x32x16_bf16 v[160:175], v[88:91], a[136:139], v[160:175]
    v_mfma_f32_32x32x16_bf16 v[176:191], v[92:95], a[136:139], v[176:191]
    s_waitcnt lgkmcnt(0)
    v_mfma_f32_32x32x16_bf16 v[128:143], v[64:67], a[144:147], v[128:143]
    ds_read_b64_tr_b16 v[80:81], v24 offset:12288
    ds_read_b64_tr_b16 v[82:83], v24 offset:13312
    ds_read_b64_tr_b16 v[84:85], v25 offset:12288
    ds_read_b64_tr_b16 v[86:87], v25 offset:13312
    v_mfma_f32_32x32x16_bf16 v[144:159], v[68:71], a[144:147], v[144:159]
    ds_read_b64_tr_b16 v[88:89], v26 offset:12288
    ds_read_b64_tr_b16 v[90:91], v26 offset:13312
    ds_read_b64_tr_b16 v[92:93], v27 offset:12288
    ds_read_b64_tr_b16 v[94:95], v27 offset:13312
    v_mfma_f32_32x32x16_bf16 v[160:175], v[72:75], a[144:147], v[160:175]
    v_mfma_f32_32x32x16_bf16 v[176:191], v[76:79], a[144:147], v[176:191]
    s_waitcnt lgkmcnt(0)
    v_mfma_f32_32x32x16_bf16 v[128:143], v[80:83], a[152:155], v[128:143]
    ds_read_b64_tr_b16 v[64:65], v24 offset:16384
    ds_read_b64_tr_b16 v[66:67], v24 offset:17408
    ds_read_b64_tr_b16 v[68:69], v25 offset:16384
    ds_read_b64_tr_b16 v[70:71], v25 offset:17408
    v_mfma_f32_32x32x16_bf16 v[144:159], v[84:87], a[152:155], v[144:159]
    ds_read_b64_tr_b16 v[72:73], v26 offset:16384
    ds_read_b64_tr_b16 v[74:75], v26 offset:17408
    ds_read_b64_tr_b16 v[76:77], v27 offset:16384
    ds_read_b64_tr_b16 v[78:79], v27 offset:17408
    v_mfma_f32_32x32x16_bf16 v[160:175], v[88:91], a[152:155], v[160:175]
    v_mfma_f32_32x32x16_bf16 v[176:191], v[92:95], a[152:155], v[176:191]
    s_waitcnt vmcnt(40)
    s_waitcnt lgkmcnt(0)
    v_mfma_f32_32x32x16_bf16 v[128:143], v[64:67], a[160:163], v[128:143]
    ds_read_b64_tr_b16 v[80:81], v24 offset:20480
    ds_read_b64_tr_b16 v[82:83], v24 offset:21504
    ds_read_b64_tr_b16 v[84:85], v25 offset:20480
    ds_read_b64_tr_b16 v[86:87], v25 offset:21504
    v_mfma_f32_32x32x16_bf16 v[144:159], v[68:71], a[160:163], v[144:159]
    ds_read_b64_tr_b16 v[88:89], v26 offset:20480
    ds_read_b64_tr_b16 v[90:91], v26 offset:21504
    ds_read_b64_tr_b16 v[92:93], v27 offset:20480
    ds_read_b64_tr_b16 v[94:95], v27 offset:21504
    v_mfma_f32_32x32x16_bf16 v[160:175], v[72:75], a[160:163], v[160:175]
    v_mfma_f32_32x32x16_bf16 v[176:191], v[76:79], a[160:163], v[176:191]
    s_waitcnt lgkmcnt(0)
    v_mfma_f32_32x32x16_bf16 v[128:143], v[80:83], a[168:171], v[128:143]
    ds_read_b64_tr_b16 v[64:65], v24 offset:24576
    ds_read_b64_tr_b16 v[66:67], v24 offset:25600
    ds_read_b64_tr_b16 v[68:69], v25 offset:24576
    ds_read_b64_tr_b16 v[70:71], v25 offset:25600
    v_mfma_f32_32x32x16_bf16 v[144:159], v[84:87], a[168:171], v[144:159]
    ds_read_b64_tr_b16 v[72:73], v26 offset:24576
    ds_read_b64_tr_b16 v[74:75], v26 offset:25600
    ds_read_b64_tr_b16 v[76:77], v27 offset:24576
    ds_read_b64_tr_b16 v[78:79], v27 offset:25600
    v_mfma_f32_32x32x16_bf16 v[160:175], v[88:91], a[168:171], v[160:175]
    v_mfma_f32_32x32x16_bf16 v[176:191], v[92:95], a[168:171], v[176:191]
    s_waitcnt lgkmcnt(0)
    v_mfma_f32_32x32x16_bf16 v[128:143], v[64:67], a[176:179], v[128:143]
    ds_read_b64_tr_b16 v[80:81], v24 offset:28672
    ds_read_b64_tr_b16 v[82:83], v24 offset:29696
    ds_read_b64_tr_b16 v[84:85], v25 offset:28672
    ds_read_b64_tr_b16 v[86:87], v25 offset:29696
    v_mfma_f32_32x32x16_bf16 v[144:159], v[68:71], a[176:179], v[144:159]
    ds_read_b64_tr_b16 v[88:89], v26 offset:28672
    ds_read_b64_tr_b16 v[90:91], v26 offset:29696
    ds_read_b64_tr_b16 v[92:93], v27 offset:28672
    ds_read_b64_tr_b16 v[94:95], v27 offset:29696
    v_mfma_f32_32x32x16_bf16 v[160:175], v[72:75], a[176:179], v[160:175]
    v_mfma_f32_32x32x16_bf16 v[176:191], v[76:79], a[176:179], v[176:191]
    s_waitcnt lgkmcnt(0)
    v_mfma_f32_32x32x16_bf16 v[128:143], v[80:83], a[184:187], v[128:143]
    ds_read_b64_tr_b16 v[64:65], v24 offset:32768
    ds_read_b64_tr_b16 v[66:67], v24 offset:33792
    ds_read_b64_tr_b16 v[68:69], v25 offset:32768
    ds_read_b64_tr_b16 v[70:71], v25 offset:33792
    v_mfma_f32_32x32x16_bf16 v[144:159], v[84:87], a[184:187], v[144:159]
    ds_read_b64_tr_b16 v[72:73], v26 offset:32768
    ds_read_b64_tr_b16 v[74:75], v26 offset:33792
    ds_read_b64_tr_b16 v[76:77], v27 offset:32768
    ds_read_b64_tr_b16 v[78:79], v27 offset:33792
    v_mfma_f32_32x32x16_bf16 v[160:175], v[88:91], a[184:187], v[160:175]
    v_mfma_f32_32x32x16_bf16 v[176:191], v[92:95], a[184:187], v[176:191]
    s_waitcnt vmcnt(36)
    s_waitcnt lgkmcnt(0)
    v_mfma_f32_32x32x16_bf16 v[128:143], v[64:67], a[192:195], v[128:143]
    ds_read_b64_tr_b16 v[80:81], v24 offset:36864
    ds_read_b64_tr_b16 v[82:83], v24 offset:37888
    ds_read_b64_tr_b16 v[84:85], v25 offset:36864
    ds_read_b64_tr_b16 v[86:87], v25 offset:37888
    v_mfma_f32_32x32x16_bf16 v[144:159], v[68:71], a[192:195], v[144:159]
    ds_read_b64_tr_b16 v[88:89], v26 offset:36864
    ds_read_b64_tr_b16 v[90:91], v26 offset:37888
    ds_read_b64_tr_b16 v[92:93], v27 offset:36864
    ds_read_b64_tr_b16 v[94:95], v27 offset:37888
    v_mfma_f32_32x32x16_bf16 v[160:175], v[72:75], a[192:195], v[160:175]
    v_mfma_f32_32x32x16_bf16 v[176:191], v[76:79], a[192:195], v[176:191]
    s_waitcnt lgkmcnt(0)
    v_mfma_f32_32x32x16_bf16 v[128:143], v[80:83], a[200:203], v[128:143]
    ds_read_b64_tr_b16 v[64:65], v24 offset:40960
    ds_read_b64_tr_b16 v[66:67], v24 offset:41984
    ds_read_b64_tr_b16 v[68:69], v25 offset:40960
    ds_read_b64_tr_b16 v[70:71], v25 offset:41984
    v_mfma_f32_32x32x16_bf16 v[144:159], v[84:87], a[200:203], v[144:159]
    ds_read_b64_tr_b16 v[72:73], v26 offset:40960
    ds_read_b64_tr_b16 v[74:75], v26 offset:41984
    ds_read_b64_tr_b16 v[76:77], v27 offset:40960
    ds_read_b64_tr_b16 v[78:79], v27 offset:41984
    v_mfma_f32_32x32x16_bf16 v[160:175], v[88:91], a[200:203], v[160:175]
    v_mfma_f32_32x32x16_bf16 v[176:191], v[92:95], a[200:203], v[176:191]
    s_waitcnt lgkmcnt(0)
    v_mfma_f32_32x32x16_bf16 v[128:143], v[64:67], a[208:211], v[128:143]
    ds_read_b64_tr_b16 v[80:81], v24 offset:45056
    ds_read_b64_tr_b16 v[82:83], v24 offset:46080
    ds_read_b64_tr_b16 v[84:85], v25 offset:45056
    ds_read_b64_tr_b16 v[86:87], v25 offset:46080
    v_mfma_f32_32x32x16_bf16 v[144:159], v[68:71], a[208:211], v[144:159]
    ds_read_b64_tr_b16 v[88:89], v26 offset:45056
    ds_read_b64_tr_b16 v[90:91], v26 offset:46080
    ds_read_b64_tr_b16 v[92:93], v27 offset:45056
    ds_read_b64_tr_b16 v[94:95], v27 offset:46080
    v_mfma_f32_32x32x16_bf16 v[160:175], v[72:75], a[208:211], v[160:175]
    v_mfma_f32_32x32x16_bf16 v[176:191], v[76:79], a[208:211], v[176:191]
    s_waitcnt lgkmcnt(0)
    v_mfma_f32_32x32x16_bf16 v[128:143], v[80:83], a[216:219], v[128:143]
    ds_read_b64_tr_b16 v[64:65], v24 offset:49152
    ds_read_b64_tr_b16 v[66:67], v24 offset:50176
    ds_read_b64_tr_b16 v[68:69], v25 offset:49152
    ds_read_b64_tr_b16 v[70:71], v25 offset:50176
    v_mfma_f32_32x32x16_bf16 v[144:159], v[84:87], a[216:219], v[144:159]
    ds_read_b64_tr_b16 v[72:73], v26 offset:49152
    ds_read_b64_tr_b16 v[74:75], v26 offset:50176
    ds_read_b64_tr_b16 v[76:77], v27 offset:49152
    ds_read_b64_tr_b16 v[78:79], v27 offset:50176
    v_mfma_f32_32x32x16_bf16 v[160:175], v[88:91], a[216:219], v[160:175]
    v_mfma_f32_32x32x16_bf16 v[176:191], v[92:95], a[216:219], v[176:191]
    s_waitcnt vmcnt(32)
    s_waitcnt lgkmcnt(0)
    v_mfma_f32_32x32x16_bf16 v[128:143], v[64:67], a[224:227], v[128:143]
    ds_read_b64_tr_b16 v[80:81], v24 offset:53248
    ds_read_b64_tr_b16 v[82:83], v24 offset:54272
    ds_read_b64_tr_b16 v[84:85], v25 offset:53248
    ds_read_b64_tr_b16 v[86:87], v25 offset:54272
    v_mfma_f32_32x32x16_bf16 v[144:159], v[68:71], a[224:227], v[144:159]
    ds_read_b64_tr_b16 v[88:89], v26 offset:53248
    ds_read_b64_tr_b16 v[90:91], v26 offset:54272
    ds_read_b64_tr_b16 v[92:93], v27 offset:53248
    ds_read_b64_tr_b16 v[94:95], v27 offset:54272
    v_mfma_f32_32x32x16_bf16 v[160:175], v[72:75], a[224:227], v[160:175]
    v_mfma_f32_32x32x16_bf16 v[176:191], v[76:79], a[224:227], v[176:191]
    s_waitcnt lgkmcnt(0)
    v_mfma_f32_32x32x16_bf16 v[128:143], v[80:83], a[232:235], v[128:143]
    ds_read_b64_tr_b16 v[64:65], v24 offset:57344
    ds_read_b64_tr_b16 v[66:67], v24 offset:58368
    ds_read_b64_tr_b16 v[68:69], v25 offset:57344
    ds_read_b64_tr_b16 v[70:71], v25 offset:58368
    v_mfma_f32_32x32x16_bf16 v[144:159], v[84:87], a[232:235], v[144:159]
    ds_read_b64_tr_b16 v[72:73], v26 offset:57344
    ds_read_b64_tr_b16 v[74:75], v26 offset:58368
    ds_read_b64_tr_b16 v[76:77], v27 offset:57344
    ds_read_b64_tr_b16 v[78:79], v27 offset:58368
    v_mfma_f32_32x32x16_bf16 v[160:175], v[88:91], a[232:235], v[160:175]
    v_mfma_f32_32x32x16_bf16 v[176:191], v[92:95], a[232:235], v[176:191]
    s_waitcnt lgkmcnt(0)
    v_mfma_f32_32x32x16_bf16 v[128:143], v[64:67], a[240:243], v[128:143]
    ds_read_b64_tr_b16 v[80:81], v24 offset:61440
    ds_read_b64_tr_b16 v[82:83], v24 offset:62464
    ds_read_b64_tr_b16 v[84:85], v25 offset:61440
    ds_read_b64_tr_b16 v[86:87], v25 offset:62464
    v_mfma_f32_32x32x16_bf16 v[144:159], v[68:71], a[240:243], v[144:159]
    ds_read_b64_tr_b16 v[88:89], v26 offset:61440
    ds_read_b64_tr_b16 v[90:91], v26 offset:62464
    ds_read_b64_tr_b16 v[92:93], v27 offset:61440
    ds_read_b64_tr_b16 v[94:95], v27 offset:62464
    v_mfma_f32_32x32x16_bf16 v[160:175], v[72:75], a[240:243], v[160:175]
    v_mfma_f32_32x32x16_bf16 v[176:191], v[76:79], a[240:243], v[176:191]
    s_waitcnt lgkmcnt(0)
    v_mfma_f32_32x32x16_bf16 v[128:143], v[80:83], a[248:251], v[128:143]
    v_mfma_f32_32x32x16_bf16 v[144:159], v[84:87], a[248:251], v[144:159]
    v_mfma_f32_32x32x16_bf16 v[160:175], v[88:91], a[248:251], v[160:175]
    v_mfma_f32_32x32x16_bf16 v[176:191], v[92:95], a[248:251], v[176:191]
    v_mov_b32 v28, v14
    v_add_u32 v28, 0, v28
    v_add_u32 v29, 131072, v28
    s_nop 5
    v_cvt_pk_bf16_f32 v32, v128, v129
    v_cvt_pk_bf16_f32 v33, v130, v131
    v_cvt_pk_bf16_f32 v34, v132, v133
    v_cvt_pk_bf16_f32 v35, v134, v135
    v_cvt_pk_bf16_f32 v36, v136, v137
    v_cvt_pk_bf16_f32 v37, v138, v139
    v_cvt_pk_bf16_f32 v38, v140, v141
    v_cvt_pk_bf16_f32 v39, v142, v143
    global_store_dwordx4 v28, v[32:35], s[68:69] offset:0 sc1
    global_store_dwordx4 v28, v[36:39], s[68:69] offset:512 sc1
    v_cvt_pk_bf16_f32 v40, v144, v145
    v_cvt_pk_bf16_f32 v41, v146, v147
    v_cvt_pk_bf16_f32 v42, v148, v149
    v_cvt_pk_bf16_f32 v43, v150, v151
    v_cvt_pk_bf16_f32 v44, v152, v153
    v_cvt_pk_bf16_f32 v45, v154, v155
    v_cvt_pk_bf16_f32 v46, v156, v157
    v_cvt_pk_bf16_f32 v47, v158, v159
    global_store_dwordx4 v28, v[40:43], s[68:69] offset:1024 sc1
    global_store_dwordx4 v28, v[44:47], s[68:69] offset:1536 sc1
    v_cvt_pk_bf16_f32 v32, v160, v161
    v_cvt_pk_bf16_f32 v33, v162, v163
    v_cvt_pk_bf16_f32 v34, v164, v165
    v_cvt_pk_bf16_f32 v35, v166, v167
    v_cvt_pk_bf16_f32 v36, v168, v169
    v_cvt_pk_bf16_f32 v37, v170, v171
    v_cvt_pk_bf16_f32 v38, v172, v173
    v_cvt_pk_bf16_f32 v39, v174, v175
    global_store_dwordx4 v28, v[32:35], s[68:69] offset:2048 sc1
    global_store_dwordx4 v28, v[36:39], s[68:69] offset:2560 sc1
    v_cvt_pk_bf16_f32 v40, v176, v177
    v_cvt_pk_bf16_f32 v41, v178, v179
    v_cvt_pk_bf16_f32 v42, v180, v181
    v_cvt_pk_bf16_f32 v43, v182, v183
    v_cvt_pk_bf16_f32 v44, v184, v185
    v_cvt_pk_bf16_f32 v45, v186, v187
    v_cvt_pk_bf16_f32 v46, v188, v189
    v_cvt_pk_bf16_f32 v47, v190, v191
    global_store_dwordx4 v28, v[40:43], s[68:69] offset:3072 sc1
    global_store_dwordx4 v28, v[44:47], s[68:69] offset:3584 sc1
    ds_read_b64_tr_b16 v[64:65], v8 offset:0
    ds_read_b64_tr_b16 v[66:67], v8 offset:1024
    ds_read_b64_tr_b16 v[68:69], v9 offset:0
    ds_read_b64_tr_b16 v[70:71], v9 offset:1024
    ds_read_b64_tr_b16 v[72:73], v10 offset:0
    ds_read_b64_tr_b16 v[74:75], v10 offset:1024
    ds_read_b64_tr_b16 v[76:77], v11 offset:0
    ds_read_b64_tr_b16 v[78:79], v11 offset:1024
    s_waitcnt vmcnt(8)
    s_waitcnt lgkmcnt(0)
    v_mfma_f32_32x32x16_bf16 v[192:207], v[64:67], a[4:7], 0
    ds_read_b64_tr_b16 v[80:81], v8 offset:4096
    ds_read_b64_tr_b16 v[82:83], v8 offset:5120
    ds_read_b64_tr_b16 v[84:85], v9 offset:4096
    ds_read_b64_tr_b16 v[86:87], v9 offset:5120
    v_mfma_f32_32x32x16_bf16 v[208:223], v[68:71], a[4:7], 0
    ds_read_b64_tr_b16 v[88:89], v10 offset:4096
    ds_read_b64_tr_b16 v[90:91], v10 offset:5120
    ds_read_b64_tr_b16 v[92:93], v11 offset:4096
    ds_read_b64_tr_b16 v[94:95], v11 offset:5120
    v_mfma_f32_32x32x16_bf16 v[224:239], v[72:75], a[4:7], 0
    v_mfma_f32_32x32x16_bf16 v[240:255], v[76:79], a[4:7], 0
    s_waitcnt lgkmcnt(0)
    v_mfma_f32_32x32x16_bf16 v[192:207], v[80:83], a[12:15], v[192:207]
    ds_read_b64_tr_b16 v[64:65], v8 offset:8192
    ds_read_b64_tr_b16 v[66:67], v8 offset:9216
    ds_read_b64_tr_b16 v[68:69], v9 offset:8192
    ds_read_b64_tr_b16 v[70:71], v9 offset:9216
    v_mfma_f32_32x32x16_bf16 v[208:223], v[84:87], a[12:15], v[208:223]
    ds_read_b64_tr_b16 v[72:73], v10 offset:8192
    ds_read_b64_tr_b16 v[74:75], v10 offset:9216
    ds_read_b64_tr_b16 v[76:77], v11 offset:8192
    ds_read_b64_tr_b16 v[78:79], v11 offset:9216
    v_mfma_f32_32x32x16_bf16 v[224:239], v[88:91], a[12:15], v[224:239]
    v_mfma_f32_32x32x16_bf16 v[240:255], v[92:95], a[12:15], v[240:255]
    s_waitcnt lgkmcnt(0)
    v_mfma_f32_32x32x16_bf16 v[192:207], v[64:67], a[20:23], v[192:207]
    ds_read_b64_tr_b16 v[80:81], v8 offset:12288
    ds_read_b64_tr_b16 v[82:83], v8 offset:13312
    ds_read_b64_tr_b16 v[84:85], v9 offset:12288
    ds_read_b64_tr_b16 v[86:87], v9 offset:13312
    v_mfma_f32_32x32x16_bf16 v[208:223], v[68:71], a[20:23], v[208:223]
    ds_read_b64_tr_b16 v[88:89], v10 offset:12288
    ds_read_b64_tr_b16 v[90:91], v10 offset:13312
    ds_read_b64_tr_b16 v[92:93], v11 offset:12288
    ds_read_b64_tr_b16 v[94:95], v11 offset:13312
    v_mfma_f32_32x32x16_bf16 v[224:239], v[72:75], a[20:23], v[224:239]
    v_mfma_f32_32x32x16_bf16 v[240:255], v[76:79], a[20:23], v[240:255]
    s_waitcnt lgkmcnt(0)
    v_mfma_f32_32x32x16_bf16 v[192:207], v[80:83], a[28:31], v[192:207]
    ds_read_b64_tr_b16 v[64:65], v8 offset:16384
    ds_read_b64_tr_b16 v[66:67], v8 offset:17408
    ds_read_b64_tr_b16 v[68:69], v9 offset:16384
    ds_read_b64_tr_b16 v[70:71], v9 offset:17408
    v_mfma_f32_32x32x16_bf16 v[208:223], v[84:87], a[28:31], v[208:223]
    ds_read_b64_tr_b16 v[72:73], v10 offset:16384
    ds_read_b64_tr_b16 v[74:75], v10 offset:17408
    ds_read_b64_tr_b16 v[76:77], v11 offset:16384
    ds_read_b64_tr_b16 v[78:79], v11 offset:17408
    v_mfma_f32_32x32x16_bf16 v[224:239], v[88:91], a[28:31], v[224:239]
    v_mfma_f32_32x32x16_bf16 v[240:255], v[92:95], a[28:31], v[240:255]
    s_waitcnt lgkmcnt(0)
    v_mfma_f32_32x32x16_bf16 v[192:207], v[64:67], a[36:39], v[192:207]
    ds_read_b64_tr_b16 v[80:81], v8 offset:20480
    ds_read_b64_tr_b16 v[82:83], v8 offset:21504
    ds_read_b64_tr_b16 v[84:85], v9 offset:20480
    ds_read_b64_tr_b16 v[86:87], v9 offset:21504
    v_mfma_f32_32x32x16_bf16 v[208:223], v[68:71], a[36:39], v[208:223]
    ds_read_b64_tr_b16 v[88:89], v10 offset:20480
    ds_read_b64_tr_b16 v[90:91], v10 offset:21504
    ds_read_b64_tr_b16 v[92:93], v11 offset:20480
    ds_read_b64_tr_b16 v[94:95], v11 offset:21504
    v_mfma_f32_32x32x16_bf16 v[224:239], v[72:75], a[36:39], v[224:239]
    v_mfma_f32_32x32x16_bf16 v[240:255], v[76:79], a[36:39], v[240:255]
    s_waitcnt lgkmcnt(0)
    v_mfma_f32_32x32x16_bf16 v[192:207], v[80:83], a[44:47], v[192:207]
    ds_read_b64_tr_b16 v[64:65], v8 offset:24576
    ds_read_b64_tr_b16 v[66:67], v8 offset:25600
    ds_read_b64_tr_b16 v[68:69], v9 offset:24576
    ds_read_b64_tr_b16 v[70:71], v9 offset:25600
    v_mfma_f32_32x32x16_bf16 v[208:223], v[84:87], a[44:47], v[208:223]
    ds_read_b64_tr_b16 v[72:73], v10 offset:24576
    ds_read_b64_tr_b16 v[74:75], v10 offset:25600
    ds_read_b64_tr_b16 v[76:77], v11 offset:24576
    ds_read_b64_tr_b16 v[78:79], v11 offset:25600
    v_mfma_f32_32x32x16_bf16 v[224:239], v[88:91], a[44:47], v[224:239]
    v_mfma_f32_32x32x16_bf16 v[240:255], v[92:95], a[44:47], v[240:255]
    s_waitcnt lgkmcnt(0)
    v_mfma_f32_32x32x16_bf16 v[192:207], v[64:67], a[52:55], v[192:207]
    ds_read_b64_tr_b16 v[80:81], v8 offset:28672
    ds_read_b64_tr_b16 v[82:83], v8 offset:29696
    ds_read_b64_tr_b16 v[84:85], v9 offset:28672
    ds_read_b64_tr_b16 v[86:87], v9 offset:29696
    v_mfma_f32_32x32x16_bf16 v[208:223], v[68:71], a[52:55], v[208:223]
    ds_read_b64_tr_b16 v[88:89], v10 offset:28672
    ds_read_b64_tr_b16 v[90:91], v10 offset:29696
    ds_read_b64_tr_b16 v[92:93], v11 offset:28672
    ds_read_b64_tr_b16 v[94:95], v11 offset:29696
    v_mfma_f32_32x32x16_bf16 v[224:239], v[72:75], a[52:55], v[224:239]
    v_mfma_f32_32x32x16_bf16 v[240:255], v[76:79], a[52:55], v[240:255]
    s_waitcnt lgkmcnt(0)
    v_mfma_f32_32x32x16_bf16 v[192:207], v[80:83], a[60:63], v[192:207]
    ds_read_b64_tr_b16 v[64:65], v8 offset:32768
    ds_read_b64_tr_b16 v[66:67], v8 offset:33792
    ds_read_b64_tr_b16 v[68:69], v9 offset:32768
    ds_read_b64_tr_b16 v[70:71], v9 offset:33792
    v_mfma_f32_32x32x16_bf16 v[208:223], v[84:87], a[60:63], v[208:223]
    ds_read_b64_tr_b16 v[72:73], v10 offset:32768
    ds_read_b64_tr_b16 v[74:75], v10 offset:33792
    ds_read_b64_tr_b16 v[76:77], v11 offset:32768
    ds_read_b64_tr_b16 v[78:79], v11 offset:33792
    v_mfma_f32_32x32x16_bf16 v[224:239], v[88:91], a[60:63], v[224:239]
    v_mfma_f32_32x32x16_bf16 v[240:255], v[92:95], a[60:63], v[240:255]
    s_waitcnt lgkmcnt(0)
    v_mfma_f32_32x32x16_bf16 v[192:207], v[64:67], a[68:71], v[192:207]
    ds_read_b64_tr_b16 v[80:81], v8 offset:36864
    ds_read_b64_tr_b16 v[82:83], v8 offset:37888
    ds_read_b64_tr_b16 v[84:85], v9 offset:36864
    ds_read_b64_tr_b16 v[86:87], v9 offset:37888
    v_mfma_f32_32x32x16_bf16 v[208:223], v[68:71], a[68:71], v[208:223]
    ds_read_b64_tr_b16 v[88:89], v10 offset:36864
    ds_read_b64_tr_b16 v[90:91], v10 offset:37888
    ds_read_b64_tr_b16 v[92:93], v11 offset:36864
    ds_read_b64_tr_b16 v[94:95], v11 offset:37888
    v_mfma_f32_32x32x16_bf16 v[224:239], v[72:75], a[68:71], v[224:239]
    v_mfma_f32_32x32x16_bf16 v[240:255], v[76:79], a[68:71], v[240:255]
    s_waitcnt lgkmcnt(0)
    v_mfma_f32_32x32x16_bf16 v[192:207], v[80:83], a[76:79], v[192:207]
    ds_read_b64_tr_b16 v[64:65], v8 offset:40960
    ds_read_b64_tr_b16 v[66:67], v8 offset:41984
    ds_read_b64_tr_b16 v[68:69], v9 offset:40960
    ds_read_b64_tr_b16 v[70:71], v9 offset:41984
    v_mfma_f32_32x32x16_bf16 v[208:223], v[84:87], a[76:79], v[208:223]
    ds_read_b64_tr_b16 v[72:73], v10 offset:40960
    ds_read_b64_tr_b16 v[74:75], v10 offset:41984
    ds_read_b64_tr_b16 v[76:77], v11 offset:40960
    ds_read_b64_tr_b16 v[78:79], v11 offset:41984
    v_mfma_f32_32x32x16_bf16 v[224:239], v[88:91], a[76:79], v[224:239]
    v_mfma_f32_32x32x16_bf16 v[240:255], v[92:95], a[76:79], v[240:255]
    v_mov_b32 v18, s97
    s_waitcnt vmcnt(0)
    s_mov_b64 exec, 0x1
    global_store_dword v19, v18, s[74:75] offset:0 sc1
    s_mov_b64 exec, -1
    s_waitcnt lgkmcnt(0)
    v_mfma_f32_32x32x16_bf16 v[192:207], v[64:67], a[84:87], v[192:207]
    ds_read_b64_tr_b16 v[80:81], v8 offset:45056
    ds_read_b64_tr_b16 v[82:83], v8 offset:46080
    ds_read_b64_tr_b16 v[84:85], v9 offset:45056
    ds_read_b64_tr_b16 v[86:87], v9 offset:46080
    v_mfma_f32_32x32x16_bf16 v[208:223], v[68:71], a[84:87], v[208:223]
    ds_read_b64_tr_b16 v[88:89], v10 offset:45056
    ds_read_b64_tr_b16 v[90:91], v10 offset:46080
    ds_read_b64_tr_b16 v[92:93], v11 offset:45056
    ds_read_b64_tr_b16 v[94:95], v11 offset:46080
    v_mfma_f32_32x32x16_bf16 v[224:239], v[72:75], a[84:87], v[224:239]
    v_mfma_f32_32x32x16_bf16 v[240:255], v[76:79], a[84:87], v[240:255]
    s_waitcnt lgkmcnt(0)
    v_mfma_f32_32x32x16_bf16 v[192:207], v[80:83], a[92:95], v[192:207]
    ds_read_b64_tr_b16 v[64:65], v8 offset:49152
    ds_read_b64_tr_b16 v[66:67], v8 offset:50176
    ds_read_b64_tr_b16 v[68:69], v9 offset:49152
    ds_read_b64_tr_b16 v[70:71], v9 offset:50176
    v_mfma_f32_32x32x16_bf16 v[208:223], v[84:87], a[92:95], v[208:223]
    ds_read_b64_tr_b16 v[72:73], v10 offset:49152
    ds_read_b64_tr_b16 v[74:75], v10 offset:50176
    ds_read_b64_tr_b16 v[76:77], v11 offset:49152
    ds_read_b64_tr_b16 v[78:79], v11 offset:50176
    v_mfma_f32_32x32x16_bf16 v[224:239], v[88:91], a[92:95], v[224:239]
    v_mfma_f32_32x32x16_bf16 v[240:255], v[92:95], a[92:95], v[240:255]
    s_waitcnt lgkmcnt(0)
    v_mfma_f32_32x32x16_bf16 v[192:207], v[64:67], a[100:103], v[192:207]
    ds_read_b64_tr_b16 v[80:81], v8 offset:53248
    ds_read_b64_tr_b16 v[82:83], v8 offset:54272
    ds_read_b64_tr_b16 v[84:85], v9 offset:53248
    ds_read_b64_tr_b16 v[86:87], v9 offset:54272
    v_mfma_f32_32x32x16_bf16 v[208:223], v[68:71], a[100:103], v[208:223]
    ds_read_b64_tr_b16 v[88:89], v10 offset:53248
    ds_read_b64_tr_b16 v[90:91], v10 offset:54272
    ds_read_b64_tr_b16 v[92:93], v11 offset:53248
    ds_read_b64_tr_b16 v[94:95], v11 offset:54272
    v_mfma_f32_32x32x16_bf16 v[224:239], v[72:75], a[100:103], v[224:239]
    v_mfma_f32_32x32x16_bf16 v[240:255], v[76:79], a[100:103], v[240:255]
    s_waitcnt lgkmcnt(0)
    v_mfma_f32_32x32x16_bf16 v[192:207], v[80:83], a[108:111], v[192:207]
    ds_read_b64_tr_b16 v[64:65], v8 offset:57344
    ds_read_b64_tr_b16 v[66:67], v8 offset:58368
    ds_read_b64_tr_b16 v[68:69], v9 offset:57344
    ds_read_b64_tr_b16 v[70:71], v9 offset:58368
    v_mfma_f32_32x32x16_bf16 v[208:223], v[84:87], a[108:111], v[208:223]
    ds_read_b64_tr_b16 v[72:73], v10 offset:57344
    ds_read_b64_tr_b16 v[74:75], v10 offset:58368
    ds_read_b64_tr_b16 v[76:77], v11 offset:57344
    ds_read_b64_tr_b16 v[78:79], v11 offset:58368
    v_mfma_f32_32x32x16_bf16 v[224:239], v[88:91], a[108:111], v[224:239]
    v_mfma_f32_32x32x16_bf16 v[240:255], v[92:95], a[108:111], v[240:255]
    s_waitcnt lgkmcnt(0)
    v_mfma_f32_32x32x16_bf16 v[192:207], v[64:67], a[116:119], v[192:207]
    ds_read_b64_tr_b16 v[80:81], v8 offset:61440
    ds_read_b64_tr_b16 v[82:83], v8 offset:62464
    ds_read_b64_tr_b16 v[84:85], v9 offset:61440
    ds_read_b64_tr_b16 v[86:87], v9 offset:62464
    v_mfma_f32_32x32x16_bf16 v[208:223], v[68:71], a[116:119], v[208:223]
    ds_read_b64_tr_b16 v[88:89], v10 offset:61440
    ds_read_b64_tr_b16 v[90:91], v10 offset:62464
    ds_read_b64_tr_b16 v[92:93], v11 offset:61440
    ds_read_b64_tr_b16 v[94:95], v11 offset:62464
    v_mfma_f32_32x32x16_bf16 v[224:239], v[72:75], a[116:119], v[224:239]
    v_mfma_f32_32x32x16_bf16 v[240:255], v[76:79], a[116:119], v[240:255]
    s_waitcnt lgkmcnt(0)
    v_mfma_f32_32x32x16_bf16 v[192:207], v[80:83], a[124:127], v[192:207]
    ds_read_b64_tr_b16 v[64:65], v24 offset:0
    ds_read_b64_tr_b16 v[66:67], v24 offset:1024
    ds_read_b64_tr_b16 v[68:69], v25 offset:0
    ds_read_b64_tr_b16 v[70:71], v25 offset:1024
    v_mfma_f32_32x32x16_bf16 v[208:223], v[84:87], a[124:127], v[208:223]
    ds_read_b64_tr_b16 v[72:73], v26 offset:0
    ds_read_b64_tr_b16 v[74:75], v26 offset:1024
    ds_read_b64_tr_b16 v[76:77], v27 offset:0
    ds_read_b64_tr_b16 v[78:79], v27 offset:1024
    v_mfma_f32_32x32x16_bf16 v[224:239], v[88:91], a[124:127], v[224:239]
    v_mfma_f32_32x32x16_bf16 v[240:255], v[92:95], a[124:127], v[240:255]
    s_waitcnt lgkmcnt(0)
    v_mfma_f32_32x32x16_bf16 v[192:207], v[64:67], a[132:135], v[192:207]
    ds_read_b64_tr_b16 v[80:81], v24 offset:4096
    ds_read_b64_tr_b16 v[82:83], v24 offset:5120
    ds_read_b64_tr_b16 v[84:85], v25 offset:4096
    ds_read_b64_tr_b16 v[86:87], v25 offset:5120
    v_mfma_f32_32x32x16_bf16 v[208:223], v[68:71], a[132:135], v[208:223]
    ds_read_b64_tr_b16 v[88:89], v26 offset:4096
    ds_read_b64_tr_b16 v[90:91], v26 offset:5120
    ds_read_b64_tr_b16 v[92:93], v27 offset:4096
    ds_read_b64_tr_b16 v[94:95], v27 offset:5120
    v_mfma_f32_32x32x16_bf16 v[224:239], v[72:75], a[132:135], v[224:239]
    v_mfma_f32_32x32x16_bf16 v[240:255], v[76:79], a[132:135], v[240:255]
    s_waitcnt lgkmcnt(0)
    v_mfma_f32_32x32x16_bf16 v[192:207], v[80:83], a[140:143], v[192:207]
    ds_read_b64_tr_b16 v[64:65], v24 offset:8192
    ds_read_b64_tr_b16 v[66:67], v24 offset:9216
    ds_read_b64_tr_b16 v[68:69], v25 offset:8192
    ds_read_b64_tr_b16 v[70:71], v25 offset:9216
    v_mfma_f32_32x32x16_bf16 v[208:223], v[84:87], a[140:143], v[208:223]
    ds_read_b64_tr_b16 v[72:73], v26 offset:8192
    ds_read_b64_tr_b16 v[74:75], v26 offset:9216
    ds_read_b64_tr_b16 v[76:77], v27 offset:8192
    ds_read_b64_tr_b16 v[78:79], v27 offset:9216
    v_mfma_f32_32x32x16_bf16 v[224:239], v[88:91], a[140:143], v[224:239]
    v_mfma_f32_32x32x16_bf16 v[240:255], v[92:95], a[140:143], v[240:255]
    s_waitcnt lgkmcnt(0)
    v_mfma_f32_32x32x16_bf16 v[192:207], v[64:67], a[148:151], v[192:207]
    ds_read_b64_tr_b16 v[80:81], v24 offset:12288
    ds_read_b64_tr_b16 v[82:83], v24 offset:13312
    ds_read_b64_tr_b16 v[84:85], v25 offset:12288
    ds_read_b64_tr_b16 v[86:87], v25 offset:13312
    v_mfma_f32_32x32x16_bf16 v[208:223], v[68:71], a[148:151], v[208:223]
    ds_read_b64_tr_b16 v[88:89], v26 offset:12288
    ds_read_b64_tr_b16 v[90:91], v26 offset:13312
    ds_read_b64_tr_b16 v[92:93], v27 offset:12288
    ds_read_b64_tr_b16 v[94:95], v27 offset:13312
    v_mfma_f32_32x32x16_bf16 v[224:239], v[72:75], a[148:151], v[224:239]
    v_mfma_f32_32x32x16_bf16 v[240:255], v[76:79], a[148:151], v[240:255]
    s_waitcnt lgkmcnt(0)
    v_mfma_f32_32x32x16_bf16 v[192:207], v[80:83], a[156:159], v[192:207]
    ds_read_b64_tr_b16 v[64:65], v24 offset:16384
    ds_read_b64_tr_b16 v[66:67], v24 offset:17408
    ds_read_b64_tr_b16 v[68:69], v25 offset:16384
    ds_read_b64_tr_b16 v[70:71], v25 offset:17408
    v_mfma_f32_32x32x16_bf16 v[208:223], v[84:87], a[156:159], v[208:223]
    ds_read_b64_tr_b16 v[72:73], v26 offset:16384
    ds_read_b64_tr_b16 v[74:75], v26 offset:17408
    ds_read_b64_tr_b16 v[76:77], v27 offset:16384
    ds_read_b64_tr_b16 v[78:79], v27 offset:17408
    v_mfma_f32_32x32x16_bf16 v[224:239], v[88:91], a[156:159], v[224:239]
    v_mfma_f32_32x32x16_bf16 v[240:255], v[92:95], a[156:159], v[240:255]
    s_waitcnt lgkmcnt(0)
    v_mfma_f32_32x32x16_bf16 v[192:207], v[64:67], a[164:167], v[192:207]
    ds_read_b64_tr_b16 v[80:81], v24 offset:20480
    ds_read_b64_tr_b16 v[82:83], v24 offset:21504
    ds_read_b64_tr_b16 v[84:85], v25 offset:20480
    ds_read_b64_tr_b16 v[86:87], v25 offset:21504
    v_mfma_f32_32x32x16_bf16 v[208:223], v[68:71], a[164:167], v[208:223]
    ds_read_b64_tr_b16 v[88:89], v26 offset:20480
    ds_read_b64_tr_b16 v[90:91], v26 offset:21504
    ds_read_b64_tr_b16 v[92:93], v27 offset:20480
    ds_read_b64_tr_b16 v[94:95], v27 offset:21504
    v_mfma_f32_32x32x16_bf16 v[224:239], v[72:75], a[164:167], v[224:239]
    v_mfma_f32_32x32x16_bf16 v[240:255], v[76:79], a[164:167], v[240:255]
    s_waitcnt lgkmcnt(0)
    v_mfma_f32_32x32x16_bf16 v[192:207], v[80:83], a[172:175], v[192:207]
    ds_read_b64_tr_b16 v[64:65], v24 offset:24576
    ds_read_b64_tr_b16 v[66:67], v24 offset:25600
    ds_read_b64_tr_b16 v[68:69], v25 offset:24576
    ds_read_b64_tr_b16 v[70:71], v25 offset:25600
    v_mfma_f32_32x32x16_bf16 v[208:223], v[84:87], a[172:175], v[208:223]
    ds_read_b64_tr_b16 v[72:73], v26 offset:24576
    ds_read_b64_tr_b16 v[74:75], v26 offset:25600
    ds_read_b64_tr_b16 v[76:77], v27 offset:24576
    ds_read_b64_tr_b16 v[78:79], v27 offset:25600
    v_mfma_f32_32x32x16_bf16 v[224:239], v[88:91], a[172:175], v[224:239]
    v_mfma_f32_32x32x16_bf16 v[240:255], v[92:95], a[172:175], v[240:255]
    s_waitcnt lgkmcnt(0)
    v_mfma_f32_32x32x16_bf16 v[192:207], v[64:67], a[180:183], v[192:207]
    ds_read_b64_tr_b16 v[80:81], v24 offset:28672
    ds_read_b64_tr_b16 v[82:83], v24 offset:29696
    ds_read_b64_tr_b16 v[84:85], v25 offset:28672
    ds_read_b64_tr_b16 v[86:87], v25 offset:29696
    v_mfma_f32_32x32x16_bf16 v[208:223], v[68:71], a[180:183], v[208:223]
    ds_read_b64_tr_b16 v[88:89], v26 offset:28672
    ds_read_b64_tr_b16 v[90:91], v26 offset:29696
    ds_read_b64_tr_b16 v[92:93], v27 offset:28672
    ds_read_b64_tr_b16 v[94:95], v27 offset:29696
    v_mfma_f32_32x32x16_bf16 v[224:239], v[72:75], a[180:183], v[224:239]
    v_mfma_f32_32x32x16_bf16 v[240:255], v[76:79], a[180:183], v[240:255]
    s_waitcnt lgkmcnt(0)
    v_mfma_f32_32x32x16_bf16 v[192:207], v[80:83], a[188:191], v[192:207]
    ds_read_b64_tr_b16 v[64:65], v24 offset:32768
    ds_read_b64_tr_b16 v[66:67], v24 offset:33792
    ds_read_b64_tr_b16 v[68:69], v25 offset:32768
    ds_read_b64_tr_b16 v[70:71], v25 offset:33792
    v_mfma_f32_32x32x16_bf16 v[208:223], v[84:87], a[188:191], v[208:223]
    ds_read_b64_tr_b16 v[72:73], v26 offset:32768
    ds_read_b64_tr_b16 v[74:75], v26 offset:33792
    ds_read_b64_tr_b16 v[76:77], v27 offset:32768
    ds_read_b64_tr_b16 v[78:79], v27 offset:33792
    v_mfma_f32_32x32x16_bf16 v[224:239], v[88:91], a[188:191], v[224:239]
    v_mfma_f32_32x32x16_bf16 v[240:255], v[92:95], a[188:191], v[240:255]
    s_waitcnt lgkmcnt(0)
    v_mfma_f32_32x32x16_bf16 v[192:207], v[64:67], a[196:199], v[192:207]
    ds_read_b64_tr_b16 v[80:81], v24 offset:36864
    ds_read_b64_tr_b16 v[82:83], v24 offset:37888
    ds_read_b64_tr_b16 v[84:85], v25 offset:36864
    ds_read_b64_tr_b16 v[86:87], v25 offset:37888
    v_mfma_f32_32x32x16_bf16 v[208:223], v[68:71], a[196:199], v[208:223]
    ds_read_b64_tr_b16 v[88:89], v26 offset:36864
    ds_read_b64_tr_b16 v[90:91], v26 offset:37888
    ds_read_b64_tr_b16 v[92:93], v27 offset:36864
    ds_read_b64_tr_b16 v[94:95], v27 offset:37888
    v_mfma_f32_32x32x16_bf16 v[224:239], v[72:75], a[196:199], v[224:239]
    v_mfma_f32_32x32x16_bf16 v[240:255], v[76:79], a[196:199], v[240:255]
    s_waitcnt lgkmcnt(0)
    v_mfma_f32_32x32x16_bf16 v[192:207], v[80:83], a[204:207], v[192:207]
    ds_read_b64_tr_b16 v[64:65], v24 offset:40960
    ds_read_b64_tr_b16 v[66:67], v24 offset:41984
    ds_read_b64_tr_b16 v[68:69], v25 offset:40960
    ds_read_b64_tr_b16 v[70:71], v25 offset:41984
    v_mfma_f32_32x32x16_bf16 v[208:223], v[84:87], a[204:207], v[208:223]
    ds_read_b64_tr_b16 v[72:73], v26 offset:40960
    ds_read_b64_tr_b16 v[74:75], v26 offset:41984
    ds_read_b64_tr_b16 v[76:77], v27 offset:40960
    ds_read_b64_tr_b16 v[78:79], v27 offset:41984
    v_mfma_f32_32x32x16_bf16 v[224:239], v[88:91], a[204:207], v[224:239]
    v_mfma_f32_32x32x16_bf16 v[240:255], v[92:95], a[204:207], v[240:255]
    s_waitcnt lgkmcnt(0)
    v_mfma_f32_32x32x16_bf16 v[192:207], v[64:67], a[212:215], v[192:207]
    ds_read_b64_tr_b16 v[80:81], v24 offset:45056
    ds_read_b64_tr_b16 v[82:83], v24 offset:46080
    ds_read_b64_tr_b16 v[84:85], v25 offset:45056
    ds_read_b64_tr_b16 v[86:87], v25 offset:46080
    v_mfma_f32_32x32x16_bf16 v[208:223], v[68:71], a[212:215], v[208:223]
    ds_read_b64_tr_b16 v[88:89], v26 offset:45056
    ds_read_b64_tr_b16 v[90:91], v26 offset:46080
    ds_read_b64_tr_b16 v[92:93], v27 offset:45056
    ds_read_b64_tr_b16 v[94:95], v27 offset:46080
    v_mfma_f32_32x32x16_bf16 v[224:239], v[72:75], a[212:215], v[224:239]
    v_mfma_f32_32x32x16_bf16 v[240:255], v[76:79], a[212:215], v[240:255]
    s_waitcnt lgkmcnt(0)
    v_mfma_f32_32x32x16_bf16 v[192:207], v[80:83], a[220:223], v[192:207]
    ds_read_b64_tr_b16 v[64:65], v24 offset:49152
    ds_read_b64_tr_b16 v[66:67], v24 offset:50176
    ds_read_b64_tr_b16 v[68:69], v25 offset:49152
    ds_read_b64_tr_b16 v[70:71], v25 offset:50176
    v_mfma_f32_32x32x16_bf16 v[208:223], v[84:87], a[220:223], v[208:223]
    ds_read_b64_tr_b16 v[72:73], v26 offset:49152
    ds_read_b64_tr_b16 v[74:75], v26 offset:50176
    ds_read_b64_tr_b16 v[76:77], v27 offset:49152
    ds_read_b64_tr_b16 v[78:79], v27 offset:50176
    v_mfma_f32_32x32x16_bf16 v[224:239], v[88:91], a[220:223], v[224:239]
    v_mfma_f32_32x32x16_bf16 v[240:255], v[92:95], a[220:223], v[240:255]
    s_waitcnt lgkmcnt(0)
    v_mfma_f32_32x32x16_bf16 v[192:207], v[64:67], a[228:231], v[192:207]
    ds_read_b64_tr_b16 v[80:81], v24 offset:53248
    ds_read_b64_tr_b16 v[82:83], v24 offset:54272
    ds_read_b64_tr_b16 v[84:85], v25 offset:53248
    ds_read_b64_tr_b16 v[86:87], v25 offset:54272
    v_mfma_f32_32x32x16_bf16 v[208:223], v[68:71], a[228:231], v[208:223]
    ds_read_b64_tr_b16 v[88:89], v26 offset:53248
    ds_read_b64_tr_b16 v[90:91], v26 offset:54272
    ds_read_b64_tr_b16 v[92:93], v27 offset:53248
    ds_read_b64_tr_b16 v[94:95], v27 offset:54272
    v_mfma_f32_32x32x16_bf16 v[224:239], v[72:75], a[228:231], v[224:239]
    v_mfma_f32_32x32x16_bf16 v[240:255], v[76:79], a[228:231], v[240:255]
    s_waitcnt lgkmcnt(0)
    v_mfma_f32_32x32x16_bf16 v[192:207], v[80:83], a[236:239], v[192:207]
    ds_read_b64_tr_b16 v[64:65], v24 offset:57344
    ds_read_b64_tr_b16 v[66:67], v24 offset:58368
    ds_read_b64_tr_b16 v[68:69], v25 offset:57344
    ds_read_b64_tr_b16 v[70:71], v25 offset:58368
    v_mfma_f32_32x32x16_bf16 v[208:223], v[84:87], a[236:239], v[208:223]
    ds_read_b64_tr_b16 v[72:73], v26 offset:57344
    ds_read_b64_tr_b16 v[74:75], v26 offset:58368
    ds_read_b64_tr_b16 v[76:77], v27 offset:57344
    ds_read_b64_tr_b16 v[78:79], v27 offset:58368
    v_mfma_f32_32x32x16_bf16 v[224:239], v[88:91], a[236:239], v[224:239]
    v_mfma_f32_32x32x16_bf16 v[240:255], v[92:95], a[236:239], v[240:255]
    s_waitcnt lgkmcnt(0)
    v_mfma_f32_32x32x16_bf16 v[192:207], v[64:67], a[244:247], v[192:207]
    ds_read_b64_tr_b16 v[80:81], v24 offset:61440
    ds_read_b64_tr_b16 v[82:83], v24 offset:62464
    ds_read_b64_tr_b16 v[84:85], v25 offset:61440
    ds_read_b64_tr_b16 v[86:87], v25 offset:62464
    v_mfma_f32_32x32x16_bf16 v[208:223], v[68:71], a[244:247], v[208:223]
    ds_read_b64_tr_b16 v[88:89], v26 offset:61440
    ds_read_b64_tr_b16 v[90:91], v26 offset:62464
    ds_read_b64_tr_b16 v[92:93], v27 offset:61440
    ds_read_b64_tr_b16 v[94:95], v27 offset:62464
    v_mfma_f32_32x32x16_bf16 v[224:239], v[72:75], a[244:247], v[224:239]
    v_mfma_f32_32x32x16_bf16 v[240:255], v[76:79], a[244:247], v[240:255]
    s_waitcnt lgkmcnt(0)
    v_mfma_f32_32x32x16_bf16 v[192:207], v[80:83], a[252:255], v[192:207]
    v_mfma_f32_32x32x16_bf16 v[208:223], v[84:87], a[252:255], v[208:223]
    v_mfma_f32_32x32x16_bf16 v[224:239], v[88:91], a[252:255], v[224:239]
    v_mfma_f32_32x32x16_bf16 v[240:255], v[92:95], a[252:255], v[240:255]
    v_mov_b32 v28, v14
    v_add_u32 v28, 0, v28
    v_add_u32 v29, 131072, v28
    s_nop 5
    v_cvt_pk_bf16_f32 v32, v192, v193
    v_cvt_pk_bf16_f32 v33, v194, v195
    v_cvt_pk_bf16_f32 v34, v196, v197
    v_cvt_pk_bf16_f32 v35, v198, v199
    v_cvt_pk_bf16_f32 v36, v200, v201
    v_cvt_pk_bf16_f32 v37, v202, v203
    v_cvt_pk_bf16_f32 v38, v204, v205
    v_cvt_pk_bf16_f32 v39, v206, v207
    global_store_dwordx4 v29, v[32:35], s[68:69] offset:0 sc1
    global_store_dwordx4 v29, v[36:39], s[68:69] offset:512 sc1
    v_cvt_pk_bf16_f32 v40, v208, v209
    v_cvt_pk_bf16_f32 v41, v210, v211
    v_cvt_pk_bf16_f32 v42, v212, v213
    v_cvt_pk_bf16_f32 v43, v214, v215
    v_cvt_pk_bf16_f32 v44, v216, v217
    v_cvt_pk_bf16_f32 v45, v218, v219
    v_cvt_pk_bf16_f32 v46, v220, v221
    v_cvt_pk_bf16_f32 v47, v222, v223
    global_store_dwordx4 v29, v[40:43], s[68:69] offset:1024 sc1
    global_store_dwordx4 v29, v[44:47], s[68:69] offset:1536 sc1
    v_cvt_pk_bf16_f32 v32, v224, v225
    v_cvt_pk_bf16_f32 v33, v226, v227
    v_cvt_pk_bf16_f32 v34, v228, v229
    v_cvt_pk_bf16_f32 v35, v230, v231
    v_cvt_pk_bf16_f32 v36, v232, v233
    v_cvt_pk_bf16_f32 v37, v234, v235
    v_cvt_pk_bf16_f32 v38, v236, v237
    v_cvt_pk_bf16_f32 v39, v238, v239
    global_store_dwordx4 v29, v[32:35], s[68:69] offset:2048 sc1
    global_store_dwordx4 v29, v[36:39], s[68:69] offset:2560 sc1
    v_cvt_pk_bf16_f32 v40, v240, v241
    v_cvt_pk_bf16_f32 v41, v242, v243
    v_cvt_pk_bf16_f32 v42, v244, v245
    v_cvt_pk_bf16_f32 v43, v246, v247
    v_cvt_pk_bf16_f32 v44, v248, v249
    v_cvt_pk_bf16_f32 v45, v250, v251
    v_cvt_pk_bf16_f32 v46, v252, v253
    v_cvt_pk_bf16_f32 v47, v254, v255
    global_store_dwordx4 v29, v[40:43], s[68:69] offset:3072 sc1
    global_store_dwordx4 v29, v[44:47], s[68:69] offset:3584 sc1
    v_mov_b32 v18, s97
    s_waitcnt vmcnt(0)
    s_mov_b64 exec, 0x1
    global_store_dword v19, v18, s[74:75] offset:16 sc1
    s_mov_b64 exec, -1
    s_barrier
    s_add_u32 s71, s70, 0
    s_add_u32 m0, s71, 0
    v_add_u32 v2, 0, v12
    global_load_lds_dwordx4 v2, s[40:41]
    s_add_u32 m0, s71, 4096
    v_add_u32 v3, 131072, v12
    global_load_lds_dwordx4 v3, s[40:41]
    s_add_u32 m0, s71, 8192
    v_add_u32 v2, 262144, v12
    global_load_lds_dwordx4 v2, s[40:41]
    s_add_u32 m0, s71, 12288
    v_add_u32 v3, 393216, v12
    global_load_lds_dwordx4 v3, s[40:41]
    s_add_u32 m0, s71, 16384
    v_add_u32 v2, 524288, v12
    global_load_lds_dwordx4 v2, s[40:41]
    s_add_u32 m0, s71, 20480
    v_add_u32 v3, 655360, v12
    global_load_lds_dwordx4 v3, s[40:41]
    s_add_u32 m0, s71, 24576
    v_add_u32 v2, 786432, v12
    global_load_lds_dwordx4 v2, s[40:41]
    s_add_u32 m0, s71, 28672
    v_add_u32 v3, 917504, v12
    global_load_lds_dwordx4 v3, s[40:41]
    s_add_u32 s71, s70, 32768
    s_add_u32 m0, s71, 0
    v_add_u32 v2, 1048576, v12
    global_load_lds_dwordx4 v2, s[40:41]
    s_add_u32 m0, s71, 4096
    v_add_u32 v3, 1179648, v12
    global_load_lds_dwordx4 v3, s[40:41]
    s_add_u32 m0, s71, 8192
    v_add_u32 v2, 1310720, v12
    global_load_lds_dwordx4 v2, s[40:41]
    s_add_u32 m0, s71, 12288
    v_add_u32 v3, 1441792, v12
    global_load_lds_dwordx4 v3, s[40:41]
    s_add_u32 m0, s71, 16384
    v_add_u32 v2, 1572864, v12
    global_load_lds_dwordx4 v2, s[40:41]
    s_add_u32 m0, s71, 20480
    v_add_u32 v3, 1703936, v12
    global_load_lds_dwordx4 v3, s[40:41]
    s_add_u32 m0, s71, 24576
    v_add_u32 v2, 1835008, v12
    global_load_lds_dwordx4 v2, s[40:41]
    s_add_u32 m0, s71, 28672
    v_add_u32 v3, 1966080, v12
    global_load_lds_dwordx4 v3, s[40:41]
    s_add_u32 s71, s70, 65536
    s_add_u32 m0, s71, 0
    v_add_u32 v2, 2097152, v12
    global_load_lds_dwordx4 v2, s[40:41]
    s_add_u32 m0, s71, 4096
    v_add_u32 v3, 2228224, v12
    global_load_lds_dwordx4 v3, s[40:41]
    s_add_u32 m0, s71, 8192
    v_add_u32 v2, 2359296, v12
    global_load_lds_dwordx4 v2, s[40:41]
    s_add_u32 m0, s71, 12288
    v_add_u32 v3, 2490368, v12
    global_load_lds_dwordx4 v3, s[40:41]
    s_add_u32 m0, s71, 16384
    v_add_u32 v2, 2621440, v12
    global_load_lds_dwordx4 v2, s[40:41]
    s_add_u32 m0, s71, 20480
    v_add_u32 v3, 2752512, v12
    global_load_lds_dwordx4 v3, s[40:41]
    s_add_u32 m0, s71, 24576
    v_add_u32 v2, 2883584, v12
    global_load_lds_dwordx4 v2, s[40:41]
    s_add_u32 m0, s71, 28672
    v_add_u32 v3, 3014656, v12
    global_load_lds_dwordx4 v3, s[40:41]
    s_add_u32 s71, s70, 98304
    s_add_u32 m0, s71, 0
    v_add_u32 v2, 3145728, v12
    global_load_lds_dwordx4 v2, s[40:41]
    s_add_u32 m0, s71, 4096
    v_add_u32 v3, 3276800, v12
    global_load_lds_dwordx4 v3, s[40:41]
    s_add_u32 m0, s71, 8192
    v_add_u32 v2, 3407872, v12
    global_load_lds_dwordx4 v2, s[40:41]
    s_add_u32 m0, s71, 12288
    v_add_u32 v3, 3538944, v12
    global_load_lds_dwordx4 v3, s[40:41]
    s_add_u32 m0, s71, 16384
    v_add_u32 v2, 3670016, v12
    global_load_lds_dwordx4 v2, s[40:41]
    s_add_u32 m0, s71, 20480
    v_add_u32 v3, 3801088, v12
    global_load_lds_dwordx4 v3, s[40:41]
    s_add_u32 m0, s71, 24576
    v_add_u32 v2, 3932160, v12
    global_load_lds_dwordx4 v2, s[40:41]
    s_add_u32 m0, s71, 28672
    v_add_u32 v3, 4063232, v12
    global_load_lds_dwordx4 v3, s[40:41]
    v_mov_b64 v[128:129], 0
    v_mov_b64 v[130:131], 0
    v_mov_b64 v[132:133], 0
    v_mov_b64 v[134:135], 0
    v_mov_b64 v[136:137], 0
    v_mov_b64 v[138:139], 0
    v_mov_b64 v[140:141], 0
    v_mov_b64 v[142:143], 0
    v_mov_b64 v[144:145], 0
    v_mov_b64 v[146:147], 0
    v_mov_b64 v[148:149], 0
    v_mov_b64 v[150:151], 0
    v_mov_b64 v[152:153], 0
    v_mov_b64 v[154:155], 0
    v_mov_b64 v[156:157], 0
    v_mov_b64 v[158:159], 0
    v_mov_b64 v[160:161], 0
    v_mov_b64 v[162:163], 0
    v_mov_b64 v[164:165], 0
    v_mov_b64 v[166:167], 0
    v_mov_b64 v[168:169], 0
    v_mov_b64 v[170:171], 0
    v_mov_b64 v[172:173], 0
    v_mov_b64 v[174:175], 0
    v_mov_b64 v[176:177], 0
    v_mov_b64 v[178:179], 0
    v_mov_b64 v[180:181], 0
    v_mov_b64 v[182:183], 0
    v_mov_b64 v[184:185], 0
    v_mov_b64 v[186:187], 0
    v_mov_b64 v[188:189], 0
    v_mov_b64 v[190:191], 0
    v_mov_b64 v[192:193], 0
    v_mov_b64 v[194:195], 0
    v_mov_b64 v[196:197], 0
    v_mov_b64 v[198:199], 0
    v_mov_b64 v[200:201], 0
    v_mov_b64 v[202:203], 0
    v_mov_b64 v[204:205], 0
    v_mov_b64 v[206:207], 0
    v_mov_b64 v[208:209], 0
    v_mov_b64 v[210:211], 0
    v_mov_b64 v[212:213], 0
    v_mov_b64 v[214:215], 0
    v_mov_b64 v[216:217], 0
    v_mov_b64 v[218:219], 0
    v_mov_b64 v[220:221], 0
    v_mov_b64 v[222:223], 0
    v_mov_b64 v[224:225], 0
    v_mov_b64 v[226:227], 0
    v_mov_b64 v[228:229], 0
    v_mov_b64 v[230:231], 0
    v_mov_b64 v[232:233], 0
    v_mov_b64 v[234:235], 0
    v_mov_b64 v[236:237], 0
    v_mov_b64 v[238:239], 0
    v_mov_b64 v[240:241], 0
    v_mov_b64 v[242:243], 0
    v_mov_b64 v[244:245], 0
    v_mov_b64 v[246:247], 0
    v_mov_b64 v[248:249], 0
    v_mov_b64 v[250:251], 0
    v_mov_b64 v[252:253], 0
    v_mov_b64 v[254:255], 0
    s_waitcnt vmcnt(24)
    s_barrier
    v_add_u32 v24, 0, v8
    v_add_u32 v25, 0, v9
    v_add_u32 v26, 0, v10
    v_add_u32 v27, 0, v11
    ds_read_b64_tr_b16 v[64:65], v24 offset:0
    ds_read_b64_tr_b16 v[66:67], v24 offset:1024
    ds_read_b64_tr_b16 v[68:69], v25 offset:0
    ds_read_b64_tr_b16 v[70:71], v25 offset:1024
    ds_read_b64_tr_b16 v[72:73], v26 offset:0
    ds_read_b64_tr_b16 v[74:75], v26 offset:1024
    ds_read_b64_tr_b16 v[76:77], v27 offset:0
    ds_read_b64_tr_b16 v[78:79], v27 offset:1024
    s_waitcnt lgkmcnt(0)
    v_mfma_f32_32x32x16_bf16 v[128:143], v[64:67], a[0:3], v[128:143]
    ds_read_b64_tr_b16 v[80:81], v24 offset:4096
    ds_read_b64_tr_b16 v[82:83], v24 offset:5120
    v_mfma_f32_32x32x16_bf16 v[144:159], v[68:71], a[0:3], v[144:159]
    ds_read_b64_tr_b16 v[84:85], v25 offset:4096
    ds_read_b64_tr_b16 v[86:87], v25 offset:5120
    v_mfma_f32_32x32x16_bf16 v[160:175], v[72:75], a[0:3], v[160:175]
    ds_read_b64_tr_b16 v[88:89], v26 offset:4096
    ds_read_b64_tr_b16 v[90:91], v26 offset:5120
    v_mfma_f32_32x32x16_bf16 v[176:191], v[76:79], a[0:3], v[176:191]
    ds_read_b64_tr_b16 v[92:93], v27 offset:4096
    ds_read_b64_tr_b16 v[94:95], v27 offset:5120
    v_mfma_f32_32x32x16_bf16 v[192:207], v[64:67], a[4:7], v[192:207]
    v_mfma_f32_32x32x16_bf16 v[208:223], v[68:71], a[4:7], v[208:223]
    v_mfma_f32_32x32x16_bf16 v[224:239], v[72:75], a[4:7], v[224:239]
    v_mfma_f32_32x32x16_bf16 v[240:255], v[76:79], a[4:7], v[240:255]
    s_waitcnt lgkmcnt(0)
    v_mfma_f32_32x32x16_bf16 v[128:143], v[80:83], a[8:11], v[128:143]
    ds_read_b64_tr_b16 v[64:65], v24 offset:8192
    ds_read_b64_tr_b16 v[66:67], v24 offset:9216
    v_mfma_f32_32x32x16_bf16 v[144:159], v[84:87], a[8:11], v[144:159]
    ds_read_b64_tr_b16 v[68:69], v25 offset:8192
    ds_read_b64_tr_b16 v[70:71], v25 offset:9216
    v_mfma_f32_32x32x16_bf16 v[160:175], v[88:91], a[8:11], v[160:175]
    ds_read_b64_tr_b16 v[72:73], v26 offset:8192
    ds_read_b64_tr_b16 v[74:75], v26 offset:9216
    v_mfma_f32_32x32x16_bf16 v[176:191], v[92:95], a[8:11], v[176:191]
    ds_read_b64_tr_b16 v[76:77], v27 offset:8192
    ds_read_b64_tr_b16 v[78:79], v27 offset:9216
    v_mfma_f32_32x32x16_bf16 v[192:207], v[80:83], a[12:15], v[192:207]
    v_mfma_f32_32x32x16_bf16 v[208:223], v[84:87], a[12:15], v[208:223]
    v_mfma_f32_32x32x16_bf16 v[224:239], v[88:91], a[12:15], v[224:239]
    v_mfma_f32_32x32x16_bf16 v[240:255], v[92:95], a[12:15], v[240:255]
    s_waitcnt lgkmcnt(0)
    v_mfma_f32_32x32x16_bf16 v[128:143], v[64:67], a[16:19], v[128:143]
    ds_read_b64_tr_b16 v[80:81], v24 offset:12288
    ds_read_b64_tr_b16 v[82:83], v24 offset:13312
    v_mfma_f32_32x32x16_bf16 v[144:159], v[68:71], a[16:19], v[144:159]
    ds_read_b64_tr_b16 v[84:85], v25 offset:12288
    ds_read_b64_tr_b16 v[86:87], v25 offset:13312
    v_mfma_f32_32x32x16_bf16 v[160:175], v[72:75], a[16:19], v[160:175]
    ds_read_b64_tr_b16 v[88:89], v26 offset:12288
    ds_read_b64_tr_b16 v[90:91], v26 offset:13312
    v_mfma_f32_32x32x16_bf16 v[176:191], v[76:79], a[16:19], v[176:191]
    ds_read_b64_tr_b16 v[92:93], v27 offset:12288
    ds_read_b64_tr_b16 v[94:95], v27 offset:13312
    v_mfma_f32_32x32x16_bf16 v[192:207], v[64:67], a[20:23], v[192:207]
    v_mfma_f32_32x32x16_bf16 v[208:223], v[68:71], a[20:23], v[208:223]
    v_mfma_f32_32x32x16_bf16 v[224:239], v[72:75], a[20:23], v[224:239]
    v_mfma_f32_32x32x16_bf16 v[240:255], v[76:79], a[20:23], v[240:255]
    s_waitcnt lgkmcnt(0)
    v_mfma_f32_32x32x16_bf16 v[128:143], v[80:83], a[24:27], v[128:143]
    ds_read_b64_tr_b16 v[64:65], v24 offset:16384
    ds_read_b64_tr_b16 v[66:67], v24 offset:17408
    v_mfma_f32_32x32x16_bf16 v[144:159], v[84:87], a[24:27], v[144:159]
    ds_read_b64_tr_b16 v[68:69], v25 offset:16384
    ds_read_b64_tr_b16 v[70:71], v25 offset:17408
    v_mfma_f32_32x32x16_bf16 v[160:175], v[88:91], a[24:27], v[160:175]
    ds_read_b64_tr_b16 v[72:73], v26 offset:16384
    ds_read_b64_tr_b16 v[74:75], v26 offset:17408
    v_mfma_f32_32x32x16_bf16 v[176:191], v[92:95], a[24:27], v[176:191]
    ds_read_b64_tr_b16 v[76:77], v27 offset:16384
    ds_read_b64_tr_b16 v[78:79], v27 offset:17408
    v_mfma_f32_32x32x16_bf16 v[192:207], v[80:83], a[28:31], v[192:207]
    v_mfma_f32_32x32x16_bf16 v[208:223], v[84:87], a[28:31], v[208:223]
    v_mfma_f32_32x32x16_bf16 v[224:239], v[88:91], a[28:31], v[224:239]
    v_mfma_f32_32x32x16_bf16 v[240:255], v[92:95], a[28:31], v[240:255]
    s_waitcnt lgkmcnt(0)
    v_mfma_f32_32x32x16_bf16 v[128:143], v[64:67], a[32:35], v[128:143]
    ds_read_b64_tr_b16 v[80:81], v24 offset:20480
    ds_read_b64_tr_b16 v[82:83], v24 offset:21504
    v_mfma_f32_32x32x16_bf16 v[144:159], v[68:71], a[32:35], v[144:159]
    ds_read_b64_tr_b16 v[84:85], v25 offset:20480
    ds_read_b64_tr_b16 v[86:87], v25 offset:21504
    v_mfma_f32_32x32x16_bf16 v[160:175], v[72:75], a[32:35], v[160:175]
    ds_read_b64_tr_b16 v[88:89], v26 offset:20480
    ds_read_b64_tr_b16 v[90:91], v26 offset:21504
    v_mfma_f32_32x32x16_bf16 v[176:191], v[76:79], a[32:35], v[176:191]
    ds_read_b64_tr_b16 v[92:93], v27 offset:20480
    ds_read_b64_tr_b16 v[94:95], v27 offset:21504
    v_mfma_f32_32x32x16_bf16 v[192:207], v[64:67], a[36:39], v[192:207]
    v_mfma_f32_32x32x16_bf16 v[208:223], v[68:71], a[36:39], v[208:223]
    v_mfma_f32_32x32x16_bf16 v[224:239], v[72:75], a[36:39], v[224:239]
    v_mfma_f32_32x32x16_bf16 v[240:255], v[76:79], a[36:39], v[240:255]
    s_waitcnt lgkmcnt(0)
    v_mfma_f32_32x32x16_bf16 v[128:143], v[80:83], a[40:43], v[128:143]
    ds_read_b64_tr_b16 v[64:65], v24 offset:24576
    ds_read_b64_tr_b16 v[66:67], v24 offset:25600
    v_mfma_f32_32x32x16_bf16 v[144:159], v[84:87], a[40:43], v[144:159]
    ds_read_b64_tr_b16 v[68:69], v25 offset:24576
    ds_read_b64_tr_b16 v[70:71], v25 offset:25600
    v_mfma_f32_32x32x16_bf16 v[160:175], v[88:91], a[40:43], v[160:175]
    ds_read_b64_tr_b16 v[72:73], v26 offset:24576
    ds_read_b64_tr_b16 v[74:75], v26 offset:25600
    v_mfma_f32_32x32x16_bf16 v[176:191], v[92:95], a[40:43], v[176:191]
    ds_read_b64_tr_b16 v[76:77], v27 offset:24576
    ds_read_b64_tr_b16 v[78:79], v27 offset:25600
    v_mfma_f32_32x32x16_bf16 v[192:207], v[80:83], a[44:47], v[192:207]
    v_mfma_f32_32x32x16_bf16 v[208:223], v[84:87], a[44:47], v[208:223]
    v_mfma_f32_32x32x16_bf16 v[224:239], v[88:91], a[44:47], v[224:239]
    v_mfma_f32_32x32x16_bf16 v[240:255], v[92:95], a[44:47], v[240:255]
    s_waitcnt lgkmcnt(0)
    v_mfma_f32_32x32x16_bf16 v[128:143], v[64:67], a[48:51], v[128:143]
    ds_read_b64_tr_b16 v[80:81], v24 offset:28672
    ds_read_b64_tr_b16 v[82:83], v24 offset:29696
    v_mfma_f32_32x32x16_bf16 v[144:159], v[68:71], a[48:51], v[144:159]
    ds_read_b64_tr_b16 v[84:85], v25 offset:28672
    ds_read_b64_tr_b16 v[86:87], v25 offset:29696
    v_mfma_f32_32x32x16_bf16 v[160:175], v[72:75], a[48:51], v[160:175]
    ds_read_b64_tr_b16 v[88:89], v26 offset:28672
    ds_read_b64_tr_b16 v[90:91], v26 offset:29696
    v_mfma_f32_32x32x16_bf16 v[176:191], v[76:79], a[48:51], v[176:191]
    ds_read_b64_tr_b16 v[92:93], v27 offset:28672
    ds_read_b64_tr_b16 v[94:95], v27 offset:29696
    v_mfma_f32_32x32x16_bf16 v[192:207], v[64:67], a[52:55], v[192:207]
    v_mfma_f32_32x32x16_bf16 v[208:223], v[68:71], a[52:55], v[208:223]
    v_mfma_f32_32x32x16_bf16 v[224:239], v[72:75], a[52:55], v[224:239]
    v_mfma_f32_32x32x16_bf16 v[240:255], v[76:79], a[52:55], v[240:255]
    s_waitcnt lgkmcnt(0)
    v_mfma_f32_32x32x16_bf16 v[128:143], v[80:83], a[56:59], v[128:143]
    v_mfma_f32_32x32x16_bf16 v[144:159], v[84:87], a[56:59], v[144:159]
    v_mfma_f32_32x32x16_bf16 v[160:175], v[88:91], a[56:59], v[160:175]
    v_mfma_f32_32x32x16_bf16 v[176:191], v[92:95], a[56:59], v[176:191]
    v_mfma_f32_32x32x16_bf16 v[192:207], v[80:83], a[60:63], v[192:207]
    v_mfma_f32_32x32x16_bf16 v[208:223], v[84:87], a[60:63], v[208:223]
    v_mfma_f32_32x32x16_bf16 v[224:239], v[88:91], a[60:63], v[224:239]
    v_mfma_f32_32x32x16_bf16 v[240:255], v[92:95], a[60:63], v[240:255]
    s_waitcnt vmcnt(16)
    s_barrier
    v_add_u32 v24, 32768, v8
    v_add_u32 v25, 32768, v9
    v_add_u32 v26, 32768, v10
    v_add_u32 v27, 32768, v11
    ds_read_b64_tr_b16 v[64:65], v24 offset:0
    ds_read_b64_tr_b16 v[66:67], v24 offset:1024
    ds_read_b64_tr_b16 v[68:69], v25 offset:0
    ds_read_b64_tr_b16 v[70:71], v25 offset:1024
    ds_read_b64_tr_b16 v[72:73], v26 offset:0
    ds_read_b64_tr_b16 v[74:75], v26 offset:1024
    ds_read_b64_tr_b16 v[76:77], v27 offset:0
    ds_read_b64_tr_b16 v[78:79], v27 offset:1024
    s_waitcnt lgkmcnt(0)
    v_mfma_f32_32x32x16_bf16 v[128:143], v[64:67], a[64:67], v[128:143]
    ds_read_b64_tr_b16 v[80:81], v24 offset:4096
    ds_read_b64_tr_b16 v[82:83], v24 offset:5120
    v_mfma_f32_32x32x16_bf16 v[144:159], v[68:71], a[64:67], v[144:159]
    ds_read_b64_tr_b16 v[84:85], v25 offset:4096
    ds_read_b64_tr_b16 v[86:87], v25 offset:5120
    v_mfma_f32_32x32x16_bf16 v[160:175], v[72:75], a[64:67], v[160:175]
    ds_read_b64_tr_b16 v[88:89], v26 offset:4096
    ds_read_b64_tr_b16 v[90:91], v26 offset:5120
    v_mfma_f32_32x32x16_bf16 v[176:191], v[76:79], a[64:67], v[176:191]
    ds_read_b64_tr_b16 v[92:93], v27 offset:4096
    ds_read_b64_tr_b16 v[94:95], v27 offset:5120
    v_mfma_f32_32x32x16_bf16 v[192:207], v[64:67], a[68:71], v[192:207]
    v_mfma_f32_32x32x16_bf16 v[208:223], v[68:71], a[68:71], v[208:223]
    v_mfma_f32_32x32x16_bf16 v[224:239], v[72:75], a[68:71], v[224:239]
    v_mfma_f32_32x32x16_bf16 v[240:255], v[76:79], a[68:71], v[240:255]
    s_waitcnt lgkmcnt(0)
    v_mfma_f32_32x32x16_bf16 v[128:143], v[80:83], a[72:75], v[128:143]
    ds_read_b64_tr_b16 v[64:65], v24 offset:8192
    ds_read_b64_tr_b16 v[66:67], v24 offset:9216
    v_mfma_f32_32x32x16_bf16 v[144:159], v[84:87], a[72:75], v[144:159]
    ds_read_b64_tr_b16 v[68:69], v25 offset:8192
    ds_read_b64_tr_b16 v[70:71], v25 offset:9216
    v_mfma_f32_32x32x16_bf16 v[160:175], v[88:91], a[72:75], v[160:175]
    ds_read_b64_tr_b16 v[72:73], v26 offset:8192
    ds_read_b64_tr_b16 v[74:75], v26 offset:9216
    v_mfma_f32_32x32x16_bf16 v[176:191], v[92:95], a[72:75], v[176:191]
    ds_read_b64_tr_b16 v[76:77], v27 offset:8192
    ds_read_b64_tr_b16 v[78:79], v27 offset:9216
    v_mfma_f32_32x32x16_bf16 v[192:207], v[80:83], a[76:79], v[192:207]
    v_mfma_f32_32x32x16_bf16 v[208:223], v[84:87], a[76:79], v[208:223]
    v_mfma_f32_32x32x16_bf16 v[224:239], v[88:91], a[76:79], v[224:239]
    v_mfma_f32_32x32x16_bf16 v[240:255], v[92:95], a[76:79], v[240:255]
    s_waitcnt lgkmcnt(0)
    v_mfma_f32_32x32x16_bf16 v[128:143], v[64:67], a[80:83], v[128:143]
    ds_read_b64_tr_b16 v[80:81], v24 offset:12288
    ds_read_b64_tr_b16 v[82:83], v24 offset:13312
    v_mfma_f32_32x32x16_bf16 v[144:159], v[68:71], a[80:83], v[144:159]
    ds_read_b64_tr_b16 v[84:85], v25 offset:12288
    ds_read_b64_tr_b16 v[86:87], v25 offset:13312
    v_mfma_f32_32x32x16_bf16 v[160:175], v[72:75], a[80:83], v[160:175]
    ds_read_b64_tr_b16 v[88:89], v26 offset:12288
    ds_read_b64_tr_b16 v[90:91], v26 offset:13312
    v_mfma_f32_32x32x16_bf16 v[176:191], v[76:79], a[80:83], v[176:191]
    ds_read_b64_tr_b16 v[92:93], v27 offset:12288
    ds_read_b64_tr_b16 v[94:95], v27 offset:13312
    v_mfma_f32_32x32x16_bf16 v[192:207], v[64:67], a[84:87], v[192:207]
    v_mfma_f32_32x32x16_bf16 v[208:223], v[68:71], a[84:87], v[208:223]
    v_mfma_f32_32x32x16_bf16 v[224:239], v[72:75], a[84:87], v[224:239]
    v_mfma_f32_32x32x16_bf16 v[240:255], v[76:79], a[84:87], v[240:255]
    s_waitcnt lgkmcnt(0)
    v_mfma_f32_32x32x16_bf16 v[128:143], v[80:83], a[88:91], v[128:143]
    ds_read_b64_tr_b16 v[64:65], v24 offset:16384
    ds_read_b64_tr_b16 v[66:67], v24 offset:17408
    v_mfma_f32_32x32x16_bf16 v[144:159], v[84:87], a[88:91], v[144:159]
    ds_read_b64_tr_b16 v[68:69], v25 offset:16384
    ds_read_b64_tr_b16 v[70:71], v25 offset:17408
    v_mfma_f32_32x32x16_bf16 v[160:175], v[88:91], a[88:91], v[160:175]
    ds_read_b64_tr_b16 v[72:73], v26 offset:16384
    ds_read_b64_tr_b16 v[74:75], v26 offset:17408
    v_mfma_f32_32x32x16_bf16 v[176:191], v[92:95], a[88:91], v[176:191]
    ds_read_b64_tr_b16 v[76:77], v27 offset:16384
    ds_read_b64_tr_b16 v[78:79], v27 offset:17408
    v_mfma_f32_32x32x16_bf16 v[192:207], v[80:83], a[92:95], v[192:207]
    v_mfma_f32_32x32x16_bf16 v[208:223], v[84:87], a[92:95], v[208:223]
    v_mfma_f32_32x32x16_bf16 v[224:239], v[88:91], a[92:95], v[224:239]
    v_mfma_f32_32x32x16_bf16 v[240:255], v[92:95], a[92:95], v[240:255]
    s_waitcnt lgkmcnt(0)
    v_mfma_f32_32x32x16_bf16 v[128:143], v[64:67], a[96:99], v[128:143]
    ds_read_b64_tr_b16 v[80:81], v24 offset:20480
    ds_read_b64_tr_b16 v[82:83], v24 offset:21504
    v_mfma_f32_32x32x16_bf16 v[144:159], v[68:71], a[96:99], v[144:159]
    ds_read_b64_tr_b16 v[84:85], v25 offset:20480
    ds_read_b64_tr_b16 v[86:87], v25 offset:21504
    v_mfma_f32_32x32x16_bf16 v[160:175], v[72:75], a[96:99], v[160:175]
    ds_read_b64_tr_b16 v[88:89], v26 offset:20480
    ds_read_b64_tr_b16 v[90:91], v26 offset:21504
    v_mfma_f32_32x32x16_bf16 v[176:191], v[76:79], a[96:99], v[176:191]
    ds_read_b64_tr_b16 v[92:93], v27 offset:20480
    ds_read_b64_tr_b16 v[94:95], v27 offset:21504
    v_mfma_f32_32x32x16_bf16 v[192:207], v[64:67], a[100:103], v[192:207]
    v_mfma_f32_32x32x16_bf16 v[208:223], v[68:71], a[100:103], v[208:223]
    v_mfma_f32_32x32x16_bf16 v[224:239], v[72:75], a[100:103], v[224:239]
    v_mfma_f32_32x32x16_bf16 v[240:255], v[76:79], a[100:103], v[240:255]
    s_waitcnt lgkmcnt(0)
    v_mfma_f32_32x32x16_bf16 v[128:143], v[80:83], a[104:107], v[128:143]
    ds_read_b64_tr_b16 v[64:65], v24 offset:24576
    ds_read_b64_tr_b16 v[66:67], v24 offset:25600
    v_mfma_f32_32x32x16_bf16 v[144:159], v[84:87], a[104:107], v[144:159]
    ds_read_b64_tr_b16 v[68:69], v25 offset:24576
    ds_read_b64_tr_b16 v[70:71], v25 offset:25600
    v_mfma_f32_32x32x16_bf16 v[160:175], v[88:91], a[104:107], v[160:175]
    ds_read_b64_tr_b16 v[72:73], v26 offset:24576
    ds_read_b64_tr_b16 v[74:75], v26 offset:25600
    v_mfma_f32_32x32x16_bf16 v[176:191], v[92:95], a[104:107], v[176:191]
    ds_read_b64_tr_b16 v[76:77], v27 offset:24576
    ds_read_b64_tr_b16 v[78:79], v27 offset:25600
    v_mfma_f32_32x32x16_bf16 v[192:207], v[80:83], a[108:111], v[192:207]
    v_mfma_f32_32x32x16_bf16 v[208:223], v[84:87], a[108:111], v[208:223]
    v_mfma_f32_32x32x16_bf16 v[224:239], v[88:91], a[108:111], v[224:239]
    v_mfma_f32_32x32x16_bf16 v[240:255], v[92:95], a[108:111], v[240:255]
    s_waitcnt lgkmcnt(0)
    v_mfma_f32_32x32x16_bf16 v[128:143], v[64:67], a[112:115], v[128:143]
    ds_read_b64_tr_b16 v[80:81], v24 offset:28672
    ds_read_b64_tr_b16 v[82:83], v24 offset:29696
    v_mfma_f32_32x32x16_bf16 v[144:159], v[68:71], a[112:115], v[144:159]
    ds_read_b64_tr_b16 v[84:85], v25 offset:28672
    ds_read_b64_tr_b16 v[86:87], v25 offset:29696
    v_mfma_f32_32x32x16_bf16 v[160:175], v[72:75], a[112:115], v[160:175]
    ds_read_b64_tr_b16 v[88:89], v26 offset:28672
    ds_read_b64_tr_b16 v[90:91], v26 offset:29696
    v_mfma_f32_32x32x16_bf16 v[176:191], v[76:79], a[112:115], v[176:191]
    ds_read_b64_tr_b16 v[92:93], v27 offset:28672
    ds_read_b64_tr_b16 v[94:95], v27 offset:29696
    v_mfma_f32_32x32x16_bf16 v[192:207], v[64:67], a[116:119], v[192:207]
    v_mfma_f32_32x32x16_bf16 v[208:223], v[68:71], a[116:119], v[208:223]
    v_mfma_f32_32x32x16_bf16 v[224:239], v[72:75], a[116:119], v[224:239]
    v_mfma_f32_32x32x16_bf16 v[240:255], v[76:79], a[116:119], v[240:255]
    s_waitcnt lgkmcnt(0)
    v_mfma_f32_32x32x16_bf16 v[128:143], v[80:83], a[120:123], v[128:143]
    v_mfma_f32_32x32x16_bf16 v[144:159], v[84:87], a[120:123], v[144:159]
    v_mfma_f32_32x32x16_bf16 v[160:175], v[88:91], a[120:123], v[160:175]
    v_mfma_f32_32x32x16_bf16 v[176:191], v[92:95], a[120:123], v[176:191]
    v_mfma_f32_32x32x16_bf16 v[192:207], v[80:83], a[124:127], v[192:207]
    v_mfma_f32_32x32x16_bf16 v[208:223], v[84:87], a[124:127], v[208:223]
    v_mfma_f32_32x32x16_bf16 v[224:239], v[88:91], a[124:127], v[224:239]
    v_mfma_f32_32x32x16_bf16 v[240:255], v[92:95], a[124:127], v[240:255]
    s_waitcnt vmcnt(8)
    s_barrier
    v_add_u32 v24, 65536, v8
    v_add_u32 v25, 65536, v9
    v_add_u32 v26, 65536, v10
    v_add_u32 v27, 65536, v11
    ds_read_b64_tr_b16 v[64:65], v24 offset:0
    ds_read_b64_tr_b16 v[66:67], v24 offset:1024
    ds_read_b64_tr_b16 v[68:69], v25 offset:0
    ds_read_b64_tr_b16 v[70:71], v25 offset:1024
    ds_read_b64_tr_b16 v[72:73], v26 offset:0
    ds_read_b64_tr_b16 v[74:75], v26 offset:1024
    ds_read_b64_tr_b16 v[76:77], v27 offset:0
    ds_read_b64_tr_b16 v[78:79], v27 offset:1024
    s_waitcnt lgkmcnt(0)
    v_mfma_f32_32x32x16_bf16 v[128:143], v[64:67], a[128:131], v[128:143]
    ds_read_b64_tr_b16 v[80:81], v24 offset:4096
    ds_read_b64_tr_b16 v[82:83], v24 offset:5120
    v_mfma_f32_32x32x16_bf16 v[144:159], v[68:71], a[128:131], v[144:159]
    ds_read_b64_tr_b16 v[84:85], v25 offset:4096
    ds_read_b64_tr_b16 v[86:87], v25 offset:5120
    v_mfma_f32_32x32x16_bf16 v[160:175], v[72:75], a[128:131], v[160:175]
    ds_read_b64_tr_b16 v[88:89], v26 offset:4096
    ds_read_b64_tr_b16 v[90:91], v26 offset:5120
    v_mfma_f32_32x32x16_bf16 v[176:191], v[76:79], a[128:131], v[176:191]
    ds_read_b64_tr_b16 v[92:93], v27 offset:4096
    ds_read_b64_tr_b16 v[94:95], v27 offset:5120
    v_mfma_f32_32x32x16_bf16 v[192:207], v[64:67], a[132:135], v[192:207]
    v_mfma_f32_32x32x16_bf16 v[208:223], v[68:71], a[132:135], v[208:223]
    v_mfma_f32_32x32x16_bf16 v[224:239], v[72:75], a[132:135], v[224:239]
    v_mfma_f32_32x32x16_bf16 v[240:255], v[76:79], a[132:135], v[240:255]
    s_waitcnt lgkmcnt(0)
    v_mfma_f32_32x32x16_bf16 v[128:143], v[80:83], a[136:139], v[128:143]
    ds_read_b64_tr_b16 v[64:65], v24 offset:8192
    ds_read_b64_tr_b16 v[66:67], v24 offset:9216
    v_mfma_f32_32x32x16_bf16 v[144:159], v[84:87], a[136:139], v[144:159]
    ds_read_b64_tr_b16 v[68:69], v25 offset:8192
    ds_read_b64_tr_b16 v[70:71], v25 offset:9216
    v_mfma_f32_32x32x16_bf16 v[160:175], v[88:91], a[136:139], v[160:175]
    ds_read_b64_tr_b16 v[72:73], v26 offset:8192
    ds_read_b64_tr_b16 v[74:75], v26 offset:9216
    v_mfma_f32_32x32x16_bf16 v[176:191], v[92:95], a[136:139], v[176:191]
    ds_read_b64_tr_b16 v[76:77], v27 offset:8192
    ds_read_b64_tr_b16 v[78:79], v27 offset:9216
    v_mfma_f32_32x32x16_bf16 v[192:207], v[80:83], a[140:143], v[192:207]
    v_mfma_f32_32x32x16_bf16 v[208:223], v[84:87], a[140:143], v[208:223]
    v_mfma_f32_32x32x16_bf16 v[224:239], v[88:91], a[140:143], v[224:239]
    v_mfma_f32_32x32x16_bf16 v[240:255], v[92:95], a[140:143], v[240:255]
    s_waitcnt lgkmcnt(0)
    v_mfma_f32_32x32x16_bf16 v[128:143], v[64:67], a[144:147], v[128:143]
    ds_read_b64_tr_b16 v[80:81], v24 offset:12288
    ds_read_b64_tr_b16 v[82:83], v24 offset:13312
    v_mfma_f32_32x32x16_bf16 v[144:159], v[68:71], a[144:147], v[144:159]
    ds_read_b64_tr_b16 v[84:85], v25 offset:12288
    ds_read_b64_tr_b16 v[86:87], v25 offset:13312
    v_mfma_f32_32x32x16_bf16 v[160:175], v[72:75], a[144:147], v[160:175]
    ds_read_b64_tr_b16 v[88:89], v26 offset:12288
    ds_read_b64_tr_b16 v[90:91], v26 offset:13312
    v_mfma_f32_32x32x16_bf16 v[176:191], v[76:79], a[144:147], v[176:191]
    ds_read_b64_tr_b16 v[92:93], v27 offset:12288
    ds_read_b64_tr_b16 v[94:95], v27 offset:13312
    v_mfma_f32_32x32x16_bf16 v[192:207], v[64:67], a[148:151], v[192:207]
    v_mfma_f32_32x32x16_bf16 v[208:223], v[68:71], a[148:151], v[208:223]
    v_mfma_f32_32x32x16_bf16 v[224:239], v[72:75], a[148:151], v[224:239]
    v_mfma_f32_32x32x16_bf16 v[240:255], v[76:79], a[148:151], v[240:255]
    s_waitcnt lgkmcnt(0)
    v_mfma_f32_32x32x16_bf16 v[128:143], v[80:83], a[152:155], v[128:143]
    ds_read_b64_tr_b16 v[64:65], v24 offset:16384
    ds_read_b64_tr_b16 v[66:67], v24 offset:17408
    v_mfma_f32_32x32x16_bf16 v[144:159], v[84:87], a[152:155], v[144:159]
    ds_read_b64_tr_b16 v[68:69], v25 offset:16384
    ds_read_b64_tr_b16 v[70:71], v25 offset:17408
    v_mfma_f32_32x32x16_bf16 v[160:175], v[88:91], a[152:155], v[160:175]
    ds_read_b64_tr_b16 v[72:73], v26 offset:16384
    ds_read_b64_tr_b16 v[74:75], v26 offset:17408
    v_mfma_f32_32x32x16_bf16 v[176:191], v[92:95], a[152:155], v[176:191]
    ds_read_b64_tr_b16 v[76:77], v27 offset:16384
    ds_read_b64_tr_b16 v[78:79], v27 offset:17408
    v_mfma_f32_32x32x16_bf16 v[192:207], v[80:83], a[156:159], v[192:207]
    v_mfma_f32_32x32x16_bf16 v[208:223], v[84:87], a[156:159], v[208:223]
    v_mfma_f32_32x32x16_bf16 v[224:239], v[88:91], a[156:159], v[224:239]
    v_mfma_f32_32x32x16_bf16 v[240:255], v[92:95], a[156:159], v[240:255]
    s_waitcnt lgkmcnt(0)
    v_mfma_f32_32x32x16_bf16 v[128:143], v[64:67], a[160:163], v[128:143]
    ds_read_b64_tr_b16 v[80:81], v24 offset:20480
    ds_read_b64_tr_b16 v[82:83], v24 offset:21504
    v_mfma_f32_32x32x16_bf16 v[144:159], v[68:71], a[160:163], v[144:159]
    ds_read_b64_tr_b16 v[84:85], v25 offset:20480
    ds_read_b64_tr_b16 v[86:87], v25 offset:21504
    v_mfma_f32_32x32x16_bf16 v[160:175], v[72:75], a[160:163], v[160:175]
    ds_read_b64_tr_b16 v[88:89], v26 offset:20480
    ds_read_b64_tr_b16 v[90:91], v26 offset:21504
    v_mfma_f32_32x32x16_bf16 v[176:191], v[76:79], a[160:163], v[176:191]
    ds_read_b64_tr_b16 v[92:93], v27 offset:20480
    ds_read_b64_tr_b16 v[94:95], v27 offset:21504
    v_mfma_f32_32x32x16_bf16 v[192:207], v[64:67], a[164:167], v[192:207]
    v_mfma_f32_32x32x16_bf16 v[208:223], v[68:71], a[164:167], v[208:223]
    v_mfma_f32_32x32x16_bf16 v[224:239], v[72:75], a[164:167], v[224:239]
    v_mfma_f32_32x32x16_bf16 v[240:255], v[76:79], a[164:167], v[240:255]
    s_waitcnt lgkmcnt(0)
    v_mfma_f32_32x32x16_bf16 v[128:143], v[80:83], a[168:171], v[128:143]
    ds_read_b64_tr_b16 v[64:65], v24 offset:24576
    ds_read_b64_tr_b16 v[66:67], v24 offset:25600
    v_mfma_f32_32x32x16_bf16 v[144:159], v[84:87], a[168:171], v[144:159]
    ds_read_b64_tr_b16 v[68:69], v25 offset:24576
    ds_read_b64_tr_b16 v[70:71], v25 offset:25600
    v_mfma_f32_32x32x16_bf16 v[160:175], v[88:91], a[168:171], v[160:175]
    ds_read_b64_tr_b16 v[72:73], v26 offset:24576
    ds_read_b64_tr_b16 v[74:75], v26 offset:25600
    v_mfma_f32_32x32x16_bf16 v[176:191], v[92:95], a[168:171], v[176:191]
    ds_read_b64_tr_b16 v[76:77], v27 offset:24576
    ds_read_b64_tr_b16 v[78:79], v27 offset:25600
    v_mfma_f32_32x32x16_bf16 v[192:207], v[80:83], a[172:175], v[192:207]
    v_mfma_f32_32x32x16_bf16 v[208:223], v[84:87], a[172:175], v[208:223]
    v_mfma_f32_32x32x16_bf16 v[224:239], v[88:91], a[172:175], v[224:239]
    v_mfma_f32_32x32x16_bf16 v[240:255], v[92:95], a[172:175], v[240:255]
    s_waitcnt lgkmcnt(0)
    v_mfma_f32_32x32x16_bf16 v[128:143], v[64:67], a[176:179], v[128:143]
    ds_read_b64_tr_b16 v[80:81], v24 offset:28672
    ds_read_b64_tr_b16 v[82:83], v24 offset:29696
    v_mfma_f32_32x32x16_bf16 v[144:159], v[68:71], a[176:179], v[144:159]
    ds_read_b64_tr_b16 v[84:85], v25 offset:28672
    ds_read_b64_tr_b16 v[86:87], v25 offset:29696
    v_mfma_f32_32x32x16_bf16 v[160:175], v[72:75], a[176:179], v[160:175]
    ds_read_b64_tr_b16 v[88:89], v26 offset:28672
    ds_read_b64_tr_b16 v[90:91], v26 offset:29696
    v_mfma_f32_32x32x16_bf16 v[176:191], v[76:79], a[176:179], v[176:191]
    ds_read_b64_tr_b16 v[92:93], v27 offset:28672
    ds_read_b64_tr_b16 v[94:95], v27 offset:29696
    v_mfma_f32_32x32x16_bf16 v[192:207], v[64:67], a[180:183], v[192:207]
    v_mfma_f32_32x32x16_bf16 v[208:223], v[68:71], a[180:183], v[208:223]
    v_mfma_f32_32x32x16_bf16 v[224:239], v[72:75], a[180:183], v[224:239]
    v_mfma_f32_32x32x16_bf16 v[240:255], v[76:79], a[180:183], v[240:255]
    s_waitcnt lgkmcnt(0)
    v_mfma_f32_32x32x16_bf16 v[128:143], v[80:83], a[184:187], v[128:143]
    v_mfma_f32_32x32x16_bf16 v[144:159], v[84:87], a[184:187], v[144:159]
    v_mfma_f32_32x32x16_bf16 v[160:175], v[88:91], a[184:187], v[160:175]
    v_mfma_f32_32x32x16_bf16 v[176:191], v[92:95], a[184:187], v[176:191]
    v_mfma_f32_32x32x16_bf16 v[192:207], v[80:83], a[188:191], v[192:207]
    v_mfma_f32_32x32x16_bf16 v[208:223], v[84:87], a[188:191], v[208:223]
    v_mfma_f32_32x32x16_bf16 v[224:239], v[88:91], a[188:191], v[224:239]
    v_mfma_f32_32x32x16_bf16 v[240:255], v[92:95], a[188:191], v[240:255]
    s_waitcnt vmcnt(0)
    s_barrier
    v_add_u32 v24, 98304, v8
    v_add_u32 v25, 98304, v9
    v_add_u32 v26, 98304, v10
    v_add_u32 v27, 98304, v11
    ds_read_b64_tr_b16 v[64:65], v24 offset:0
    ds_read_b64_tr_b16 v[66:67], v24 offset:1024
    ds_read_b64_tr_b16 v[68:69], v25 offset:0
    ds_read_b64_tr_b16 v[70:71], v25 offset:1024
    ds_read_b64_tr_b16 v[72:73], v26 offset:0
    ds_read_b64_tr_b16 v[74:75], v26 offset:1024
    ds_read_b64_tr_b16 v[76:77], v27 offset:0
    ds_read_b64_tr_b16 v[78:79], v27 offset:1024
    s_waitcnt lgkmcnt(0)
    v_mfma_f32_32x32x16_bf16 v[128:143], v[64:67], a[192:195], v[128:143]
    ds_read_b64_tr_b16 v[80:81], v24 offset:4096
    ds_read_b64_tr_b16 v[82:83], v24 offset:5120
    v_mfma_f32_32x32x16_bf16 v[144:159], v[68:71], a[192:195], v[144:159]
    ds_read_b64_tr_b16 v[84:85], v25 offset:4096
    ds_read_b64_tr_b16 v[86:87], v25 offset:5120
    v_mfma_f32_32x32x16_bf16 v[160:175], v[72:75], a[192:195], v[160:175]
    ds_read_b64_tr_b16 v[88:89], v26 offset:4096
    ds_read_b64_tr_b16 v[90:91], v26 offset:5120
    v_mfma_f32_32x32x16_bf16 v[176:191], v[76:79], a[192:195], v[176:191]
    ds_read_b64_tr_b16 v[92:93], v27 offset:4096
    ds_read_b64_tr_b16 v[94:95], v27 offset:5120
    v_mfma_f32_32x32x16_bf16 v[192:207], v[64:67], a[196:199], v[192:207]
    v_mfma_f32_32x32x16_bf16 v[208:223], v[68:71], a[196:199], v[208:223]
    v_mfma_f32_32x32x16_bf16 v[224:239], v[72:75], a[196:199], v[224:239]
    v_mfma_f32_32x32x16_bf16 v[240:255], v[76:79], a[196:199], v[240:255]
    s_waitcnt lgkmcnt(0)
    v_mfma_f32_32x32x16_bf16 v[128:143], v[80:83], a[200:203], v[128:143]
    ds_read_b64_tr_b16 v[64:65], v24 offset:8192
    ds_read_b64_tr_b16 v[66:67], v24 offset:9216
    v_mfma_f32_32x32x16_bf16 v[144:159], v[84:87], a[200:203], v[144:159]
    ds_read_b64_tr_b16 v[68:69], v25 offset:8192
    ds_read_b64_tr_b16 v[70:71], v25 offset:9216
    v_mfma_f32_32x32x16_bf16 v[160:175], v[88:91], a[200:203], v[160:175]
    ds_read_b64_tr_b16 v[72:73], v26 offset:8192
    ds_read_b64_tr_b16 v[74:75], v26 offset:9216
    v_mfma_f32_32x32x16_bf16 v[176:191], v[92:95], a[200:203], v[176:191]
    ds_read_b64_tr_b16 v[76:77], v27 offset:8192
    ds_read_b64_tr_b16 v[78:79], v27 offset:9216
    v_mfma_f32_32x32x16_bf16 v[192:207], v[80:83], a[204:207], v[192:207]
    v_mfma_f32_32x32x16_bf16 v[208:223], v[84:87], a[204:207], v[208:223]
    v_mfma_f32_32x32x16_bf16 v[224:239], v[88:91], a[204:207], v[224:239]
    v_mfma_f32_32x32x16_bf16 v[240:255], v[92:95], a[204:207], v[240:255]
    s_waitcnt lgkmcnt(0)
    v_mfma_f32_32x32x16_bf16 v[128:143], v[64:67], a[208:211], v[128:143]
    ds_read_b64_tr_b16 v[80:81], v24 offset:12288
    ds_read_b64_tr_b16 v[82:83], v24 offset:13312
    v_mfma_f32_32x32x16_bf16 v[144:159], v[68:71], a[208:211], v[144:159]
    ds_read_b64_tr_b16 v[84:85], v25 offset:12288
    ds_read_b64_tr_b16 v[86:87], v25 offset:13312
    v_mfma_f32_32x32x16_bf16 v[160:175], v[72:75], a[208:211], v[160:175]
    ds_read_b64_tr_b16 v[88:89], v26 offset:12288
    ds_read_b64_tr_b16 v[90:91], v26 offset:13312
    v_mfma_f32_32x32x16_bf16 v[176:191], v[76:79], a[208:211], v[176:191]
    ds_read_b64_tr_b16 v[92:93], v27 offset:12288
    ds_read_b64_tr_b16 v[94:95], v27 offset:13312
    v_mfma_f32_32x32x16_bf16 v[192:207], v[64:67], a[212:215], v[192:207]
    v_mfma_f32_32x32x16_bf16 v[208:223], v[68:71], a[212:215], v[208:223]
    v_mfma_f32_32x32x16_bf16 v[224:239], v[72:75], a[212:215], v[224:239]
    v_mfma_f32_32x32x16_bf16 v[240:255], v[76:79], a[212:215], v[240:255]
    s_waitcnt lgkmcnt(0)
    v_mfma_f32_32x32x16_bf16 v[128:143], v[80:83], a[216:219], v[128:143]
    ds_read_b64_tr_b16 v[64:65], v24 offset:16384
    ds_read_b64_tr_b16 v[66:67], v24 offset:17408
    v_mfma_f32_32x32x16_bf16 v[144:159], v[84:87], a[216:219], v[144:159]
    ds_read_b64_tr_b16 v[68:69], v25 offset:16384
    ds_read_b64_tr_b16 v[70:71], v25 offset:17408
    v_mfma_f32_32x32x16_bf16 v[160:175], v[88:91], a[216:219], v[160:175]
    ds_read_b64_tr_b16 v[72:73], v26 offset:16384
    ds_read_b64_tr_b16 v[74:75], v26 offset:17408
    v_mfma_f32_32x32x16_bf16 v[176:191], v[92:95], a[216:219], v[176:191]
    ds_read_b64_tr_b16 v[76:77], v27 offset:16384
    ds_read_b64_tr_b16 v[78:79], v27 offset:17408
    v_mfma_f32_32x32x16_bf16 v[192:207], v[80:83], a[220:223], v[192:207]
    v_mfma_f32_32x32x16_bf16 v[208:223], v[84:87], a[220:223], v[208:223]
    v_mfma_f32_32x32x16_bf16 v[224:239], v[88:91], a[220:223], v[224:239]
    v_mfma_f32_32x32x16_bf16 v[240:255], v[92:95], a[220:223], v[240:255]
    s_waitcnt lgkmcnt(0)
    v_mfma_f32_32x32x16_bf16 v[128:143], v[64:67], a[224:227], v[128:143]
    ds_read_b64_tr_b16 v[80:81], v24 offset:20480
    ds_read_b64_tr_b16 v[82:83], v24 offset:21504
    v_mfma_f32_32x32x16_bf16 v[144:159], v[68:71], a[224:227], v[144:159]
    ds_read_b64_tr_b16 v[84:85], v25 offset:20480
    ds_read_b64_tr_b16 v[86:87], v25 offset:21504
    v_mfma_f32_32x32x16_bf16 v[160:175], v[72:75], a[224:227], v[160:175]
    ds_read_b64_tr_b16 v[88:89], v26 offset:20480
    ds_read_b64_tr_b16 v[90:91], v26 offset:21504
    v_mfma_f32_32x32x16_bf16 v[176:191], v[76:79], a[224:227], v[176:191]
    ds_read_b64_tr_b16 v[92:93], v27 offset:20480
    ds_read_b64_tr_b16 v[94:95], v27 offset:21504
    v_mfma_f32_32x32x16_bf16 v[192:207], v[64:67], a[228:231], v[192:207]
    v_mfma_f32_32x32x16_bf16 v[208:223], v[68:71], a[228:231], v[208:223]
    v_mfma_f32_32x32x16_bf16 v[224:239], v[72:75], a[228:231], v[224:239]
    v_mfma_f32_32x32x16_bf16 v[240:255], v[76:79], a[228:231], v[240:255]
    s_waitcnt lgkmcnt(0)
    v_mfma_f32_32x32x16_bf16 v[128:143], v[80:83], a[232:235], v[128:143]
    ds_read_b64_tr_b16 v[64:65], v24 offset:24576
    ds_read_b64_tr_b16 v[66:67], v24 offset:25600
    v_mfma_f32_32x32x16_bf16 v[144:159], v[84:87], a[232:235], v[144:159]
    ds_read_b64_tr_b16 v[68:69], v25 offset:24576
    ds_read_b64_tr_b16 v[70:71], v25 offset:25600
    v_mfma_f32_32x32x16_bf16 v[160:175], v[88:91], a[232:235], v[160:175]
    ds_read_b64_tr_b16 v[72:73], v26 offset:24576
    ds_read_b64_tr_b16 v[74:75], v26 offset:25600
    v_mfma_f32_32x32x16_bf16 v[176:191], v[92:95], a[232:235], v[176:191]
    ds_read_b64_tr_b16 v[76:77], v27 offset:24576
    ds_read_b64_tr_b16 v[78:79], v27 offset:25600
    v_mfma_f32_32x32x16_bf16 v[192:207], v[80:83], a[236:239], v[192:207]
    v_mfma_f32_32x32x16_bf16 v[208:223], v[84:87], a[236:239], v[208:223]
    v_mfma_f32_32x32x16_bf16 v[224:239], v[88:91], a[236:239], v[224:239]
    v_mfma_f32_32x32x16_bf16 v[240:255], v[92:95], a[236:239], v[240:255]
    s_waitcnt lgkmcnt(0)
    v_mfma_f32_32x32x16_bf16 v[128:143], v[64:67], a[240:243], v[128:143]
    ds_read_b64_tr_b16 v[80:81], v24 offset:28672
    ds_read_b64_tr_b16 v[82:83], v24 offset:29696
    v_mfma_f32_32x32x16_bf16 v[144:159], v[68:71], a[240:243], v[144:159]
    ds_read_b64_tr_b16 v[84:85], v25 offset:28672
    ds_read_b64_tr_b16 v[86:87], v25 offset:29696
    v_mfma_f32_32x32x16_bf16 v[160:175], v[72:75], a[240:243], v[160:175]
    ds_read_b64_tr_b16 v[88:89], v26 offset:28672
    ds_read_b64_tr_b16 v[90:91], v26 offset:29696
    v_mfma_f32_32x32x16_bf16 v[176:191], v[76:79], a[240:243], v[176:191]
    ds_read_b64_tr_b16 v[92:93], v27 offset:28672
    ds_read_b64_tr_b16 v[94:95], v27 offset:29696
    v_mfma_f32_32x32x16_bf16 v[192:207], v[64:67], a[244:247], v[192:207]
    v_mfma_f32_32x32x16_bf16 v[208:223], v[68:71], a[244:247], v[208:223]
    v_mfma_f32_32x32x16_bf16 v[224:239], v[72:75], a[244:247], v[224:239]
    v_mfma_f32_32x32x16_bf16 v[240:255], v[76:79], a[244:247], v[240:255]
    s_waitcnt lgkmcnt(0)
    v_mfma_f32_32x32x16_bf16 v[128:143], v[80:83], a[248:251], v[128:143]
    v_mfma_f32_32x32x16_bf16 v[144:159], v[84:87], a[248:251], v[144:159]
    v_mfma_f32_32x32x16_bf16 v[160:175], v[88:91], a[248:251], v[160:175]
    v_mfma_f32_32x32x16_bf16 v[176:191], v[92:95], a[248:251], v[176:191]
    v_mfma_f32_32x32x16_bf16 v[192:207], v[80:83], a[252:255], v[192:207]
    v_mfma_f32_32x32x16_bf16 v[208:223], v[84:87], a[252:255], v[208:223]
    v_mfma_f32_32x32x16_bf16 v[224:239], v[88:91], a[252:255], v[224:239]
    v_mfma_f32_32x32x16_bf16 v[240:255], v[92:95], a[252:255], v[240:255]
    v_lshl_add_u32 v28, v16, 12, v15
    v_add_u32 v28, 16384, v28
    v_add_u32 v29, 131072, v28
    s_nop 1
    v_cvt_pk_bf16_f32 v32, v128, v129
    v_cvt_pk_bf16_f32 v33, v130, v131
    v_cvt_pk_bf16_f32 v34, v132, v133
    v_cvt_pk_bf16_f32 v35, v134, v135
    v_cvt_pk_bf16_f32 v36, v136, v137
    v_cvt_pk_bf16_f32 v37, v138, v139
    v_cvt_pk_bf16_f32 v38, v140, v141
    v_cvt_pk_bf16_f32 v39, v142, v143
    global_store_dwordx4 v28, v[32:35], s[68:69] offset:0 sc1
    global_store_dwordx4 v28, v[36:39], s[68:69] offset:512 sc1
    v_cvt_pk_bf16_f32 v40, v144, v145
    v_cvt_pk_bf16_f32 v41, v146, v147
    v_cvt_pk_bf16_f32 v42, v148, v149
    v_cvt_pk_bf16_f32 v43, v150, v151
    v_cvt_pk_bf16_f32 v44, v152, v153
    v_cvt_pk_bf16_f32 v45, v154, v155
    v_cvt_pk_bf16_f32 v46, v156, v157
    v_cvt_pk_bf16_f32 v47, v158, v159
    global_store_dwordx4 v28, v[40:43], s[68:69] offset:1024 sc1
    global_store_dwordx4 v28, v[44:47], s[68:69] offset:1536 sc1
    v_cvt_pk_bf16_f32 v32, v160, v161
    v_cvt_pk_bf16_f32 v33, v162, v163
    v_cvt_pk_bf16_f32 v34, v164, v165
    v_cvt_pk_bf16_f32 v35, v166, v167
    v_cvt_pk_bf16_f32 v36, v168, v169
    v_cvt_pk_bf16_f32 v37, v170, v171
    v_cvt_pk_bf16_f32 v38, v172, v173
    v_cvt_pk_bf16_f32 v39, v174, v175
    global_store_dwordx4 v28, v[32:35], s[68:69] offset:2048 sc1
    global_store_dwordx4 v28, v[36:39], s[68:69] offset:2560 sc1
    v_cvt_pk_bf16_f32 v40, v176, v177
    v_cvt_pk_bf16_f32 v41, v178, v179
    v_cvt_pk_bf16_f32 v42, v180, v181
    v_cvt_pk_bf16_f32 v43, v182, v183
    v_cvt_pk_bf16_f32 v44, v184, v185
    v_cvt_pk_bf16_f32 v45, v186, v187
    v_cvt_pk_bf16_f32 v46, v188, v189
    v_cvt_pk_bf16_f32 v47, v190, v191
    global_store_dwordx4 v28, v[40:43], s[68:69] offset:3072 sc1
    global_store_dwordx4 v28, v[44:47], s[68:69] offset:3584 sc1
    v_cvt_pk_bf16_f32 v32, v192, v193
    v_cvt_pk_bf16_f32 v33, v194, v195
    v_cvt_pk_bf16_f32 v34, v196, v197
    v_cvt_pk_bf16_f32 v35, v198, v199
    v_cvt_pk_bf16_f32 v36, v200, v201
    v_cvt_pk_bf16_f32 v37, v202, v203
    v_cvt_pk_bf16_f32 v38, v204, v205
    v_cvt_pk_bf16_f32 v39, v206, v207
    global_store_dwordx4 v29, v[32:35], s[68:69] offset:0 sc1
    global_store_dwordx4 v29, v[36:39], s[68:69] offset:512 sc1
    v_cvt_pk_bf16_f32 v40, v208, v209
    v_cvt_pk_bf16_f32 v41, v210, v211
    v_cvt_pk_bf16_f32 v42, v212, v213
    v_cvt_pk_bf16_f32 v43, v214, v215
    v_cvt_pk_bf16_f32 v44, v216, v217
    v_cvt_pk_bf16_f32 v45, v218, v219
    v_cvt_pk_bf16_f32 v46, v220, v221
    v_cvt_pk_bf16_f32 v47, v222, v223
    global_store_dwordx4 v29, v[40:43], s[68:69] offset:1024 sc1
    global_store_dwordx4 v29, v[44:47], s[68:69] offset:1536 sc1
    v_cvt_pk_bf16_f32 v32, v224, v225
    v_cvt_pk_bf16_f32 v33, v226, v227
    v_cvt_pk_bf16_f32 v34, v228, v229
    v_cvt_pk_bf16_f32 v35, v230, v231
    v_cvt_pk_bf16_f32 v36, v232, v233
    v_cvt_pk_bf16_f32 v37, v234, v235
    v_cvt_pk_bf16_f32 v38, v236, v237
    v_cvt_pk_bf16_f32 v39, v238, v239
    global_store_dwordx4 v29, v[32:35], s[68:69] offset:2048 sc1
    global_store_dwordx4 v29, v[36:39], s[68:69] offset:2560 sc1
    v_cvt_pk_bf16_f32 v40, v240, v241
    v_cvt_pk_bf16_f32 v41, v242, v243
    v_cvt_pk_bf16_f32 v42, v244, v245
    v_cvt_pk_bf16_f32 v43, v246, v247
    v_cvt_pk_bf16_f32 v44, v248, v249
    v_cvt_pk_bf16_f32 v45, v250, v251
    v_cvt_pk_bf16_f32 v46, v252, v253
    v_cvt_pk_bf16_f32 v47, v254, v255
    global_store_dwordx4 v29, v[40:43], s[68:69] offset:3072 sc1
    global_store_dwordx4 v29, v[44:47], s[68:69] offset:3584 sc1
    v_mov_b32 v18, s97
    s_waitcnt vmcnt(0)
    s_mov_b64 exec, 0x3
    global_store_dword v17, v18, s[74:75] offset:512 sc1
    s_mov_b64 exec, -1
    s_cmp_lg_u32 s96, 0
    s_cbranch_scc1 Lp4
    s_mov_b32 s3, 5
    s_branch Lp3
Lp2:
    s_load_dwordx4 s[40:43], s[0:1], 16
    s_load_dwordx2 s[44:45], s[0:1], 32
    s_lshl_b32 s46, s3, 18
    s_add_u32 s66, s4, 1048576
    s_addc_u32 s67, s5, 0
    s_add_u32 s66, s66, s46
    s_addc_u32 s67, s67, 0
    s_lshl_b32 s47, s8, 21
    s_add_u32 s47, s47, s46
    s_lshl_b32 s48, s9, 15
    s_add_u32 s47, s47, s48
    s_add_u32 s47, s47, 4194304
    s_add_u32 s68, s4, s47
    s_addc_u32 s69, s5, 0
    s_lshl_b32 s48, s8, 8
    s_waitcnt lgkmcnt(0)
    s_add_u32 s40, s40, s48
    s_addc_u32 s41, s41, 0
    s_add_u32 s42, s42, s48
    s_addc_u32 s43, s43, 0
    s_add_u32 s44, s44, s48
    s_addc_u32 s45, s45, 0
    s_barrier
    s_cmp_lg_u32 s98, 0
    s_cbranch_scc1 Lcf_64
    s_cmp_lg_u32 s9, 0
    s_cbranch_scc1 Lcf_65
    s_mov_b32 s60, 0
    s_lshr_b32 s94, s2, 2
    s_and_b32 s95, s2, 3
Lcf_66:
    v_mbcnt_lo_u32_b32 v20, -1, 0
    v_mbcnt_hi_u32_b32 v20, -1, v20
    v_lshlrev_b32 v20, 2, v20
    global_load_dword v21, v20, s[6:7] sc1
    s_add_u32 s60, s60, 1
    s_cmp_gt_u32 s60, 300000
    s_cbranch_scc1 Lfail
    s_cmp_lg_u32 s60, 64
    s_cbranch_scc1 Lcf_69
    s_cmp_eq_u32 s100, 0
    s_cbranch_scc1 Lcf_69
    s_memtime s[88:89]
    s_memrealtime s[90:91]
    s_waitcnt lgkmcnt(0)
    s_lshr_b32 s89, s88, 4
    s_xor_b32 s88, s88, s89
    s_lshr_b32 s89, s88, 9
    s_xor_b32 s88, s88, s89
    s_xor_b32 s88, s88, s90
    s_lshr_b32 s89, s90, 5
    s_xor_b32 s88, s88, s89
    s_and_b32 s88, s88, 15
    s_lshl_b32 s88, s88, 3
    s_or_b32 s88, s88, s100
    s_or_b32 s88, s88, 0x80
    v_mov_b32 v22, s2
    v_mov_b32 v23, s88
    s_mov_b64 exec, 1
    global_store_byte v22, v23, s[6:7] sc1
    s_mov_b64 exec, -1
Lcf_69:
    s_waitcnt vmcnt(0)
    v_and_b32 v22, 0x80808080, v21
    v_cmp_ne_u32 vcc, 0x80808080, v22
    s_nop 0
    s_cmp_eq_u64 vcc, 0
    s_cselect_b32 s93, 8, 1
    s_mov_b32 s85, 0x80
Lcf_67:
    s_mov_b32 s86, 0
    s_mov_b32 s87, 0
    s_mov_b32 s84, 0
    v_bfe_u32 v22, v21, 0, 8
    v_and_b32 v23, 0x87, v22
    v_cmp_eq_u32 vcc, s85, v23
    s_nop 0
    s_bcnt1_i32_b64 s88, vcc
    s_add_u32 s86, s86, s88
    s_cmp_gt_u32 s95, 0
    s_cselect_b32 s88, 1, 0
    s_add_u32 s88, s88, s94
    s_bfm_b64 s[90:91], s88, 0
    s_cmp_eq_u32 s88, 64
    s_cselect_b64 s[90:91], -1, s[90:91]
    s_and_b64 s[90:91], s[90:91], vcc
    s_bcnt1_i32_b64 s88, s[90:91]
    s_add_u32 s87, s87, s88
    v_cndmask_b32 v22, 0, v22, vcc
    v_bfe_u32 v23, v22, 3, 1
    v_cmp_ne_u32 s[90:91], 0, v23
    s_mul_i32 s84, s84, 0x9e3779b1
    s_xor_b32 s84, s84, s90
    s_mul_i32 s84, s84, 0x85ebca6b
    s_add_u32 s84, s84, s91
    v_bfe_u32 v23, v22, 4, 1
    v_cmp_ne_u32 s[90:91], 0, v23
    s_mul_i32 s84, s84, 0x9e3779b1
    s_xor_b32 s84, s84, s90
    s_mul_i32 s84, s84, 0x85ebca6b
    s_add_u32 s84, s84, s91
    v_bfe_u32 v23, v22, 5, 1
    v_cmp_ne_u32 s[90:91], 0, v23
    s_mul_i32 s84, s84, 0x9e3779b1
    s_xor_b32 s84, s84, s90
    s_mul_i32 s84, s84, 0x85ebca6b
    s_add_u32 s84, s84, s91
    v_bfe_u32 v23, v22, 6, 1
    v_cmp_ne_u32 s[90:91], 0, v23
    s_mul_i32 s84, s84, 0x9e3779b1
    s_xor_b32 s84, s84, s90
    s_mul_i32 s84, s84, 0x85ebca6b
    s_add_u32 s84, s84, s91
    v_bfe_u32 v22, v21, 8, 8
    v_and_b32 v23, 0x87, v22
    v_cmp_eq_u32 vcc, s85, v23
    s_nop 0
    s_bcnt1_i32_b64 s88, vcc
    s_add_u32 s86, s86, s88
    s_cmp_gt_u32 s95, 1
    s_cselect_b32 s88, 1, 0
    s_add_u32 s88, s88, s94
    s_bfm_b64 s[90:91], s88, 0
    s_cmp_eq_u32 s88, 64
    s_cselect_b64 s[90:91], -1, s[90:91]
    s_and_b64 s[90:91], s[90:91], vcc
    s_bcnt1_i32_b64 s88, s[90:91]
    s_add_u32 s87, s87, s88
    v_cndmask_b32 v22, 0, v22, vcc
    v_bfe_u32 v23, v22, 3, 1
    v_cmp_ne_u32 s[90:91], 0, v23
    s_mul_i32 s84, s84, 0x9e3779b1
    s_xor_b32 s84, s84, s90
    s_mul_i32 s84, s84, 0x85ebca6b
    s_add_u32 s84, s84, s91
    v_bfe_u32 v23, v22, 4, 1
    v_cmp_ne_u32 s[90:91], 0, v23
    s_mul_i32 s84, s84, 0x9e3779b1
    s_xor_b32 s84, s84, s90
    s_mul_i32 s84, s84, 0x85ebca6b
    s_add_u32 s84, s84, s91
    v_bfe_u32 v23, v22, 5, 1
    v_cmp_ne_u32 s[90:91], 0, v23
    s_mul_i32 s84, s84, 0x9e3779b1
    s_xor_b32 s84, s84, s90
    s_mul_i32 s84, s84, 0x85ebca6b
    s_add_u32 s84, s84, s91
    v_bfe_u32 v23, v22, 6, 1
    v_cmp_ne_u32 s[90:91], 0, v23
    s_mul_i32 s84, s84, 0x9e3779b1
    s_xor_b32 s84, s84, s90
    s_mul_i32 s84, s84, 0x85ebca6b
    s_add_u32 s84, s84, s91
    v_bfe_u32 v22, v21, 16, 8
    v_and_b32 v23, 0x87, v22
    v_cmp_eq_u32 vcc, s85, v23
    s_nop 0
    s_bcnt1_i32_b64 s88, vcc
    s_add_u32 s86, s86, s88
    s_cmp_gt_u32 s95, 2
    s_cselect_b32 s88, 1, 0
    s_add_u32 s88, s88, s94
    s_bfm_b64 s[90:91], s88, 0
    s_cmp_eq_u32 s88, 64
    s_cselect_b64 s[90:91], -1, s[90:91]
    s_and_b64 s[90:91], s[90:91], vcc
    s_bcnt1_i32_b64 s88, s[90:91]
    s_add_u32 s87, s87, s88
    v_cndmask_b32 v22, 0, v22, vcc
    v_bfe_u32 v23, v22, 3, 1
    v_cmp_ne_u32 s[90:91], 0, v23
    s_mul_i32 s84, s84, 0x9e3779b1
    s_xor_b32 s84, s84, s90
    s_mul_i32 s84, s84, 0x85ebca6b
    s_add_u32 s84, s84, s91
    v_bfe_u32 v23, v22, 4, 1
    v_cmp_ne_u32 s[90:91], 0, v23
    s_mul_i32 s84, s84, 0x9e3779b1
    s_xor_b32 s84, s84, s90
    s_mul_i32 s84, s84, 0x85ebca6b
    s_add_u32 s84, s84, s91
    v_bfe_u32 v23, v22, 5, 1
    v_cmp_ne_u32 s[90:91], 0, v23
    s_mul_i32 s84, s84, 0x9e3779b1
    s_xor_b32 s84, s84, s90
    s_mul_i32 s84, s84, 0x85ebca6b
    s_add_u32 s84, s84, s91
    v_bfe_u32 v23, v22, 6, 1
    v_cmp_ne_u32 s[90:91], 0, v23
    s_mul_i32 s84, s84, 0x9e3779b1
    s_xor_b32 s84, s84, s90
    s_mul_i32 s84, s84, 0x85ebca6b
    s_add_u32 s84, s84, s91
    v_bfe_u32 v22, v21, 24, 8
    v_and_b32 v23, 0x87, v22
    v_cmp_eq_u32 vcc, s85, v23
    s_nop 0
    s_bcnt1_i32_b64 s88, vcc
    s_add_u32 s86, s86, s88
    s_cmp_gt_u32 s95, 3
    s_cselect_b32 s88, 1, 0
    s_add_u32 s88, s88, s94
    s_bfm_b64 s[90:91], s88, 0
    s_cmp_eq_u32 s88, 64
    s_cselect_b64 s[90:91], -1, s[90:91]
    s_and_b64 s[90:91], s[90:91], vcc
    s_bcnt1_i32_b64 s88, s[90:91]
    s_add_u32 s87, s87, s88
    v_cndmask_b32 v22, 0, v22, vcc
    v_bfe_u32 v23, v22, 3, 1
    v_cmp_ne_u32 s[90:91], 0, v23
    s_mul_i32 s84, s84, 0x9e3779b1
    s_xor_b32 s84, s84, s90
    s_mul_i32 s84, s84, 0x85ebca6b
    s_add_u32 s84, s84, s91
    v_bfe_u32 v23, v22, 4, 1
    v_cmp_ne_u32 s[90:91], 0, v23
    s_mul_i32 s84, s84, 0x9e3779b1
    s_xor_b32 s84, s84, s90
    s_mul_i32 s84, s84, 0x85ebca6b
    s_add_u32 s84, s84, s91
    v_bfe_u32 v23, v22, 5, 1
    v_cmp_ne_u32 s[90:91], 0, v23
    s_mul_i32 s84, s84, 0x9e3779b1
    s_xor_b32 s84, s84, s90
    s_mul_i32 s84, s84, 0x85ebca6b
    s_add_u32 s84, s84, s91
    v_bfe_u32 v23, v22, 6, 1
    v_cmp_ne_u32 s[90:91], 0, v23
    s_mul_i32 s84, s84, 0x9e3779b1
    s_xor_b32 s84, s84, s90
    s_mul_i32 s84, s84, 0x85ebca6b
    s_add_u32 s84, s84, s91
    s_cmp_ge_u32 s86, 32
    s_cbranch_scc1 Lcf_68
    s_add_u32 s85, s85, 1
    s_and_b32 s88, s85, 15
    s_cmp_lt_u32 s88, s93
    s_cbranch_scc1 Lcf_67
    s_branch Lcf_66
Lcf_68:
    s_or_b32 s84, s84, 1
    s_and_b32 s85, s85, 7
    s_min_u32 s88, s87, 32
    s_sub_u32 s88, s2, s88
    s_add_u32 s88, s88, 32
    s_cmp_lt_u32 s87, 32
    s_cselect_b32 s89, s87, s88
    s_cmp_eq_u32 s85, s100
    s_cselect_b32 s89, s89, s88
    v_mov_b32 v22, s84
    v_mov_b32 v23, s89
    v_mov_b32 v20, 163824
    ds_write_b64 v20, v[22:23]
    s_waitcnt lgkmcnt(0)
Lcf_65:
    s_barrier
    v_mov_b32 v20, 163824
    ds_read_b64 v[22:23], v20
    s_waitcnt lgkmcnt(0)
    v_readfirstlane_b32 s97, v22
    v_readfirstlane_b32 s89, v23
    s_mov_b32 s98, 1
    s_nop 3
    s_cmp_eq_u32 s89, s99
    s_cbranch_scc1 Lcf_64
    s_mov_b32 s99, s89
    s_waitcnt vmcnt(0)
    s_barrier
    s_branch Lstart
Lcf_64:
    s_add_u32 s71, s70, 0
    s_add_u32 m0, s71, 0
    v_add_u32 v2, 0, v12
    global_load_lds_dwordx4 v2, s[44:45]
    s_add_u32 m0, s71, 4096
    v_add_u32 v3, 131072, v12
    global_load_lds_dwordx4 v3, s[44:45]
    s_add_u32 m0, s71, 8192
    v_add_u32 v2, 262144, v12
    global_load_lds_dwordx4 v2, s[44:45]
    s_add_u32 m0, s71, 12288
    v_add_u32 v3, 393216, v12
    global_load_lds_dwordx4 v3, s[44:45]
    s_add_u32 m0, s71, 16384
    v_add_u32 v2, 524288, v12
    global_load_lds_dwordx4 v2, s[44:45]
    s_add_u32 m0, s71, 20480
    v_add_u32 v3, 655360, v12
    global_load_lds_dwordx4 v3, s[44:45]
    s_add_u32 m0, s71, 24576
    v_add_u32 v2, 786432, v12
    global_load_lds_dwordx4 v2, s[44:45]
    s_add_u32 m0, s71, 28672
    v_add_u32 v3, 917504, v12
    global_load_lds_dwordx4 v3, s[44:45]
    s_add_u32 s71, s70, 32768
    s_add_u32 m0, s71, 0
    v_add_u32 v2, 1048576, v12
    global_load_lds_dwordx4 v2, s[44:45]
    s_add_u32 m0, s71, 4096
    v_add_u32 v3, 1179648, v12
    global_load_lds_dwordx4 v3, s[44:45]
    s_add_u32 m0, s71, 8192
    v_add_u32 v2, 1310720, v12
    global_load_lds_dwordx4 v2, s[44:45]
    s_add_u32 m0, s71, 12288
    v_add_u32 v3, 1441792, v12
    global_load_lds_dwordx4 v3, s[44:45]
    s_add_u32 m0, s71, 16384
    v_add_u32 v2, 1572864, v12
    global_load_lds_dwordx4 v2, s[44:45]
    s_add_u32 m0, s71, 20480
    v_add_u32 v3, 1703936, v12
    global_load_lds_dwordx4 v3, s[44:45]
    s_add_u32 m0, s71, 24576
    v_add_u32 v2, 1835008, v12
    global_load_lds_dwordx4 v2, s[44:45]
    s_add_u32 m0, s71, 28672
    v_add_u32 v3, 1966080, v12
    global_load_lds_dwordx4 v3, s[44:45]
    s_add_u32 s71, s70, 65536
    s_add_u32 m0, s71, 0
    v_add_u32 v2, 2097152, v12
    global_load_lds_dwordx4 v2, s[44:45]
    s_add_u32 m0, s71, 4096
    v_add_u32 v3, 2228224, v12
    global_load_lds_dwordx4 v3, s[44:45]
    s_add_u32 m0, s71, 8192
    v_add_u32 v2, 2359296, v12
    global_load_lds_dwordx4 v2, s[44:45]
    s_add_u32 m0, s71, 12288
    v_add_u32 v3, 2490368, v12
    global_load_lds_dwordx4 v3, s[44:45]
    s_add_u32 m0, s71, 16384
    v_add_u32 v2, 2621440, v12
    global_load_lds_dwordx4 v2, s[44:45]
    s_add_u32 m0, s71, 20480
    v_add_u32 v3, 2752512, v12
    global_load_lds_dwordx4 v3, s[44:45]
    s_add_u32 m0, s71, 24576
    v_add_u32 v2, 2883584, v12
    global_load_lds_dwordx4 v2, s[44:45]
    s_add_u32 m0, s71, 28672
    v_add_u32 v3, 3014656, v12
    global_load_lds_dwordx4 v3, s[44:45]
    s_add_u32 s71, s70, 98304
    s_add_u32 m0, s71, 0
    v_add_u32 v2, 3145728, v12
    global_load_lds_dwordx4 v2, s[44:45]
    s_add_u32 m0, s71, 4096
    v_add_u32 v3, 3276800, v12
    global_load_lds_dwordx4 v3, s[44:45]
    s_add_u32 m0, s71, 8192
    v_add_u32 v2, 3407872, v12
    global_load_lds_dwordx4 v2, s[44:45]
    s_add_u32 m0, s71, 12288
    v_add_u32 v3, 3538944, v12
    global_load_lds_dwordx4 v3, s[44:45]
    s_add_u32 m0, s71, 16384
    v_add_u32 v2, 3670016, v12
    global_load_lds_dwordx4 v2, s[44:45]
    s_add_u32 m0, s71, 20480
    v_add_u32 v3, 3801088, v12
    global_load_lds_dwordx4 v3, s[44:45]
    s_add_u32 m0, s71, 24576
    v_add_u32 v2, 3932160, v12
    global_load_lds_dwordx4 v2, s[44:45]
    s_add_u32 m0, s71, 28672
    v_add_u32 v3, 4063232, v12
    global_load_lds_dwordx4 v3, s[44:45]
    s_lshl_b32 s49, s8, 10
    s_lshl_b32 s50, s3, 5
    s_add_u32 s49, s49, s50
    s_lshl_b32 s50, s9, 2
    s_add_u32 s49, s49, s50
    s_add_u32 s49, s49, 127533056
    s_add_u32 s74, s4, s49
    s_addc_u32 s75, s5, 0
    s_lshl_b32 s49, s3, 10
    s_lshl_b32 s50, s9, 7
    s_add_u32 s49, s49, s50
    s_add_u32 s49, s49, 127598592
    v_and_b32 v2, 1, v0
    v_lshlrev_b32 v2, 9, v2
    v_add_u32 v2, s49, v2
    s_mov_b32 s60, 0
    s_mov_b64 exec, 0x3
    global_load_dword v19, v2, s[4:5] sc1
    s_waitcnt vmcnt(0)
    v_cmp_ne_u32 vcc, s97, v19
    s_cbranch_vccz Lwf_72
    global_load_dword v19, v2, s[4:5] sc1
    s_sleep 2
Lwf_71:
    global_load_dword v19, v2, s[4:5] sc1
    s_add_u32 s60, s60, 1
    s_cmp_gt_u32 s60, 1000000
    s_cbranch_scc1 Lfail
    s_waitcnt vmcnt(1)
    v_cmp_ne_u32 vcc, s97, v19
    s_cbranch_vccz Lwf_72
    s_sleep 1
    s_branch Lwf_71
Lwf_72:
    s_mov_b64 exec, -1
    v_add_u32 v4, 0, v13
    global_load_dwordx4 a[0:3], v4, s[66:67] offset:0 sc1
    global_load_dwordx4 a[8:11], v4, s[66:67] offset:1024 sc1
    global_load_dwordx4 a[16:19], v4, s[66:67] offset:2048 sc1
    global_load_dwordx4 a[24:27], v4, s[66:67] offset:3072 sc1
    v_add_u32 v4, 4096, v13
    global_load_dwordx4 a[32:35], v4, s[66:67] offset:0 sc1
    global_load_dwordx4 a[40:43], v4, s[66:67] offset:1024 sc1
    global_load_dwordx4 a[48:51], v4, s[66:67] offset:2048 sc1
    global_load_dwordx4 a[56:59], v4, s[66:67] offset:3072 sc1
    v_add_u32 v4, 8192, v13
    global_load_dwordx4 a[64:67], v4, s[66:67] offset:0 sc1
    global_load_dwordx4 a[72:75], v4, s[66:67] offset:1024 sc1
    global_load_dwordx4 a[80:83], v4, s[66:67] offset:2048 sc1
    global_load_dwordx4 a[88:91], v4, s[66:67] offset:3072 sc1
    v_add_u32 v4, 12288, v13
    global_load_dwordx4 a[96:99], v4, s[66:67] offset:0 sc1
    global_load_dwordx4 a[104:107], v4, s[66:67] offset:1024 sc1
    global_load_dwordx4 a[112:115], v4, s[66:67] offset:2048 sc1
    global_load_dwordx4 a[120:123], v4, s[66:67] offset:3072 sc1
    v_add_u32 v4, 16384, v13
    global_load_dwordx4 a[128:131], v4, s[66:67] offset:0 sc1
    global_load_dwordx4 a[136:139], v4, s[66:67] offset:1024 sc1
    global_load_dwordx4 a[144:147], v4, s[66:67] offset:2048 sc1
    global_load_dwordx4 a[152:155], v4, s[66:67] offset:3072 sc1
    v_add_u32 v4, 20480, v13
    global_load_dwordx4 a[160:163], v4, s[66:67] offset:0 sc1
    global_load_dwordx4 a[168:171], v4, s[66:67] offset:1024 sc1
    global_load_dwordx4 a[176:179], v4, s[66:67] offset:2048 sc1
    global_load_dwordx4 a[184:187], v4, s[66:67] offset:3072 sc1
    v_add_u32 v4, 24576, v13
    global_load_dwordx4 a[192:195], v4, s[66:67] offset:0 sc1
    global_load_dwordx4 a[200:203], v4, s[66:67] offset:1024 sc1
    global_load_dwordx4 a[208:211], v4, s[66:67] offset:2048 sc1
    global_load_dwordx4 a[216:219], v4, s[66:67] offset:3072 sc1
    v_add_u32 v4, 28672, v13
    global_load_dwordx4 a[224:227], v4, s[66:67] offset:0 sc1
    global_load_dwordx4 a[232:235], v4, s[66:67] offset:1024 sc1
    global_load_dwordx4 a[240:243], v4, s[66:67] offset:2048 sc1
    global_load_dwordx4 a[248:251], v4, s[66:67] offset:3072 sc1
    v_add_u32 v4, 131072, v13
    global_load_dwordx4 a[4:7], v4, s[66:67] offset:0 sc1
    global_load_dwordx4 a[12:15], v4, s[66:67] offset:1024 sc1
    global_load_dwordx4 a[20:23], v4, s[66:67] offset:2048 sc1
    global_load_dwordx4 a[28:31], v4, s[66:67] offset:3072 sc1
    v_add_u32 v4, 135168, v13
    global_load_dwordx4 a[36:39], v4, s[66:67] offset:0 sc1
    global_load_dwordx4 a[44:47], v4, s[66:67] offset:1024 sc1
    global_load_dwordx4 a[52:55], v4, s[66:67] offset:2048 sc1
    global_load_dwordx4 a[60:63], v4, s[66:67] offset:3072 sc1
    v_add_u32 v4, 139264, v13
    global_load_dwordx4 a[68:71], v4, s[66:67] offset:0 sc1
    global_load_dwordx4 a[76:79], v4, s[66:67] offset:1024 sc1
    global_load_dwordx4 a[84:87], v4, s[66:67] offset:2048 sc1
    global_load_dwordx4 a[92:95], v4, s[66:67] offset:3072 sc1
    v_add_u32 v4, 143360, v13
    global_load_dwordx4 a[100:103], v4, s[66:67] offset:0 sc1
    global_load_dwordx4 a[108:111], v4, s[66:67] offset:1024 sc1
    global_load_dwordx4 a[116:119], v4, s[66:67] offset:2048 sc1
    global_load_dwordx4 a[124:127], v4, s[66:67] offset:3072 sc1
    v_add_u32 v4, 147456, v13
    global_load_dwordx4 a[132:135], v4, s[66:67] offset:0 sc1
    global_load_dwordx4 a[140:143], v4, s[66:67] offset:1024 sc1
    global_load_dwordx4 a[148:151], v4, s[66:67] offset:2048 sc1
    global_load_dwordx4 a[156:159], v4, s[66:67] offset:3072 sc1
    v_add_u32 v4, 151552, v13
    global_load_dwordx4 a[164:167], v4, s[66:67] offset:0 sc1
    global_load_dwordx4 a[172:175], v4, s[66:67] offset:1024 sc1
    global_load_dwordx4 a[180:183], v4, s[66:67] offset:2048 sc1
    global_load_dwordx4 a[188:191], v4, s[66:67] offset:3072 sc1
    v_add_u32 v4, 155648, v13
    global_load_dwordx4 a[196:199], v4, s[66:67] offset:0 sc1
    global_load_dwordx4 a[204:207], v4, s[66:67] offset:1024 sc1
    global_load_dwordx4 a[212:215], v4, s[66:67] offset:2048 sc1
    global_load_dwordx4 a[220:223], v4, s[66:67] offset:3072 sc1
    v_add_u32 v4, 159744, v13
    global_load_dwordx4 a[228:231], v4, s[66:67] offset:0 sc1
    s_waitcnt vmcnt(58)
    global_load_dwordx4 a[236:239], v4, s[66:67] offset:1024 sc1
    global_load_dwordx4 a[244:247], v4, s[66:67] offset:2048 sc1
    global_load_dwordx4 a[252:255], v4, s[66:67] offset:3072 sc1
    s_barrier
    v_mov_b32 v19, 0
    v_add_u32 v24, 65536, v8
    v_add_u32 v25, 65536, v9
    v_add_u32 v26, 65536, v10
    v_add_u32 v27, 65536, v11
    ds_read_b64_tr_b16 v[64:65], v8 offset:0
    ds_read_b64_tr_b16 v[66:67], v8 offset:1024
    ds_read_b64_tr_b16 v[68:69], v9 offset:0
    ds_read_b64_tr_b16 v[70:71], v9 offset:1024
    ds_read_b64_tr_b16 v[72:73], v10 offset:0
    ds_read_b64_tr_b16 v[74:75], v10 offset:1024
    ds_read_b64_tr_b16 v[76:77], v11 offset:0
    ds_read_b64_tr_b16 v[78:79], v11 offset:1024
    s_waitcnt vmcnt(60)
    s_waitcnt lgkmcnt(0)
    v_mfma_f32_32x32x16_bf16 v[128:143], a[0:3], v[64:67], 0
    ds_read_b64_tr_b16 v[80:81], v8 offset:4096
    ds_read_b64_tr_b16 v[82:83], v8 offset:5120
    ds_read_b64_tr_b16 v[84:85], v9 offset:4096
    ds_read_b64_tr_b16 v[86:87], v9 offset:5120
    v_mfma_f32_32x32x16_bf16 v[144:159], a[0:3], v[68:71], 0
    ds_read_b64_tr_b16 v[88:89], v10 offset:4096
    ds_read_b64_tr_b16 v[90:91], v10 offset:5120
    ds_read_b64_tr_b16 v[92:93], v11 offset:4096
    ds_read_b64_tr_b16 v[94:95], v11 offset:5120
    v_mfma_f32_32x32x16_bf16 v[160:175], a[0:3], v[72:75], 0
    v_mfma_f32_32x32x16_bf16 v[176:191], a[0:3], v[76:79], 0
    s_waitcnt lgkmcnt(0)
    v_mfma_f32_32x32x16_bf16 v[128:143], a[8:11], v[80:83], v[128:143]
    ds_read_b64_tr_b16 v[64:65], v8 offset:8192
    ds_read_b64_tr_b16 v[66:67], v8 offset:9216
    ds_read_b64_tr_b16 v[68:69], v9 offset:8192
    ds_read_b64_tr_b16 v[70:71], v9 offset:9216
    v_mfma_f32_32x32x16_bf16 v[144:159], a[8:11], v[84:87], v[144:159]
    ds_read_b64_tr_b16 v[72:73], v10 offset:8192
    ds_read_b64_tr_b16 v[74:75], v10 offset:9216
    ds_read_b64_tr_b16 v[76:77], v11 offset:8192
    ds_read_b64_tr_b16 v[78:79], v11 offset:9216
    v_mfma_f32_32x32x16_bf16 v[160:175], a[8:11], v[88:91], v[160:175]
    v_mfma_f32_32x32x16_bf16 v[176:191], a[8:11], v[92:95], v[176:191]
    s_waitcnt lgkmcnt(0)
    v_mfma_f32_32x32x16_bf16 v[128:143], a[16:19], v[64:67], v[128:143]
    ds_read_b64_tr_b16 v[80:81], v8 offset:12288
    ds_read_b64_tr_b16 v[82:83], v8 offset:13312
    ds_read_b64_tr_b16 v[84:85], v9 offset:12288
    ds_read_b64_tr_b16 v[86:87], v9 offset:13312
    v_mfma_f32_32x32x16_bf16 v[144:159], a[16:19], v[68:71], v[144:159]
    ds_read_b64_tr_b16 v[88:89], v10 offset:12288
    ds_read_b64_tr_b16 v[90:91], v10 offset:13312
    ds_read_b64_tr_b16 v[92:93], v11 offset:12288
    ds_read_b64_tr_b16 v[94:95], v11 offset:13312
    v_mfma_f32_32x32x16_bf16 v[160:175], a[16:19], v[72:75], v[160:175]
    v_mfma_f32_32x32x16_bf16 v[176:191], a[16:19], v[76:79], v[176:191]
    s_waitcnt lgkmcnt(0)
    v_mfma_f32_32x32x16_bf16 v[128:143], a[24:27], v[80:83], v[128:143]
    ds_read_b64_tr_b16 v[64:65], v8 offset:16384
    ds_read_b64_tr_b16 v[66:67], v8 offset:17408
    ds_read_b64_tr_b16 v[68:69], v9 offset:16384
    ds_read_b64_tr_b16 v[70:71], v9 offset:17408
    v_mfma_f32_32x32x16_bf16 v[144:159], a[24:27], v[84:87], v[144:159]
    ds_read_b64_tr_b16 v[72:73], v10 offset:16384
    ds_read_b64_tr_b16 v[74:75], v10 offset:17408
    ds_read_b64_tr_b16 v[76:77], v11 offset:16384
    ds_read_b64_tr_b16 v[78:79], v11 offset:17408
    v_mfma_f32_32x32x16_bf16 v[160:175], a[24:27], v[88:91], v[160:175]
    v_mfma_f32_32x32x16_bf16 v[176:191], a[24:27], v[92:95], v[176:191]
    s_waitcnt vmcnt(56)
    s_waitcnt lgkmcnt(0)
    v_mfma_f32_32x32x16_bf16 v[128:143], a[32:35], v[64:67], v[128:143]
    ds_read_b64_tr_b16 v[80:81], v8 offset:20480
    ds_read_b64_tr_b16 v[82:83], v8 offset:21504
    ds_read_b64_tr_b16 v[84:85], v9 offset:20480
    ds_read_b64_tr_b16 v[86:87], v9 offset:21504
    v_mfma_f32_32x32x16_bf16 v[144:159], a[32:35], v[68:71], v[144:159]
    ds_read_b64_tr_b16 v[88:89], v10 offset:20480
    ds_read_b64_tr_b16 v[90:91], v10 offset:21504
    ds_read_b64_tr_b16 v[92:93], v11 offset:20480
    ds_read_b64_tr_b16 v[94:95], v11 offset:21504
    v_mfma_f32_32x32x16_bf16 v[160:175], a[32:35], v[72:75], v[160:175]
    v_mfma_f32_32x32x16_bf16 v[176:191], a[32:35], v[76:79], v[176:191]
    s_waitcnt lgkmcnt(0)
    v_mfma_f32_32x32x16_bf16 v[128:143], a[40:43], v[80:83], v[128:143]
    ds_read_b64_tr_b16 v[64:65], v8 offset:24576
    ds_read_b64_tr_b16 v[66:67], v8 offset:25600
    ds_read_b64_tr_b16 v[68:69], v9 offset:24576
    ds_read_b64_tr_b16 v[70:71], v9 offset:25600
    v_mfma_f32_32x32x16_bf16 v[144:159], a[40:43], v[84:87], v[144:159]
    ds_read_b64_tr_b16 v[72:73], v10 offset:24576
    ds_read_b64_tr_b16 v[74:75], v10 offset:25600
    ds_read_b64_tr_b16 v[76:77], v11 offset:24576
    ds_read_b64_tr_b16 v[78:79], v11 offset:25600
    v_mfma_f32_32x32x16_bf16 v[160:175], a[40:43], v[88:91], v[160:175]
    v_mfma_f32_32x32x16_bf16 v[176:191], a[40:43], v[92:95], v[176:191]
    s_waitcnt lgkmcnt(0)
    v_mfma_f32_32x32x16_bf16 v[128:143], a[48:51], v[64:67], v[128:143]
    ds_read_b64_tr_b16 v[80:81], v8 offset:28672
    ds_read_b64_tr_b16 v[82:83], v8 offset:29696
    ds_read_b64_tr_b16 v[84:85], v9 offset:28672
    ds_read_b64_tr_b16 v[86:87], v9 offset:29696
    v_mfma_f32_32x32x16_bf16 v[144:159], a[48:51], v[68:71], v[144:159]
    ds_read_b64_tr_b16 v[88:89], v10 offset:28672
    ds_read_b64_tr_b16 v[90:91], v10 offset:29696
    ds_read_b64_tr_b16 v[92:93], v11 offset:28672
    ds_read_b64_tr_b16 v[94:95], v11 offset:29696
    v_mfma_f32_32x32x16_bf16 v[160:175], a[48:51], v[72:75], v[160:175]
    v_mfma_f32_32x32x16_bf16 v[176:191], a[48:51], v[76:79], v[176:191]
    s_waitcnt lgkmcnt(0)
    v_mfma_f32_32x32x16_bf16 v[128:143], a[56:59], v[80:83], v[128:143]
    ds_read_b64_tr_b16 v[64:65], v8 offset:32768
    ds_read_b64_tr_b16 v[66:67], v8 offset:33792
    ds_read_b64_tr_b16 v[68:69], v9 offset:32768
    ds_read_b64_tr_b16 v[70:71], v9 offset:33792
    v_mfma_f32_32x32x16_bf16 v[144:159], a[56:59], v[84:87], v[144:159]
    ds_read_b64_tr_b16 v[72:73], v10 offset:32768
    ds_read_b64_tr_b16 v[74:75], v10 offset:33792
    ds_read_b64_tr_b16 v[76:77], v11 offset:32768
    ds_read_b64_tr_b16 v[78:79], v11 offset:33792
    v_mfma_f32_32x32x16_bf16 v[160:175], a[56:59], v[88:91], v[160:175]
    v_mfma_f32_32x32x16_bf16 v[176:191], a[56:59], v[92:95], v[176:191]
    s_waitcnt vmcnt(52)
    s_waitcnt lgkmcnt(0)
    v_mfma_f32_32x32x16_bf16 v[128:143], a[64:67], v[64:67], v[128:143]
    ds_read_b64_tr_b16 v[80:81], v8 offset:36864
    ds_read_b64_tr_b16 v[82:83], v8 offset:37888
    ds_read_b64_tr_b16 v[84:85], v9 offset:36864
    ds_read_b64_tr_b16 v[86:87], v9 offset:37888
    v_mfma_f32_32x32x16_bf16 v[144:159], a[64:67], v[68:71], v[144:159]
    ds_read_b64_tr_b16 v[88:89], v10 offset:36864
    ds_read_b64_tr_b16 v[90:91], v10 offset:37888
    ds_read_b64_tr_b16 v[92:93], v11 offset:36864
    ds_read_b64_tr_b16 v[94:95], v11 offset:37888
    v_mfma_f32_32x32x16_bf16 v[160:175], a[64:67], v[72:75], v[160:175]
    v_mfma_f32_32x32x16_bf16 v[176:191], a[64:67], v[76:79], v[176:191]
    s_waitcnt lgkmcnt(0)
    v_mfma_f32_32x32x16_bf16 v[128:143], a[72:75], v[80:83], v[128:143]
    ds_read_b64_tr_b16 v[64:65], v8 offset:40960
    ds_read_b64_tr_b16 v[66:67], v8 offset:41984
    ds_read_b64_tr_b16 v[68:69], v9 offset:40960
    ds_read_b64_tr_b16 v[70:71], v9 offset:41984
    v_mfma_f32_32x32x16_bf16 v[144:159], a[72:75], v[84:87], v[144:159]
    ds_read_b64_tr_b16 v[72:73], v10 offset:40960
    ds_read_b64_tr_b16 v[74:75], v10 offset:41984
    ds_read_b64_tr_b16 v[76:77], v11 offset:40960
    ds_read_b64_tr_b16 v[78:79], v11 offset:41984
    v_mfma_f32_32x32x16_bf16 v[160:175], a[72:75], v[88:91], v[160:175]
    v_mfma_f32_32x32x16_bf16 v[176:191], a[72:75], v[92:95], v[176:191]
    s_waitcnt lgkmcnt(0)
    v_mfma_f32_32x32x16_bf16 v[128:143], a[80:83], v[64:67], v[128:143]
    ds_read_b64_tr_b16 v[80:81], v8 offset:45056
    ds_read_b64_tr_b16 v[82:83], v8 offset:46080
    ds_read_b64_tr_b16 v[84:85], v9 offset:45056
    ds_read_b64_tr_b16 v[86:87], v9 offset:46080
    v_mfma_f32_32x32x16_bf16 v[144:159], a[80:83], v[68:71], v[144:159]
    ds_read_b64_tr_b16 v[88:89], v10 offset:45056
    ds_read_b64_tr_b16 v[90:91], v10 offset:46080
    ds_read_b64_tr_b16 v[92:93], v11 offset:45056
    ds_read_b64_tr_b16 v[94:95], v11 offset:46080
    v_mfma_f32_32x32x16_bf16 v[160:175], a[80:83], v[72:75], v[160:175]
    v_mfma_f32_32x32x16_bf16 v[176:191], a[80:83], v[76:79], v[176:191]
    s_waitcnt lgkmcnt(0)
    v_mfma_f32_32x32x16_bf16 v[128:143], a[88:91], v[80:83], v[128:143]
    ds_read_b64_tr_b16 v[64:65], v8 offset:49152
    ds_read_b64_tr_b16 v[66:67], v8 offset:50176
    ds_read_b64_tr_b16 v[68:69], v9 offset:49152
    ds_read_b64_tr_b16 v[70:71], v9 offset:50176
    v_mfma_f32_32x32x16_bf16 v[144:159], a[88:91], v[84:87], v[144:159]
    ds_read_b64_tr_b16 v[72:73], v10 offset:49152
    ds_read_b64_tr_b16 v[74:75], v10 offset:50176
    ds_read_b64_tr_b16 v[76:77], v11 offset:49152
    ds_read_b64_tr_b16 v[78:79], v11 offset:50176
    v_mfma_f32_32x32x16_bf16 v[160:175], a[88:91], v[88:91], v[160:175]
    v_mfma_f32_32x32x16_bf16 v[176:191], a[88:91], v[92:95], v[176:191]
    s_waitcnt vmcnt(48)
    s_waitcnt lgkmcnt(0)
    v_mfma_f32_32x32x16_bf16 v[128:143], a[96:99], v[64:67], v[128:143]
    ds_read_b64_tr_b16 v[80:81], v8 offset:53248
    ds_read_b64_tr_b16 v[82:83], v8 offset:54272
    ds_read_b64_tr_b16 v[84:85], v9 offset:53248
    ds_read_b64_tr_b16 v[86:87], v9 offset:54272
    v_mfma_f32_32x32x16_bf16 v[144:159], a[96:99], v[68:71], v[144:159]
    ds_read_b64_tr_b16 v[88:89], v10 offset:53248
    ds_read_b64_tr_b16 v[90:91], v10 offset:54272
    ds_read_b64_tr_b16 v[92:93], v11 offset:53248
    ds_read_b64_tr_b16 v[94:95], v11 offset:54272
    v_mfma_f32_32x32x16_bf16 v[160:175], a[96:99], v[72:75], v[160:175]
    v_mfma_f32_32x32x16_bf16 v[176:191], a[96:99], v[76:79], v[176:191]
    s_waitcnt lgkmcnt(0)
    v_mfma_f32_32x32x16_bf16 v[128:143], a[104:107], v[80:83], v[128:143]
    ds_read_b64_tr_b16 v[64:65], v8 offset:57344
    ds_read_b64_tr_b16 v[66:67], v8 offset:58368
    ds_read_b64_tr_b16 v[68:69], v9 offset:57344
    ds_read_b64_tr_b16 v[70:71], v9 offset:58368
    v_mfma_f32_32x32x16_bf16 v[144:159], a[104:107], v[84:87], v[144:159]
    ds_read_b64_tr_b16 v[72:73], v10 offset:57344
    ds_read_b64_tr_b16 v[74:75], v10 offset:58368
    ds_read_b64_tr_b16 v[76:77], v11 offset:57344
    ds_read_b64_tr_b16 v[78:79], v11 offset:58368
    v_mfma_f32_32x32x16_bf16 v[160:175], a[104:107], v[88:91], v[160:175]
    v_mfma_f32_32x32x16_bf16 v[176:191], a[104:107], v[92:95], v[176:191]
    s_waitcnt lgkmcnt(0)
    v_mfma_f32_32x32x16_bf16 v[128:143], a[112:115], v[64:67], v[128:143]
    ds_read_b64_tr_b16 v[80:81], v8 offset:61440
    ds_read_b64_tr_b16 v[82:83], v8 offset:62464
    ds_read_b64_tr_b16 v[84:85], v9 offset:61440
    ds_read_b64_tr_b16 v[86:87], v9 offset:62464
    v_mfma_f32_32x32x16_bf16 v[144:159], a[112:115], v[68:71], v[144:159]
    ds_read_b64_tr_b16 v[88:89], v10 offset:61440
    ds_read_b64_tr_b16 v[90:91], v10 offset:62464
    ds_read_b64_tr_b16 v[92:93], v11 offset:61440
    ds_read_b64_tr_b16 v[94:95], v11 offset:62464
    v_mfma_f32_32x32x16_bf16 v[160:175], a[112:115], v[72:75], v[160:175]
    v_mfma_f32_32x32x16_bf16 v[176:191], a[112:115], v[76:79], v[176:191]
    s_waitcnt lgkmcnt(0)
    v_mfma_f32_32x32x16_bf16 v[128:143], a[120:123], v[80:83], v[128:143]
    ds_read_b64_tr_b16 v[64:65], v24 offset:0
    ds_read_b64_tr_b16 v[66:67], v24 offset:1024
    ds_read_b64_tr_b16 v[68:69], v25 offset:0
    ds_read_b64_tr_b16 v[70:71], v25 offset:1024
    v_mfma_f32_32x32x16_bf16 v[144:159], a[120:123], v[84:87], v[144:159]
    ds_read_b64_tr_b16 v[72:73], v26 offset:0
    ds_read_b64_tr_b16 v[74:75], v26 offset:1024
    ds_read_b64_tr_b16 v[76:77], v27 offset:0
    ds_read_b64_tr_b16 v[78:79], v27 offset:1024
    v_mfma_f32_32x32x16_bf16 v[160:175], a[120:123], v[88:91], v[160:175]
    v_mfma_f32_32x32x16_bf16 v[176:191], a[120:123], v[92:95], v[176:191]
    s_waitcnt vmcnt(44)
    s_waitcnt lgkmcnt(0)
    v_mfma_f32_32x32x16_bf16 v[128:143], a[128:131], v[64:67], v[128:143]
    ds_read_b64_tr_b16 v[80:81], v24 offset:4096
    ds_read_b64_tr_b16 v[82:83], v24 offset:5120
    ds_read_b64_tr_b16 v[84:85], v25 offset:4096
    ds_read_b64_tr_b16 v[86:87], v25 offset:5120
    v_mfma_f32_32x32x16_bf16 v[144:159], a[128:131], v[68:71], v[144:159]
    ds_read_b64_tr_b16 v[88:89], v26 offset:4096
    ds_read_b64_tr_b16 v[90:91], v26 offset:5120
    ds_read_b64_tr_b16 v[92:93], v27 offset:4096
    ds_read_b64_tr_b16 v[94:95], v27 offset:5120
    v_mfma_f32_32x32x16_bf16 v[160:175], a[128:131], v[72:75], v[160:175]
    v_mfma_f32_32x32x16_bf16 v[176:191], a[128:131], v[76:79], v[176:191]
    s_waitcnt lgkmcnt(0)
    v_mfma_f32_32x32x16_bf16 v[128:143], a[136:139], v[80:83], v[128:143]
    ds_read_b64_tr_b16 v[64:65], v24 offset:8192
    ds_read_b64_tr_b16 v[66:67], v24 offset:9216
    ds_read_b64_tr_b16 v[68:69], v25 offset:8192
    ds_read_b64_tr_b16 v[70:71], v25 offset:9216
    v_mfma_f32_32x32x16_bf16 v[144:159], a[136:139], v[84:87], v[144:159]
    ds_read_b64_tr_b16 v[72:73], v26 offset:8192
    ds_read_b64_tr_b16 v[74:75], v26 offset:9216
    ds_read_b64_tr_b16 v[76:77], v27 offset:8192
    ds_read_b64_tr_b16 v[78:79], v27 offset:9216
    v_mfma_f32_32x32x16_bf16 v[160:175], a[136:139], v[88:91], v[160:175]
    v_mfma_f32_32x32x16_bf16 v[176:191], a[136:139], v[92:95], v[176:191]
    s_waitcnt lgkmcnt(0)
    v_mfma_f32_32x32x16_bf16 v[128:143], a[144:147], v[64:67], v[128:143]
    ds_read_b64_tr_b16 v[80:81], v24 offset:12288
    ds_read_b64_tr_b16 v[82:83], v24 offset:13312
    ds_read_b64_tr_b16 v[84:85], v25 offset:12288
    ds_read_b64_tr_b16 v[86:87], v25 offset:13312
    v_mfma_f32_32x32x16_bf16 v[144:159], a[144:147], v[68:71], v[144:159]
    ds_read_b64_tr_b16 v[88:89], v26 offset:12288
    ds_read_b64_tr_b16 v[90:91], v26 offset:13312
    ds_read_b64_tr_b16 v[92:93], v27 offset:12288
    ds_read_b64_tr_b16 v[94:95], v27 offset:13312
    v_mfma_f32_32x32x16_bf16 v[160:175], a[144:147], v[72:75], v[160:175]
    v_mfma_f32_32x32x16_bf16 v[176:191], a[144:147], v[76:79], v[176:191]
    s_waitcnt lgkmcnt(0)
    v_mfma_f32_32x32x16_bf16 v[128:143], a[152:155], v[80:83], v[128:143]
    ds_read_b64_tr_b16 v[64:65], v24 offset:16384
    ds_read_b64_tr_b16 v[66:67], v24 offset:17408
    ds_read_b64_tr_b16 v[68:69], v25 offset:16384
    ds_read_b64_tr_b16 v[70:71], v25 offset:17408
    v_mfma_f32_32x32x16_bf16 v[144:159], a[152:155], v[84:87], v[144:159]
    ds_read_b64_tr_b16 v[72:73], v26 offset:16384
    ds_read_b64_tr_b16 v[74:75], v26 offset:17408
    ds_read_b64_tr_b16 v[76:77], v27 offset:16384
    ds_read_b64_tr_b16 v[78:79], v27 offset:17408
    v_mfma_f32_32x32x16_bf16 v[160:175], a[152:155], v[88:91], v[160:175]
    v_mfma_f32_32x32x16_bf16 v[176:191], a[152:155], v[92:95], v[176:191]
    s_waitcnt vmcnt(40)
    s_waitcnt lgkmcnt(0)
    v_mfma_f32_32x32x16_bf16 v[128:143], a[160:163], v[64:67], v[128:143]
    ds_read_b64_tr_b16 v[80:81], v24 offset:20480
    ds_read_b64_tr_b16 v[82:83], v24 offset:21504
    ds_read_b64_tr_b16 v[84:85], v25 offset:20480
    ds_read_b64_tr_b16 v[86:87], v25 offset:21504
    v_mfma_f32_32x32x16_bf16 v[144:159], a[160:163], v[68:71], v[144:159]
    ds_read_b64_tr_b16 v[88:89], v26 offset:20480
    ds_read_b64_tr_b16 v[90:91], v26 offset:21504
    ds_read_b64_tr_b16 v[92:93], v27 offset:20480
    ds_read_b64_tr_b16 v[94:95], v27 offset:21504
    v_mfma_f32_32x32x16_bf16 v[160:175], a[160:163], v[72:75], v[160:175]
    v_mfma_f32_32x32x16_bf16 v[176:191], a[160:163], v[76:79], v[176:191]
    s_waitcnt lgkmcnt(0)
    v_mfma_f32_32x32x16_bf16 v[128:143], a[168:171], v[80:83], v[128:143]
    ds_read_b64_tr_b16 v[64:65], v24 offset:24576
    ds_read_b64_tr_b16 v[66:67], v24 offset:25600
    ds_read_b64_tr_b16 v[68:69], v25 offset:24576
    ds_read_b64_tr_b16 v[70:71], v25 offset:25600
    v_mfma_f32_32x32x16_bf16 v[144:159], a[168:171], v[84:87], v[144:159]
    ds_read_b64_tr_b16 v[72:73], v26 offset:24576
    ds_read_b64_tr_b16 v[74:75], v26 offset:25600
    ds_read_b64_tr_b16 v[76:77], v27 offset:24576
    ds_read_b64_tr_b16 v[78:79], v27 offset:25600
    v_mfma_f32_32x32x16_bf16 v[160:175], a[168:171], v[88:91], v[160:175]
    v_mfma_f32_32x32x16_bf16 v[176:191], a[168:171], v[92:95], v[176:191]
    s_waitcnt lgkmcnt(0)
    v_mfma_f32_32x32x16_bf16 v[128:143], a[176:179], v[64:67], v[128:143]
    ds_read_b64_tr_b16 v[80:81], v24 offset:28672
    ds_read_b64_tr_b16 v[82:83], v24 offset:29696
    ds_read_b64_tr_b16 v[84:85], v25 offset:28672
    ds_read_b64_tr_b16 v[86:87], v25 offset:29696
    v_mfma_f32_32x32x16_bf16 v[144:159], a[176:179], v[68:71], v[144:159]
    ds_read_b64_tr_b16 v[88:89], v26 offset:28672
    ds_read_b64_tr_b16 v[90:91], v26 offset:29696
    ds_read_b64_tr_b16 v[92:93], v27 offset:28672
    ds_read_b64_tr_b16 v[94:95], v27 offset:29696
    v_mfma_f32_32x32x16_bf16 v[160:175], a[176:179], v[72:75], v[160:175]
    v_mfma_f32_32x32x16_bf16 v[176:191], a[176:179], v[76:79], v[176:191]
    s_waitcnt lgkmcnt(0)
    v_mfma_f32_32x32x16_bf16 v[128:143], a[184:187], v[80:83], v[128:143]
    ds_read_b64_tr_b16 v[64:65], v24 offset:32768
    ds_read_b64_tr_b16 v[66:67], v24 offset:33792
    ds_read_b64_tr_b16 v[68:69], v25 offset:32768
    ds_read_b64_tr_b16 v[70:71], v25 offset:33792
    v_mfma_f32_32x32x16_bf16 v[144:159], a[184:187], v[84:87], v[144:159]
    ds_read_b64_tr_b16 v[72:73], v26 offset:32768
    ds_read_b64_tr_b16 v[74:75], v26 offset:33792
    ds_read_b64_tr_b16 v[76:77], v27 offset:32768
    ds_read_b64_tr_b16 v[78:79], v27 offset:33792
    v_mfma_f32_32x32x16_bf16 v[160:175], a[184:187], v[88:91], v[160:175]
    v_mfma_f32_32x32x16_bf16 v[176:191], a[184:187], v[92:95], v[176:191]
    s_waitcnt vmcnt(36)
    s_waitcnt lgkmcnt(0)
    v_mfma_f32_32x32x16_bf16 v[128:143], a[192:195], v[64:67], v[128:143]
    ds_read_b64_tr_b16 v[80:81], v24 offset:36864
    ds_read_b64_tr_b16 v[82:83], v24 offset:37888
    ds_read_b64_tr_b16 v[84:85], v25 offset:36864
    ds_read_b64_tr_b16 v[86:87], v25 offset:37888
    v_mfma_f32_32x32x16_bf16 v[144:159], a[192:195], v[68:71], v[144:159]
    ds_read_b64_tr_b16 v[88:89], v26 offset:36864
    ds_read_b64_tr_b16 v[90:91], v26 offset:37888
    ds_read_b64_tr_b16 v[92:93], v27 offset:36864
    ds_read_b64_tr_b16 v[94:95], v27 offset:37888
    v_mfma_f32_32x32x16_bf16 v[160:175], a[192:195], v[72:75], v[160:175]
    v_mfma_f32_32x32x16_bf16 v[176:191], a[192:195], v[76:79], v[176:191]
    s_waitcnt lgkmcnt(0)
    v_mfma_f32_32x32x16_bf16 v[128:143], a[200:203], v[80:83], v[128:143]
    ds_read_b64_tr_b16 v[64:65], v24 offset:40960
    ds_read_b64_tr_b16 v[66:67], v24 offset:41984
    ds_read_b64_tr_b16 v[68:69], v25 offset:40960
    ds_read_b64_tr_b16 v[70:71], v25 offset:41984
    v_mfma_f32_32x32x16_bf16 v[144:159], a[200:203], v[84:87], v[144:159]
    ds_read_b64_tr_b16 v[72:73], v26 offset:40960
    ds_read_b64_tr_b16 v[74:75], v26 offset:41984
    ds_read_b64_tr_b16 v[76:77], v27 offset:40960
    ds_read_b64_tr_b16 v[78:79], v27 offset:41984
    v_mfma_f32_32x32x16_bf16 v[160:175], a[200:203], v[88:91], v[160:175]
    v_mfma_f32_32x32x16_bf16 v[176:191], a[200:203], v[92:95], v[176:191]
    s_waitcnt lgkmcnt(0)
    v_mfma_f32_32x32x16_bf16 v[128:143], a[208:211], v[64:67], v[128:143]
    ds_read_b64_tr_b16 v[80:81], v24 offset:45056
    ds_read_b64_tr_b16 v[82:83], v24 offset:46080
    ds_read_b64_tr_b16 v[84:85], v25 offset:45056
    ds_read_b64_tr_b16 v[86:87], v25 offset:46080
    v_mfma_f32_32x32x16_bf16 v[144:159], a[208:211], v[68:71], v[144:159]
    ds_read_b64_tr_b16 v[88:89], v26 offset:45056
    ds_read_b64_tr_b16 v[90:91], v26 offset:46080
    ds_read_b64_tr_b16 v[92:93], v27 offset:45056
    ds_read_b64_tr_b16 v[94:95], v27 offset:46080
    v_mfma_f32_32x32x16_bf16 v[160:175], a[208:211], v[72:75], v[160:175]
    v_mfma_f32_32x32x16_bf16 v[176:191], a[208:211], v[76:79], v[176:191]
    s_waitcnt lgkmcnt(0)
    v_mfma_f32_32x32x16_bf16 v[128:143], a[216:219], v[80:83], v[128:143]
    ds_read_b64_tr_b16 v[64:65], v24 offset:49152
    ds_read_b64_tr_b16 v[66:67], v24 offset:50176
    ds_read_b64_tr_b16 v[68:69], v25 offset:49152
    ds_read_b64_tr_b16 v[70:71], v25 offset:50176
    v_mfma_f32_32x32x16_bf16 v[144:159], a[216:219], v[84:87], v[144:159]
    ds_read_b64_tr_b16 v[72:73], v26 offset:49152
    ds_read_b64_tr_b16 v[74:75], v26 offset:50176
    ds_read_b64_tr_b16 v[76:77], v27 offset:49152
    ds_read_b64_tr_b16 v[78:79], v27 offset:50176
    v_mfma_f32_32x32x16_bf16 v[160:175], a[216:219], v[88:91], v[160:175]
    v_mfma_f32_32x32x16_bf16 v[176:191], a[216:219], v[92:95], v[176:191]
    s_waitcnt vmcnt(32)
    s_waitcnt lgkmcnt(0)
    v_mfma_f32_32x32x16_bf16 v[128:143], a[224:227], v[64:67], v[128:143]
    ds_read_b64_tr_b16 v[80:81], v24 offset:53248
    ds_read_b64_tr_b16 v[82:83], v24 offset:54272
    ds_read_b64_tr_b16 v[84:85], v25 offset:53248
    ds_read_b64_tr_b16 v[86:87], v25 offset:54272
    v_mfma_f32_32x32x16_bf16 v[144:159], a[224:227], v[68:71], v[144:159]
    ds_read_b64_tr_b16 v[88:89], v26 offset:53248
    ds_read_b64_tr_b16 v[90:91], v26 offset:54272
    ds_read_b64_tr_b16 v[92:93], v27 offset:53248
    ds_read_b64_tr_b16 v[94:95], v27 offset:54272
    v_mfma_f32_32x32x16_bf16 v[160:175], a[224:227], v[72:75], v[160:175]
    v_mfma_f32_32x32x16_bf16 v[176:191], a[224:227], v[76:79], v[176:191]
    s_waitcnt lgkmcnt(0)
    v_mfma_f32_32x32x16_bf16 v[128:143], a[232:235], v[80:83], v[128:143]
    ds_read_b64_tr_b16 v[64:65], v24 offset:57344
    ds_read_b64_tr_b16 v[66:67], v24 offset:58368
    ds_read_b64_tr_b16 v[68:69], v25 offset:57344
    ds_read_b64_tr_b16 v[70:71], v25 offset:58368
    v_mfma_f32_32x32x16_bf16 v[144:159], a[232:235], v[84:87], v[144:159]
    ds_read_b64_tr_b16 v[72:73], v26 offset:57344
    ds_read_b64_tr_b16 v[74:75], v26 offset:58368
    ds_read_b64_tr_b16 v[76:77], v27 offset:57344
    ds_read_b64_tr_b16 v[78:79], v27 offset:58368
    v_mfma_f32_32x32x16_bf16 v[160:175], a[232:235], v[88:91], v[160:175]
    v_mfma_f32_32x32x16_bf16 v[176:191], a[232:235], v[92:95], v[176:191]
    s_waitcnt lgkmcnt(0)
    v_mfma_f32_32x32x16_bf16 v[128:143], a[240:243], v[64:67], v[128:143]
    ds_read_b64_tr_b16 v[80:81], v24 offset:61440
    ds_read_b64_tr_b16 v[82:83], v24 offset:62464
    ds_read_b64_tr_b16 v[84:85], v25 offset:61440
    ds_read_b64_tr_b16 v[86:87], v25 offset:62464
    v_mfma_f32_32x32x16_bf16 v[144:159], a[240:243], v[68:71], v[144:159]
    ds_read_b64_tr_b16 v[88:89], v26 offset:61440
    ds_read_b64_tr_b16 v[90:91], v26 offset:62464
    ds_read_b64_tr_b16 v[92:93], v27 offset:61440
    ds_read_b64_tr_b16 v[94:95], v27 offset:62464
    v_mfma_f32_32x32x16_bf16 v[160:175], a[240:243], v[72:75], v[160:175]
    v_mfma_f32_32x32x16_bf16 v[176:191], a[240:243], v[76:79], v[176:191]
    s_waitcnt lgkmcnt(0)
    v_mfma_f32_32x32x16_bf16 v[128:143], a[248:251], v[80:83], v[128:143]
    v_mfma_f32_32x32x16_bf16 v[144:159], a[248:251], v[84:87], v[144:159]
    v_mfma_f32_32x32x16_bf16 v[160:175], a[248:251], v[88:91], v[160:175]
    v_mfma_f32_32x32x16_bf16 v[176:191], a[248:251], v[92:95], v[176:191]
    v_lshl_add_u32 v28, v16, 10, v15
    v_add_u32 v28, 8192, v28
    v_add_u32 v29, 131072, v28
    v_add_u32 v30, 4096, v28
    v_add_u32 v31, 4096, v29
    s_nop 3
    v_cvt_pk_bf16_f32 v32, v128, v129
    v_cvt_pk_bf16_f32 v33, v130, v131
    v_cvt_pk_bf16_f32 v34, v132, v133
    v_cvt_pk_bf16_f32 v35, v134, v135
    v_cvt_pk_bf16_f32 v36, v136, v137
    v_cvt_pk_bf16_f32 v37, v138, v139
    v_cvt_pk_bf16_f32 v38, v140, v141
    v_cvt_pk_bf16_f32 v39, v142, v143
    global_store_dwordx4 v28, v[32:35], s[68:69] offset:0 sc1
    global_store_dwordx4 v28, v[36:39], s[68:69] offset:512 sc1
    v_cvt_pk_bf16_f32 v40, v144, v145
    v_cvt_pk_bf16_f32 v41, v146, v147
    v_cvt_pk_bf16_f32 v42, v148, v149
    v_cvt_pk_bf16_f32 v43, v150, v151
    v_cvt_pk_bf16_f32 v44, v152, v153
    v_cvt_pk_bf16_f32 v45, v154, v155
    v_cvt_pk_bf16_f32 v46, v156, v157
    v_cvt_pk_bf16_f32 v47, v158, v159
    global_store_dwordx4 v28, v[40:43], s[68:69] offset:2048 sc1
    global_store_dwordx4 v28, v[44:47], s[68:69] offset:2560 sc1
    v_cvt_pk_bf16_f32 v32, v160, v161
    v_cvt_pk_bf16_f32 v33, v162, v163
    v_cvt_pk_bf16_f32 v34, v164, v165
    v_cvt_pk_bf16_f32 v35, v166, v167
    v_cvt_pk_bf16_f32 v36, v168, v169
    v_cvt_pk_bf16_f32 v37, v170, v171
    v_cvt_pk_bf16_f32 v38, v172, v173
    v_cvt_pk_bf16_f32 v39, v174, v175
    global_store_dwordx4 v30, v[32:35], s[68:69] offset:0 sc1
    global_store_dwordx4 v30, v[36:39], s[68:69] offset:512 sc1
    v_cvt_pk_bf16_f32 v40, v176, v177
    v_cvt_pk_bf16_f32 v41, v178, v179
    v_cvt_pk_bf16_f32 v42, v180, v181
    v_cvt_pk_bf16_f32 v43, v182, v183
    v_cvt_pk_bf16_f32 v44, v184, v185
    v_cvt_pk_bf16_f32 v45, v186, v187
    v_cvt_pk_bf16_f32 v46, v188, v189
    v_cvt_pk_bf16_f32 v47, v190, v191
    global_store_dwordx4 v30, v[40:43], s[68:69] offset:2048 sc1
    global_store_dwordx4 v30, v[44:47], s[68:69] offset:2560 sc1
    ds_read_b64_tr_b16 v[64:65], v8 offset:0
    ds_read_b64_tr_b16 v[66:67], v8 offset:1024
    ds_read_b64_tr_b16 v[68:69], v9 offset:0
    ds_read_b64_tr_b16 v[70:71], v9 offset:1024
    ds_read_b64_tr_b16 v[72:73], v10 offset:0
    ds_read_b64_tr_b16 v[74:75], v10 offset:1024
    ds_read_b64_tr_b16 v[76:77], v11 offset:0
    ds_read_b64_tr_b16 v[78:79], v11 offset:1024
    s_waitcnt vmcnt(8)
    s_waitcnt lgkmcnt(0)
    v_mfma_f32_32x32x16_bf16 v[192:207], a[4:7], v[64:67], 0
    ds_read_b64_tr_b16 v[80:81], v8 offset:4096
    ds_read_b64_tr_b16 v[82:83], v8 offset:5120
    ds_read_b64_tr_b16 v[84:85], v9 offset:4096
    ds_read_b64_tr_b16 v[86:87], v9 offset:5120
    v_mfma_f32_32x32x16_bf16 v[208:223], a[4:7], v[68:71], 0
    ds_read_b64_tr_b16 v[88:89], v10 offset:4096
    ds_read_b64_tr_b16 v[90:91], v10 offset:5120
    ds_read_b64_tr_b16 v[92:93], v11 offset:4096
    ds_read_b64_tr_b16 v[94:95], v11 offset:5120
    v_mfma_f32_32x32x16_bf16 v[224:239], a[4:7], v[72:75], 0
    v_mfma_f32_32x32x16_bf16 v[240:255], a[4:7], v[76:79], 0
    s_waitcnt lgkmcnt(0)
    v_mfma_f32_32x32x16_bf16 v[192:207], a[12:15], v[80:83], v[192:207]
    ds_read_b64_tr_b16 v[64:65], v8 offset:8192
    ds_read_b64_tr_b16 v[66:67], v8 offset:9216
    ds_read_b64_tr_b16 v[68:69], v9 offset:8192
    ds_read_b64_tr_b16 v[70:71], v9 offset:9216
    v_mfma_f32_32x32x16_bf16 v[208:223], a[12:15], v[84:87], v[208:223]
    ds_read_b64_tr_b16 v[72:73], v10 offset:8192
    ds_read_b64_tr_b16 v[74:75], v10 offset:9216
    ds_read_b64_tr_b16 v[76:77], v11 offset:8192
    ds_read_b64_tr_b16 v[78:79], v11 offset:9216
    v_mfma_f32_32x32x16_bf16 v[224:239], a[12:15], v[88:91], v[224:239]
    v_mfma_f32_32x32x16_bf16 v[240:255], a[12:15], v[92:95], v[240:255]
    s_waitcnt lgkmcnt(0)
    v_mfma_f32_32x32x16_bf16 v[192:207], a[20:23], v[64:67], v[192:207]
    ds_read_b64_tr_b16 v[80:81], v8 offset:12288
    ds_read_b64_tr_b16 v[82:83], v8 offset:13312
    ds_read_b64_tr_b16 v[84:85], v9 offset:12288
    ds_read_b64_tr_b16 v[86:87], v9 offset:13312
    v_mfma_f32_32x32x16_bf16 v[208:223], a[20:23], v[68:71], v[208:223]
    ds_read_b64_tr_b16 v[88:89], v10 offset:12288
    ds_read_b64_tr_b16 v[90:91], v10 offset:13312
    ds_read_b64_tr_b16 v[92:93], v11 offset:12288
    ds_read_b64_tr_b16 v[94:95], v11 offset:13312
    v_mfma_f32_32x32x16_bf16 v[224:239], a[20:23], v[72:75], v[224:239]
    v_mfma_f32_32x32x16_bf16 v[240:255], a[20:23], v[76:79], v[240:255]
    s_waitcnt lgkmcnt(0)
    v_mfma_f32_32x32x16_bf16 v[192:207], a[28:31], v[80:83], v[192:207]
    ds_read_b64_tr_b16 v[64:65], v8 offset:16384
    ds_read_b64_tr_b16 v[66:67], v8 offset:17408
    ds_read_b64_tr_b16 v[68:69], v9 offset:16384
    ds_read_b64_tr_b16 v[70:71], v9 offset:17408
    v_mfma_f32_32x32x16_bf16 v[208:223], a[28:31], v[84:87], v[208:223]
    ds_read_b64_tr_b16 v[72:73], v10 offset:16384
    ds_read_b64_tr_b16 v[74:75], v10 offset:17408
    ds_read_b64_tr_b16 v[76:77], v11 offset:16384
    ds_read_b64_tr_b16 v[78:79], v11 offset:17408
    v_mfma_f32_32x32x16_bf16 v[224:239], a[28:31], v[88:91], v[224:239]
    v_mfma_f32_32x32x16_bf16 v[240:255], a[28:31], v[92:95], v[240:255]
    s_waitcnt lgkmcnt(0)
    v_mfma_f32_32x32x16_bf16 v[192:207], a[36:39], v[64:67], v[192:207]
    ds_read_b64_tr_b16 v[80:81], v8 offset:20480
    ds_read_b64_tr_b16 v[82:83], v8 offset:21504
    ds_read_b64_tr_b16 v[84:85], v9 offset:20480
    ds_read_b64_tr_b16 v[86:87], v9 offset:21504
    v_mfma_f32_32x32x16_bf16 v[208:223], a[36:39], v[68:71], v[208:223]
    ds_read_b64_tr_b16 v[88:89], v10 offset:20480
    ds_read_b64_tr_b16 v[90:91], v10 offset:21504
    ds_read_b64_tr_b16 v[92:93], v11 offset:20480
    ds_read_b64_tr_b16 v[94:95], v11 offset:21504
    v_mfma_f32_32x32x16_bf16 v[224:239], a[36:39], v[72:75], v[224:239]
    v_mfma_f32_32x32x16_bf16 v[240:255], a[36:39], v[76:79], v[240:255]
    s_waitcnt lgkmcnt(0)
    v_mfma_f32_32x32x16_bf16 v[192:207], a[44:47], v[80:83], v[192:207]
    ds_read_b64_tr_b16 v[64:65], v8 offset:24576
    ds_read_b64_tr_b16 v[66:67], v8 offset:25600
    ds_read_b64_tr_b16 v[68:69], v9 offset:24576
    ds_read_b64_tr_b16 v[70:71], v9 offset:25600
    v_mfma_f32_32x32x16_bf16 v[208:223], a[44:47], v[84:87], v[208:223]
    ds_read_b64_tr_b16 v[72:73], v10 offset:24576
    ds_read_b64_tr_b16 v[74:75], v10 offset:25600
    ds_read_b64_tr_b16 v[76:77], v11 offset:24576
    ds_read_b64_tr_b16 v[78:79], v11 offset:25600
    v_mfma_f32_32x32x16_bf16 v[224:239], a[44:47], v[88:91], v[224:239]
    v_mfma_f32_32x32x16_bf16 v[240:255], a[44:47], v[92:95], v[240:255]
    s_waitcnt lgkmcnt(0)
    v_mfma_f32_32x32x16_bf16 v[192:207], a[52:55], v[64:67], v[192:207]
    ds_read_b64_tr_b16 v[80:81], v8 offset:28672
    ds_read_b64_tr_b16 v[82:83], v8 offset:29696
    ds_read_b64_tr_b16 v[84:85], v9 offset:28672
    ds_read_b64_tr_b16 v[86:87], v9 offset:29696
    v_mfma_f32_32x32x16_bf16 v[208:223], a[52:55], v[68:71], v[208:223]
    ds_read_b64_tr_b16 v[88:89], v10 offset:28672
    ds_read_b64_tr_b16 v[90:91], v10 offset:29696
    ds_read_b64_tr_b16 v[92:93], v11 offset:28672
    ds_read_b64_tr_b16 v[94:95], v11 offset:29696
    v_mfma_f32_32x32x16_bf16 v[224:239], a[52:55], v[72:75], v[224:239]
    v_mfma_f32_32x32x16_bf16 v[240:255], a[52:55], v[76:79], v[240:255]
    s_waitcnt lgkmcnt(0)
    v_mfma_f32_32x32x16_bf16 v[192:207], a[60:63], v[80:83], v[192:207]
    ds_read_b64_tr_b16 v[64:65], v8 offset:32768
    ds_read_b64_tr_b16 v[66:67], v8 offset:33792
    ds_read_b64_tr_b16 v[68:69], v9 offset:32768
    ds_read_b64_tr_b16 v[70:71], v9 offset:33792
    v_mfma_f32_32x32x16_bf16 v[208:223], a[60:63], v[84:87], v[208:223]
    ds_read_b64_tr_b16 v[72:73], v10 offset:32768
    ds_read_b64_tr_b16 v[74:75], v10 offset:33792
    ds_read_b64_tr_b16 v[76:77], v11 offset:32768
    ds_read_b64_tr_b16 v[78:79], v11 offset:33792
    v_mfma_f32_32x32x16_bf16 v[224:239], a[60:63], v[88:91], v[224:239]
    v_mfma_f32_32x32x16_bf16 v[240:255], a[60:63], v[92:95], v[240:255]
    s_waitcnt lgkmcnt(0)
    v_mfma_f32_32x32x16_bf16 v[192:207], a[68:71], v[64:67], v[192:207]
    ds_read_b64_tr_b16 v[80:81], v8 offset:36864
    ds_read_b64_tr_b16 v[82:83], v8 offset:37888
    ds_read_b64_tr_b16 v[84:85], v9 offset:36864
    ds_read_b64_tr_b16 v[86:87], v9 offset:37888
    v_mfma_f32_32x32x16_bf16 v[208:223], a[68:71], v[68:71], v[208:223]
    ds_read_b64_tr_b16 v[88:89], v10 offset:36864
    ds_read_b64_tr_b16 v[90:91], v10 offset:37888
    ds_read_b64_tr_b16 v[92:93], v11 offset:36864
    ds_read_b64_tr_b16 v[94:95], v11 offset:37888
    v_mfma_f32_32x32x16_bf16 v[224:239], a[68:71], v[72:75], v[224:239]
    v_mfma_f32_32x32x16_bf16 v[240:255], a[68:71], v[76:79], v[240:255]
    s_waitcnt lgkmcnt(0)
    v_mfma_f32_32x32x16_bf16 v[192:207], a[76:79], v[80:83], v[192:207]
    ds_read_b64_tr_b16 v[64:65], v8 offset:40960
    ds_read_b64_tr_b16 v[66:67], v8 offset:41984
    ds_read_b64_tr_b16 v[68:69], v9 offset:40960
    ds_read_b64_tr_b16 v[70:71], v9 offset:41984
    v_mfma_f32_32x32x16_bf16 v[208:223], a[76:79], v[84:87], v[208:223]
    ds_read_b64_tr_b16 v[72:73], v10 offset:40960
    ds_read_b64_tr_b16 v[74:75], v10 offset:41984
    ds_read_b64_tr_b16 v[76:77], v11 offset:40960
    ds_read_b64_tr_b16 v[78:79], v11 offset:41984
    v_mfma_f32_32x32x16_bf16 v[224:239], a[76:79], v[88:91], v[224:239]
    v_mfma_f32_32x32x16_bf16 v[240:255], a[76:79], v[92:95], v[240:255]
    v_mov_b32 v18, s97
    s_waitcnt vmcnt(0)
    s_mov_b64 exec, 0x1
    global_store_dword v19, v18, s[74:75] offset:256 sc1
    s_mov_b64 exec, -1
    s_waitcnt lgkmcnt(0)
    v_mfma_f32_32x32x16_bf16 v[192:207], a[84:87], v[64:67], v[192:207]
    ds_read_b64_tr_b16 v[80:81], v8 offset:45056
    ds_read_b64_tr_b16 v[82:83], v8 offset:46080
    ds_read_b64_tr_b16 v[84:85], v9 offset:45056
    ds_read_b64_tr_b16 v[86:87], v9 offset:46080
    v_mfma_f32_32x32x16_bf16 v[208:223], a[84:87], v[68:71], v[208:223]
    ds_read_b64_tr_b16 v[88:89], v10 offset:45056
    ds_read_b64_tr_b16 v[90:91], v10 offset:46080
    ds_read_b64_tr_b16 v[92:93], v11 offset:45056
    ds_read_b64_tr_b16 v[94:95], v11 offset:46080
    v_mfma_f32_32x32x16_bf16 v[224:239], a[84:87], v[72:75], v[224:239]
    v_mfma_f32_32x32x16_bf16 v[240:255], a[84:87], v[76:79], v[240:255]
    s_waitcnt lgkmcnt(0)
    v_mfma_f32_32x32x16_bf16 v[192:207], a[92:95], v[80:83], v[192:207]
    ds_read_b64_tr_b16 v[64:65], v8 offset:49152
    ds_read_b64_tr_b16 v[66:67], v8 offset:50176
    ds_read_b64_tr_b16 v[68:69], v9 offset:49152
    ds_read_b64_tr_b16 v[70:71], v9 offset:50176
    v_mfma_f32_32x32x16_bf16 v[208:223], a[92:95], v[84:87], v[208:223]
    ds_read_b64_tr_b16 v[72:73], v10 offset:49152
    ds_read_b64_tr_b16 v[74:75], v10 offset:50176
    ds_read_b64_tr_b16 v[76:77], v11 offset:49152
    ds_read_b64_tr_b16 v[78:79], v11 offset:50176
    v_mfma_f32_32x32x16_bf16 v[224:239], a[92:95], v[88:91], v[224:239]
    v_mfma_f32_32x32x16_bf16 v[240:255], a[92:95], v[92:95], v[240:255]
    s_waitcnt lgkmcnt(0)
    v_mfma_f32_32x32x16_bf16 v[192:207], a[100:103], v[64:67], v[192:207]
    ds_read_b64_tr_b16 v[80:81], v8 offset:53248
    ds_read_b64_tr_b16 v[82:83], v8 offset:54272
    ds_read_b64_tr_b16 v[84:85], v9 offset:53248
    ds_read_b64_tr_b16 v[86:87], v9 offset:54272
    v_mfma_f32_32x32x16_bf16 v[208:223], a[100:103], v[68:71], v[208:223]
    ds_read_b64_tr_b16 v[88:89], v10 offset:53248
    ds_read_b64_tr_b16 v[90:91], v10 offset:54272
    ds_read_b64_tr_b16 v[92:93], v11 offset:53248
    ds_read_b64_tr_b16 v[94:95], v11 offset:54272
    v_mfma_f32_32x32x16_bf16 v[224:239], a[100:103], v[72:75], v[224:239]
    v_mfma_f32_32x32x16_bf16 v[240:255], a[100:103], v[76:79], v[240:255]
    s_waitcnt lgkmcnt(0)
    v_mfma_f32_32x32x16_bf16 v[192:207], a[108:111], v[80:83], v[192:207]
    ds_read_b64_tr_b16 v[64:65], v8 offset:57344
    ds_read_b64_tr_b16 v[66:67], v8 offset:58368
    ds_read_b64_tr_b16 v[68:69], v9 offset:57344
    ds_read_b64_tr_b16 v[70:71], v9 offset:58368
    v_mfma_f32_32x32x16_bf16 v[208:223], a[108:111], v[84:87], v[208:223]
    ds_read_b64_tr_b16 v[72:73], v10 offset:57344
    ds_read_b64_tr_b16 v[74:75], v10 offset:58368
    ds_read_b64_tr_b16 v[76:77], v11 offset:57344
    ds_read_b64_tr_b16 v[78:79], v11 offset:58368
    v_mfma_f32_32x32x16_bf16 v[224:239], a[108:111], v[88:91], v[224:239]
    v_mfma_f32_32x32x16_bf16 v[240:255], a[108:111], v[92:95], v[240:255]
    s_waitcnt lgkmcnt(0)
    v_mfma_f32_32x32x16_bf16 v[192:207], a[116:119], v[64:67], v[192:207]
    ds_read_b64_tr_b16 v[80:81], v8 offset:61440
    ds_read_b64_tr_b16 v[82:83], v8 offset:62464
    ds_read_b64_tr_b16 v[84:85], v9 offset:61440
    ds_read_b64_tr_b16 v[86:87], v9 offset:62464
    v_mfma_f32_32x32x16_bf16 v[208:223], a[116:119], v[68:71], v[208:223]
    ds_read_b64_tr_b16 v[88:89], v10 offset:61440
    ds_read_b64_tr_b16 v[90:91], v10 offset:62464
    ds_read_b64_tr_b16 v[92:93], v11 offset:61440
    ds_read_b64_tr_b16 v[94:95], v11 offset:62464
    v_mfma_f32_32x32x16_bf16 v[224:239], a[116:119], v[72:75], v[224:239]
    v_mfma_f32_32x32x16_bf16 v[240:255], a[116:119], v[76:79], v[240:255]
    s_waitcnt lgkmcnt(0)
    v_mfma_f32_32x32x16_bf16 v[192:207], a[124:127], v[80:83], v[192:207]
    ds_read_b64_tr_b16 v[64:65], v24 offset:0
    ds_read_b64_tr_b16 v[66:67], v24 offset:1024
    ds_read_b64_tr_b16 v[68:69], v25 offset:0
    ds_read_b64_tr_b16 v[70:71], v25 offset:1024
    v_mfma_f32_32x32x16_bf16 v[208:223], a[124:127], v[84:87], v[208:223]
    ds_read_b64_tr_b16 v[72:73], v26 offset:0
    ds_read_b64_tr_b16 v[74:75], v26 offset:1024
    ds_read_b64_tr_b16 v[76:77], v27 offset:0
    ds_read_b64_tr_b16 v[78:79], v27 offset:1024
    v_mfma_f32_32x32x16_bf16 v[224:239], a[124:127], v[88:91], v[224:239]
    v_mfma_f32_32x32x16_bf16 v[240:255], a[124:127], v[92:95], v[240:255]
    s_waitcnt lgkmcnt(0)
    v_mfma_f32_32x32x16_bf16 v[192:207], a[132:135], v[64:67], v[192:207]
    ds_read_b64_tr_b16 v[80:81], v24 offset:4096
    ds_read_b64_tr_b16 v[82:83], v24 offset:5120
    ds_read_b64_tr_b16 v[84:85], v25 offset:4096
    ds_read_b64_tr_b16 v[86:87], v25 offset:5120
    v_mfma_f32_32x32x16_bf16 v[208:223], a[132:135], v[68:71], v[208:223]
    ds_read_b64_tr_b16 v[88:89], v26 offset:4096
    ds_read_b64_tr_b16 v[90:91], v26 offset:5120
    ds_read_b64_tr_b16 v[92:93], v27 offset:4096
    ds_read_b64_tr_b16 v[94:95], v27 offset:5120
    v_mfma_f32_32x32x16_bf16 v[224:239], a[132:135], v[72:75], v[224:239]
    v_mfma_f32_32x32x16_bf16 v[240:255], a[132:135], v[76:79], v[240:255]
    s_waitcnt lgkmcnt(0)
    v_mfma_f32_32x32x16_bf16 v[192:207], a[140:143], v[80:83], v[192:207]
    ds_read_b64_tr_b16 v[64:65], v24 offset:8192
    ds_read_b64_tr_b16 v[66:67], v24 offset:9216
    ds_read_b64_tr_b16 v[68:69], v25 offset:8192
    ds_read_b64_tr_b16 v[70:71], v25 offset:9216
    v_mfma_f32_32x32x16_bf16 v[208:223], a[140:143], v[84:87], v[208:223]
    ds_read_b64_tr_b16 v[72:73], v26 offset:8192
    ds_read_b64_tr_b16 v[74:75], v26 offset:9216
    ds_read_b64_tr_b16 v[76:77], v27 offset:8192
    ds_read_b64_tr_b16 v[78:79], v27 offset:9216
    v_mfma_f32_32x32x16_bf16 v[224:239], a[140:143], v[88:91], v[224:239]
    v_mfma_f32_32x32x16_bf16 v[240:255], a[140:143], v[92:95], v[240:255]
    s_waitcnt lgkmcnt(0)
    v_mfma_f32_32x32x16_bf16 v[192:207], a[148:151], v[64:67], v[192:207]
    ds_read_b64_tr_b16 v[80:81], v24 offset:12288
    ds_read_b64_tr_b16 v[82:83], v24 offset:13312
    ds_read_b64_tr_b16 v[84:85], v25 offset:12288
    ds_read_b64_tr_b16 v[86:87], v25 offset:13312
    v_mfma_f32_32x32x16_bf16 v[208:223], a[148:151], v[68:71], v[208:223]
    ds_read_b64_tr_b16 v[88:89], v26 offset:12288
    ds_read_b64_tr_b16 v[90:91], v26 offset:13312
    ds_read_b64_tr_b16 v[92:93], v27 offset:12288
    ds_read_b64_tr_b16 v[94:95], v27 offset:13312
    v_mfma_f32_32x32x16_bf16 v[224:239], a[148:151], v[72:75], v[224:239]
    v_mfma_f32_32x32x16_bf16 v[240:255], a[148:151], v[76:79], v[240:255]
    s_waitcnt lgkmcnt(0)
    v_mfma_f32_32x32x16_bf16 v[192:207], a[156:159], v[80:83], v[192:207]
    ds_read_b64_tr_b16 v[64:65], v24 offset:16384
    ds_read_b64_tr_b16 v[66:67], v24 offset:17408
    ds_read_b64_tr_b16 v[68:69], v25 offset:16384
    ds_read_b64_tr_b16 v[70:71], v25 offset:17408
    v_mfma_f32_32x32x16_bf16 v[208:223], a[156:159], v[84:87], v[208:223]
    ds_read_b64_tr_b16 v[72:73], v26 offset:16384
    ds_read_b64_tr_b16 v[74:75], v26 offset:17408
    ds_read_b64_tr_b16 v[76:77], v27 offset:16384
    ds_read_b64_tr_b16 v[78:79], v27 offset:17408
    v_mfma_f32_32x32x16_bf16 v[224:239], a[156:159], v[88:91], v[224:239]
    v_mfma_f32_32x32x16_bf16 v[240:255], a[156:159], v[92:95], v[240:255]
    s_waitcnt lgkmcnt(0)
    v_mfma_f32_32x32x16_bf16 v[192:207], a[164:167], v[64:67], v[192:207]
    ds_read_b64_tr_b16 v[80:81], v24 offset:20480
    ds_read_b64_tr_b16 v[82:83], v24 offset:21504
    ds_read_b64_tr_b16 v[84:85], v25 offset:20480
    ds_read_b64_tr_b16 v[86:87], v25 offset:21504
    v_mfma_f32_32x32x16_bf16 v[208:223], a[164:167], v[68:71], v[208:223]
    ds_read_b64_tr_b16 v[88:89], v26 offset:20480
    ds_read_b64_tr_b16 v[90:91], v26 offset:21504
    ds_read_b64_tr_b16 v[92:93], v27 offset:20480
    ds_read_b64_tr_b16 v[94:95], v27 offset:21504
    v_mfma_f32_32x32x16_bf16 v[224:239], a[164:167], v[72:75], v[224:239]
    v_mfma_f32_32x32x16_bf16 v[240:255], a[164:167], v[76:79], v[240:255]
    s_waitcnt lgkmcnt(0)
    v_mfma_f32_32x32x16_bf16 v[192:207], a[172:175], v[80:83], v[192:207]
    ds_read_b64_tr_b16 v[64:65], v24 offset:24576
    ds_read_b64_tr_b16 v[66:67], v24 offset:25600
    ds_read_b64_tr_b16 v[68:69], v25 offset:24576
    ds_read_b64_tr_b16 v[70:71], v25 offset:25600
    v_mfma_f32_32x32x16_bf16 v[208:223], a[172:175], v[84:87], v[208:223]
    ds_read_b64_tr_b16 v[72:73], v26 offset:24576
    ds_read_b64_tr_b16 v[74:75], v26 offset:25600
    ds_read_b64_tr_b16 v[76:77], v27 offset:24576
    ds_read_b64_tr_b16 v[78:79], v27 offset:25600
    v_mfma_f32_32x32x16_bf16 v[224:239], a[172:175], v[88:91], v[224:239]
    v_mfma_f32_32x32x16_bf16 v[240:255], a[172:175], v[92:95], v[240:255]
    s_waitcnt lgkmcnt(0)
    v_mfma_f32_32x32x16_bf16 v[192:207], a[180:183], v[64:67], v[192:207]
    ds_read_b64_tr_b16 v[80:81], v24 offset:28672
    ds_read_b64_tr_b16 v[82:83], v24 offset:29696
    ds_read_b64_tr_b16 v[84:85], v25 offset:28672
    ds_read_b64_tr_b16 v[86:87], v25 offset:29696
    v_mfma_f32_32x32x16_bf16 v[208:223], a[180:183], v[68:71], v[208:223]
    ds_read_b64_tr_b16 v[88:89], v26 offset:28672
    ds_read_b64_tr_b16 v[90:91], v26 offset:29696
    ds_read_b64_tr_b16 v[92:93], v27 offset:28672
    ds_read_b64_tr_b16 v[94:95], v27 offset:29696
    v_mfma_f32_32x32x16_bf16 v[224:239], a[180:183], v[72:75], v[224:239]
    v_mfma_f32_32x32x16_bf16 v[240:255], a[180:183], v[76:79], v[240:255]
    s_waitcnt lgkmcnt(0)
    v_mfma_f32_32x32x16_bf16 v[192:207], a[188:191], v[80:83], v[192:207]
    ds_read_b64_tr_b16 v[64:65], v24 offset:32768
    ds_read_b64_tr_b16 v[66:67], v24 offset:33792
    ds_read_b64_tr_b16 v[68:69], v25 offset:32768
    ds_read_b64_tr_b16 v[70:71], v25 offset:33792
    v_mfma_f32_32x32x16_bf16 v[208:223], a[188:191], v[84:87], v[208:223]
    ds_read_b64_tr_b16 v[72:73], v26 offset:32768
    ds_read_b64_tr_b16 v[74:75], v26 offset:33792
    ds_read_b64_tr_b16 v[76:77], v27 offset:32768
    ds_read_b64_tr_b16 v[78:79], v27 offset:33792
    v_mfma_f32_32x32x16_bf16 v[224:239], a[188:191], v[88:91], v[224:239]
    v_mfma_f32_32x32x16_bf16 v[240:255], a[188:191], v[92:95], v[240:255]
    s_waitcnt lgkmcnt(0)
    v_mfma_f32_32x32x16_bf16 v[192:207], a[196:199], v[64:67], v[192:207]
    ds_read_b64_tr_b16 v[80:81], v24 offset:36864
    ds_read_b64_tr_b16 v[82:83], v24 offset:37888
    ds_read_b64_tr_b16 v[84:85], v25 offset:36864
    ds_read_b64_tr_b16 v[86:87], v25 offset:37888
    v_mfma_f32_32x32x16_bf16 v[208:223], a[196:199], v[68:71], v[208:223]
    ds_read_b64_tr_b16 v[88:89], v26 offset:36864
    ds_read_b64_tr_b16 v[90:91], v26 offset:37888
    ds_read_b64_tr_b16 v[92:93], v27 offset:36864
    ds_read_b64_tr_b16 v[94:95], v27 offset:37888
    v_mfma_f32_32x32x16_bf16 v[224:239], a[196:199], v[72:75], v[224:239]
    v_mfma_f32_32x32x16_bf16 v[240:255], a[196:199], v[76:79], v[240:255]
    s_waitcnt lgkmcnt(0)
    v_mfma_f32_32x32x16_bf16 v[192:207], a[204:207], v[80:83], v[192:207]
    ds_read_b64_tr_b16 v[64:65], v24 offset:40960
    ds_read_b64_tr_b16 v[66:67], v24 offset:41984
    ds_read_b64_tr_b16 v[68:69], v25 offset:40960
    ds_read_b64_tr_b16 v[70:71], v25 offset:41984
    v_mfma_f32_32x32x16_bf16 v[208:223], a[204:207], v[84:87], v[208:223]
    ds_read_b64_tr_b16 v[72:73], v26 offset:40960
    ds_read_b64_tr_b16 v[74:75], v26 offset:41984
    ds_read_b64_tr_b16 v[76:77], v27 offset:40960
    ds_read_b64_tr_b16 v[78:79], v27 offset:41984
    v_mfma_f32_32x32x16_bf16 v[224:239], a[204:207], v[88:91], v[224:239]
    v_mfma_f32_32x32x16_bf16 v[240:255], a[204:207], v[92:95], v[240:255]
    s_waitcnt lgkmcnt(0)
    v_mfma_f32_32x32x16_bf16 v[192:207], a[212:215], v[64:67], v[192:207]
    ds_read_b64_tr_b16 v[80:81], v24 offset:45056
    ds_read_b64_tr_b16 v[82:83], v24 offset:46080
    ds_read_b64_tr_b16 v[84:85], v25 offset:45056
    ds_read_b64_tr_b16 v[86:87], v25 offset:46080
    v_mfma_f32_32x32x16_bf16 v[208:223], a[212:215], v[68:71], v[208:223]
    ds_read_b64_tr_b16 v[88:89], v26 offset:45056
    ds_read_b64_tr_b16 v[90:91], v26 offset:46080
    ds_read_b64_tr_b16 v[92:93], v27 offset:45056
    ds_read_b64_tr_b16 v[94:95], v27 offset:46080
    v_mfma_f32_32x32x16_bf16 v[224:239], a[212:215], v[72:75], v[224:239]
    v_mfma_f32_32x32x16_bf16 v[240:255], a[212:215], v[76:79], v[240:255]
    s_waitcnt lgkmcnt(0)
    v_mfma_f32_32x32x16_bf16 v[192:207], a[220:223], v[80:83], v[192:207]
    ds_read_b64_tr_b16 v[64:65], v24 offset:49152
    ds_read_b64_tr_b16 v[66:67], v24 offset:50176
    ds_read_b64_tr_b16 v[68:69], v25 offset:49152
    ds_read_b64_tr_b16 v[70:71], v25 offset:50176
    v_mfma_f32_32x32x16_bf16 v[208:223], a[220:223], v[84:87], v[208:223]
    ds_read_b64_tr_b16 v[72:73], v26 offset:49152
    ds_read_b64_tr_b16 v[74:75], v26 offset:50176
    ds_read_b64_tr_b16 v[76:77], v27 offset:49152
    ds_read_b64_tr_b16 v[78:79], v27 offset:50176
    v_mfma_f32_32x32x16_bf16 v[224:239], a[220:223], v[88:91], v[224:239]
    v_mfma_f32_32x32x16_bf16 v[240:255], a[220:223], v[92:95], v[240:255]
    s_waitcnt lgkmcnt(0)
    v_mfma_f32_32x32x16_bf16 v[192:207], a[228:231], v[64:67], v[192:207]
    ds_read_b64_tr_b16 v[80:81], v24 offset:53248
    ds_read_b64_tr_b16 v[82:83], v24 offset:54272
    ds_read_b64_tr_b16 v[84:85], v25 offset:53248
    ds_read_b64_tr_b16 v[86:87], v25 offset:54272
    v_mfma_f32_32x32x16_bf16 v[208:223], a[228:231], v[68:71], v[208:223]
    ds_read_b64_tr_b16 v[88:89], v26 offset:53248
    ds_read_b64_tr_b16 v[90:91], v26 offset:54272
    ds_read_b64_tr_b16 v[92:93], v27 offset:53248
    ds_read_b64_tr_b16 v[94:95], v27 offset:54272
    v_mfma_f32_32x32x16_bf16 v[224:239], a[228:231], v[72:75], v[224:239]
    v_mfma_f32_32x32x16_bf16 v[240:255], a[228:231], v[76:79], v[240:255]
    s_waitcnt lgkmcnt(0)
    v_mfma_f32_32x32x16_bf16 v[192:207], a[236:239], v[80:83], v[192:207]
    ds_read_b64_tr_b16 v[64:65], v24 offset:57344
    ds_read_b64_tr_b16 v[66:67], v24 offset:58368
    ds_read_b64_tr_b16 v[68:69], v25 offset:57344
    ds_read_b64_tr_b16 v[70:71], v25 offset:58368
    v_mfma_f32_32x32x16_bf16 v[208:223], a[236:239], v[84:87], v[208:223]
    ds_read_b64_tr_b16 v[72:73], v26 offset:57344
    ds_read_b64_tr_b16 v[74:75], v26 offset:58368
    ds_read_b64_tr_b16 v[76:77], v27 offset:57344
    ds_read_b64_tr_b16 v[78:79], v27 offset:58368
    v_mfma_f32_32x32x16_bf16 v[224:239], a[236:239], v[88:91], v[224:239]
    v_mfma_f32_32x32x16_bf16 v[240:255], a[236:239], v[92:95], v[240:255]
    s_waitcnt lgkmcnt(0)
    v_mfma_f32_32x32x16_bf16 v[192:207], a[244:247], v[64:67], v[192:207]
    ds_read_b64_tr_b16 v[80:81], v24 offset:61440
    ds_read_b64_tr_b16 v[82:83], v24 offset:62464
    ds_read_b64_tr_b16 v[84:85], v25 offset:61440
    ds_read_b64_tr_b16 v[86:87], v25 offset:62464
    v_mfma_f32_32x32x16_bf16 v[208:223], a[244:247], v[68:71], v[208:223]
    ds_read_b64_tr_b16 v[88:89], v26 offset:61440
    ds_read_b64_tr_b16 v[90:91], v26 offset:62464
    ds_read_b64_tr_b16 v[92:93], v27 offset:61440
    ds_read_b64_tr_b16 v[94:95], v27 offset:62464
    v_mfma_f32_32x32x16_bf16 v[224:239], a[244:247], v[72:75], v[224:239]
    v_mfma_f32_32x32x16_bf16 v[240:255], a[244:247], v[76:79], v[240:255]
    s_waitcnt lgkmcnt(0)
    v_mfma_f32_32x32x16_bf16 v[192:207], a[252:255], v[80:83], v[192:207]
    v_mfma_f32_32x32x16_bf16 v[208:223], a[252:255], v[84:87], v[208:223]
    v_mfma_f32_32x32x16_bf16 v[224:239], a[252:255], v[88:91], v[224:239]
    v_mfma_f32_32x32x16_bf16 v[240:255], a[252:255], v[92:95], v[240:255]
    v_lshl_add_u32 v28, v16, 10, v15
    v_add_u32 v28, 8192, v28
    v_add_u32 v29, 131072, v28
    v_add_u32 v30, 4096, v28
    v_add_u32 v31, 4096, v29
    s_nop 3
    v_cvt_pk_bf16_f32 v32, v192, v193
    v_cvt_pk_bf16_f32 v33, v194, v195
    v_cvt_pk_bf16_f32 v34, v196, v197
    v_cvt_pk_bf16_f32 v35, v198, v199
    v_cvt_pk_bf16_f32 v36, v200, v201
    v_cvt_pk_bf16_f32 v37, v202, v203
    v_cvt_pk_bf16_f32 v38, v204, v205
    v_cvt_pk_bf16_f32 v39, v206, v207
    global_store_dwordx4 v29, v[32:35], s[68:69] offset:0 sc1
    global_store_dwordx4 v29, v[36:39], s[68:69] offset:512 sc1
    v_cvt_pk_bf16_f32 v40, v208, v209
    v_cvt_pk_bf16_f32 v41, v210, v211
    v_cvt_pk_bf16_f32 v42, v212, v213
    v_cvt_pk_bf16_f32 v43, v214, v215
    v_cvt_pk_bf16_f32 v44, v216, v217
    v_cvt_pk_bf16_f32 v45, v218, v219
    v_cvt_pk_bf16_f32 v46, v220, v221
    v_cvt_pk_bf16_f32 v47, v222, v223
    global_store_dwordx4 v29, v[40:43], s[68:69] offset:2048 sc1
    global_store_dwordx4 v29, v[44:47], s[68:69] offset:2560 sc1
    v_cvt_pk_bf16_f32 v32, v224, v225
    v_cvt_pk_bf16_f32 v33, v226, v227
    v_cvt_pk_bf16_f32 v34, v228, v229
    v_cvt_pk_bf16_f32 v35, v230, v231
    v_cvt_pk_bf16_f32 v36, v232, v233
    v_cvt_pk_bf16_f32 v37, v234, v235
    v_cvt_pk_bf16_f32 v38, v236, v237
    v_cvt_pk_bf16_f32 v39, v238, v239
    global_store_dwordx4 v31, v[32:35], s[68:69] offset:0 sc1
    global_store_dwordx4 v31, v[36:39], s[68:69] offset:512 sc1
    v_cvt_pk_bf16_f32 v40, v240, v241
    v_cvt_pk_bf16_f32 v41, v242, v243
    v_cvt_pk_bf16_f32 v42, v244, v245
    v_cvt_pk_bf16_f32 v43, v246, v247
    v_cvt_pk_bf16_f32 v44, v248, v249
    v_cvt_pk_bf16_f32 v45, v250, v251
    v_cvt_pk_bf16_f32 v46, v252, v253
    v_cvt_pk_bf16_f32 v47, v254, v255
    global_store_dwordx4 v31, v[40:43], s[68:69] offset:2048 sc1
    global_store_dwordx4 v31, v[44:47], s[68:69] offset:2560 sc1
    v_mov_b32 v18, s97
    s_waitcnt vmcnt(0)
    s_mov_b64 exec, 0x1
    global_store_dword v19, v18, s[74:75] offset:272 sc1
    s_mov_b64 exec, -1
    s_add_u32 s3, s3, 6
    s_branch Lp3
Lp3a:
    s_sub_u32 s3, s96, 2
Lp3:
    s_load_dwordx4 s[40:43], s[0:1], 16
    s_load_dwordx2 s[44:45], s[0:1], 32
    s_lshl_b32 s46, s3, 18
    s_add_u32 s66, s4, 1048576
    s_addc_u32 s67, s5, 0
    s_add_u32 s66, s66, s46
    s_addc_u32 s67, s67, 0
    s_lshl_b32 s47, s8, 21
    s_add_u32 s47, s47, s46
    s_lshl_b32 s48, s9, 15
    s_add_u32 s47, s47, s48
    s_add_u32 s47, s47, 4194304
    s_add_u32 s68, s4, s47
    s_addc_u32 s69, s5, 0
    s_lshl_b32 s48, s8, 8
    s_waitcnt lgkmcnt(0)
    s_add_u32 s40, s40, s48
    s_addc_u32 s41, s41, 0
    s_add_u32 s42, s42, s48
    s_addc_u32 s43, s43, 0
    s_add_u32 s44, s44, s48
    s_addc_u32 s45, s45, 0
    s_barrier
    s_lshl_b32 s49, s8, 10
    s_lshl_b32 s50, s3, 5
    s_add_u32 s49, s49, s50
    s_lshl_b32 s50, s9, 2
    s_add_u32 s49, s49, s50
    s_add_u32 s49, s49, 127533056
    s_add_u32 s74, s4, s49
    s_addc_u32 s75, s5, 0
    s_lshl_b32 s49, s3, 10
    s_lshl_b32 s50, s9, 7
    s_add_u32 s49, s49, s50
    s_add_u32 s49, s49, 127598592
    v_and_b32 v2, 1, v0
    v_lshlrev_b32 v2, 9, v2
    v_add_u32 v2, s49, v2
    s_mov_b32 s60, 0
    s_mov_b64 exec, 0x3
    global_load_dword v19, v2, s[4:5] sc1
    s_waitcnt vmcnt(0)
    v_cmp_ne_u32 vcc, s97, v19
    s_cbranch_vccz Lwf_74
    global_load_dword v19, v2, s[4:5] sc1
    s_sleep 2
Lwf_73:
    global_load_dword v19, v2, s[4:5] sc1
    s_add_u32 s60, s60, 1
    s_cmp_gt_u32 s60, 1000000
    s_cbranch_scc1 Lfail
    s_waitcnt vmcnt(1)
    v_cmp_ne_u32 vcc, s97, v19
    s_cbranch_vccz Lwf_74
    s_sleep 1
    s_branch Lwf_73
Lwf_74:
    s_mov_b64 exec, -1
    s_add_u32 s71, s70, 0
    s_add_u32 m0, s71, 0
    v_add_u32 v2, 0, v12
    global_load_lds_dwordx4 v2, s[42:43]
    s_add_u32 m0, s71, 4096
    v_add_u32 v3, 131072, v12
    global_load_lds_dwordx4 v3, s[42:43]
    s_add_u32 m0, s71, 8192
    v_add_u32 v2, 262144, v12
    global_load_lds_dwordx4 v2, s[42:43]
    s_add_u32 m0, s71, 12288
    v_add_u32 v3, 393216, v12
    global_load_lds_dwordx4 v3, s[42:43]
    s_add_u32 m0, s71, 16384
    v_add_u32 v2, 524288, v12
    global_load_lds_dwordx4 v2, s[42:43]
    s_add_u32 m0, s71, 20480
    v_add_u32 v3, 655360, v12
    global_load_lds_dwordx4 v3, s[42:43]
    s_add_u32 m0, s71, 24576
    v_add_u32 v2, 786432, v12
    global_load_lds_dwordx4 v2, s[42:43]
    s_add_u32 m0, s71, 28672
    v_add_u32 v3, 917504, v12
    global_load_lds_dwordx4 v3, s[42:43]
    v_add_u32 v4, 0, v13
    v_add_u32 v5, 131072, v13
    global_load_dwordx4 a[0:3], v4, s[66:67] offset:0 sc1
    global_load_dwordx4 a[4:7], v5, s[66:67] offset:0 sc1
    global_load_dwordx4 a[8:11], v4, s[66:67] offset:1024 sc1
    global_load_dwordx4 a[12:15], v5, s[66:67] offset:1024 sc1
    global_load_dwordx4 a[16:19], v4, s[66:67] offset:2048 sc1
    global_load_dwordx4 a[20:23], v5, s[66:67] offset:2048 sc1
    global_load_dwordx4 a[24:27], v4, s[66:67] offset:3072 sc1
    global_load_dwordx4 a[28:31], v5, s[66:67] offset:3072 sc1
    v_add_u32 v4, 4096, v13
    v_add_u32 v5, 135168, v13
    global_load_dwordx4 a[32:35], v4, s[66:67] offset:0 sc1
    global_load_dwordx4 a[36:39], v5, s[66:67] offset:0 sc1
    global_load_dwordx4 a[40:43], v4, s[66:67] offset:1024 sc1
    global_load_dwordx4 a[44:47], v5, s[66:67] offset:1024 sc1
    global_load_dwordx4 a[48:51], v4, s[66:67] offset:2048 sc1
    global_load_dwordx4 a[52:55], v5, s[66:67] offset:2048 sc1
    global_load_dwordx4 a[56:59], v4, s[66:67] offset:3072 sc1
    global_load_dwordx4 a[60:63], v5, s[66:67] offset:3072 sc1
    s_add_u32 s71, s70, 32768
    s_add_u32 m0, s71, 0
    v_add_u32 v2, 1048576, v12
    global_load_lds_dwordx4 v2, s[42:43]
    s_add_u32 m0, s71, 4096
    v_add_u32 v3, 1179648, v12
    global_load_lds_dwordx4 v3, s[42:43]
    s_add_u32 m0, s71, 8192
    v_add_u32 v2, 1310720, v12
    global_load_lds_dwordx4 v2, s[42:43]
    s_add_u32 m0, s71, 12288
    v_add_u32 v3, 1441792, v12
    global_load_lds_dwordx4 v3, s[42:43]
    s_add_u32 m0, s71, 16384
    v_add_u32 v2, 1572864, v12
    global_load_lds_dwordx4 v2, s[42:43]
    s_add_u32 m0, s71, 20480
    v_add_u32 v3, 1703936, v12
    global_load_lds_dwordx4 v3, s[42:43]
    s_add_u32 m0, s71, 24576
    v_add_u32 v2, 1835008, v12
    global_load_lds_dwordx4 v2, s[42:43]
    s_add_u32 m0, s71, 28672
    v_add_u32 v3, 1966080, v12
    global_load_lds_dwordx4 v3, s[42:43]
    v_add_u32 v4, 8192, v13
    v_add_u32 v5, 139264, v13
    global_load_dwordx4 a[64:67], v4, s[66:67] offset:0 sc1
    global_load_dwordx4 a[68:71], v5, s[66:67] offset:0 sc1
    global_load_dwordx4 a[72:75], v4, s[66:67] offset:1024 sc1
    global_load_dwordx4 a[76:79], v5, s[66:67] offset:1024 sc1
    global_load_dwordx4 a[80:83], v4, s[66:67] offset:2048 sc1
    global_load_dwordx4 a[84:87], v5, s[66:67] offset:2048 sc1
    global_load_dwordx4 a[88:91], v4, s[66:67] offset:3072 sc1
    global_load_dwordx4 a[92:95], v5, s[66:67] offset:3072 sc1
    v_add_u32 v4, 12288, v13
    v_add_u32 v5, 143360, v13
    global_load_dwordx4 a[96:99], v4, s[66:67] offset:0 sc1
    global_load_dwordx4 a[100:103], v5, s[66:67] offset:0 sc1
    global_load_dwordx4 a[104:107], v4, s[66:67] offset:1024 sc1
    global_load_dwordx4 a[108:111], v5, s[66:67] offset:1024 sc1
    global_load_dwordx4 a[112:115], v4, s[66:67] offset:2048 sc1
    global_load_dwordx4 a[116:119], v5, s[66:67] offset:2048 sc1
    global_load_dwordx4 a[120:123], v4, s[66:67] offset:3072 sc1
    global_load_dwordx4 a[124:127], v5, s[66:67] offset:3072 sc1
    s_waitcnt vmcnt(24)
    s_add_u32 s71, s70, 65536
    s_add_u32 m0, s71, 0
    v_add_u32 v2, 2097152, v12
    global_load_lds_dwordx4 v2, s[42:43]
    s_add_u32 m0, s71, 4096
    v_add_u32 v3, 2228224, v12
    global_load_lds_dwordx4 v3, s[42:43]
    s_add_u32 m0, s71, 8192
    v_add_u32 v2, 2359296, v12
    global_load_lds_dwordx4 v2, s[42:43]
    s_add_u32 m0, s71, 12288
    v_add_u32 v3, 2490368, v12
    global_load_lds_dwordx4 v3, s[42:43]
    s_add_u32 m0, s71, 16384
    v_add_u32 v2, 2621440, v12
    global_load_lds_dwordx4 v2, s[42:43]
    s_add_u32 m0, s71, 20480
    v_add_u32 v3, 2752512, v12
    global_load_lds_dwordx4 v3, s[42:43]
    s_add_u32 m0, s71, 24576
    v_add_u32 v2, 2883584, v12
    global_load_lds_dwordx4 v2, s[42:43]
    s_add_u32 m0, s71, 28672
    v_add_u32 v3, 3014656, v12
    global_load_lds_dwordx4 v3, s[42:43]
    v_add_u32 v4, 16384, v13
    v_add_u32 v5, 147456, v13
    global_load_dwordx4 a[128:131], v4, s[66:67] offset:0 sc1
    global_load_dwordx4 a[132:135], v5, s[66:67] offset:0 sc1
    global_load_dwordx4 a[136:139], v4, s[66:67] offset:1024 sc1
    global_load_dwordx4 a[140:143], v5, s[66:67] offset:1024 sc1
    global_load_dwordx4 a[144:147], v4, s[66:67] offset:2048 sc1
    global_load_dwordx4 a[148:151], v5, s[66:67] offset:2048 sc1
    global_load_dwordx4 a[152:155], v4, s[66:67] offset:3072 sc1
    global_load_dwordx4 a[156:159], v5, s[66:67] offset:3072 sc1
    v_add_u32 v4, 20480, v13
    v_add_u32 v5, 151552, v13
    global_load_dwordx4 a[160:163], v4, s[66:67] offset:0 sc1
    global_load_dwordx4 a[164:167], v5, s[66:67] offset:0 sc1
    global_load_dwordx4 a[168:171], v4, s[66:67] offset:1024 sc1
    global_load_dwordx4 a[172:175], v5, s[66:67] offset:1024 sc1
    global_load_dwordx4 a[176:179], v4, s[66:67] offset:2048 sc1
    global_load_dwordx4 a[180:183], v5, s[66:67] offset:2048 sc1
    global_load_dwordx4 a[184:187], v4, s[66:67] offset:3072 sc1
    global_load_dwordx4 a[188:191], v5, s[66:67] offset:3072 sc1
    s_waitcnt vmcnt(24)
    s_add_u32 s71, s70, 98304
    s_add_u32 m0, s71, 0
    v_add_u32 v2, 3145728, v12
    global_load_lds_dwordx4 v2, s[42:43]
    s_add_u32 m0, s71, 4096
    v_add_u32 v3, 3276800, v12
    global_load_lds_dwordx4 v3, s[42:43]
    s_add_u32 m0, s71, 8192
    v_add_u32 v2, 3407872, v12
    global_load_lds_dwordx4 v2, s[42:43]
    s_add_u32 m0, s71, 12288
    v_add_u32 v3, 3538944, v12
    global_load_lds_dwordx4 v3, s[42:43]
    s_add_u32 m0, s71, 16384
    v_add_u32 v2, 3670016, v12
    global_load_lds_dwordx4 v2, s[42:43]
    s_add_u32 m0, s71, 20480
    v_add_u32 v3, 3801088, v12
    global_load_lds_dwordx4 v3, s[42:43]
    s_add_u32 m0, s71, 24576
    v_add_u32 v2, 3932160, v12
    global_load_lds_dwordx4 v2, s[42:43]
    s_add_u32 m0, s71, 28672
    v_add_u32 v3, 4063232, v12
    global_load_lds_dwordx4 v3, s[42:43]
    v_add_u32 v4, 24576, v13
    v_add_u32 v5, 155648, v13
    global_load_dwordx4 a[192:195], v4, s[66:67] offset:0 sc1
    global_load_dwordx4 a[196:199], v5, s[66:67] offset:0 sc1
    global_load_dwordx4 a[200:203], v4, s[66:67] offset:1024 sc1
    global_load_dwordx4 a[204:207], v5, s[66:67] offset:1024 sc1
    global_load_dwordx4 a[208:211], v4, s[66:67] offset:2048 sc1
    global_load_dwordx4 a[212:215], v5, s[66:67] offset:2048 sc1
    global_load_dwordx4 a[216:219], v4, s[66:67] offset:3072 sc1
    global_load_dwordx4 a[220:223], v5, s[66:67] offset:3072 sc1
    v_add_u32 v4, 28672, v13
    v_add_u32 v5, 159744, v13
    global_load_dwordx4 a[224:227], v4, s[66:67] offset:0 sc1
    global_load_dwordx4 a[228:231], v5, s[66:67] offset:0 sc1
    global_load_dwordx4 a[232:235], v4, s[66:67] offset:1024 sc1
    global_load_dwordx4 a[236:239], v5, s[66:67] offset:1024 sc1
    global_load_dwordx4 a[240:243], v4, s[66:67] offset:2048 sc1
    global_load_dwordx4 a[244:247], v5, s[66:67] offset:2048 sc1
    global_load_dwordx4 a[248:251], v4, s[66:67] offset:3072 sc1
    global_load_dwordx4 a[252:255], v5, s[66:67] offset:3072 sc1
    s_mov_b64 s[72:73], s[44:45]
    v_mov_b64 v[128:129], 0
    v_mov_b64 v[130:131], 0
    v_mov_b64 v[132:133], 0
    v_mov_b64 v[134:135], 0
    v_mov_b64 v[136:137], 0
    v_mov_b64 v[138:139], 0
    v_mov_b64 v[140:141], 0
    v_mov_b64 v[142:143], 0
    v_mov_b64 v[144:145], 0
    v_mov_b64 v[146:147], 0
    v_mov_b64 v[148:149], 0
    v_mov_b64 v[150:151], 0
    v_mov_b64 v[152:153], 0
    v_mov_b64 v[154:155], 0
    v_mov_b64 v[156:157], 0
    v_mov_b64 v[158:159], 0
    v_mov_b64 v[160:161], 0
    v_mov_b64 v[162:163], 0
    v_mov_b64 v[164:165], 0
    v_mov_b64 v[166:167], 0
    v_mov_b64 v[168:169], 0
    v_mov_b64 v[170:171], 0
    v_mov_b64 v[172:173], 0
    v_mov_b64 v[174:175], 0
    v_mov_b64 v[176:177], 0
    v_mov_b64 v[178:179], 0
    v_mov_b64 v[180:181], 0
    v_mov_b64 v[182:183], 0
    v_mov_b64 v[184:185], 0
    v_mov_b64 v[186:187], 0
    v_mov_b64 v[188:189], 0
    v_mov_b64 v[190:191], 0
    v_mov_b64 v[192:193], 0
    v_mov_b64 v[194:195], 0
    v_mov_b64 v[196:197], 0
    v_mov_b64 v[198:199], 0
    v_mov_b64 v[200:201], 0
    v_mov_b64 v[202:203], 0
    v_mov_b64 v[204:205], 0
    v_mov_b64 v[206:207], 0
    v_mov_b64 v[208:209], 0
    v_mov_b64 v[210:211], 0
    v_mov_b64 v[212:213], 0
    v_mov_b64 v[214:215], 0
    v_mov_b64 v[216:217], 0
    v_mov_b64 v[218:219], 0
    v_mov_b64 v[220:221], 0
    v_mov_b64 v[222:223], 0
    v_mov_b64 v[224:225], 0
    v_mov_b64 v[226:227], 0
    v_mov_b64 v[228:229], 0
    v_mov_b64 v[230:231], 0
    v_mov_b64 v[232:233], 0
    v_mov_b64 v[234:235], 0
    v_mov_b64 v[236:237], 0
    v_mov_b64 v[238:239], 0
    v_mov_b64 v[240:241], 0
    v_mov_b64 v[242:243], 0
    v_mov_b64 v[244:245], 0
    v_mov_b64 v[246:247], 0
    v_mov_b64 v[248:249], 0
    v_mov_b64 v[250:251], 0
    v_mov_b64 v[252:253], 0
    v_mov_b64 v[254:255], 0
    s_waitcnt vmcnt(48)
    s_barrier
    v_add_u32 v24, 0, v8
    v_add_u32 v25, 0, v9
    v_add_u32 v26, 0, v10
    v_add_u32 v27, 0, v11
    ds_read_b64_tr_b16 v[64:65], v24 offset:0
    ds_read_b64_tr_b16 v[66:67], v24 offset:1024
    ds_read_b64_tr_b16 v[68:69], v25 offset:0
    ds_read_b64_tr_b16 v[70:71], v25 offset:1024
    ds_read_b64_tr_b16 v[72:73], v26 offset:0
    ds_read_b64_tr_b16 v[74:75], v26 offset:1024
    ds_read_b64_tr_b16 v[76:77], v27 offset:0
    ds_read_b64_tr_b16 v[78:79], v27 offset:1024
    s_waitcnt lgkmcnt(0)
    v_mfma_f32_32x32x16_bf16 v[128:143], v[64:67], a[0:3], v[128:143]
    ds_read_b64_tr_b16 v[80:81], v24 offset:4096
    ds_read_b64_tr_b16 v[82:83], v24 offset:5120
    v_mfma_f32_32x32x16_bf16 v[144:159], v[68:71], a[0:3], v[144:159]
    ds_read_b64_tr_b16 v[84:85], v25 offset:4096
    ds_read_b64_tr_b16 v[86:87], v25 offset:5120
    v_mfma_f32_32x32x16_bf16 v[160:175], v[72:75], a[0:3], v[160:175]
    ds_read_b64_tr_b16 v[88:89], v26 offset:4096
    ds_read_b64_tr_b16 v[90:91], v26 offset:5120
    v_mfma_f32_32x32x16_bf16 v[176:191], v[76:79], a[0:3], v[176:191]
    ds_read_b64_tr_b16 v[92:93], v27 offset:4096
    ds_read_b64_tr_b16 v[94:95], v27 offset:5120
    v_mfma_f32_32x32x16_bf16 v[192:207], v[64:67], a[4:7], v[192:207]
    v_mfma_f32_32x32x16_bf16 v[208:223], v[68:71], a[4:7], v[208:223]
    s_add_u32 m0, s70, 131072
    v_add_u32 v2, 0, v12
    global_load_lds_dwordx4 v2, s[72:73]
    v_mfma_f32_32x32x16_bf16 v[224:239], v[72:75], a[4:7], v[224:239]
    v_mfma_f32_32x32x16_bf16 v[240:255], v[76:79], a[4:7], v[240:255]
    s_waitcnt lgkmcnt(0)
    v_mfma_f32_32x32x16_bf16 v[128:143], v[80:83], a[8:11], v[128:143]
    ds_read_b64_tr_b16 v[64:65], v24 offset:8192
    ds_read_b64_tr_b16 v[66:67], v24 offset:9216
    v_mfma_f32_32x32x16_bf16 v[144:159], v[84:87], a[8:11], v[144:159]
    ds_read_b64_tr_b16 v[68:69], v25 offset:8192
    ds_read_b64_tr_b16 v[70:71], v25 offset:9216
    v_mfma_f32_32x32x16_bf16 v[160:175], v[88:91], a[8:11], v[160:175]
    ds_read_b64_tr_b16 v[72:73], v26 offset:8192
    ds_read_b64_tr_b16 v[74:75], v26 offset:9216
    v_mfma_f32_32x32x16_bf16 v[176:191], v[92:95], a[8:11], v[176:191]
    ds_read_b64_tr_b16 v[76:77], v27 offset:8192
    ds_read_b64_tr_b16 v[78:79], v27 offset:9216
    v_mfma_f32_32x32x16_bf16 v[192:207], v[80:83], a[12:15], v[192:207]
    v_mfma_f32_32x32x16_bf16 v[208:223], v[84:87], a[12:15], v[208:223]
    s_add_u32 m0, s70, 135168
    v_add_u32 v3, 131072, v12
    global_load_lds_dwordx4 v3, s[72:73]
    v_mfma_f32_32x32x16_bf16 v[224:239], v[88:91], a[12:15], v[224:239]
    v_mfma_f32_32x32x16_bf16 v[240:255], v[92:95], a[12:15], v[240:255]
    s_waitcnt lgkmcnt(0)
    v_mfma_f32_32x32x16_bf16 v[128:143], v[64:67], a[16:19], v[128:143]
    ds_read_b64_tr_b16 v[80:81], v24 offset:12288
    ds_read_b64_tr_b16 v[82:83], v24 offset:13312
    v_mfma_f32_32x32x16_bf16 v[144:159], v[68:71], a[16:19], v[144:159]
    ds_read_b64_tr_b16 v[84:85], v25 offset:12288
    ds_read_b64_tr_b16 v[86:87], v25 offset:13312
    v_mfma_f32_32x32x16_bf16 v[160:175], v[72:75], a[16:19], v[160:175]
    ds_read_b64_tr_b16 v[88:89], v26 offset:12288
    ds_read_b64_tr_b16 v[90:91], v26 offset:13312
    v_mfma_f32_32x32x16_bf16 v[176:191], v[76:79], a[16:19], v[176:191]
    ds_read_b64_tr_b16 v[92:93], v27 offset:12288
    ds_read_b64_tr_b16 v[94:95], v27 offset:13312
    v_mfma_f32_32x32x16_bf16 v[192:207], v[64:67], a[20:23], v[192:207]
    v_mfma_f32_32x32x16_bf16 v[208:223], v[68:71], a[20:23], v[208:223]
    s_add_u32 m0, s70, 139264
    v_add_u32 v2, 262144, v12
    global_load_lds_dwordx4 v2, s[72:73]
    v_mfma_f32_32x32x16_bf16 v[224:239], v[72:75], a[20:23], v[224:239]
    v_mfma_f32_32x32x16_bf16 v[240:255], v[76:79], a[20:23], v[240:255]
    s_waitcnt lgkmcnt(0)
    v_mfma_f32_32x32x16_bf16 v[128:143], v[80:83], a[24:27], v[128:143]
    ds_read_b64_tr_b16 v[64:65], v24 offset:16384
    ds_read_b64_tr_b16 v[66:67], v24 offset:17408
    v_mfma_f32_32x32x16_bf16 v[144:159], v[84:87], a[24:27], v[144:159]
    ds_read_b64_tr_b16 v[68:69], v25 offset:16384
    ds_read_b64_tr_b16 v[70:71], v25 offset:17408
    v_mfma_f32_32x32x16_bf16 v[160:175], v[88:91], a[24:27], v[160:175]
    ds_read_b64_tr_b16 v[72:73], v26 offset:16384
    ds_read_b64_tr_b16 v[74:75], v26 offset:17408
    v_mfma_f32_32x32x16_bf16 v[176:191], v[92:95], a[24:27], v[176:191]
    ds_read_b64_tr_b16 v[76:77], v27 offset:16384
    ds_read_b64_tr_b16 v[78:79], v27 offset:17408
    v_mfma_f32_32x32x16_bf16 v[192:207], v[80:83], a[28:31], v[192:207]
    v_mfma_f32_32x32x16_bf16 v[208:223], v[84:87], a[28:31], v[208:223]
    s_add_u32 m0, s70, 143360
    v_add_u32 v3, 393216, v12
    global_load_lds_dwordx4 v3, s[72:73]
    v_mfma_f32_32x32x16_bf16 v[224:239], v[88:91], a[28:31], v[224:239]
    v_mfma_f32_32x32x16_bf16 v[240:255], v[92:95], a[28:31], v[240:255]
    s_waitcnt lgkmcnt(0)
    v_mfma_f32_32x32x16_bf16 v[128:143], v[64:67], a[32:35], v[128:143]
    ds_read_b64_tr_b16 v[80:81], v24 offset:20480
    ds_read_b64_tr_b16 v[82:83], v24 offset:21504
    v_mfma_f32_32x32x16_bf16 v[144:159], v[68:71], a[32:35], v[144:159]
    ds_read_b64_tr_b16 v[84:85], v25 offset:20480
    ds_read_b64_tr_b16 v[86:87], v25 offset:21504
    v_mfma_f32_32x32x16_bf16 v[160:175], v[72:75], a[32:35], v[160:175]
    ds_read_b64_tr_b16 v[88:89], v26 offset:20480
    ds_read_b64_tr_b16 v[90:91], v26 offset:21504
    v_mfma_f32_32x32x16_bf16 v[176:191], v[76:79], a[32:35], v[176:191]
    ds_read_b64_tr_b16 v[92:93], v27 offset:20480
    ds_read_b64_tr_b16 v[94:95], v27 offset:21504
    v_mfma_f32_32x32x16_bf16 v[192:207], v[64:67], a[36:39], v[192:207]
    v_mfma_f32_32x32x16_bf16 v[208:223], v[68:71], a[36:39], v[208:223]
    s_add_u32 m0, s70, 147456
    v_add_u32 v2, 524288, v12
    global_load_lds_dwordx4 v2, s[72:73]
    v_mfma_f32_32x32x16_bf16 v[224:239], v[72:75], a[36:39], v[224:239]
    v_mfma_f32_32x32x16_bf16 v[240:255], v[76:79], a[36:39], v[240:255]
    s_waitcnt lgkmcnt(0)
    v_mfma_f32_32x32x16_bf16 v[128:143], v[80:83], a[40:43], v[128:143]
    ds_read_b64_tr_b16 v[64:65], v24 offset:24576
    ds_read_b64_tr_b16 v[66:67], v24 offset:25600
    v_mfma_f32_32x32x16_bf16 v[144:159], v[84:87], a[40:43], v[144:159]
    ds_read_b64_tr_b16 v[68:69], v25 offset:24576
    ds_read_b64_tr_b16 v[70:71], v25 offset:25600
    v_mfma_f32_32x32x16_bf16 v[160:175], v[88:91], a[40:43], v[160:175]
    ds_read_b64_tr_b16 v[72:73], v26 offset:24576
    ds_read_b64_tr_b16 v[74:75], v26 offset:25600
    v_mfma_f32_32x32x16_bf16 v[176:191], v[92:95], a[40:43], v[176:191]
    ds_read_b64_tr_b16 v[76:77], v27 offset:24576
    ds_read_b64_tr_b16 v[78:79], v27 offset:25600
    v_mfma_f32_32x32x16_bf16 v[192:207], v[80:83], a[44:47], v[192:207]
    v_mfma_f32_32x32x16_bf16 v[208:223], v[84:87], a[44:47], v[208:223]
    s_add_u32 m0, s70, 151552
    v_add_u32 v3, 655360, v12
    global_load_lds_dwordx4 v3, s[72:73]
    v_mfma_f32_32x32x16_bf16 v[224:239], v[88:91], a[44:47], v[224:239]
    v_mfma_f32_32x32x16_bf16 v[240:255], v[92:95], a[44:47], v[240:255]
    s_waitcnt lgkmcnt(0)
    v_mfma_f32_32x32x16_bf16 v[128:143], v[64:67], a[48:51], v[128:143]
    ds_read_b64_tr_b16 v[80:81], v24 offset:28672
    ds_read_b64_tr_b16 v[82:83], v24 offset:29696
    v_mfma_f32_32x32x16_bf16 v[144:159], v[68:71], a[48:51], v[144:159]
    ds_read_b64_tr_b16 v[84:85], v25 offset:28672
    ds_read_b64_tr_b16 v[86:87], v25 offset:29696
    v_mfma_f32_32x32x16_bf16 v[160:175], v[72:75], a[48:51], v[160:175]
    ds_read_b64_tr_b16 v[88:89], v26 offset:28672
    ds_read_b64_tr_b16 v[90:91], v26 offset:29696
    v_mfma_f32_32x32x16_bf16 v[176:191], v[76:79], a[48:51], v[176:191]
    ds_read_b64_tr_b16 v[92:93], v27 offset:28672
    ds_read_b64_tr_b16 v[94:95], v27 offset:29696
    v_mfma_f32_32x32x16_bf16 v[192:207], v[64:67], a[52:55], v[192:207]
    v_mfma_f32_32x32x16_bf16 v[208:223], v[68:71], a[52:55], v[208:223]
    s_add_u32 m0, s70, 155648
    v_add_u32 v2, 786432, v12
    global_load_lds_dwordx4 v2, s[72:73]
    v_mfma_f32_32x32x16_bf16 v[224:239], v[72:75], a[52:55], v[224:239]
    v_mfma_f32_32x32x16_bf16 v[240:255], v[76:79], a[52:55], v[240:255]
    s_waitcnt lgkmcnt(0)
    v_mfma_f32_32x32x16_bf16 v[128:143], v[80:83], a[56:59], v[128:143]
    v_mfma_f32_32x32x16_bf16 v[144:159], v[84:87], a[56:59], v[144:159]
    v_mfma_f32_32x32x16_bf16 v[160:175], v[88:91], a[56:59], v[160:175]
    v_mfma_f32_32x32x16_bf16 v[176:191], v[92:95], a[56:59], v[176:191]
    v_mfma_f32_32x32x16_bf16 v[192:207], v[80:83], a[60:63], v[192:207]
    v_mfma_f32_32x32x16_bf16 v[208:223], v[84:87], a[60:63], v[208:223]
    s_add_u32 m0, s70, 159744
    v_add_u32 v3, 917504, v12
    global_load_lds_dwordx4 v3, s[72:73]
    v_mfma_f32_32x32x16_bf16 v[224:239], v[88:91], a[60:63], v[224:239]
    v_mfma_f32_32x32x16_bf16 v[240:255], v[92:95], a[60:63], v[240:255]
    s_waitcnt vmcnt(56)
    s_barrier
    v_add_u32 v24, 32768, v8
    v_add_u32 v25, 32768, v9
    v_add_u32 v26, 32768, v10
    v_add_u32 v27, 32768, v11
    ds_read_b64_tr_b16 v[64:65], v24 offset:0
    ds_read_b64_tr_b16 v[66:67], v24 offset:1024
    ds_read_b64_tr_b16 v[68:69], v25 offset:0
    ds_read_b64_tr_b16 v[70:71], v25 offset:1024
    ds_read_b64_tr_b16 v[72:73], v26 offset:0
    ds_read_b64_tr_b16 v[74:75], v26 offset:1024
    ds_read_b64_tr_b16 v[76:77], v27 offset:0
    ds_read_b64_tr_b16 v[78:79], v27 offset:1024
    s_waitcnt lgkmcnt(0)
    v_mfma_f32_32x32x16_bf16 v[128:143], v[64:67], a[64:67], v[128:143]
    ds_read_b64_tr_b16 v[80:81], v24 offset:4096
    ds_read_b64_tr_b16 v[82:83], v24 offset:5120
    v_mfma_f32_32x32x16_bf16 v[144:159], v[68:71], a[64:67], v[144:159]
    ds_read_b64_tr_b16 v[84:85], v25 offset:4096
    ds_read_b64_tr_b16 v[86:87], v25 offset:5120
    v_mfma_f32_32x32x16_bf16 v[160:175], v[72:75], a[64:67], v[160:175]
    ds_read_b64_tr_b16 v[88:89], v26 offset:4096
    ds_read_b64_tr_b16 v[90:91], v26 offset:5120
    v_mfma_f32_32x32x16_bf16 v[176:191], v[76:79], a[64:67], v[176:191]
    ds_read_b64_tr_b16 v[92:93], v27 offset:4096
    ds_read_b64_tr_b16 v[94:95], v27 offset:5120
    v_mfma_f32_32x32x16_bf16 v[192:207], v[64:67], a[68:71], v[192:207]
    v_mfma_f32_32x32x16_bf16 v[208:223], v[68:71], a[68:71], v[208:223]
    s_add_u32 m0, s70, 0
    v_add_u32 v2, 1048576, v12
    global_load_lds_dwordx4 v2, s[72:73]
    v_mfma_f32_32x32x16_bf16 v[224:239], v[72:75], a[68:71], v[224:239]
    v_mfma_f32_32x32x16_bf16 v[240:255], v[76:79], a[68:71], v[240:255]
    s_waitcnt lgkmcnt(0)
    v_mfma_f32_32x32x16_bf16 v[128:143], v[80:83], a[72:75], v[128:143]
    ds_read_b64_tr_b16 v[64:65], v24 offset:8192
    ds_read_b64_tr_b16 v[66:67], v24 offset:9216
    v_mfma_f32_32x32x16_bf16 v[144:159], v[84:87], a[72:75], v[144:159]
    ds_read_b64_tr_b16 v[68:69], v25 offset:8192
    ds_read_b64_tr_b16 v[70:71], v25 offset:9216
    v_mfma_f32_32x32x16_bf16 v[160:175], v[88:91], a[72:75], v[160:175]
    ds_read_b64_tr_b16 v[72:73], v26 offset:8192
    ds_read_b64_tr_b16 v[74:75], v26 offset:9216
    v_mfma_f32_32x32x16_bf16 v[176:191], v[92:95], a[72:75], v[176:191]
    ds_read_b64_tr_b16 v[76:77], v27 offset:8192
    ds_read_b64_tr_b16 v[78:79], v27 offset:9216
    v_mfma_f32_32x32x16_bf16 v[192:207], v[80:83], a[76:79], v[192:207]
    v_mfma_f32_32x32x16_bf16 v[208:223], v[84:87], a[76:79], v[208:223]
    s_add_u32 m0, s70, 4096
    v_add_u32 v3, 1179648, v12
    global_load_lds_dwordx4 v3, s[72:73]
    v_mfma_f32_32x32x16_bf16 v[224:239], v[88:91], a[76:79], v[224:239]
    v_mfma_f32_32x32x16_bf16 v[240:255], v[92:95], a[76:79], v[240:255]
    s_waitcnt lgkmcnt(0)
    v_mfma_f32_32x32x16_bf16 v[128:143], v[64:67], a[80:83], v[128:143]
    ds_read_b64_tr_b16 v[80:81], v24 offset:12288
    ds_read_b64_tr_b16 v[82:83], v24 offset:13312
    v_mfma_f32_32x32x16_bf16 v[144:159], v[68:71], a[80:83], v[144:159]
    ds_read_b64_tr_b16 v[84:85], v25 offset:12288
    ds_read_b64_tr_b16 v[86:87], v25 offset:13312
    v_mfma_f32_32x32x16_bf16 v[160:175], v[72:75], a[80:83], v[160:175]
    ds_read_b64_tr_b16 v[88:89], v26 offset:12288
    ds_read_b64_tr_b16 v[90:91], v26 offset:13312
    v_mfma_f32_32x32x16_bf16 v[176:191], v[76:79], a[80:83], v[176:191]
    ds_read_b64_tr_b16 v[92:93], v27 offset:12288
    ds_read_b64_tr_b16 v[94:95], v27 offset:13312
    v_mfma_f32_32x32x16_bf16 v[192:207], v[64:67], a[84:87], v[192:207]
    v_mfma_f32_32x32x16_bf16 v[208:223], v[68:71], a[84:87], v[208:223]
    s_add_u32 m0, s70, 8192
    v_add_u32 v2, 1310720, v12
    global_load_lds_dwordx4 v2, s[72:73]
    v_mfma_f32_32x32x16_bf16 v[224:239], v[72:75], a[84:87], v[224:239]
    v_mfma_f32_32x32x16_bf16 v[240:255], v[76:79], a[84:87], v[240:255]
    s_waitcnt lgkmcnt(0)
    v_mfma_f32_32x32x16_bf16 v[128:143], v[80:83], a[88:91], v[128:143]
    ds_read_b64_tr_b16 v[64:65], v24 offset:16384
    ds_read_b64_tr_b16 v[66:67], v24 offset:17408
    v_mfma_f32_32x32x16_bf16 v[144:159], v[84:87], a[88:91], v[144:159]
    ds_read_b64_tr_b16 v[68:69], v25 offset:16384
    ds_read_b64_tr_b16 v[70:71], v25 offset:17408
    v_mfma_f32_32x32x16_bf16 v[160:175], v[88:91], a[88:91], v[160:175]
    ds_read_b64_tr_b16 v[72:73], v26 offset:16384
    ds_read_b64_tr_b16 v[74:75], v26 offset:17408
    v_mfma_f32_32x32x16_bf16 v[176:191], v[92:95], a[88:91], v[176:191]
    ds_read_b64_tr_b16 v[76:77], v27 offset:16384
    ds_read_b64_tr_b16 v[78:79], v27 offset:17408
    v_mfma_f32_32x32x16_bf16 v[192:207], v[80:83], a[92:95], v[192:207]
    v_mfma_f32_32x32x16_bf16 v[208:223], v[84:87], a[92:95], v[208:223]
    s_add_u32 m0, s70, 12288
    v_add_u32 v3, 1441792, v12
    global_load_lds_dwordx4 v3, s[72:73]
    v_mfma_f32_32x32x16_bf16 v[224:239], v[88:91], a[92:95], v[224:239]
    v_mfma_f32_32x32x16_bf16 v[240:255], v[92:95], a[92:95], v[240:255]
    s_waitcnt lgkmcnt(0)
    v_mfma_f32_32x32x16_bf16 v[128:143], v[64:67], a[96:99], v[128:143]
    ds_read_b64_tr_b16 v[80:81], v24 offset:20480
    ds_read_b64_tr_b16 v[82:83], v24 offset:21504
    v_mfma_f32_32x32x16_bf16 v[144:159], v[68:71], a[96:99], v[144:159]
    ds_read_b64_tr_b16 v[84:85], v25 offset:20480
    ds_read_b64_tr_b16 v[86:87], v25 offset:21504
    v_mfma_f32_32x32x16_bf16 v[160:175], v[72:75], a[96:99], v[160:175]
    ds_read_b64_tr_b16 v[88:89], v26 offset:20480
    ds_read_b64_tr_b16 v[90:91], v26 offset:21504
    v_mfma_f32_32x32x16_bf16 v[176:191], v[76:79], a[96:99], v[176:191]
    ds_read_b64_tr_b16 v[92:93], v27 offset:20480
    ds_read_b64_tr_b16 v[94:95], v27 offset:21504
    v_mfma_f32_32x32x16_bf16 v[192:207], v[64:67], a[100:103], v[192:207]
    v_mfma_f32_32x32x16_bf16 v[208:223], v[68:71], a[100:103], v[208:223]
    s_add_u32 m0, s70, 16384
    v_add_u32 v2, 1572864, v12
    global_load_lds_dwordx4 v2, s[72:73]
    v_mfma_f32_32x32x16_bf16 v[224:239], v[72:75], a[100:103], v[224:239]
    v_mfma_f32_32x32x16_bf16 v[240:255], v[76:79], a[100:103], v[240:255]
    s_waitcnt lgkmcnt(0)
    v_mfma_f32_32x32x16_bf16 v[128:143], v[80:83], a[104:107], v[128:143]
    ds_read_b64_tr_b16 v[64:65], v24 offset:24576
    ds_read_b64_tr_b16 v[66:67], v24 offset:25600
    v_mfma_f32_32x32x16_bf16 v[144:159], v[84:87], a[104:107], v[144:159]
    ds_read_b64_tr_b16 v[68:69], v25 offset:24576
    ds_read_b64_tr_b16 v[70:71], v25 offset:25600
    v_mfma_f32_32x32x16_bf16 v[160:175], v[88:91], a[104:107], v[160:175]
    ds_read_b64_tr_b16 v[72:73], v26 offset:24576
    ds_read_b64_tr_b16 v[74:75], v26 offset:25600
    v_mfma_f32_32x32x16_bf16 v[176:191], v[92:95], a[104:107], v[176:191]
    ds_read_b64_tr_b16 v[76:77], v27 offset:24576
    ds_read_b64_tr_b16 v[78:79], v27 offset:25600
    v_mfma_f32_32x32x16_bf16 v[192:207], v[80:83], a[108:111], v[192:207]
    v_mfma_f32_32x32x16_bf16 v[208:223], v[84:87], a[108:111], v[208:223]
    s_add_u32 m0, s70, 20480
    v_add_u32 v3, 1703936, v12
    global_load_lds_dwordx4 v3, s[72:73]
    v_mfma_f32_32x32x16_bf16 v[224:239], v[88:91], a[108:111], v[224:239]
    v_mfma_f32_32x32x16_bf16 v[240:255], v[92:95], a[108:111], v[240:255]
    s_waitcnt lgkmcnt(0)
    v_mfma_f32_32x32x16_bf16 v[128:143], v[64:67], a[112:115], v[128:143]
    ds_read_b64_tr_b16 v[80:81], v24 offset:28672
    ds_read_b64_tr_b16 v[82:83], v24 offset:29696
    v_mfma_f32_32x32x16_bf16 v[144:159], v[68:71], a[112:115], v[144:159]
    ds_read_b64_tr_b16 v[84:85], v25 offset:28672
    ds_read_b64_tr_b16 v[86:87], v25 offset:29696
    v_mfma_f32_32x32x16_bf16 v[160:175], v[72:75], a[112:115], v[160:175]
    ds_read_b64_tr_b16 v[88:89], v26 offset:28672
    ds_read_b64_tr_b16 v[90:91], v26 offset:29696
    v_mfma_f32_32x32x16_bf16 v[176:191], v[76:79], a[112:115], v[176:191]
    ds_read_b64_tr_b16 v[92:93], v27 offset:28672
    ds_read_b64_tr_b16 v[94:95], v27 offset:29696
    v_mfma_f32_32x32x16_bf16 v[192:207], v[64:67], a[116:119], v[192:207]
    v_mfma_f32_32x32x16_bf16 v[208:223], v[68:71], a[116:119], v[208:223]
    s_add_u32 m0, s70, 24576
    v_add_u32 v2, 1835008, v12
    global_load_lds_dwordx4 v2, s[72:73]
    v_mfma_f32_32x32x16_bf16 v[224:239], v[72:75], a[116:119], v[224:239]
    v_mfma_f32_32x32x16_bf16 v[240:255], v[76:79], a[116:119], v[240:255]
    s_waitcnt lgkmcnt(0)
    v_mfma_f32_32x32x16_bf16 v[128:143], v[80:83], a[120:123], v[128:143]
    v_mfma_f32_32x32x16_bf16 v[144:159], v[84:87], a[120:123], v[144:159]
    v_mfma_f32_32x32x16_bf16 v[160:175], v[88:91], a[120:123], v[160:175]
    v_mfma_f32_32x32x16_bf16 v[176:191], v[92:95], a[120:123], v[176:191]
    v_mfma_f32_32x32x16_bf16 v[192:207], v[80:83], a[124:127], v[192:207]
    v_mfma_f32_32x32x16_bf16 v[208:223], v[84:87], a[124:127], v[208:223]
    s_add_u32 m0, s70, 28672
    v_add_u32 v3, 1966080, v12
    global_load_lds_dwordx4 v3, s[72:73]
    v_mfma_f32_32x32x16_bf16 v[224:239], v[88:91], a[124:127], v[224:239]
    v_mfma_f32_32x32x16_bf16 v[240:255], v[92:95], a[124:127], v[240:255]
    s_waitcnt vmcnt(40)
    s_barrier
    v_add_u32 v24, 65536, v8
    v_add_u32 v25, 65536, v9
    v_add_u32 v26, 65536, v10
    v_add_u32 v27, 65536, v11
    ds_read_b64_tr_b16 v[64:65], v24 offset:0
    ds_read_b64_tr_b16 v[66:67], v24 offset:1024
    ds_read_b64_tr_b16 v[68:69], v25 offset:0
    ds_read_b64_tr_b16 v[70:71], v25 offset:1024
    ds_read_b64_tr_b16 v[72:73], v26 offset:0
    ds_read_b64_tr_b16 v[74:75], v26 offset:1024
    ds_read_b64_tr_b16 v[76:77], v27 offset:0
    ds_read_b64_tr_b16 v[78:79], v27 offset:1024
    s_waitcnt lgkmcnt(0)
    v_mfma_f32_32x32x16_bf16 v[128:143], v[64:67], a[128:131], v[128:143]
    ds_read_b64_tr_b16 v[80:81], v24 offset:4096
    ds_read_b64_tr_b16 v[82:83], v24 offset:5120
    v_mfma_f32_32x32x16_bf16 v[144:159], v[68:71], a[128:131], v[144:159]
    ds_read_b64_tr_b16 v[84:85], v25 offset:4096
    ds_read_b64_tr_b16 v[86:87], v25 offset:5120
    v_mfma_f32_32x32x16_bf16 v[160:175], v[72:75], a[128:131], v[160:175]
    ds_read_b64_tr_b16 v[88:89], v26 offset:4096
    ds_read_b64_tr_b16 v[90:91], v26 offset:5120
    v_mfma_f32_32x32x16_bf16 v[176:191], v[76:79], a[128:131], v[176:191]
    ds_read_b64_tr_b16 v[92:93], v27 offset:4096
    ds_read_b64_tr_b16 v[94:95], v27 offset:5120
    v_mfma_f32_32x32x16_bf16 v[192:207], v[64:67], a[132:135], v[192:207]
    v_mfma_f32_32x32x16_bf16 v[208:223], v[68:71], a[132:135], v[208:223]
    s_add_u32 m0, s70, 32768
    v_add_u32 v2, 2097152, v12
    global_load_lds_dwordx4 v2, s[72:73]
    v_mfma_f32_32x32x16_bf16 v[224:239], v[72:75], a[132:135], v[224:239]
    v_mfma_f32_32x32x16_bf16 v[240:255], v[76:79], a[132:135], v[240:255]
    s_waitcnt lgkmcnt(0)
    v_mfma_f32_32x32x16_bf16 v[128:143], v[80:83], a[136:139], v[128:143]
    ds_read_b64_tr_b16 v[64:65], v24 offset:8192
    ds_read_b64_tr_b16 v[66:67], v24 offset:9216
    v_mfma_f32_32x32x16_bf16 v[144:159], v[84:87], a[136:139], v[144:159]
    ds_read_b64_tr_b16 v[68:69], v25 offset:8192
    ds_read_b64_tr_b16 v[70:71], v25 offset:9216
    v_mfma_f32_32x32x16_bf16 v[160:175], v[88:91], a[136:139], v[160:175]
    ds_read_b64_tr_b16 v[72:73], v26 offset:8192
    ds_read_b64_tr_b16 v[74:75], v26 offset:9216
    v_mfma_f32_32x32x16_bf16 v[176:191], v[92:95], a[136:139], v[176:191]
    ds_read_b64_tr_b16 v[76:77], v27 offset:8192
    ds_read_b64_tr_b16 v[78:79], v27 offset:9216
    v_mfma_f32_32x32x16_bf16 v[192:207], v[80:83], a[140:143], v[192:207]
    v_mfma_f32_32x32x16_bf16 v[208:223], v[84:87], a[140:143], v[208:223]
    s_add_u32 m0, s70, 36864
    v_add_u32 v3, 2228224, v12
    global_load_lds_dwordx4 v3, s[72:73]
    v_mfma_f32_32x32x16_bf16 v[224:239], v[88:91], a[140:143], v[224:239]
    v_mfma_f32_32x32x16_bf16 v[240:255], v[92:95], a[140:143], v[240:255]
    s_waitcnt lgkmcnt(0)
    v_mfma_f32_32x32x16_bf16 v[128:143], v[64:67], a[144:147], v[128:143]
    ds_read_b64_tr_b16 v[80:81], v24 offset:12288
    ds_read_b64_tr_b16 v[82:83], v24 offset:13312
    v_mfma_f32_32x32x16_bf16 v[144:159], v[68:71], a[144:147], v[144:159]
    ds_read_b64_tr_b16 v[84:85], v25 offset:12288
    ds_read_b64_tr_b16 v[86:87], v25 offset:13312
    v_mfma_f32_32x32x16_bf16 v[160:175], v[72:75], a[144:147], v[160:175]
    ds_read_b64_tr_b16 v[88:89], v26 offset:12288
    ds_read_b64_tr_b16 v[90:91], v26 offset:13312
    v_mfma_f32_32x32x16_bf16 v[176:191], v[76:79], a[144:147], v[176:191]
    ds_read_b64_tr_b16 v[92:93], v27 offset:12288
    ds_read_b64_tr_b16 v[94:95], v27 offset:13312
    v_mfma_f32_32x32x16_bf16 v[192:207], v[64:67], a[148:151], v[192:207]
    v_mfma_f32_32x32x16_bf16 v[208:223], v[68:71], a[148:151], v[208:223]
    s_add_u32 m0, s70, 40960
    v_add_u32 v2, 2359296, v12
    global_load_lds_dwordx4 v2, s[72:73]
    v_mfma_f32_32x32x16_bf16 v[224:239], v[72:75], a[148:151], v[224:239]
    v_mfma_f32_32x32x16_bf16 v[240:255], v[76:79], a[148:151], v[240:255]
    s_waitcnt lgkmcnt(0)
    v_mfma_f32_32x32x16_bf16 v[128:143], v[80:83], a[152:155], v[128:143]
    ds_read_b64_tr_b16 v[64:65], v24 offset:16384
    ds_read_b64_tr_b16 v[66:67], v24 offset:17408
    v_mfma_f32_32x32x16_bf16 v[144:159], v[84:87], a[152:155], v[144:159]
    ds_read_b64_tr_b16 v[68:69], v25 offset:16384
    ds_read_b64_tr_b16 v[70:71], v25 offset:17408
    v_mfma_f32_32x32x16_bf16 v[160:175], v[88:91], a[152:155], v[160:175]
    ds_read_b64_tr_b16 v[72:73], v26 offset:16384
    ds_read_b64_tr_b16 v[74:75], v26 offset:17408
    v_mfma_f32_32x32x16_bf16 v[176:191], v[92:95], a[152:155], v[176:191]
    ds_read_b64_tr_b16 v[76:77], v27 offset:16384
    ds_read_b64_tr_b16 v[78:79], v27 offset:17408
    v_mfma_f32_32x32x16_bf16 v[192:207], v[80:83], a[156:159], v[192:207]
    v_mfma_f32_32x32x16_bf16 v[208:223], v[84:87], a[156:159], v[208:223]
    s_add_u32 m0, s70, 45056
    v_add_u32 v3, 2490368, v12
    global_load_lds_dwordx4 v3, s[72:73]
    v_mfma_f32_32x32x16_bf16 v[224:239], v[88:91], a[156:159], v[224:239]
    v_mfma_f32_32x32x16_bf16 v[240:255], v[92:95], a[156:159], v[240:255]
    s_waitcnt lgkmcnt(0)
    v_mfma_f32_32x32x16_bf16 v[128:143], v[64:67], a[160:163], v[128:143]
    ds_read_b64_tr_b16 v[80:81], v24 offset:20480
    ds_read_b64_tr_b16 v[82:83], v24 offset:21504
    v_mfma_f32_32x32x16_bf16 v[144:159], v[68:71], a[160:163], v[144:159]
    ds_read_b64_tr_b16 v[84:85], v25 offset:20480
    ds_read_b64_tr_b16 v[86:87], v25 offset:21504
    v_mfma_f32_32x32x16_bf16 v[160:175], v[72:75], a[160:163], v[160:175]
    ds_read_b64_tr_b16 v[88:89], v26 offset:20480
    ds_read_b64_tr_b16 v[90:91], v26 offset:21504
    v_mfma_f32_32x32x16_bf16 v[176:191], v[76:79], a[160:163], v[176:191]
    ds_read_b64_tr_b16 v[92:93], v27 offset:20480
    ds_read_b64_tr_b16 v[94:95], v27 offset:21504
    v_mfma_f32_32x32x16_bf16 v[192:207], v[64:67], a[164:167], v[192:207]
    v_mfma_f32_32x32x16_bf16 v[208:223], v[68:71], a[164:167], v[208:223]
    s_add_u32 m0, s70, 49152
    v_add_u32 v2, 2621440, v12
    global_load_lds_dwordx4 v2, s[72:73]
    v_mfma_f32_32x32x16_bf16 v[224:239], v[72:75], a[164:167], v[224:239]
    v_mfma_f32_32x32x16_bf16 v[240:255], v[76:79], a[164:167], v[240:255]
    s_waitcnt lgkmcnt(0)
    v_mfma_f32_32x32x16_bf16 v[128:143], v[80:83], a[168:171], v[128:143]
    ds_read_b64_tr_b16 v[64:65], v24 offset:24576
    ds_read_b64_tr_b16 v[66:67], v24 offset:25600
    v_mfma_f32_32x32x16_bf16 v[144:159], v[84:87], a[168:171], v[144:159]
    ds_read_b64_tr_b16 v[68:69], v25 offset:24576
    ds_read_b64_tr_b16 v[70:71], v25 offset:25600
    v_mfma_f32_32x32x16_bf16 v[160:175], v[88:91], a[168:171], v[160:175]
    ds_read_b64_tr_b16 v[72:73], v26 offset:24576
    ds_read_b64_tr_b16 v[74:75], v26 offset:25600
    v_mfma_f32_32x32x16_bf16 v[176:191], v[92:95], a[168:171], v[176:191]
    ds_read_b64_tr_b16 v[76:77], v27 offset:24576
    ds_read_b64_tr_b16 v[78:79], v27 offset:25600
    v_mfma_f32_32x32x16_bf16 v[192:207], v[80:83], a[172:175], v[192:207]
    v_mfma_f32_32x32x16_bf16 v[208:223], v[84:87], a[172:175], v[208:223]
    s_add_u32 m0, s70, 53248
    v_add_u32 v3, 2752512, v12
    global_load_lds_dwordx4 v3, s[72:73]
    v_mfma_f32_32x32x16_bf16 v[224:239], v[88:91], a[172:175], v[224:239]
    v_mfma_f32_32x32x16_bf16 v[240:255], v[92:95], a[172:175], v[240:255]
    s_waitcnt lgkmcnt(0)
    v_mfma_f32_32x32x16_bf16 v[128:143], v[64:67], a[176:179], v[128:143]
    ds_read_b64_tr_b16 v[80:81], v24 offset:28672
    ds_read_b64_tr_b16 v[82:83], v24 offset:29696
    v_mfma_f32_32x32x16_bf16 v[144:159], v[68:71], a[176:179], v[144:159]
    ds_read_b64_tr_b16 v[84:85], v25 offset:28672
    ds_read_b64_tr_b16 v[86:87], v25 offset:29696
    v_mfma_f32_32x32x16_bf16 v[160:175], v[72:75], a[176:179], v[160:175]
    ds_read_b64_tr_b16 v[88:89], v26 offset:28672
    ds_read_b64_tr_b16 v[90:91], v26 offset:29696
    v_mfma_f32_32x32x16_bf16 v[176:191], v[76:79], a[176:179], v[176:191]
    ds_read_b64_tr_b16 v[92:93], v27 offset:28672
    ds_read_b64_tr_b16 v[94:95], v27 offset:29696
    v_mfma_f32_32x32x16_bf16 v[192:207], v[64:67], a[180:183], v[192:207]
    v_mfma_f32_32x32x16_bf16 v[208:223], v[68:71], a[180:183], v[208:223]
    s_add_u32 m0, s70, 57344
    v_add_u32 v2, 2883584, v12
    global_load_lds_dwordx4 v2, s[72:73]
    v_mfma_f32_32x32x16_bf16 v[224:239], v[72:75], a[180:183], v[224:239]
    v_mfma_f32_32x32x16_bf16 v[240:255], v[76:79], a[180:183], v[240:255]
    s_waitcnt lgkmcnt(0)
    v_mfma_f32_32x32x16_bf16 v[128:143], v[80:83], a[184:187], v[128:143]
    v_mfma_f32_32x32x16_bf16 v[144:159], v[84:87], a[184:187], v[144:159]
    v_mfma_f32_32x32x16_bf16 v[160:175], v[88:91], a[184:187], v[160:175]
    v_mfma_f32_32x32x16_bf16 v[176:191], v[92:95], a[184:187], v[176:191]
    v_mfma_f32_32x32x16_bf16 v[192:207], v[80:83], a[188:191], v[192:207]
    v_mfma_f32_32x32x16_bf16 v[208:223], v[84:87], a[188:191], v[208:223]
    s_add_u32 m0, s70, 61440
    v_add_u32 v3, 3014656, v12
    global_load_lds_dwordx4 v3, s[72:73]
    v_mfma_f32_32x32x16_bf16 v[224:239], v[88:91], a[188:191], v[224:239]
    v_mfma_f32_32x32x16_bf16 v[240:255], v[92:95], a[188:191], v[240:255]
    s_waitcnt vmcnt(24)
    s_barrier
    v_add_u32 v24, 98304, v8
    v_add_u32 v25, 98304, v9
    v_add_u32 v26, 98304, v10
    v_add_u32 v27, 98304, v11
    ds_read_b64_tr_b16 v[64:65], v24 offset:0
    ds_read_b64_tr_b16 v[66:67], v24 offset:1024
    ds_read_b64_tr_b16 v[68:69], v25 offset:0
    ds_read_b64_tr_b16 v[70:71], v25 offset:1024
    ds_read_b64_tr_b16 v[72:73], v26 offset:0
    ds_read_b64_tr_b16 v[74:75], v26 offset:1024
    ds_read_b64_tr_b16 v[76:77], v27 offset:0
    ds_read_b64_tr_b16 v[78:79], v27 offset:1024
    s_waitcnt lgkmcnt(0)
    v_mfma_f32_32x32x16_bf16 v[128:143], v[64:67], a[192:195], v[128:143]
    ds_read_b64_tr_b16 v[80:81], v24 offset:4096
    ds_read_b64_tr_b16 v[82:83], v24 offset:5120
    v_mfma_f32_32x32x16_bf16 v[144:159], v[68:71], a[192:195], v[144:159]
    ds_read_b64_tr_b16 v[84:85], v25 offset:4096
    ds_read_b64_tr_b16 v[86:87], v25 offset:5120
    v_mfma_f32_32x32x16_bf16 v[160:175], v[72:75], a[192:195], v[160:175]
    ds_read_b64_tr_b16 v[88:89], v26 offset:4096
    ds_read_b64_tr_b16 v[90:91], v26 offset:5120
    v_mfma_f32_32x32x16_bf16 v[176:191], v[76:79], a[192:195], v[176:191]
    ds_read_b64_tr_b16 v[92:93], v27 offset:4096
    ds_read_b64_tr_b16 v[94:95], v27 offset:5120
    v_mfma_f32_32x32x16_bf16 v[192:207], v[64:67], a[196:199], v[192:207]
    v_mfma_f32_32x32x16_bf16 v[208:223], v[68:71], a[196:199], v[208:223]
    s_add_u32 m0, s70, 65536
    v_add_u32 v2, 3145728, v12
    global_load_lds_dwordx4 v2, s[72:73]
    v_mfma_f32_32x32x16_bf16 v[224:239], v[72:75], a[196:199], v[224:239]
    v_mfma_f32_32x32x16_bf16 v[240:255], v[76:79], a[196:199], v[240:255]
    s_waitcnt lgkmcnt(0)
    v_mfma_f32_32x32x16_bf16 v[128:143], v[80:83], a[200:203], v[128:143]
    ds_read_b64_tr_b16 v[64:65], v24 offset:8192
    ds_read_b64_tr_b16 v[66:67], v24 offset:9216
    v_mfma_f32_32x32x16_bf16 v[144:159], v[84:87], a[200:203], v[144:159]
    ds_read_b64_tr_b16 v[68:69], v25 offset:8192
    ds_read_b64_tr_b16 v[70:71], v25 offset:9216
    v_mfma_f32_32x32x16_bf16 v[160:175], v[88:91], a[200:203], v[160:175]
    ds_read_b64_tr_b16 v[72:73], v26 offset:8192
    ds_read_b64_tr_b16 v[74:75], v26 offset:9216
    v_mfma_f32_32x32x16_bf16 v[176:191], v[92:95], a[200:203], v[176:191]
    ds_read_b64_tr_b16 v[76:77], v27 offset:8192
    ds_read_b64_tr_b16 v[78:79], v27 offset:9216
    v_mfma_f32_32x32x16_bf16 v[192:207], v[80:83], a[204:207], v[192:207]
    v_mfma_f32_32x32x16_bf16 v[208:223], v[84:87], a[204:207], v[208:223]
    s_add_u32 m0, s70, 69632
    v_add_u32 v3, 3276800, v12
    global_load_lds_dwordx4 v3, s[72:73]
    v_mfma_f32_32x32x16_bf16 v[224:239], v[88:91], a[204:207], v[224:239]
    v_mfma_f32_32x32x16_bf16 v[240:255], v[92:95], a[204:207], v[240:255]
    s_waitcnt lgkmcnt(0)
    v_mfma_f32_32x32x16_bf16 v[128:143], v[64:67], a[208:211], v[128:143]
    ds_read_b64_tr_b16 v[80:81], v24 offset:12288
    ds_read_b64_tr_b16 v[82:83], v24 offset:13312
    v_mfma_f32_32x32x16_bf16 v[144:159], v[68:71], a[208:211], v[144:159]
    ds_read_b64_tr_b16 v[84:85], v25 offset:12288
    ds_read_b64_tr_b16 v[86:87], v25 offset:13312
    v_mfma_f32_32x32x16_bf16 v[160:175], v[72:75], a[208:211], v[160:175]
    ds_read_b64_tr_b16 v[88:89], v26 offset:12288
    ds_read_b64_tr_b16 v[90:91], v26 offset:13312
    v_mfma_f32_32x32x16_bf16 v[176:191], v[76:79], a[208:211], v[176:191]
    ds_read_b64_tr_b16 v[92:93], v27 offset:12288
    ds_read_b64_tr_b16 v[94:95], v27 offset:13312
    v_mfma_f32_32x32x16_bf16 v[192:207], v[64:67], a[212:215], v[192:207]
    v_mfma_f32_32x32x16_bf16 v[208:223], v[68:71], a[212:215], v[208:223]
    s_add_u32 m0, s70, 73728
    v_add_u32 v2, 3407872, v12
    global_load_lds_dwordx4 v2, s[72:73]
    v_mfma_f32_32x32x16_bf16 v[224:239], v[72:75], a[212:215], v[224:239]
    v_mfma_f32_32x32x16_bf16 v[240:255], v[76:79], a[212:215], v[240:255]
    s_waitcnt lgkmcnt(0)
    v_mfma_f32_32x32x16_bf16 v[128:143], v[80:83], a[216:219], v[128:143]
    ds_read_b64_tr_b16 v[64:65], v24 offset:16384
    ds_read_b64_tr_b16 v[66:67], v24 offset:17408
    v_mfma_f32_32x32x16_bf16 v[144:159], v[84:87], a[216:219], v[144:159]
    ds_read_b64_tr_b16 v[68:69], v25 offset:16384
    ds_read_b64_tr_b16 v[70:71], v25 offset:17408
    v_mfma_f32_32x32x16_bf16 v[160:175], v[88:91], a[216:219], v[160:175]
    ds_read_b64_tr_b16 v[72:73], v26 offset:16384
    ds_read_b64_tr_b16 v[74:75], v26 offset:17408
    v_mfma_f32_32x32x16_bf16 v[176:191], v[92:95], a[216:219], v[176:191]
    ds_read_b64_tr_b16 v[76:77], v27 offset:16384
    ds_read_b64_tr_b16 v[78:79], v27 offset:17408
    v_mfma_f32_32x32x16_bf16 v[192:207], v[80:83], a[220:223], v[192:207]
    v_mfma_f32_32x32x16_bf16 v[208:223], v[84:87], a[220:223], v[208:223]
    s_add_u32 m0, s70, 77824
    v_add_u32 v3, 3538944, v12
    global_load_lds_dwordx4 v3, s[72:73]
    v_mfma_f32_32x32x16_bf16 v[224:239], v[88:91], a[220:223], v[224:239]
    v_mfma_f32_32x32x16_bf16 v[240:255], v[92:95], a[220:223], v[240:255]
    s_waitcnt lgkmcnt(0)
    v_mfma_f32_32x32x16_bf16 v[128:143], v[64:67], a[224:227], v[128:143]
    ds_read_b64_tr_b16 v[80:81], v24 offset:20480
    ds_read_b64_tr_b16 v[82:83], v24 offset:21504
    v_mfma_f32_32x32x16_bf16 v[144:159], v[68:71], a[224:227], v[144:159]
    ds_read_b64_tr_b16 v[84:85], v25 offset:20480
    ds_read_b64_tr_b16 v[86:87], v25 offset:21504
    v_mfma_f32_32x32x16_bf16 v[160:175], v[72:75], a[224:227], v[160:175]
    ds_read_b64_tr_b16 v[88:89], v26 offset:20480
    ds_read_b64_tr_b16 v[90:91], v26 offset:21504
    v_mfma_f32_32x32x16_bf16 v[176:191], v[76:79], a[224:227], v[176:191]
    ds_read_b64_tr_b16 v[92:93], v27 offset:20480
    ds_read_b64_tr_b16 v[94:95], v27 offset:21504
    v_mfma_f32_32x32x16_bf16 v[192:207], v[64:67], a[228:231], v[192:207]
    v_mfma_f32_32x32x16_bf16 v[208:223], v[68:71], a[228:231], v[208:223]
    s_add_u32 m0, s70, 81920
    v_add_u32 v2, 3670016, v12
    global_load_lds_dwordx4 v2, s[72:73]
    v_mfma_f32_32x32x16_bf16 v[224:239], v[72:75], a[228:231], v[224:239]
    v_mfma_f32_32x32x16_bf16 v[240:255], v[76:79], a[228:231], v[240:255]
    s_waitcnt lgkmcnt(0)
    v_mfma_f32_32x32x16_bf16 v[128:143], v[80:83], a[232:235], v[128:143]
    ds_read_b64_tr_b16 v[64:65], v24 offset:24576
    ds_read_b64_tr_b16 v[66:67], v24 offset:25600
    v_mfma_f32_32x32x16_bf16 v[144:159], v[84:87], a[232:235], v[144:159]
    ds_read_b64_tr_b16 v[68:69], v25 offset:24576
    ds_read_b64_tr_b16 v[70:71], v25 offset:25600
    v_mfma_f32_32x32x16_bf16 v[160:175], v[88:91], a[232:235], v[160:175]
    ds_read_b64_tr_b16 v[72:73], v26 offset:24576
    ds_read_b64_tr_b16 v[74:75], v26 offset:25600
    v_mfma_f32_32x32x16_bf16 v[176:191], v[92:95], a[232:235], v[176:191]
    ds_read_b64_tr_b16 v[76:77], v27 offset:24576
    ds_read_b64_tr_b16 v[78:79], v27 offset:25600
    v_mfma_f32_32x32x16_bf16 v[192:207], v[80:83], a[236:239], v[192:207]
    v_mfma_f32_32x32x16_bf16 v[208:223], v[84:87], a[236:239], v[208:223]
    s_add_u32 m0, s70, 86016
    v_add_u32 v3, 3801088, v12
    global_load_lds_dwordx4 v3, s[72:73]
    v_mfma_f32_32x32x16_bf16 v[224:239], v[88:91], a[236:239], v[224:239]
    v_mfma_f32_32x32x16_bf16 v[240:255], v[92:95], a[236:239], v[240:255]
    s_waitcnt lgkmcnt(0)
    v_mfma_f32_32x32x16_bf16 v[128:143], v[64:67], a[240:243], v[128:143]
    ds_read_b64_tr_b16 v[80:81], v24 offset:28672
    ds_read_b64_tr_b16 v[82:83], v24 offset:29696
    v_mfma_f32_32x32x16_bf16 v[144:159], v[68:71], a[240:243], v[144:159]
    ds_read_b64_tr_b16 v[84:85], v25 offset:28672
    ds_read_b64_tr_b16 v[86:87], v25 offset:29696
    v_mfma_f32_32x32x16_bf16 v[160:175], v[72:75], a[240:243], v[160:175]
    ds_read_b64_tr_b16 v[88:89], v26 offset:28672
    ds_read_b64_tr_b16 v[90:91], v26 offset:29696
    v_mfma_f32_32x32x16_bf16 v[176:191], v[76:79], a[240:243], v[176:191]
    ds_read_b64_tr_b16 v[92:93], v27 offset:28672
    ds_read_b64_tr_b16 v[94:95], v27 offset:29696
    v_mfma_f32_32x32x16_bf16 v[192:207], v[64:67], a[244:247], v[192:207]
    v_mfma_f32_32x32x16_bf16 v[208:223], v[68:71], a[244:247], v[208:223]
    s_add_u32 m0, s70, 90112
    v_add_u32 v2, 3932160, v12
    global_load_lds_dwordx4 v2, s[72:73]
    v_mfma_f32_32x32x16_bf16 v[224:239], v[72:75], a[244:247], v[224:239]
    v_mfma_f32_32x32x16_bf16 v[240:255], v[76:79], a[244:247], v[240:255]
    s_waitcnt lgkmcnt(0)
    v_mfma_f32_32x32x16_bf16 v[128:143], v[80:83], a[248:251], v[128:143]
    v_mfma_f32_32x32x16_bf16 v[144:159], v[84:87], a[248:251], v[144:159]
    v_mfma_f32_32x32x16_bf16 v[160:175], v[88:91], a[248:251], v[160:175]
    v_mfma_f32_32x32x16_bf16 v[176:191], v[92:95], a[248:251], v[176:191]
    v_mfma_f32_32x32x16_bf16 v[192:207], v[80:83], a[252:255], v[192:207]
    v_mfma_f32_32x32x16_bf16 v[208:223], v[84:87], a[252:255], v[208:223]
    s_add_u32 m0, s70, 94208
    v_add_u32 v3, 4063232, v12
    global_load_lds_dwordx4 v3, s[72:73]
    v_mfma_f32_32x32x16_bf16 v[224:239], v[88:91], a[252:255], v[224:239]
    v_mfma_f32_32x32x16_bf16 v[240:255], v[92:95], a[252:255], v[240:255]
    v_mov_b32 v28, v14
    v_add_u32 v28, 0, v28
    v_add_u32 v29, 131072, v28
    v_cvt_pk_bf16_f32 v32, v128, v129
    v_cvt_pk_bf16_f32 v33, v130, v131
    v_cvt_pk_bf16_f32 v34, v132, v133
    v_cvt_pk_bf16_f32 v35, v134, v135
    v_cvt_pk_bf16_f32 v36, v136, v137
    v_cvt_pk_bf16_f32 v37, v138, v139
    v_cvt_pk_bf16_f32 v38, v140, v141
    v_cvt_pk_bf16_f32 v39, v142, v143
    global_store_dwordx4 v28, v[32:35], s[68:69] offset:0 sc1
    global_store_dwordx4 v28, v[36:39], s[68:69] offset:512 sc1
    v_cvt_pk_bf16_f32 v40, v144, v145
    v_cvt_pk_bf16_f32 v41, v146, v147
    v_cvt_pk_bf16_f32 v42, v148, v149
    v_cvt_pk_bf16_f32 v43, v150, v151
    v_cvt_pk_bf16_f32 v44, v152, v153
    v_cvt_pk_bf16_f32 v45, v154, v155
    v_cvt_pk_bf16_f32 v46, v156, v157
    v_cvt_pk_bf16_f32 v47, v158, v159
    global_store_dwordx4 v28, v[40:43], s[68:69] offset:1024 sc1
    global_store_dwordx4 v28, v[44:47], s[68:69] offset:1536 sc1
    v_cvt_pk_bf16_f32 v32, v160, v161
    v_cvt_pk_bf16_f32 v33, v162, v163
    v_cvt_pk_bf16_f32 v34, v164, v165
    v_cvt_pk_bf16_f32 v35, v166, v167
    v_cvt_pk_bf16_f32 v36, v168, v169
    v_cvt_pk_bf16_f32 v37, v170, v171
    v_cvt_pk_bf16_f32 v38, v172, v173
    v_cvt_pk_bf16_f32 v39, v174, v175
    global_store_dwordx4 v28, v[32:35], s[68:69] offset:2048 sc1
    global_store_dwordx4 v28, v[36:39], s[68:69] offset:2560 sc1
    v_cvt_pk_bf16_f32 v40, v176, v177
    v_cvt_pk_bf16_f32 v41, v178, v179
    v_cvt_pk_bf16_f32 v42, v180, v181
    v_cvt_pk_bf16_f32 v43, v182, v183
    v_cvt_pk_bf16_f32 v44, v184, v185
    v_cvt_pk_bf16_f32 v45, v186, v187
    v_cvt_pk_bf16_f32 v46, v188, v189
    v_cvt_pk_bf16_f32 v47, v190, v191
    global_store_dwordx4 v28, v[40:43], s[68:69] offset:3072 sc1
    global_store_dwordx4 v28, v[44:47], s[68:69] offset:3584 sc1
    v_cvt_pk_bf16_f32 v32, v192, v193
    v_cvt_pk_bf16_f32 v33, v194, v195
    v_cvt_pk_bf16_f32 v34, v196, v197
    v_cvt_pk_bf16_f32 v35, v198, v199
    v_cvt_pk_bf16_f32 v36, v200, v201
    v_cvt_pk_bf16_f32 v37, v202, v203
    v_cvt_pk_bf16_f32 v38, v204, v205
    v_cvt_pk_bf16_f32 v39, v206, v207
    global_store_dwordx4 v29, v[32:35], s[68:69] offset:0 sc1
    global_store_dwordx4 v29, v[36:39], s[68:69] offset:512 sc1
    v_cvt_pk_bf16_f32 v40, v208, v209
    v_cvt_pk_bf16_f32 v41, v210, v211
    v_cvt_pk_bf16_f32 v42, v212, v213
    v_cvt_pk_bf16_f32 v43, v214, v215
    v_cvt_pk_bf16_f32 v44, v216, v217
    v_cvt_pk_bf16_f32 v45, v218, v219
    v_cvt_pk_bf16_f32 v46, v220, v221
    v_cvt_pk_bf16_f32 v47, v222, v223
    global_store_dwordx4 v29, v[40:43], s[68:69] offset:1024 sc1
    global_store_dwordx4 v29, v[44:47], s[68:69] offset:1536 sc1
    v_cvt_pk_bf16_f32 v32, v224, v225
    v_cvt_pk_bf16_f32 v33, v226, v227
    v_cvt_pk_bf16_f32 v34, v228, v229
    v_cvt_pk_bf16_f32 v35, v230, v231
    v_cvt_pk_bf16_f32 v36, v232, v233
    v_cvt_pk_bf16_f32 v37, v234, v235
    v_cvt_pk_bf16_f32 v38, v236, v237
    v_cvt_pk_bf16_f32 v39, v238, v239
    global_store_dwordx4 v29, v[32:35], s[68:69] offset:2048 sc1
    global_store_dwordx4 v29, v[36:39], s[68:69] offset:2560 sc1
    v_cvt_pk_bf16_f32 v40, v240, v241
    v_cvt_pk_bf16_f32 v41, v242, v243
    v_cvt_pk_bf16_f32 v42, v244, v245
    v_cvt_pk_bf16_f32 v43, v246, v247
    v_cvt_pk_bf16_f32 v44, v248, v249
    v_cvt_pk_bf16_f32 v45, v250, v251
    v_cvt_pk_bf16_f32 v46, v252, v253
    v_cvt_pk_bf16_f32 v47, v254, v255
    global_store_dwordx4 v29, v[40:43], s[68:69] offset:3072 sc1
    global_store_dwordx4 v29, v[44:47], s[68:69] offset:3584 sc1
    s_mov_b64 s[72:73], s[40:41]
    v_mov_b64 v[128:129], 0
    v_mov_b64 v[130:131], 0
    v_mov_b64 v[132:133], 0
    v_mov_b64 v[134:135], 0
    v_mov_b64 v[136:137], 0
    v_mov_b64 v[138:139], 0
    v_mov_b64 v[140:141], 0
    v_mov_b64 v[142:143], 0
    v_mov_b64 v[144:145], 0
    v_mov_b64 v[146:147], 0
    v_mov_b64 v[148:149], 0
    v_mov_b64 v[150:151], 0
    v_mov_b64 v[152:153], 0
    v_mov_b64 v[154:155], 0
    v_mov_b64 v[156:157], 0
    v_mov_b64 v[158:159], 0
    v_mov_b64 v[160:161], 0
    v_mov_b64 v[162:163], 0
    v_mov_b64 v[164:165], 0
    v_mov_b64 v[166:167], 0
    v_mov_b64 v[168:169], 0
    v_mov_b64 v[170:171], 0
    v_mov_b64 v[172:173], 0
    v_mov_b64 v[174:175], 0
    v_mov_b64 v[176:177], 0
    v_mov_b64 v[178:179], 0
    v_mov_b64 v[180:181], 0
    v_mov_b64 v[182:183], 0
    v_mov_b64 v[184:185], 0
    v_mov_b64 v[186:187], 0
    v_mov_b64 v[188:189], 0
    v_mov_b64 v[190:191], 0
    v_mov_b64 v[192:193], 0
    v_mov_b64 v[194:195], 0
    v_mov_b64 v[196:197], 0
    v_mov_b64 v[198:199], 0
    v_mov_b64 v[200:201], 0
    v_mov_b64 v[202:203], 0
    v_mov_b64 v[204:205], 0
    v_mov_b64 v[206:207], 0
    v_mov_b64 v[208:209], 0
    v_mov_b64 v[210:211], 0
    v_mov_b64 v[212:213], 0
    v_mov_b64 v[214:215], 0
    v_mov_b64 v[216:217], 0
    v_mov_b64 v[218:219], 0
    v_mov_b64 v[220:221], 0
    v_mov_b64 v[222:223], 0
    v_mov_b64 v[224:225], 0
    v_mov_b64 v[226:227], 0
    v_mov_b64 v[228:229], 0
    v_mov_b64 v[230:231], 0
    v_mov_b64 v[232:233], 0
    v_mov_b64 v[234:235], 0
    v_mov_b64 v[236:237], 0
    v_mov_b64 v[238:239], 0
    v_mov_b64 v[240:241], 0
    v_mov_b64 v[242:243], 0
    v_mov_b64 v[244:245], 0
    v_mov_b64 v[246:247], 0
    v_mov_b64 v[248:249], 0
    v_mov_b64 v[250:251], 0
    v_mov_b64 v[252:253], 0
    v_mov_b64 v[254:255], 0
    s_waitcnt vmcnt(40)
    s_barrier
    v_add_u32 v24, 131072, v8
    v_add_u32 v25, 131072, v9
    v_add_u32 v26, 131072, v10
    v_add_u32 v27, 131072, v11
    ds_read_b64_tr_b16 v[64:65], v24 offset:0
    ds_read_b64_tr_b16 v[66:67], v24 offset:1024
    ds_read_b64_tr_b16 v[68:69], v25 offset:0
    ds_read_b64_tr_b16 v[70:71], v25 offset:1024
    ds_read_b64_tr_b16 v[72:73], v26 offset:0
    ds_read_b64_tr_b16 v[74:75], v26 offset:1024
    ds_read_b64_tr_b16 v[76:77], v27 offset:0
    ds_read_b64_tr_b16 v[78:79], v27 offset:1024
    s_waitcnt lgkmcnt(0)
    v_mfma_f32_32x32x16_bf16 v[128:143], a[0:3], v[64:67], v[128:143]
    ds_read_b64_tr_b16 v[80:81], v24 offset:4096
    ds_read_b64_tr_b16 v[82:83], v24 offset:5120
    v_mfma_f32_32x32x16_bf16 v[144:159], a[0:3], v[68:71], v[144:159]
    ds_read_b64_tr_b16 v[84:85], v25 offset:4096
    ds_read_b64_tr_b16 v[86:87], v25 offset:5120
    v_mfma_f32_32x32x16_bf16 v[160:175], a[0:3], v[72:75], v[160:175]
    ds_read_b64_tr_b16 v[88:89], v26 offset:4096
    ds_read_b64_tr_b16 v[90:91], v26 offset:5120
    v_mfma_f32_32x32x16_bf16 v[176:191], a[0:3], v[76:79], v[176:191]
    ds_read_b64_tr_b16 v[92:93], v27 offset:4096
    ds_read_b64_tr_b16 v[94:95], v27 offset:5120
    v_mfma_f32_32x32x16_bf16 v[192:207], a[4:7], v[64:67], v[192:207]
    v_mfma_f32_32x32x16_bf16 v[208:223], a[4:7], v[68:71], v[208:223]
    s_add_u32 m0, s70, 98304
    v_add_u32 v2, 0, v12
    global_load_lds_dwordx4 v2, s[72:73]
    v_mfma_f32_32x32x16_bf16 v[224:239], a[4:7], v[72:75], v[224:239]
    v_mfma_f32_32x32x16_bf16 v[240:255], a[4:7], v[76:79], v[240:255]
    s_waitcnt lgkmcnt(0)
    v_mfma_f32_32x32x16_bf16 v[128:143], a[8:11], v[80:83], v[128:143]
    ds_read_b64_tr_b16 v[64:65], v24 offset:8192
    ds_read_b64_tr_b16 v[66:67], v24 offset:9216
    v_mfma_f32_32x32x16_bf16 v[144:159], a[8:11], v[84:87], v[144:159]
    ds_read_b64_tr_b16 v[68:69], v25 offset:8192
    ds_read_b64_tr_b16 v[70:71], v25 offset:9216
    v_mfma_f32_32x32x16_bf16 v[160:175], a[8:11], v[88:91], v[160:175]
    ds_read_b64_tr_b16 v[72:73], v26 offset:8192
    ds_read_b64_tr_b16 v[74:75], v26 offset:9216
    v_mfma_f32_32x32x16_bf16 v[176:191], a[8:11], v[92:95], v[176:191]
    ds_read_b64_tr_b16 v[76:77], v27 offset:8192
    ds_read_b64_tr_b16 v[78:79], v27 offset:9216
    v_mfma_f32_32x32x16_bf16 v[192:207], a[12:15], v[80:83], v[192:207]
    v_mfma_f32_32x32x16_bf16 v[208:223], a[12:15], v[84:87], v[208:223]
    s_add_u32 m0, s70, 102400
    v_add_u32 v3, 131072, v12
    global_load_lds_dwordx4 v3, s[72:73]
    v_mfma_f32_32x32x16_bf16 v[224:239], a[12:15], v[88:91], v[224:239]
    v_mfma_f32_32x32x16_bf16 v[240:255], a[12:15], v[92:95], v[240:255]
    s_waitcnt lgkmcnt(0)
    v_mfma_f32_32x32x16_bf16 v[128:143], a[16:19], v[64:67], v[128:143]
    ds_read_b64_tr_b16 v[80:81], v24 offset:12288
    ds_read_b64_tr_b16 v[82:83], v24 offset:13312
    v_mfma_f32_32x32x16_bf16 v[144:159], a[16:19], v[68:71], v[144:159]
    ds_read_b64_tr_b16 v[84:85], v25 offset:12288
    ds_read_b64_tr_b16 v[86:87], v25 offset:13312
    v_mfma_f32_32x32x16_bf16 v[160:175], a[16:19], v[72:75], v[160:175]
    ds_read_b64_tr_b16 v[88:89], v26 offset:12288
    ds_read_b64_tr_b16 v[90:91], v26 offset:13312
    v_mfma_f32_32x32x16_bf16 v[176:191], a[16:19], v[76:79], v[176:191]
    ds_read_b64_tr_b16 v[92:93], v27 offset:12288
    ds_read_b64_tr_b16 v[94:95], v27 offset:13312
    v_mfma_f32_32x32x16_bf16 v[192:207], a[20:23], v[64:67], v[192:207]
    v_mfma_f32_32x32x16_bf16 v[208:223], a[20:23], v[68:71], v[208:223]
    s_add_u32 m0, s70, 106496
    v_add_u32 v2, 262144, v12
    global_load_lds_dwordx4 v2, s[72:73]
    v_mfma_f32_32x32x16_bf16 v[224:239], a[20:23], v[72:75], v[224:239]
    v_mfma_f32_32x32x16_bf16 v[240:255], a[20:23], v[76:79], v[240:255]
    s_waitcnt lgkmcnt(0)
    v_mfma_f32_32x32x16_bf16 v[128:143], a[24:27], v[80:83], v[128:143]
    ds_read_b64_tr_b16 v[64:65], v24 offset:16384
    ds_read_b64_tr_b16 v[66:67], v24 offset:17408
    v_mfma_f32_32x32x16_bf16 v[144:159], a[24:27], v[84:87], v[144:159]
    ds_read_b64_tr_b16 v[68:69], v25 offset:16384
    ds_read_b64_tr_b16 v[70:71], v25 offset:17408
    v_mfma_f32_32x32x16_bf16 v[160:175], a[24:27], v[88:91], v[160:175]
    ds_read_b64_tr_b16 v[72:73], v26 offset:16384
    ds_read_b64_tr_b16 v[74:75], v26 offset:17408
    v_mfma_f32_32x32x16_bf16 v[176:191], a[24:27], v[92:95], v[176:191]
    ds_read_b64_tr_b16 v[76:77], v27 offset:16384
    ds_read_b64_tr_b16 v[78:79], v27 offset:17408
    v_mfma_f32_32x32x16_bf16 v[192:207], a[28:31], v[80:83], v[192:207]
    v_mfma_f32_32x32x16_bf16 v[208:223], a[28:31], v[84:87], v[208:223]
    s_add_u32 m0, s70, 110592
    v_add_u32 v3, 393216, v12
    global_load_lds_dwordx4 v3, s[72:73]
    v_mfma_f32_32x32x16_bf16 v[224:239], a[28:31], v[88:91], v[224:239]
    v_mfma_f32_32x32x16_bf16 v[240:255], a[28:31], v[92:95], v[240:255]
    s_waitcnt lgkmcnt(0)
    v_mfma_f32_32x32x16_bf16 v[128:143], a[32:35], v[64:67], v[128:143]
    ds_read_b64_tr_b16 v[80:81], v24 offset:20480
    ds_read_b64_tr_b16 v[82:83], v24 offset:21504
    v_mfma_f32_32x32x16_bf16 v[144:159], a[32:35], v[68:71], v[144:159]
    ds_read_b64_tr_b16 v[84:85], v25 offset:20480
    ds_read_b64_tr_b16 v[86:87], v25 offset:21504
    v_mfma_f32_32x32x16_bf16 v[160:175], a[32:35], v[72:75], v[160:175]
    ds_read_b64_tr_b16 v[88:89], v26 offset:20480
    ds_read_b64_tr_b16 v[90:91], v26 offset:21504
    v_mfma_f32_32x32x16_bf16 v[176:191], a[32:35], v[76:79], v[176:191]
    ds_read_b64_tr_b16 v[92:93], v27 offset:20480
    ds_read_b64_tr_b16 v[94:95], v27 offset:21504
    v_mfma_f32_32x32x16_bf16 v[192:207], a[36:39], v[64:67], v[192:207]
    v_mfma_f32_32x32x16_bf16 v[208:223], a[36:39], v[68:71], v[208:223]
    s_add_u32 m0, s70, 114688
    v_add_u32 v2, 524288, v12
    global_load_lds_dwordx4 v2, s[72:73]
    v_mfma_f32_32x32x16_bf16 v[224:239], a[36:39], v[72:75], v[224:239]
    v_mfma_f32_32x32x16_bf16 v[240:255], a[36:39], v[76:79], v[240:255]
    s_waitcnt lgkmcnt(0)
    v_mfma_f32_32x32x16_bf16 v[128:143], a[40:43], v[80:83], v[128:143]
    ds_read_b64_tr_b16 v[64:65], v24 offset:24576
    ds_read_b64_tr_b16 v[66:67], v24 offset:25600
    v_mfma_f32_32x32x16_bf16 v[144:159], a[40:43], v[84:87], v[144:159]
    ds_read_b64_tr_b16 v[68:69], v25 offset:24576
    ds_read_b64_tr_b16 v[70:71], v25 offset:25600
    v_mfma_f32_32x32x16_bf16 v[160:175], a[40:43], v[88:91], v[160:175]
    ds_read_b64_tr_b16 v[72:73], v26 offset:24576
    ds_read_b64_tr_b16 v[74:75], v26 offset:25600
    v_mfma_f32_32x32x16_bf16 v[176:191], a[40:43], v[92:95], v[176:191]
    ds_read_b64_tr_b16 v[76:77], v27 offset:24576
    ds_read_b64_tr_b16 v[78:79], v27 offset:25600
    v_mfma_f32_32x32x16_bf16 v[192:207], a[44:47], v[80:83], v[192:207]
    v_mfma_f32_32x32x16_bf16 v[208:223], a[44:47], v[84:87], v[208:223]
    s_add_u32 m0, s70, 118784
    v_add_u32 v3, 655360, v12
    global_load_lds_dwordx4 v3, s[72:73]
    v_mfma_f32_32x32x16_bf16 v[224:239], a[44:47], v[88:91], v[224:239]
    v_mfma_f32_32x32x16_bf16 v[240:255], a[44:47], v[92:95], v[240:255]
    s_waitcnt lgkmcnt(0)
    v_mfma_f32_32x32x16_bf16 v[128:143], a[48:51], v[64:67], v[128:143]
    ds_read_b64_tr_b16 v[80:81], v24 offset:28672
    ds_read_b64_tr_b16 v[82:83], v24 offset:29696
    v_mfma_f32_32x32x16_bf16 v[144:159], a[48:51], v[68:71], v[144:159]
    ds_read_b64_tr_b16 v[84:85], v25 offset:28672
    ds_read_b64_tr_b16 v[86:87], v25 offset:29696
    v_mfma_f32_32x32x16_bf16 v[160:175], a[48:51], v[72:75], v[160:175]
    ds_read_b64_tr_b16 v[88:89], v26 offset:28672
    ds_read_b64_tr_b16 v[90:91], v26 offset:29696
    v_mfma_f32_32x32x16_bf16 v[176:191], a[48:51], v[76:79], v[176:191]
    ds_read_b64_tr_b16 v[92:93], v27 offset:28672
    ds_read_b64_tr_b16 v[94:95], v27 offset:29696
    v_mfma_f32_32x32x16_bf16 v[192:207], a[52:55], v[64:67], v[192:207]
    v_mfma_f32_32x32x16_bf16 v[208:223], a[52:55], v[68:71], v[208:223]
    s_add_u32 m0, s70, 122880
    v_add_u32 v2, 786432, v12
    global_load_lds_dwordx4 v2, s[72:73]
    v_mfma_f32_32x32x16_bf16 v[224:239], a[52:55], v[72:75], v[224:239]
    v_mfma_f32_32x32x16_bf16 v[240:255], a[52:55], v[76:79], v[240:255]
    s_waitcnt lgkmcnt(0)
    v_mfma_f32_32x32x16_bf16 v[128:143], a[56:59], v[80:83], v[128:143]
    v_mfma_f32_32x32x16_bf16 v[144:159], a[56:59], v[84:87], v[144:159]
    v_mfma_f32_32x32x16_bf16 v[160:175], a[56:59], v[88:91], v[160:175]
    v_mfma_f32_32x32x16_bf16 v[176:191], a[56:59], v[92:95], v[176:191]
    v_mfma_f32_32x32x16_bf16 v[192:207], a[60:63], v[80:83], v[192:207]
    v_mfma_f32_32x32x16_bf16 v[208:223], a[60:63], v[84:87], v[208:223]
    s_add_u32 m0, s70, 126976
    v_add_u32 v3, 917504, v12
    global_load_lds_dwordx4 v3, s[72:73]
    v_mfma_f32_32x32x16_bf16 v[224:239], a[60:63], v[88:91], v[224:239]
    v_mfma_f32_32x32x16_bf16 v[240:255], a[60:63], v[92:95], v[240:255]
    s_waitcnt vmcnt(40)
    v_mov_b32 v18, s97
    s_waitcnt vmcnt(8)
    s_mov_b64 exec, 0x3
    global_store_dword v17, v18, s[74:75] offset:0 sc1
    s_mov_b64 exec, -1
    s_barrier
    v_add_u32 v24, 0, v8
    v_add_u32 v25, 0, v9
    v_add_u32 v26, 0, v10
    v_add_u32 v27, 0, v11
    ds_read_b64_tr_b16 v[64:65], v24 offset:0
    ds_read_b64_tr_b16 v[66:67], v24 offset:1024
    ds_read_b64_tr_b16 v[68:69], v25 offset:0
    ds_read_b64_tr_b16 v[70:71], v25 offset:1024
    ds_read_b64_tr_b16 v[72:73], v26 offset:0
    ds_read_b64_tr_b16 v[74:75], v26 offset:1024
    ds_read_b64_tr_b16 v[76:77], v27 offset:0
    ds_read_b64_tr_b16 v[78:79], v27 offset:1024
    s_waitcnt lgkmcnt(0)
    v_mfma_f32_32x32x16_bf16 v[128:143], a[64:67], v[64:67], v[128:143]
    ds_read_b64_tr_b16 v[80:81], v24 offset:4096
    ds_read_b64_tr_b16 v[82:83], v24 offset:5120
    v_mfma_f32_32x32x16_bf16 v[144:159], a[64:67], v[68:71], v[144:159]
    ds_read_b64_tr_b16 v[84:85], v25 offset:4096
    ds_read_b64_tr_b16 v[86:87], v25 offset:5120
    v_mfma_f32_32x32x16_bf16 v[160:175], a[64:67], v[72:75], v[160:175]
    ds_read_b64_tr_b16 v[88:89], v26 offset:4096
    ds_read_b64_tr_b16 v[90:91], v26 offset:5120
    v_mfma_f32_32x32x16_bf16 v[176:191], a[64:67], v[76:79], v[176:191]
    ds_read_b64_tr_b16 v[92:93], v27 offset:4096
    ds_read_b64_tr_b16 v[94:95], v27 offset:5120
    v_mfma_f32_32x32x16_bf16 v[192:207], a[68:71], v[64:67], v[192:207]
    v_mfma_f32_32x32x16_bf16 v[208:223], a[68:71], v[68:71], v[208:223]
    s_add_u32 m0, s70, 131072
    v_add_u32 v2, 1048576, v12
    global_load_lds_dwordx4 v2, s[72:73]
    v_mfma_f32_32x32x16_bf16 v[224:239], a[68:71], v[72:75], v[224:239]
    v_mfma_f32_32x32x16_bf16 v[240:255], a[68:71], v[76:79], v[240:255]
    s_waitcnt lgkmcnt(0)
    v_mfma_f32_32x32x16_bf16 v[128:143], a[72:75], v[80:83], v[128:143]
    ds_read_b64_tr_b16 v[64:65], v24 offset:8192
    ds_read_b64_tr_b16 v[66:67], v24 offset:9216
    v_mfma_f32_32x32x16_bf16 v[144:159], a[72:75], v[84:87], v[144:159]
    ds_read_b64_tr_b16 v[68:69], v25 offset:8192
    ds_read_b64_tr_b16 v[70:71], v25 offset:9216
    v_mfma_f32_32x32x16_bf16 v[160:175], a[72:75], v[88:91], v[160:175]
    ds_read_b64_tr_b16 v[72:73], v26 offset:8192
    ds_read_b64_tr_b16 v[74:75], v26 offset:9216
    v_mfma_f32_32x32x16_bf16 v[176:191], a[72:75], v[92:95], v[176:191]
    ds_read_b64_tr_b16 v[76:77], v27 offset:8192
    ds_read_b64_tr_b16 v[78:79], v27 offset:9216
    v_mfma_f32_32x32x16_bf16 v[192:207], a[76:79], v[80:83], v[192:207]
    v_mfma_f32_32x32x16_bf16 v[208:223], a[76:79], v[84:87], v[208:223]
    s_add_u32 m0, s70, 135168
    v_add_u32 v3, 1179648, v12
    global_load_lds_dwordx4 v3, s[72:73]
    v_mfma_f32_32x32x16_bf16 v[224:239], a[76:79], v[88:91], v[224:239]
    v_mfma_f32_32x32x16_bf16 v[240:255], a[76:79], v[92:95], v[240:255]
    s_waitcnt lgkmcnt(0)
    v_mfma_f32_32x32x16_bf16 v[128:143], a[80:83], v[64:67], v[128:143]
    ds_read_b64_tr_b16 v[80:81], v24 offset:12288
    ds_read_b64_tr_b16 v[82:83], v24 offset:13312
    v_mfma_f32_32x32x16_bf16 v[144:159], a[80:83], v[68:71], v[144:159]
    ds_read_b64_tr_b16 v[84:85], v25 offset:12288
    ds_read_b64_tr_b16 v[86:87], v25 offset:13312
    v_mfma_f32_32x32x16_bf16 v[160:175], a[80:83], v[72:75], v[160:175]
    ds_read_b64_tr_b16 v[88:89], v26 offset:12288
    ds_read_b64_tr_b16 v[90:91], v26 offset:13312
    v_mfma_f32_32x32x16_bf16 v[176:191], a[80:83], v[76:79], v[176:191]
    ds_read_b64_tr_b16 v[92:93], v27 offset:12288
    ds_read_b64_tr_b16 v[94:95], v27 offset:13312
    v_mfma_f32_32x32x16_bf16 v[192:207], a[84:87], v[64:67], v[192:207]
    v_mfma_f32_32x32x16_bf16 v[208:223], a[84:87], v[68:71], v[208:223]
    s_add_u32 m0, s70, 139264
    v_add_u32 v2, 1310720, v12
    global_load_lds_dwordx4 v2, s[72:73]
    v_mfma_f32_32x32x16_bf16 v[224:239], a[84:87], v[72:75], v[224:239]
    v_mfma_f32_32x32x16_bf16 v[240:255], a[84:87], v[76:79], v[240:255]
    s_waitcnt lgkmcnt(0)
    v_mfma_f32_32x32x16_bf16 v[128:143], a[88:91], v[80:83], v[128:143]
    ds_read_b64_tr_b16 v[64:65], v24 offset:16384
    ds_read_b64_tr_b16 v[66:67], v24 offset:17408
    v_mfma_f32_32x32x16_bf16 v[144:159], a[88:91], v[84:87], v[144:159]
    ds_read_b64_tr_b16 v[68:69], v25 offset:16384
    ds_read_b64_tr_b16 v[70:71], v25 offset:17408
    v_mfma_f32_32x32x16_bf16 v[160:175], a[88:91], v[88:91], v[160:175]
    ds_read_b64_tr_b16 v[72:73], v26 offset:16384
    ds_read_b64_tr_b16 v[74:75], v26 offset:17408
    v_mfma_f32_32x32x16_bf16 v[176:191], a[88:91], v[92:95], v[176:191]
    ds_read_b64_tr_b16 v[76:77], v27 offset:16384
    ds_read_b64_tr_b16 v[78:79], v27 offset:17408
    v_mfma_f32_32x32x16_bf16 v[192:207], a[92:95], v[80:83], v[192:207]
    v_mfma_f32_32x32x16_bf16 v[208:223], a[92:95], v[84:87], v[208:223]
    s_add_u32 m0, s70, 143360
    v_add_u32 v3, 1441792, v12
    global_load_lds_dwordx4 v3, s[72:73]
    v_mfma_f32_32x32x16_bf16 v[224:239], a[92:95], v[88:91], v[224:239]
    v_mfma_f32_32x32x16_bf16 v[240:255], a[92:95], v[92:95], v[240:255]
    s_waitcnt lgkmcnt(0)
    v_mfma_f32_32x32x16_bf16 v[128:143], a[96:99], v[64:67], v[128:143]
    ds_read_b64_tr_b16 v[80:81], v24 offset:20480
    ds_read_b64_tr_b16 v[82:83], v24 offset:21504
    v_mfma_f32_32x32x16_bf16 v[144:159], a[96:99], v[68:71], v[144:159]
    ds_read_b64_tr_b16 v[84:85], v25 offset:20480
    ds_read_b64_tr_b16 v[86:87], v25 offset:21504
    v_mfma_f32_32x32x16_bf16 v[160:175], a[96:99], v[72:75], v[160:175]
    ds_read_b64_tr_b16 v[88:89], v26 offset:20480
    ds_read_b64_tr_b16 v[90:91], v26 offset:21504
    v_mfma_f32_32x32x16_bf16 v[176:191], a[96:99], v[76:79], v[176:191]
    ds_read_b64_tr_b16 v[92:93], v27 offset:20480
    ds_read_b64_tr_b16 v[94:95], v27 offset:21504
    v_mfma_f32_32x32x16_bf16 v[192:207], a[100:103], v[64:67], v[192:207]
    v_mfma_f32_32x32x16_bf16 v[208:223], a[100:103], v[68:71], v[208:223]
    s_add_u32 m0, s70, 147456
    v_add_u32 v2, 1572864, v12
    global_load_lds_dwordx4 v2, s[72:73]
    v_mfma_f32_32x32x16_bf16 v[224:239], a[100:103], v[72:75], v[224:239]
    v_mfma_f32_32x32x16_bf16 v[240:255], a[100:103], v[76:79], v[240:255]
    s_waitcnt lgkmcnt(0)
    v_mfma_f32_32x32x16_bf16 v[128:143], a[104:107], v[80:83], v[128:143]
    ds_read_b64_tr_b16 v[64:65], v24 offset:24576
    ds_read_b64_tr_b16 v[66:67], v24 offset:25600
    v_mfma_f32_32x32x16_bf16 v[144:159], a[104:107], v[84:87], v[144:159]
    ds_read_b64_tr_b16 v[68:69], v25 offset:24576
    ds_read_b64_tr_b16 v[70:71], v25 offset:25600
    v_mfma_f32_32x32x16_bf16 v[160:175], a[104:107], v[88:91], v[160:175]
    ds_read_b64_tr_b16 v[72:73], v26 offset:24576
    ds_read_b64_tr_b16 v[74:75], v26 offset:25600
    v_mfma_f32_32x32x16_bf16 v[176:191], a[104:107], v[92:95], v[176:191]
    ds_read_b64_tr_b16 v[76:77], v27 offset:24576
    ds_read_b64_tr_b16 v[78:79], v27 offset:25600
    v_mfma_f32_32x32x16_bf16 v[192:207], a[108:111], v[80:83], v[192:207]
    v_mfma_f32_32x32x16_bf16 v[208:223], a[108:111], v[84:87], v[208:223]
    s_add_u32 m0, s70, 151552
    v_add_u32 v3, 1703936, v12
    global_load_lds_dwordx4 v3, s[72:73]
    v_mfma_f32_32x32x16_bf16 v[224:239], a[108:111], v[88:91], v[224:239]
    v_mfma_f32_32x32x16_bf16 v[240:255], a[108:111], v[92:95], v[240:255]
    s_waitcnt lgkmcnt(0)
    v_mfma_f32_32x32x16_bf16 v[128:143], a[112:115], v[64:67], v[128:143]
    ds_read_b64_tr_b16 v[80:81], v24 offset:28672
    ds_read_b64_tr_b16 v[82:83], v24 offset:29696
    v_mfma_f32_32x32x16_bf16 v[144:159], a[112:115], v[68:71], v[144:159]
    ds_read_b64_tr_b16 v[84:85], v25 offset:28672
    ds_read_b64_tr_b16 v[86:87], v25 offset:29696
    v_mfma_f32_32x32x16_bf16 v[160:175], a[112:115], v[72:75], v[160:175]
    ds_read_b64_tr_b16 v[88:89], v26 offset:28672
    ds_read_b64_tr_b16 v[90:91], v26 offset:29696
    v_mfma_f32_32x32x16_bf16 v[176:191], a[112:115], v[76:79], v[176:191]
    ds_read_b64_tr_b16 v[92:93], v27 offset:28672
    ds_read_b64_tr_b16 v[94:95], v27 offset:29696
    v_mfma_f32_32x32x16_bf16 v[192:207], a[116:119], v[64:67], v[192:207]
    v_mfma_f32_32x32x16_bf16 v[208:223], a[116:119], v[68:71], v[208:223]
    s_add_u32 m0, s70, 155648
    v_add_u32 v2, 1835008, v12
    global_load_lds_dwordx4 v2, s[72:73]
    v_mfma_f32_32x32x16_bf16 v[224:239], a[116:119], v[72:75], v[224:239]
    v_mfma_f32_32x32x16_bf16 v[240:255], a[116:119], v[76:79], v[240:255]
    s_waitcnt lgkmcnt(0)
    v_mfma_f32_32x32x16_bf16 v[128:143], a[120:123], v[80:83], v[128:143]
    v_mfma_f32_32x32x16_bf16 v[144:159], a[120:123], v[84:87], v[144:159]
    v_mfma_f32_32x32x16_bf16 v[160:175], a[120:123], v[88:91], v[160:175]
    v_mfma_f32_32x32x16_bf16 v[176:191], a[120:123], v[92:95], v[176:191]
    v_mfma_f32_32x32x16_bf16 v[192:207], a[124:127], v[80:83], v[192:207]
    v_mfma_f32_32x32x16_bf16 v[208:223], a[124:127], v[84:87], v[208:223]
    s_add_u32 m0, s70, 159744
    v_add_u32 v3, 1966080, v12
    global_load_lds_dwordx4 v3, s[72:73]
    v_mfma_f32_32x32x16_bf16 v[224:239], a[124:127], v[88:91], v[224:239]
    v_mfma_f32_32x32x16_bf16 v[240:255], a[124:127], v[92:95], v[240:255]
    s_waitcnt vmcnt(40)
    s_barrier
    v_add_u32 v24, 32768, v8
    v_add_u32 v25, 32768, v9
    v_add_u32 v26, 32768, v10
    v_add_u32 v27, 32768, v11
    ds_read_b64_tr_b16 v[64:65], v24 offset:0
    ds_read_b64_tr_b16 v[66:67], v24 offset:1024
    ds_read_b64_tr_b16 v[68:69], v25 offset:0
    ds_read_b64_tr_b16 v[70:71], v25 offset:1024
    ds_read_b64_tr_b16 v[72:73], v26 offset:0
    ds_read_b64_tr_b16 v[74:75], v26 offset:1024
    ds_read_b64_tr_b16 v[76:77], v27 offset:0
    ds_read_b64_tr_b16 v[78:79], v27 offset:1024
    s_waitcnt lgkmcnt(0)
    v_mfma_f32_32x32x16_bf16 v[128:143], a[128:131], v[64:67], v[128:143]
    ds_read_b64_tr_b16 v[80:81], v24 offset:4096
    ds_read_b64_tr_b16 v[82:83], v24 offset:5120
    v_mfma_f32_32x32x16_bf16 v[144:159], a[128:131], v[68:71], v[144:159]
    ds_read_b64_tr_b16 v[84:85], v25 offset:4096
    ds_read_b64_tr_b16 v[86:87], v25 offset:5120
    v_mfma_f32_32x32x16_bf16 v[160:175], a[128:131], v[72:75], v[160:175]
    ds_read_b64_tr_b16 v[88:89], v26 offset:4096
    ds_read_b64_tr_b16 v[90:91], v26 offset:5120
    v_mfma_f32_32x32x16_bf16 v[176:191], a[128:131], v[76:79], v[176:191]
    ds_read_b64_tr_b16 v[92:93], v27 offset:4096
    ds_read_b64_tr_b16 v[94:95], v27 offset:5120
    v_mfma_f32_32x32x16_bf16 v[192:207], a[132:135], v[64:67], v[192:207]
    v_mfma_f32_32x32x16_bf16 v[208:223], a[132:135], v[68:71], v[208:223]
    s_add_u32 m0, s70, 0
    v_add_u32 v2, 2097152, v12
    global_load_lds_dwordx4 v2, s[72:73]
    v_mfma_f32_32x32x16_bf16 v[224:239], a[132:135], v[72:75], v[224:239]
    v_mfma_f32_32x32x16_bf16 v[240:255], a[132:135], v[76:79], v[240:255]
    s_waitcnt lgkmcnt(0)
    v_mfma_f32_32x32x16_bf16 v[128:143], a[136:139], v[80:83], v[128:143]
    ds_read_b64_tr_b16 v[64:65], v24 offset:8192
    ds_read_b64_tr_b16 v[66:67], v24 offset:9216
    v_mfma_f32_32x32x16_bf16 v[144:159], a[136:139], v[84:87], v[144:159]
    ds_read_b64_tr_b16 v[68:69], v25 offset:8192
    ds_read_b64_tr_b16 v[70:71], v25 offset:9216
    v_mfma_f32_32x32x16_bf16 v[160:175], a[136:139], v[88:91], v[160:175]
    ds_read_b64_tr_b16 v[72:73], v26 offset:8192
    ds_read_b64_tr_b16 v[74:75], v26 offset:9216
    v_mfma_f32_32x32x16_bf16 v[176:191], a[136:139], v[92:95], v[176:191]
    ds_read_b64_tr_b16 v[76:77], v27 offset:8192
    ds_read_b64_tr_b16 v[78:79], v27 offset:9216
    v_mfma_f32_32x32x16_bf16 v[192:207], a[140:143], v[80:83], v[192:207]
    v_mfma_f32_32x32x16_bf16 v[208:223], a[140:143], v[84:87], v[208:223]
    s_add_u32 m0, s70, 4096
    v_add_u32 v3, 2228224, v12
    global_load_lds_dwordx4 v3, s[72:73]
    v_mfma_f32_32x32x16_bf16 v[224:239], a[140:143], v[88:91], v[224:239]
    v_mfma_f32_32x32x16_bf16 v[240:255], a[140:143], v[92:95], v[240:255]
    s_waitcnt lgkmcnt(0)
    v_mfma_f32_32x32x16_bf16 v[128:143], a[144:147], v[64:67], v[128:143]
    ds_read_b64_tr_b16 v[80:81], v24 offset:12288
    ds_read_b64_tr_b16 v[82:83], v24 offset:13312
    v_mfma_f32_32x32x16_bf16 v[144:159], a[144:147], v[68:71], v[144:159]
    ds_read_b64_tr_b16 v[84:85], v25 offset:12288
    ds_read_b64_tr_b16 v[86:87], v25 offset:13312
    v_mfma_f32_32x32x16_bf16 v[160:175], a[144:147], v[72:75], v[160:175]
    ds_read_b64_tr_b16 v[88:89], v26 offset:12288
    ds_read_b64_tr_b16 v[90:91], v26 offset:13312
    v_mfma_f32_32x32x16_bf16 v[176:191], a[144:147], v[76:79], v[176:191]
    ds_read_b64_tr_b16 v[92:93], v27 offset:12288
    ds_read_b64_tr_b16 v[94:95], v27 offset:13312
    v_mfma_f32_32x32x16_bf16 v[192:207], a[148:151], v[64:67], v[192:207]
    v_mfma_f32_32x32x16_bf16 v[208:223], a[148:151], v[68:71], v[208:223]
    s_add_u32 m0, s70, 8192
    v_add_u32 v2, 2359296, v12
    global_load_lds_dwordx4 v2, s[72:73]
    v_mfma_f32_32x32x16_bf16 v[224:239], a[148:151], v[72:75], v[224:239]
    v_mfma_f32_32x32x16_bf16 v[240:255], a[148:151], v[76:79], v[240:255]
    s_waitcnt lgkmcnt(0)
    v_mfma_f32_32x32x16_bf16 v[128:143], a[152:155], v[80:83], v[128:143]
    ds_read_b64_tr_b16 v[64:65], v24 offset:16384
    ds_read_b64_tr_b16 v[66:67], v24 offset:17408
    v_mfma_f32_32x32x16_bf16 v[144:159], a[152:155], v[84:87], v[144:159]
    ds_read_b64_tr_b16 v[68:69], v25 offset:16384
    ds_read_b64_tr_b16 v[70:71], v25 offset:17408
    v_mfma_f32_32x32x16_bf16 v[160:175], a[152:155], v[88:91], v[160:175]
    ds_read_b64_tr_b16 v[72:73], v26 offset:16384
    ds_read_b64_tr_b16 v[74:75], v26 offset:17408
    v_mfma_f32_32x32x16_bf16 v[176:191], a[152:155], v[92:95], v[176:191]
    ds_read_b64_tr_b16 v[76:77], v27 offset:16384
    ds_read_b64_tr_b16 v[78:79], v27 offset:17408
    v_mfma_f32_32x32x16_bf16 v[192:207], a[156:159], v[80:83], v[192:207]
    v_mfma_f32_32x32x16_bf16 v[208:223], a[156:159], v[84:87], v[208:223]
    s_add_u32 m0, s70, 12288
    v_add_u32 v3, 2490368, v12
    global_load_lds_dwordx4 v3, s[72:73]
    v_mfma_f32_32x32x16_bf16 v[224:239], a[156:159], v[88:91], v[224:239]
    v_mfma_f32_32x32x16_bf16 v[240:255], a[156:159], v[92:95], v[240:255]
    s_waitcnt lgkmcnt(0)
    v_mfma_f32_32x32x16_bf16 v[128:143], a[160:163], v[64:67], v[128:143]
    ds_read_b64_tr_b16 v[80:81], v24 offset:20480
    ds_read_b64_tr_b16 v[82:83], v24 offset:21504
    v_mfma_f32_32x32x16_bf16 v[144:159], a[160:163], v[68:71], v[144:159]
    ds_read_b64_tr_b16 v[84:85], v25 offset:20480
    ds_read_b64_tr_b16 v[86:87], v25 offset:21504
    v_mfma_f32_32x32x16_bf16 v[160:175], a[160:163], v[72:75], v[160:175]
    ds_read_b64_tr_b16 v[88:89], v26 offset:20480
    ds_read_b64_tr_b16 v[90:91], v26 offset:21504
    v_mfma_f32_32x32x16_bf16 v[176:191], a[160:163], v[76:79], v[176:191]
    ds_read_b64_tr_b16 v[92:93], v27 offset:20480
    ds_read_b64_tr_b16 v[94:95], v27 offset:21504
    v_mfma_f32_32x32x16_bf16 v[192:207], a[164:167], v[64:67], v[192:207]
    v_mfma_f32_32x32x16_bf16 v[208:223], a[164:167], v[68:71], v[208:223]
    s_add_u32 m0, s70, 16384
    v_add_u32 v2, 2621440, v12
    global_load_lds_dwordx4 v2, s[72:73]
    v_mfma_f32_32x32x16_bf16 v[224:239], a[164:167], v[72:75], v[224:239]
    v_mfma_f32_32x32x16_bf16 v[240:255], a[164:167], v[76:79], v[240:255]
    s_waitcnt lgkmcnt(0)
    v_mfma_f32_32x32x16_bf16 v[128:143], a[168:171], v[80:83], v[128:143]
    ds_read_b64_tr_b16 v[64:65], v24 offset:24576
    ds_read_b64_tr_b16 v[66:67], v24 offset:25600
    v_mfma_f32_32x32x16_bf16 v[144:159], a[168:171], v[84:87], v[144:159]
    ds_read_b64_tr_b16 v[68:69], v25 offset:24576
    ds_read_b64_tr_b16 v[70:71], v25 offset:25600
    v_mfma_f32_32x32x16_bf16 v[160:175], a[168:171], v[88:91], v[160:175]
    ds_read_b64_tr_b16 v[72:73], v26 offset:24576
    ds_read_b64_tr_b16 v[74:75], v26 offset:25600
    v_mfma_f32_32x32x16_bf16 v[176:191], a[168:171], v[92:95], v[176:191]
    ds_read_b64_tr_b16 v[76:77], v27 offset:24576
    ds_read_b64_tr_b16 v[78:79], v27 offset:25600
    v_mfma_f32_32x32x16_bf16 v[192:207], a[172:175], v[80:83], v[192:207]
    v_mfma_f32_32x32x16_bf16 v[208:223], a[172:175], v[84:87], v[208:223]
    s_add_u32 m0, s70, 20480
    v_add_u32 v3, 2752512, v12
    global_load_lds_dwordx4 v3, s[72:73]
    v_mfma_f32_32x32x16_bf16 v[224:239], a[172:175], v[88:91], v[224:239]
    v_mfma_f32_32x32x16_bf16 v[240:255], a[172:175], v[92:95], v[240:255]
    s_waitcnt lgkmcnt(0)
    v_mfma_f32_32x32x16_bf16 v[128:143], a[176:179], v[64:67], v[128:143]
    ds_read_b64_tr_b16 v[80:81], v24 offset:28672
    ds_read_b64_tr_b16 v[82:83], v24 offset:29696
    v_mfma_f32_32x32x16_bf16 v[144:159], a[176:179], v[68:71], v[144:159]
    ds_read_b64_tr_b16 v[84:85], v25 offset:28672
    ds_read_b64_tr_b16 v[86:87], v25 offset:29696
    v_mfma_f32_32x32x16_bf16 v[160:175], a[176:179], v[72:75], v[160:175]
    ds_read_b64_tr_b16 v[88:89], v26 offset:28672
    ds_read_b64_tr_b16 v[90:91], v26 offset:29696
    v_mfma_f32_32x32x16_bf16 v[176:191], a[176:179], v[76:79], v[176:191]
    ds_read_b64_tr_b16 v[92:93], v27 offset:28672
    ds_read_b64_tr_b16 v[94:95], v27 offset:29696
    v_mfma_f32_32x32x16_bf16 v[192:207], a[180:183], v[64:67], v[192:207]
    v_mfma_f32_32x32x16_bf16 v[208:223], a[180:183], v[68:71], v[208:223]
    s_add_u32 m0, s70, 24576
    v_add_u32 v2, 2883584, v12
    global_load_lds_dwordx4 v2, s[72:73]
    v_mfma_f32_32x32x16_bf16 v[224:239], a[180:183], v[72:75], v[224:239]
    v_mfma_f32_32x32x16_bf16 v[240:255], a[180:183], v[76:79], v[240:255]
    s_waitcnt lgkmcnt(0)
    v_mfma_f32_32x32x16_bf16 v[128:143], a[184:187], v[80:83], v[128:143]
    v_mfma_f32_32x32x16_bf16 v[144:159], a[184:187], v[84:87], v[144:159]
    v_mfma_f32_32x32x16_bf16 v[160:175], a[184:187], v[88:91], v[160:175]
    v_mfma_f32_32x32x16_bf16 v[176:191], a[184:187], v[92:95], v[176:191]
    v_mfma_f32_32x32x16_bf16 v[192:207], a[188:191], v[80:83], v[192:207]
    v_mfma_f32_32x32x16_bf16 v[208:223], a[188:191], v[84:87], v[208:223]
    s_add_u32 m0, s70, 28672
    v_add_u32 v3, 3014656, v12
    global_load_lds_dwordx4 v3, s[72:73]
    v_mfma_f32_32x32x16_bf16 v[224:239], a[188:191], v[88:91], v[224:239]
    v_mfma_f32_32x32x16_bf16 v[240:255], a[188:191], v[92:95], v[240:255]
    s_waitcnt vmcnt(40)
    s_barrier
    v_add_u32 v24, 65536, v8
    v_add_u32 v25, 65536, v9
    v_add_u32 v26, 65536, v10
    v_add_u32 v27, 65536, v11
    ds_read_b64_tr_b16 v[64:65], v24 offset:0
    ds_read_b64_tr_b16 v[66:67], v24 offset:1024
    ds_read_b64_tr_b16 v[68:69], v25 offset:0
    ds_read_b64_tr_b16 v[70:71], v25 offset:1024
    ds_read_b64_tr_b16 v[72:73], v26 offset:0
    ds_read_b64_tr_b16 v[74:75], v26 offset:1024
    ds_read_b64_tr_b16 v[76:77], v27 offset:0
    ds_read_b64_tr_b16 v[78:79], v27 offset:1024
    s_waitcnt lgkmcnt(0)
    v_mfma_f32_32x32x16_bf16 v[128:143], a[192:195], v[64:67], v[128:143]
    ds_read_b64_tr_b16 v[80:81], v24 offset:4096
    ds_read_b64_tr_b16 v[82:83], v24 offset:5120
    v_mfma_f32_32x32x16_bf16 v[144:159], a[192:195], v[68:71], v[144:159]
    ds_read_b64_tr_b16 v[84:85], v25 offset:4096
    ds_read_b64_tr_b16 v[86:87], v25 offset:5120
    v_mfma_f32_32x32x16_bf16 v[160:175], a[192:195], v[72:75], v[160:175]
    ds_read_b64_tr_b16 v[88:89], v26 offset:4096
    ds_read_b64_tr_b16 v[90:91], v26 offset:5120
    v_mfma_f32_32x32x16_bf16 v[176:191], a[192:195], v[76:79], v[176:191]
    ds_read_b64_tr_b16 v[92:93], v27 offset:4096
    ds_read_b64_tr_b16 v[94:95], v27 offset:5120
    v_mfma_f32_32x32x16_bf16 v[192:207], a[196:199], v[64:67], v[192:207]
    v_mfma_f32_32x32x16_bf16 v[208:223], a[196:199], v[68:71], v[208:223]
    s_add_u32 m0, s70, 32768
    v_add_u32 v2, 3145728, v12
    global_load_lds_dwordx4 v2, s[72:73]
    v_mfma_f32_32x32x16_bf16 v[224:239], a[196:199], v[72:75], v[224:239]
    v_mfma_f32_32x32x16_bf16 v[240:255], a[196:199], v[76:79], v[240:255]
    s_waitcnt lgkmcnt(0)
    v_mfma_f32_32x32x16_bf16 v[128:143], a[200:203], v[80:83], v[128:143]
    ds_read_b64_tr_b16 v[64:65], v24 offset:8192
    ds_read_b64_tr_b16 v[66:67], v24 offset:9216
    v_mfma_f32_32x32x16_bf16 v[144:159], a[200:203], v[84:87], v[144:159]
    ds_read_b64_tr_b16 v[68:69], v25 offset:8192
    ds_read_b64_tr_b16 v[70:71], v25 offset:9216
    v_mfma_f32_32x32x16_bf16 v[160:175], a[200:203], v[88:91], v[160:175]
    ds_read_b64_tr_b16 v[72:73], v26 offset:8192
    ds_read_b64_tr_b16 v[74:75], v26 offset:9216
    v_mfma_f32_32x32x16_bf16 v[176:191], a[200:203], v[92:95], v[176:191]
    ds_read_b64_tr_b16 v[76:77], v27 offset:8192
    ds_read_b64_tr_b16 v[78:79], v27 offset:9216
    v_mfma_f32_32x32x16_bf16 v[192:207], a[204:207], v[80:83], v[192:207]
    v_mfma_f32_32x32x16_bf16 v[208:223], a[204:207], v[84:87], v[208:223]
    s_add_u32 m0, s70, 36864
    v_add_u32 v3, 3276800, v12
    global_load_lds_dwordx4 v3, s[72:73]
    v_mfma_f32_32x32x16_bf16 v[224:239], a[204:207], v[88:91], v[224:239]
    v_mfma_f32_32x32x16_bf16 v[240:255], a[204:207], v[92:95], v[240:255]
    s_waitcnt lgkmcnt(0)
    v_mfma_f32_32x32x16_bf16 v[128:143], a[208:211], v[64:67], v[128:143]
    ds_read_b64_tr_b16 v[80:81], v24 offset:12288
    ds_read_b64_tr_b16 v[82:83], v24 offset:13312
    v_mfma_f32_32x32x16_bf16 v[144:159], a[208:211], v[68:71], v[144:159]
    ds_read_b64_tr_b16 v[84:85], v25 offset:12288
    ds_read_b64_tr_b16 v[86:87], v25 offset:13312
    v_mfma_f32_32x32x16_bf16 v[160:175], a[208:211], v[72:75], v[160:175]
    ds_read_b64_tr_b16 v[88:89], v26 offset:12288
    ds_read_b64_tr_b16 v[90:91], v26 offset:13312
    v_mfma_f32_32x32x16_bf16 v[176:191], a[208:211], v[76:79], v[176:191]
    ds_read_b64_tr_b16 v[92:93], v27 offset:12288
    ds_read_b64_tr_b16 v[94:95], v27 offset:13312
    v_mfma_f32_32x32x16_bf16 v[192:207], a[212:215], v[64:67], v[192:207]
    v_mfma_f32_32x32x16_bf16 v[208:223], a[212:215], v[68:71], v[208:223]
    s_add_u32 m0, s70, 40960
    v_add_u32 v2, 3407872, v12
    global_load_lds_dwordx4 v2, s[72:73]
    v_mfma_f32_32x32x16_bf16 v[224:239], a[212:215], v[72:75], v[224:239]
    v_mfma_f32_32x32x16_bf16 v[240:255], a[212:215], v[76:79], v[240:255]
    s_waitcnt lgkmcnt(0)
    v_mfma_f32_32x32x16_bf16 v[128:143], a[216:219], v[80:83], v[128:143]
    ds_read_b64_tr_b16 v[64:65], v24 offset:16384
    ds_read_b64_tr_b16 v[66:67], v24 offset:17408
    v_mfma_f32_32x32x16_bf16 v[144:159], a[216:219], v[84:87], v[144:159]
    ds_read_b64_tr_b16 v[68:69], v25 offset:16384
    ds_read_b64_tr_b16 v[70:71], v25 offset:17408
    v_mfma_f32_32x32x16_bf16 v[160:175], a[216:219], v[88:91], v[160:175]
    ds_read_b64_tr_b16 v[72:73], v26 offset:16384
    ds_read_b64_tr_b16 v[74:75], v26 offset:17408
    v_mfma_f32_32x32x16_bf16 v[176:191], a[216:219], v[92:95], v[176:191]
    ds_read_b64_tr_b16 v[76:77], v27 offset:16384
    ds_read_b64_tr_b16 v[78:79], v27 offset:17408
    v_mfma_f32_32x32x16_bf16 v[192:207], a[220:223], v[80:83], v[192:207]
    v_mfma_f32_32x32x16_bf16 v[208:223], a[220:223], v[84:87], v[208:223]
    s_add_u32 m0, s70, 45056
    v_add_u32 v3, 3538944, v12
    global_load_lds_dwordx4 v3, s[72:73]
    v_mfma_f32_32x32x16_bf16 v[224:239], a[220:223], v[88:91], v[224:239]
    v_mfma_f32_32x32x16_bf16 v[240:255], a[220:223], v[92:95], v[240:255]
    s_waitcnt lgkmcnt(0)
    v_mfma_f32_32x32x16_bf16 v[128:143], a[224:227], v[64:67], v[128:143]
    ds_read_b64_tr_b16 v[80:81], v24 offset:20480
    ds_read_b64_tr_b16 v[82:83], v24 offset:21504
    v_mfma_f32_32x32x16_bf16 v[144:159], a[224:227], v[68:71], v[144:159]
    ds_read_b64_tr_b16 v[84:85], v25 offset:20480
    ds_read_b64_tr_b16 v[86:87], v25 offset:21504
    v_mfma_f32_32x32x16_bf16 v[160:175], a[224:227], v[72:75], v[160:175]
    ds_read_b64_tr_b16 v[88:89], v26 offset:20480
    ds_read_b64_tr_b16 v[90:91], v26 offset:21504
    v_mfma_f32_32x32x16_bf16 v[176:191], a[224:227], v[76:79], v[176:191]
    ds_read_b64_tr_b16 v[92:93], v27 offset:20480
    ds_read_b64_tr_b16 v[94:95], v27 offset:21504
    v_mfma_f32_32x32x16_bf16 v[192:207], a[228:231], v[64:67], v[192:207]
    v_mfma_f32_32x32x16_bf16 v[208:223], a[228:231], v[68:71], v[208:223]
    s_add_u32 m0, s70, 49152
    v_add_u32 v2, 3670016, v12
    global_load_lds_dwordx4 v2, s[72:73]
    v_mfma_f32_32x32x16_bf16 v[224:239], a[228:231], v[72:75], v[224:239]
    v_mfma_f32_32x32x16_bf16 v[240:255], a[228:231], v[76:79], v[240:255]
    s_waitcnt lgkmcnt(0)
    v_mfma_f32_32x32x16_bf16 v[128:143], a[232:235], v[80:83], v[128:143]
    ds_read_b64_tr_b16 v[64:65], v24 offset:24576
    ds_read_b64_tr_b16 v[66:67], v24 offset:25600
    v_mfma_f32_32x32x16_bf16 v[144:159], a[232:235], v[84:87], v[144:159]
    ds_read_b64_tr_b16 v[68:69], v25 offset:24576
    ds_read_b64_tr_b16 v[70:71], v25 offset:25600
    v_mfma_f32_32x32x16_bf16 v[160:175], a[232:235], v[88:91], v[160:175]
    ds_read_b64_tr_b16 v[72:73], v26 offset:24576
    ds_read_b64_tr_b16 v[74:75], v26 offset:25600
    v_mfma_f32_32x32x16_bf16 v[176:191], a[232:235], v[92:95], v[176:191]
    ds_read_b64_tr_b16 v[76:77], v27 offset:24576
    ds_read_b64_tr_b16 v[78:79], v27 offset:25600
    v_mfma_f32_32x32x16_bf16 v[192:207], a[236:239], v[80:83], v[192:207]
    v_mfma_f32_32x32x16_bf16 v[208:223], a[236:239], v[84:87], v[208:223]
    s_add_u32 m0, s70, 53248
    v_add_u32 v3, 3801088, v12
    global_load_lds_dwordx4 v3, s[72:73]
    v_mfma_f32_32x32x16_bf16 v[224:239], a[236:239], v[88:91], v[224:239]
    v_mfma_f32_32x32x16_bf16 v[240:255], a[236:239], v[92:95], v[240:255]
    s_waitcnt lgkmcnt(0)
    v_mfma_f32_32x32x16_bf16 v[128:143], a[240:243], v[64:67], v[128:143]
    ds_read_b64_tr_b16 v[80:81], v24 offset:28672
    ds_read_b64_tr_b16 v[82:83], v24 offset:29696
    v_mfma_f32_32x32x16_bf16 v[144:159], a[240:243], v[68:71], v[144:159]
    ds_read_b64_tr_b16 v[84:85], v25 offset:28672
    ds_read_b64_tr_b16 v[86:87], v25 offset:29696
    v_mfma_f32_32x32x16_bf16 v[160:175], a[240:243], v[72:75], v[160:175]
    ds_read_b64_tr_b16 v[88:89], v26 offset:28672
    ds_read_b64_tr_b16 v[90:91], v26 offset:29696
    v_mfma_f32_32x32x16_bf16 v[176:191], a[240:243], v[76:79], v[176:191]
    ds_read_b64_tr_b16 v[92:93], v27 offset:28672
    ds_read_b64_tr_b16 v[94:95], v27 offset:29696
    v_mfma_f32_32x32x16_bf16 v[192:207], a[244:247], v[64:67], v[192:207]
    v_mfma_f32_32x32x16_bf16 v[208:223], a[244:247], v[68:71], v[208:223]
    s_add_u32 m0, s70, 57344
    v_add_u32 v2, 3932160, v12
    global_load_lds_dwordx4 v2, s[72:73]
    v_mfma_f32_32x32x16_bf16 v[224:239], a[244:247], v[72:75], v[224:239]
    v_mfma_f32_32x32x16_bf16 v[240:255], a[244:247], v[76:79], v[240:255]
    s_waitcnt lgkmcnt(0)
    v_mfma_f32_32x32x16_bf16 v[128:143], a[248:251], v[80:83], v[128:143]
    v_mfma_f32_32x32x16_bf16 v[144:159], a[248:251], v[84:87], v[144:159]
    v_mfma_f32_32x32x16_bf16 v[160:175], a[248:251], v[88:91], v[160:175]
    v_mfma_f32_32x32x16_bf16 v[176:191], a[248:251], v[92:95], v[176:191]
    v_mfma_f32_32x32x16_bf16 v[192:207], a[252:255], v[80:83], v[192:207]
    v_mfma_f32_32x32x16_bf16 v[208:223], a[252:255], v[84:87], v[208:223]
    s_add_u32 m0, s70, 61440
    v_add_u32 v3, 4063232, v12
    global_load_lds_dwordx4 v3, s[72:73]
    v_mfma_f32_32x32x16_bf16 v[224:239], a[252:255], v[88:91], v[224:239]
    v_mfma_f32_32x32x16_bf16 v[240:255], a[252:255], v[92:95], v[240:255]
    v_lshl_add_u32 v28, v16, 10, v15
    v_add_u32 v28, 8192, v28
    v_add_u32 v29, 131072, v28
    v_add_u32 v30, 4096, v28
    v_add_u32 v31, 4096, v29
    v_cvt_pk_bf16_f32 v32, v128, v129
    v_cvt_pk_bf16_f32 v33, v130, v131
    v_cvt_pk_bf16_f32 v34, v132, v133
    v_cvt_pk_bf16_f32 v35, v134, v135
    v_cvt_pk_bf16_f32 v36, v136, v137
    v_cvt_pk_bf16_f32 v37, v138, v139
    v_cvt_pk_bf16_f32 v38, v140, v141
    v_cvt_pk_bf16_f32 v39, v142, v143
    global_store_dwordx4 v28, v[32:35], s[68:69] offset:0 sc1
    global_store_dwordx4 v28, v[36:39], s[68:69] offset:512 sc1
    v_cvt_pk_bf16_f32 v40, v144, v145
    v_cvt_pk_bf16_f32 v41, v146, v147
    v_cvt_pk_bf16_f32 v42, v148, v149
    v_cvt_pk_bf16_f32 v43, v150, v151
    v_cvt_pk_bf16_f32 v44, v152, v153
    v_cvt_pk_bf16_f32 v45, v154, v155
    v_cvt_pk_bf16_f32 v46, v156, v157
    v_cvt_pk_bf16_f32 v47, v158, v159
    global_store_dwordx4 v28, v[40:43], s[68:69] offset:2048 sc1
    global_store_dwordx4 v28, v[44:47], s[68:69] offset:2560 sc1
    v_cvt_pk_bf16_f32 v32, v160, v161
    v_cvt_pk_bf16_f32 v33, v162, v163
    v_cvt_pk_bf16_f32 v34, v164, v165
    v_cvt_pk_bf16_f32 v35, v166, v167
    v_cvt_pk_bf16_f32 v36, v168, v169
    v_cvt_pk_bf16_f32 v37, v170, v171
    v_cvt_pk_bf16_f32 v38, v172, v173
    v_cvt_pk_bf16_f32 v39, v174, v175
    global_store_dwordx4 v30, v[32:35], s[68:69] offset:0 sc1
    global_store_dwordx4 v30, v[36:39], s[68:69] offset:512 sc1
    v_cvt_pk_bf16_f32 v40, v176, v177
    v_cvt_pk_bf16_f32 v41, v178, v179
    v_cvt_pk_bf16_f32 v42, v180, v181
    v_cvt_pk_bf16_f32 v43, v182, v183
    v_cvt_pk_bf16_f32 v44, v184, v185
    v_cvt_pk_bf16_f32 v45, v186, v187
    v_cvt_pk_bf16_f32 v46, v188, v189
    v_cvt_pk_bf16_f32 v47, v190, v191
    global_store_dwordx4 v30, v[40:43], s[68:69] offset:2048 sc1
    global_store_dwordx4 v30, v[44:47], s[68:69] offset:2560 sc1
    v_cvt_pk_bf16_f32 v32, v192, v193
    v_cvt_pk_bf16_f32 v33, v194, v195
    v_cvt_pk_bf16_f32 v34, v196, v197
    v_cvt_pk_bf16_f32 v35, v198, v199
    v_cvt_pk_bf16_f32 v36, v200, v201
    v_cvt_pk_bf16_f32 v37, v202, v203
    v_cvt_pk_bf16_f32 v38, v204, v205
    v_cvt_pk_bf16_f32 v39, v206, v207
    global_store_dwordx4 v29, v[32:35], s[68:69] offset:0 sc1
    global_store_dwordx4 v29, v[36:39], s[68:69] offset:512 sc1
    v_cvt_pk_bf16_f32 v40, v208, v209
    v_cvt_pk_bf16_f32 v41, v210, v211
    v_cvt_pk_bf16_f32 v42, v212, v213
    v_cvt_pk_bf16_f32 v43, v214, v215
    v_cvt_pk_bf16_f32 v44, v216, v217
    v_cvt_pk_bf16_f32 v45, v218, v219
    v_cvt_pk_bf16_f32 v46, v220, v221
    v_cvt_pk_bf16_f32 v47, v222, v223
    global_store_dwordx4 v29, v[40:43], s[68:69] offset:2048 sc1
    global_store_dwordx4 v29, v[44:47], s[68:69] offset:2560 sc1
    v_cvt_pk_bf16_f32 v32, v224, v225
    v_cvt_pk_bf16_f32 v33, v226, v227
    v_cvt_pk_bf16_f32 v34, v228, v229
    v_cvt_pk_bf16_f32 v35, v230, v231
    v_cvt_pk_bf16_f32 v36, v232, v233
    v_cvt_pk_bf16_f32 v37, v234, v235
    v_cvt_pk_bf16_f32 v38, v236, v237
    v_cvt_pk_bf16_f32 v39, v238, v239
    global_store_dwordx4 v31, v[32:35], s[68:69] offset:0 sc1
    global_store_dwordx4 v31, v[36:39], s[68:69] offset:512 sc1
    v_cvt_pk_bf16_f32 v40, v240, v241
    v_cvt_pk_bf16_f32 v41, v242, v243
    v_cvt_pk_bf16_f32 v42, v244, v245
    v_cvt_pk_bf16_f32 v43, v246, v247
    v_cvt_pk_bf16_f32 v44, v248, v249
    v_cvt_pk_bf16_f32 v45, v250, v251
    v_cvt_pk_bf16_f32 v46, v252, v253
    v_cvt_pk_bf16_f32 v47, v254, v255
    global_store_dwordx4 v31, v[40:43], s[68:69] offset:2048 sc1
    global_store_dwordx4 v31, v[44:47], s[68:69] offset:2560 sc1
    v_mov_b64 v[128:129], 0
    v_mov_b64 v[130:131], 0
    v_mov_b64 v[132:133], 0
    v_mov_b64 v[134:135], 0
    v_mov_b64 v[136:137], 0
    v_mov_b64 v[138:139], 0
    v_mov_b64 v[140:141], 0
    v_mov_b64 v[142:143], 0
    v_mov_b64 v[144:145], 0
    v_mov_b64 v[146:147], 0
    v_mov_b64 v[148:149], 0
    v_mov_b64 v[150:151], 0
    v_mov_b64 v[152:153], 0
    v_mov_b64 v[154:155], 0
    v_mov_b64 v[156:157], 0
    v_mov_b64 v[158:159], 0
    v_mov_b64 v[160:161], 0
    v_mov_b64 v[162:163], 0
    v_mov_b64 v[164:165], 0
    v_mov_b64 v[166:167], 0
    v_mov_b64 v[168:169], 0
    v_mov_b64 v[170:171], 0
    v_mov_b64 v[172:173], 0
    v_mov_b64 v[174:175], 0
    v_mov_b64 v[176:177], 0
    v_mov_b64 v[178:179], 0
    v_mov_b64 v[180:181], 0
    v_mov_b64 v[182:183], 0
    v_mov_b64 v[184:185], 0
    v_mov_b64 v[186:187], 0
    v_mov_b64 v[188:189], 0
    v_mov_b64 v[190:191], 0
    v_mov_b64 v[192:193], 0
    v_mov_b64 v[194:195], 0
    v_mov_b64 v[196:197], 0
    v_mov_b64 v[198:199], 0
    v_mov_b64 v[200:201], 0
    v_mov_b64 v[202:203], 0
    v_mov_b64 v[204:205], 0
    v_mov_b64 v[206:207], 0
    v_mov_b64 v[208:209], 0
    v_mov_b64 v[210:211], 0
    v_mov_b64 v[212:213], 0
    v_mov_b64 v[214:215], 0
    v_mov_b64 v[216:217], 0
    v_mov_b64 v[218:219], 0
    v_mov_b64 v[220:221], 0
    v_mov_b64 v[222:223], 0
    v_mov_b64 v[224:225], 0
    v_mov_b64 v[226:227], 0
    v_mov_b64 v[228:229], 0
    v_mov_b64 v[230:231], 0
    v_mov_b64 v[232:233], 0
    v_mov_b64 v[234:235], 0
    v_mov_b64 v[236:237], 0
    v_mov_b64 v[238:239], 0
    v_mov_b64 v[240:241], 0
    v_mov_b64 v[242:243], 0
    v_mov_b64 v[244:245], 0
    v_mov_b64 v[246:247], 0
    v_mov_b64 v[248:249], 0
    v_mov_b64 v[250:251], 0
    v_mov_b64 v[252:253], 0
    v_mov_b64 v[254:255], 0
    s_waitcnt vmcnt(40)
    s_barrier
    v_add_u32 v24, 98304, v8
    v_add_u32 v25, 98304, v9
    v_add_u32 v26, 98304, v10
    v_add_u32 v27, 98304, v11
    ds_read_b64_tr_b16 v[64:65], v24 offset:0
    ds_read_b64_tr_b16 v[66:67], v24 offset:1024
    ds_read_b64_tr_b16 v[68:69], v25 offset:0
    ds_read_b64_tr_b16 v[70:71], v25 offset:1024
    ds_read_b64_tr_b16 v[72:73], v26 offset:0
    ds_read_b64_tr_b16 v[74:75], v26 offset:1024
    ds_read_b64_tr_b16 v[76:77], v27 offset:0
    ds_read_b64_tr_b16 v[78:79], v27 offset:1024
    s_waitcnt lgkmcnt(0)
    v_mfma_f32_32x32x16_bf16 v[128:143], v[64:67], a[0:3], v[128:143]
    ds_read_b64_tr_b16 v[80:81], v24 offset:4096
    ds_read_b64_tr_b16 v[82:83], v24 offset:5120
    v_mfma_f32_32x32x16_bf16 v[144:159], v[68:71], a[0:3], v[144:159]
    ds_read_b64_tr_b16 v[84:85], v25 offset:4096
    ds_read_b64_tr_b16 v[86:87], v25 offset:5120
    v_mfma_f32_32x32x16_bf16 v[160:175], v[72:75], a[0:3], v[160:175]
    ds_read_b64_tr_b16 v[88:89], v26 offset:4096
    ds_read_b64_tr_b16 v[90:91], v26 offset:5120
    v_mfma_f32_32x32x16_bf16 v[176:191], v[76:79], a[0:3], v[176:191]
    ds_read_b64_tr_b16 v[92:93], v27 offset:4096
    ds_read_b64_tr_b16 v[94:95], v27 offset:5120
    v_mfma_f32_32x32x16_bf16 v[192:207], v[64:67], a[4:7], v[192:207]
    v_mfma_f32_32x32x16_bf16 v[208:223], v[68:71], a[4:7], v[208:223]
    v_mfma_f32_32x32x16_bf16 v[224:239], v[72:75], a[4:7], v[224:239]
    v_mfma_f32_32x32x16_bf16 v[240:255], v[76:79], a[4:7], v[240:255]
    s_waitcnt lgkmcnt(0)
    v_mfma_f32_32x32x16_bf16 v[128:143], v[80:83], a[8:11], v[128:143]
    ds_read_b64_tr_b16 v[64:65], v24 offset:8192
    ds_read_b64_tr_b16 v[66:67], v24 offset:9216
    v_mfma_f32_32x32x16_bf16 v[144:159], v[84:87], a[8:11], v[144:159]
    ds_read_b64_tr_b16 v[68:69], v25 offset:8192
    ds_read_b64_tr_b16 v[70:71], v25 offset:9216
    v_mfma_f32_32x32x16_bf16 v[160:175], v[88:91], a[8:11], v[160:175]
    ds_read_b64_tr_b16 v[72:73], v26 offset:8192
    ds_read_b64_tr_b16 v[74:75], v26 offset:9216
    v_mfma_f32_32x32x16_bf16 v[176:191], v[92:95], a[8:11], v[176:191]
    ds_read_b64_tr_b16 v[76:77], v27 offset:8192
    ds_read_b64_tr_b16 v[78:79], v27 offset:9216
    v_mfma_f32_32x32x16_bf16 v[192:207], v[80:83], a[12:15], v[192:207]
    v_mfma_f32_32x32x16_bf16 v[208:223], v[84:87], a[12:15], v[208:223]
    v_mfma_f32_32x32x16_bf16 v[224:239], v[88:91], a[12:15], v[224:239]
    v_mfma_f32_32x32x16_bf16 v[240:255], v[92:95], a[12:15], v[240:255]
    s_waitcnt lgkmcnt(0)
    v_mfma_f32_32x32x16_bf16 v[128:143], v[64:67], a[16:19], v[128:143]
    ds_read_b64_tr_b16 v[80:81], v24 offset:12288
    ds_read_b64_tr_b16 v[82:83], v24 offset:13312
    v_mfma_f32_32x32x16_bf16 v[144:159], v[68:71], a[16:19], v[144:159]
    ds_read_b64_tr_b16 v[84:85], v25 offset:12288
    ds_read_b64_tr_b16 v[86:87], v25 offset:13312
    v_mfma_f32_32x32x16_bf16 v[160:175], v[72:75], a[16:19], v[160:175]
    ds_read_b64_tr_b16 v[88:89], v26 offset:12288
    ds_read_b64_tr_b16 v[90:91], v26 offset:13312
    v_mfma_f32_32x32x16_bf16 v[176:191], v[76:79], a[16:19], v[176:191]
    ds_read_b64_tr_b16 v[92:93], v27 offset:12288
    ds_read_b64_tr_b16 v[94:95], v27 offset:13312
    v_mfma_f32_32x32x16_bf16 v[192:207], v[64:67], a[20:23], v[192:207]
    v_mfma_f32_32x32x16_bf16 v[208:223], v[68:71], a[20:23], v[208:223]
    v_mfma_f32_32x32x16_bf16 v[224:239], v[72:75], a[20:23], v[224:239]
    v_mfma_f32_32x32x16_bf16 v[240:255], v[76:79], a[20:23], v[240:255]
    s_waitcnt lgkmcnt(0)
    v_mfma_f32_32x32x16_bf16 v[128:143], v[80:83], a[24:27], v[128:143]
    ds_read_b64_tr_b16 v[64:65], v24 offset:16384
    ds_read_b64_tr_b16 v[66:67], v24 offset:17408
    v_mfma_f32_32x32x16_bf16 v[144:159], v[84:87], a[24:27], v[144:159]
    ds_read_b64_tr_b16 v[68:69], v25 offset:16384
    ds_read_b64_tr_b16 v[70:71], v25 offset:17408
    v_mfma_f32_32x32x16_bf16 v[160:175], v[88:91], a[24:27], v[160:175]
    ds_read_b64_tr_b16 v[72:73], v26 offset:16384
    ds_read_b64_tr_b16 v[74:75], v26 offset:17408
    v_mfma_f32_32x32x16_bf16 v[176:191], v[92:95], a[24:27], v[176:191]
    ds_read_b64_tr_b16 v[76:77], v27 offset:16384
    ds_read_b64_tr_b16 v[78:79], v27 offset:17408
    v_mfma_f32_32x32x16_bf16 v[192:207], v[80:83], a[28:31], v[192:207]
    v_mfma_f32_32x32x16_bf16 v[208:223], v[84:87], a[28:31], v[208:223]
    v_mfma_f32_32x32x16_bf16 v[224:239], v[88:91], a[28:31], v[224:239]
    v_mfma_f32_32x32x16_bf16 v[240:255], v[92:95], a[28:31], v[240:255]
    s_waitcnt lgkmcnt(0)
    v_mfma_f32_32x32x16_bf16 v[128:143], v[64:67], a[32:35], v[128:143]
    ds_read_b64_tr_b16 v[80:81], v24 offset:20480
    ds_read_b64_tr_b16 v[82:83], v24 offset:21504
    v_mfma_f32_32x32x16_bf16 v[144:159], v[68:71], a[32:35], v[144:159]
    ds_read_b64_tr_b16 v[84:85], v25 offset:20480
    ds_read_b64_tr_b16 v[86:87], v25 offset:21504
    v_mfma_f32_32x32x16_bf16 v[160:175], v[72:75], a[32:35], v[160:175]
    ds_read_b64_tr_b16 v[88:89], v26 offset:20480
    ds_read_b64_tr_b16 v[90:91], v26 offset:21504
    v_mfma_f32_32x32x16_bf16 v[176:191], v[76:79], a[32:35], v[176:191]
    ds_read_b64_tr_b16 v[92:93], v27 offset:20480
    ds_read_b64_tr_b16 v[94:95], v27 offset:21504
    v_mfma_f32_32x32x16_bf16 v[192:207], v[64:67], a[36:39], v[192:207]
    v_mfma_f32_32x32x16_bf16 v[208:223], v[68:71], a[36:39], v[208:223]
    v_mfma_f32_32x32x16_bf16 v[224:239], v[72:75], a[36:39], v[224:239]
    v_mfma_f32_32x32x16_bf16 v[240:255], v[76:79], a[36:39], v[240:255]
    s_waitcnt lgkmcnt(0)
    v_mfma_f32_32x32x16_bf16 v[128:143], v[80:83], a[40:43], v[128:143]
    ds_read_b64_tr_b16 v[64:65], v24 offset:24576
    ds_read_b64_tr_b16 v[66:67], v24 offset:25600
    v_mfma_f32_32x32x16_bf16 v[144:159], v[84:87], a[40:43], v[144:159]
    ds_read_b64_tr_b16 v[68:69], v25 offset:24576
    ds_read_b64_tr_b16 v[70:71], v25 offset:25600
    v_mfma_f32_32x32x16_bf16 v[160:175], v[88:91], a[40:43], v[160:175]
    ds_read_b64_tr_b16 v[72:73], v26 offset:24576
    ds_read_b64_tr_b16 v[74:75], v26 offset:25600
    v_mfma_f32_32x32x16_bf16 v[176:191], v[92:95], a[40:43], v[176:191]
    ds_read_b64_tr_b16 v[76:77], v27 offset:24576
    ds_read_b64_tr_b16 v[78:79], v27 offset:25600
    v_mfma_f32_32x32x16_bf16 v[192:207], v[80:83], a[44:47], v[192:207]
    v_mfma_f32_32x32x16_bf16 v[208:223], v[84:87], a[44:47], v[208:223]
    v_mfma_f32_32x32x16_bf16 v[224:239], v[88:91], a[44:47], v[224:239]
    v_mfma_f32_32x32x16_bf16 v[240:255], v[92:95], a[44:47], v[240:255]
    s_waitcnt lgkmcnt(0)
    v_mfma_f32_32x32x16_bf16 v[128:143], v[64:67], a[48:51], v[128:143]
    ds_read_b64_tr_b16 v[80:81], v24 offset:28672
    ds_read_b64_tr_b16 v[82:83], v24 offset:29696
    v_mfma_f32_32x32x16_bf16 v[144:159], v[68:71], a[48:51], v[144:159]
    ds_read_b64_tr_b16 v[84:85], v25 offset:28672
    ds_read_b64_tr_b16 v[86:87], v25 offset:29696
    v_mfma_f32_32x32x16_bf16 v[160:175], v[72:75], a[48:51], v[160:175]
    ds_read_b64_tr_b16 v[88:89], v26 offset:28672
    ds_read_b64_tr_b16 v[90:91], v26 offset:29696
    v_mfma_f32_32x32x16_bf16 v[176:191], v[76:79], a[48:51], v[176:191]
    ds_read_b64_tr_b16 v[92:93], v27 offset:28672
    ds_read_b64_tr_b16 v[94:95], v27 offset:29696
    v_mfma_f32_32x32x16_bf16 v[192:207], v[64:67], a[52:55], v[192:207]
    v_mfma_f32_32x32x16_bf16 v[208:223], v[68:71], a[52:55], v[208:223]
    v_mfma_f32_32x32x16_bf16 v[224:239], v[72:75], a[52:55], v[224:239]
    v_mfma_f32_32x32x16_bf16 v[240:255], v[76:79], a[52:55], v[240:255]
    s_waitcnt lgkmcnt(0)
    v_mfma_f32_32x32x16_bf16 v[128:143], v[80:83], a[56:59], v[128:143]
    v_mfma_f32_32x32x16_bf16 v[144:159], v[84:87], a[56:59], v[144:159]
    v_mfma_f32_32x32x16_bf16 v[160:175], v[88:91], a[56:59], v[160:175]
    v_mfma_f32_32x32x16_bf16 v[176:191], v[92:95], a[56:59], v[176:191]
    v_mfma_f32_32x32x16_bf16 v[192:207], v[80:83], a[60:63], v[192:207]
    v_mfma_f32_32x32x16_bf16 v[208:223], v[84:87], a[60:63], v[208:223]
    v_mfma_f32_32x32x16_bf16 v[224:239], v[88:91], a[60:63], v[224:239]
    v_mfma_f32_32x32x16_bf16 v[240:255], v[92:95], a[60:63], v[240:255]
    s_waitcnt vmcnt(32)
    v_mov_b32 v18, s97
    s_waitcnt vmcnt(0)
    s_mov_b64 exec, 0x3
    global_store_dword v17, v18, s[74:75] offset:256 sc1
    s_mov_b64 exec, -1
    s_barrier
    v_add_u32 v24, 131072, v8
    v_add_u32 v25, 131072, v9
    v_add_u32 v26, 131072, v10
    v_add_u32 v27, 131072, v11
    ds_read_b64_tr_b16 v[64:65], v24 offset:0
    ds_read_b64_tr_b16 v[66:67], v24 offset:1024
    ds_read_b64_tr_b16 v[68:69], v25 offset:0
    ds_read_b64_tr_b16 v[70:71], v25 offset:1024
    ds_read_b64_tr_b16 v[72:73], v26 offset:0
    ds_read_b64_tr_b16 v[74:75], v26 offset:1024
    ds_read_b64_tr_b16 v[76:77], v27 offset:0
    ds_read_b64_tr_b16 v[78:79], v27 offset:1024
    s_waitcnt lgkmcnt(0)
    v_mfma_f32_32x32x16_bf16 v[128:143], v[64:67], a[64:67], v[128:143]
    ds_read_b64_tr_b16 v[80:81], v24 offset:4096
    ds_read_b64_tr_b16 v[82:83], v24 offset:5120
    v_mfma_f32_32x32x16_bf16 v[144:159], v[68:71], a[64:67], v[144:159]
    ds_read_b64_tr_b16 v[84:85], v25 offset:4096
    ds_read_b64_tr_b16 v[86:87], v25 offset:5120
    v_mfma_f32_32x32x16_bf16 v[160:175], v[72:75], a[64:67], v[160:175]
    ds_read_b64_tr_b16 v[88:89], v26 offset:4096
    ds_read_b64_tr_b16 v[90:91], v26 offset:5120
    v_mfma_f32_32x32x16_bf16 v[176:191], v[76:79], a[64:67], v[176:191]
    ds_read_b64_tr_b16 v[92:93], v27 offset:4096
    ds_read_b64_tr_b16 v[94:95], v27 offset:5120
    v_mfma_f32_32x32x16_bf16 v[192:207], v[64:67], a[68:71], v[192:207]
    v_mfma_f32_32x32x16_bf16 v[208:223], v[68:71], a[68:71], v[208:223]
    v_mfma_f32_32x32x16_bf16 v[224:239], v[72:75], a[68:71], v[224:239]
    v_mfma_f32_32x32x16_bf16 v[240:255], v[76:79], a[68:71], v[240:255]
    s_waitcnt lgkmcnt(0)
    v_mfma_f32_32x32x16_bf16 v[128:143], v[80:83], a[72:75], v[128:143]
    ds_read_b64_tr_b16 v[64:65], v24 offset:8192
    ds_read_b64_tr_b16 v[66:67], v24 offset:9216
    v_mfma_f32_32x32x16_bf16 v[144:159], v[84:87], a[72:75], v[144:159]
    ds_read_b64_tr_b16 v[68:69], v25 offset:8192
    ds_read_b64_tr_b16 v[70:71], v25 offset:9216
    v_mfma_f32_32x32x16_bf16 v[160:175], v[88:91], a[72:75], v[160:175]
    ds_read_b64_tr_b16 v[72:73], v26 offset:8192
    ds_read_b64_tr_b16 v[74:75], v26 offset:9216
    v_mfma_f32_32x32x16_bf16 v[176:191], v[92:95], a[72:75], v[176:191]
    ds_read_b64_tr_b16 v[76:77], v27 offset:8192
    ds_read_b64_tr_b16 v[78:79], v27 offset:9216
    v_mfma_f32_32x32x16_bf16 v[192:207], v[80:83], a[76:79], v[192:207]
    v_mfma_f32_32x32x16_bf16 v[208:223], v[84:87], a[76:79], v[208:223]
    v_mfma_f32_32x32x16_bf16 v[224:239], v[88:91], a[76:79], v[224:239]
    v_mfma_f32_32x32x16_bf16 v[240:255], v[92:95], a[76:79], v[240:255]
    s_waitcnt lgkmcnt(0)
    v_mfma_f32_32x32x16_bf16 v[128:143], v[64:67], a[80:83], v[128:143]
    ds_read_b64_tr_b16 v[80:81], v24 offset:12288
    ds_read_b64_tr_b16 v[82:83], v24 offset:13312
    v_mfma_f32_32x32x16_bf16 v[144:159], v[68:71], a[80:83], v[144:159]
    ds_read_b64_tr_b16 v[84:85], v25 offset:12288
    ds_read_b64_tr_b16 v[86:87], v25 offset:13312
    v_mfma_f32_32x32x16_bf16 v[160:175], v[72:75], a[80:83], v[160:175]
    ds_read_b64_tr_b16 v[88:89], v26 offset:12288
    ds_read_b64_tr_b16 v[90:91], v26 offset:13312
    v_mfma_f32_32x32x16_bf16 v[176:191], v[76:79], a[80:83], v[176:191]
    ds_read_b64_tr_b16 v[92:93], v27 offset:12288
    ds_read_b64_tr_b16 v[94:95], v27 offset:13312
    v_mfma_f32_32x32x16_bf16 v[192:207], v[64:67], a[84:87], v[192:207]
    v_mfma_f32_32x32x16_bf16 v[208:223], v[68:71], a[84:87], v[208:223]
    v_mfma_f32_32x32x16_bf16 v[224:239], v[72:75], a[84:87], v[224:239]
    v_mfma_f32_32x32x16_bf16 v[240:255], v[76:79], a[84:87], v[240:255]
    s_waitcnt lgkmcnt(0)
    v_mfma_f32_32x32x16_bf16 v[128:143], v[80:83], a[88:91], v[128:143]
    ds_read_b64_tr_b16 v[64:65], v24 offset:16384
    ds_read_b64_tr_b16 v[66:67], v24 offset:17408
    v_mfma_f32_32x32x16_bf16 v[144:159], v[84:87], a[88:91], v[144:159]
    ds_read_b64_tr_b16 v[68:69], v25 offset:16384
    ds_read_b64_tr_b16 v[70:71], v25 offset:17408
    v_mfma_f32_32x32x16_bf16 v[160:175], v[88:91], a[88:91], v[160:175]
    ds_read_b64_tr_b16 v[72:73], v26 offset:16384
    ds_read_b64_tr_b16 v[74:75], v26 offset:17408
    v_mfma_f32_32x32x16_bf16 v[176:191], v[92:95], a[88:91], v[176:191]
    ds_read_b64_tr_b16 v[76:77], v27 offset:16384
    ds_read_b64_tr_b16 v[78:79], v27 offset:17408
    v_mfma_f32_32x32x16_bf16 v[192:207], v[80:83], a[92:95], v[192:207]
    v_mfma_f32_32x32x16_bf16 v[208:223], v[84:87], a[92:95], v[208:223]
    v_mfma_f32_32x32x16_bf16 v[224:239], v[88:91], a[92:95], v[224:239]
    v_mfma_f32_32x32x16_bf16 v[240:255], v[92:95], a[92:95], v[240:255]
    s_waitcnt lgkmcnt(0)
    v_mfma_f32_32x32x16_bf16 v[128:143], v[64:67], a[96:99], v[128:143]
    ds_read_b64_tr_b16 v[80:81], v24 offset:20480
    ds_read_b64_tr_b16 v[82:83], v24 offset:21504
    v_mfma_f32_32x32x16_bf16 v[144:159], v[68:71], a[96:99], v[144:159]
    ds_read_b64_tr_b16 v[84:85], v25 offset:20480
    ds_read_b64_tr_b16 v[86:87], v25 offset:21504
    v_mfma_f32_32x32x16_bf16 v[160:175], v[72:75], a[96:99], v[160:175]
    ds_read_b64_tr_b16 v[88:89], v26 offset:20480
    ds_read_b64_tr_b16 v[90:91], v26 offset:21504
    v_mfma_f32_32x32x16_bf16 v[176:191], v[76:79], a[96:99], v[176:191]
    ds_read_b64_tr_b16 v[92:93], v27 offset:20480
    ds_read_b64_tr_b16 v[94:95], v27 offset:21504
    v_mfma_f32_32x32x16_bf16 v[192:207], v[64:67], a[100:103], v[192:207]
    v_mfma_f32_32x32x16_bf16 v[208:223], v[68:71], a[100:103], v[208:223]
    v_mfma_f32_32x32x16_bf16 v[224:239], v[72:75], a[100:103], v[224:239]
    v_mfma_f32_32x32x16_bf16 v[240:255], v[76:79], a[100:103], v[240:255]
    s_waitcnt lgkmcnt(0)
    v_mfma_f32_32x32x16_bf16 v[128:143], v[80:83], a[104:107], v[128:143]
    ds_read_b64_tr_b16 v[64:65], v24 offset:24576
    ds_read_b64_tr_b16 v[66:67], v24 offset:25600
    v_mfma_f32_32x32x16_bf16 v[144:159], v[84:87], a[104:107], v[144:159]
    ds_read_b64_tr_b16 v[68:69], v25 offset:24576
    ds_read_b64_tr_b16 v[70:71], v25 offset:25600
    v_mfma_f32_32x32x16_bf16 v[160:175], v[88:91], a[104:107], v[160:175]
    ds_read_b64_tr_b16 v[72:73], v26 offset:24576
    ds_read_b64_tr_b16 v[74:75], v26 offset:25600
    v_mfma_f32_32x32x16_bf16 v[176:191], v[92:95], a[104:107], v[176:191]
    ds_read_b64_tr_b16 v[76:77], v27 offset:24576
    ds_read_b64_tr_b16 v[78:79], v27 offset:25600
    v_mfma_f32_32x32x16_bf16 v[192:207], v[80:83], a[108:111], v[192:207]
    v_mfma_f32_32x32x16_bf16 v[208:223], v[84:87], a[108:111], v[208:223]
    v_mfma_f32_32x32x16_bf16 v[224:239], v[88:91], a[108:111], v[224:239]
    v_mfma_f32_32x32x16_bf16 v[240:255], v[92:95], a[108:111], v[240:255]
    s_waitcnt lgkmcnt(0)
    v_mfma_f32_32x32x16_bf16 v[128:143], v[64:67], a[112:115], v[128:143]
    ds_read_b64_tr_b16 v[80:81], v24 offset:28672
    ds_read_b64_tr_b16 v[82:83], v24 offset:29696
    v_mfma_f32_32x32x16_bf16 v[144:159], v[68:71], a[112:115], v[144:159]
    ds_read_b64_tr_b16 v[84:85], v25 offset:28672
    ds_read_b64_tr_b16 v[86:87], v25 offset:29696
    v_mfma_f32_32x32x16_bf16 v[160:175], v[72:75], a[112:115], v[160:175]
    ds_read_b64_tr_b16 v[88:89], v26 offset:28672
    ds_read_b64_tr_b16 v[90:91], v26 offset:29696
    v_mfma_f32_32x32x16_bf16 v[176:191], v[76:79], a[112:115], v[176:191]
    ds_read_b64_tr_b16 v[92:93], v27 offset:28672
    ds_read_b64_tr_b16 v[94:95], v27 offset:29696
    v_mfma_f32_32x32x16_bf16 v[192:207], v[64:67], a[116:119], v[192:207]
    v_mfma_f32_32x32x16_bf16 v[208:223], v[68:71], a[116:119], v[208:223]
    v_mfma_f32_32x32x16_bf16 v[224:239], v[72:75], a[116:119], v[224:239]
    v_mfma_f32_32x32x16_bf16 v[240:255], v[76:79], a[116:119], v[240:255]
    s_waitcnt lgkmcnt(0)
    v_mfma_f32_32x32x16_bf16 v[128:143], v[80:83], a[120:123], v[128:143]
    v_mfma_f32_32x32x16_bf16 v[144:159], v[84:87], a[120:123], v[144:159]
    v_mfma_f32_32x32x16_bf16 v[160:175], v[88:91], a[120:123], v[160:175]
    v_mfma_f32_32x32x16_bf16 v[176:191], v[92:95], a[120:123], v[176:191]
    v_mfma_f32_32x32x16_bf16 v[192:207], v[80:83], a[124:127], v[192:207]
    v_mfma_f32_32x32x16_bf16 v[208:223], v[84:87], a[124:127], v[208:223]
    v_mfma_f32_32x32x16_bf16 v[224:239], v[88:91], a[124:127], v[224:239]
    v_mfma_f32_32x32x16_bf16 v[240:255], v[92:95], a[124:127], v[240:255]
    s_waitcnt vmcnt(24)
    s_barrier
    v_add_u32 v24, 0, v8
    v_add_u32 v25, 0, v9
    v_add_u32 v26, 0, v10
    v_add_u32 v27, 0, v11
    ds_read_b64_tr_b16 v[64:65], v24 offset:0
    ds_read_b64_tr_b16 v[66:67], v24 offset:1024
    ds_read_b64_tr_b16 v[68:69], v25 offset:0
    ds_read_b64_tr_b16 v[70:71], v25 offset:1024
    ds_read_b64_tr_b16 v[72:73], v26 offset:0
    ds_read_b64_tr_b16 v[74:75], v26 offset:1024
    ds_read_b64_tr_b16 v[76:77], v27 offset:0
    ds_read_b64_tr_b16 v[78:79], v27 offset:1024
    s_waitcnt lgkmcnt(0)
    v_mfma_f32_32x32x16_bf16 v[128:143], v[64:67], a[128:131], v[128:143]
    ds_read_b64_tr_b16 v[80:81], v24 offset:4096
    ds_read_b64_tr_b16 v[82:83], v24 offset:5120
    v_mfma_f32_32x32x16_bf16 v[144:159], v[68:71], a[128:131], v[144:159]
    ds_read_b64_tr_b16 v[84:85], v25 offset:4096
    ds_read_b64_tr_b16 v[86:87], v25 offset:5120
    v_mfma_f32_32x32x16_bf16 v[160:175], v[72:75], a[128:131], v[160:175]
    ds_read_b64_tr_b16 v[88:89], v26 offset:4096
    ds_read_b64_tr_b16 v[90:91], v26 offset:5120
    v_mfma_f32_32x32x16_bf16 v[176:191], v[76:79], a[128:131], v[176:191]
    ds_read_b64_tr_b16 v[92:93], v27 offset:4096
    ds_read_b64_tr_b16 v[94:95], v27 offset:5120
    v_mfma_f32_32x32x16_bf16 v[192:207], v[64:67], a[132:135], v[192:207]
    v_mfma_f32_32x32x16_bf16 v[208:223], v[68:71], a[132:135], v[208:223]
    v_mfma_f32_32x32x16_bf16 v[224:239], v[72:75], a[132:135], v[224:239]
    v_mfma_f32_32x32x16_bf16 v[240:255], v[76:79], a[132:135], v[240:255]
    s_waitcnt lgkmcnt(0)
    v_mfma_f32_32x32x16_bf16 v[128:143], v[80:83], a[136:139], v[128:143]
    ds_read_b64_tr_b16 v[64:65], v24 offset:8192
    ds_read_b64_tr_b16 v[66:67], v24 offset:9216
    v_mfma_f32_32x32x16_bf16 v[144:159], v[84:87], a[136:139], v[144:159]
    ds_read_b64_tr_b16 v[68:69], v25 offset:8192
    ds_read_b64_tr_b16 v[70:71], v25 offset:9216
    v_mfma_f32_32x32x16_bf16 v[160:175], v[88:91], a[136:139], v[160:175]
    ds_read_b64_tr_b16 v[72:73], v26 offset:8192
    ds_read_b64_tr_b16 v[74:75], v26 offset:9216
    v_mfma_f32_32x32x16_bf16 v[176:191], v[92:95], a[136:139], v[176:191]
    ds_read_b64_tr_b16 v[76:77], v27 offset:8192
    ds_read_b64_tr_b16 v[78:79], v27 offset:9216
    v_mfma_f32_32x32x16_bf16 v[192:207], v[80:83], a[140:143], v[192:207]
    v_mfma_f32_32x32x16_bf16 v[208:223], v[84:87], a[140:143], v[208:223]
    v_mfma_f32_32x32x16_bf16 v[224:239], v[88:91], a[140:143], v[224:239]
    v_mfma_f32_32x32x16_bf16 v[240:255], v[92:95], a[140:143], v[240:255]
    s_waitcnt lgkmcnt(0)
    v_mfma_f32_32x32x16_bf16 v[128:143], v[64:67], a[144:147], v[128:143]
    ds_read_b64_tr_b16 v[80:81], v24 offset:12288
    ds_read_b64_tr_b16 v[82:83], v24 offset:13312
    v_mfma_f32_32x32x16_bf16 v[144:159], v[68:71], a[144:147], v[144:159]
    ds_read_b64_tr_b16 v[84:85], v25 offset:12288
    ds_read_b64_tr_b16 v[86:87], v25 offset:13312
    v_mfma_f32_32x32x16_bf16 v[160:175], v[72:75], a[144:147], v[160:175]
    ds_read_b64_tr_b16 v[88:89], v26 offset:12288
    ds_read_b64_tr_b16 v[90:91], v26 offset:13312
    v_mfma_f32_32x32x16_bf16 v[176:191], v[76:79], a[144:147], v[176:191]
    ds_read_b64_tr_b16 v[92:93], v27 offset:12288
    ds_read_b64_tr_b16 v[94:95], v27 offset:13312
    v_mfma_f32_32x32x16_bf16 v[192:207], v[64:67], a[148:151], v[192:207]
    v_mfma_f32_32x32x16_bf16 v[208:223], v[68:71], a[148:151], v[208:223]
    v_mfma_f32_32x32x16_bf16 v[224:239], v[72:75], a[148:151], v[224:239]
    v_mfma_f32_32x32x16_bf16 v[240:255], v[76:79], a[148:151], v[240:255]
    s_waitcnt lgkmcnt(0)
    v_mfma_f32_32x32x16_bf16 v[128:143], v[80:83], a[152:155], v[128:143]
    ds_read_b64_tr_b16 v[64:65], v24 offset:16384
    ds_read_b64_tr_b16 v[66:67], v24 offset:17408
    v_mfma_f32_32x32x16_bf16 v[144:159], v[84:87], a[152:155], v[144:159]
    ds_read_b64_tr_b16 v[68:69], v25 offset:16384
    ds_read_b64_tr_b16 v[70:71], v25 offset:17408
    v_mfma_f32_32x32x16_bf16 v[160:175], v[88:91], a[152:155], v[160:175]
    ds_read_b64_tr_b16 v[72:73], v26 offset:16384
    ds_read_b64_tr_b16 v[74:75], v26 offset:17408
    v_mfma_f32_32x32x16_bf16 v[176:191], v[92:95], a[152:155], v[176:191]
    ds_read_b64_tr_b16 v[76:77], v27 offset:16384
    ds_read_b64_tr_b16 v[78:79], v27 offset:17408
    v_mfma_f32_32x32x16_bf16 v[192:207], v[80:83], a[156:159], v[192:207]
    v_mfma_f32_32x32x16_bf16 v[208:223], v[84:87], a[156:159], v[208:223]
    v_mfma_f32_32x32x16_bf16 v[224:239], v[88:91], a[156:159], v[224:239]
    v_mfma_f32_32x32x16_bf16 v[240:255], v[92:95], a[156:159], v[240:255]
    s_waitcnt lgkmcnt(0)
    v_mfma_f32_32x32x16_bf16 v[128:143], v[64:67], a[160:163], v[128:143]
    ds_read_b64_tr_b16 v[80:81], v24 offset:20480
    ds_read_b64_tr_b16 v[82:83], v24 offset:21504
    v_mfma_f32_32x32x16_bf16 v[144:159], v[68:71], a[160:163], v[144:159]
    ds_read_b64_tr_b16 v[84:85], v25 offset:20480
    ds_read_b64_tr_b16 v[86:87], v25 offset:21504
    v_mfma_f32_32x32x16_bf16 v[160:175], v[72:75], a[160:163], v[160:175]
    ds_read_b64_tr_b16 v[88:89], v26 offset:20480
    ds_read_b64_tr_b16 v[90:91], v26 offset:21504
    v_mfma_f32_32x32x16_bf16 v[176:191], v[76:79], a[160:163], v[176:191]
    ds_read_b64_tr_b16 v[92:93], v27 offset:20480
    ds_read_b64_tr_b16 v[94:95], v27 offset:21504
    v_mfma_f32_32x32x16_bf16 v[192:207], v[64:67], a[164:167], v[192:207]
    v_mfma_f32_32x32x16_bf16 v[208:223], v[68:71], a[164:167], v[208:223]
    v_mfma_f32_32x32x16_bf16 v[224:239], v[72:75], a[164:167], v[224:239]
    v_mfma_f32_32x32x16_bf16 v[240:255], v[76:79], a[164:167], v[240:255]
    s_waitcnt lgkmcnt(0)
    v_mfma_f32_32x32x16_bf16 v[128:143], v[80:83], a[168:171], v[128:143]
    ds_read_b64_tr_b16 v[64:65], v24 offset:24576
    ds_read_b64_tr_b16 v[66:67], v24 offset:25600
    v_mfma_f32_32x32x16_bf16 v[144:159], v[84:87], a[168:171], v[144:159]
    ds_read_b64_tr_b16 v[68:69], v25 offset:24576
    ds_read_b64_tr_b16 v[70:71], v25 offset:25600
    v_mfma_f32_32x32x16_bf16 v[160:175], v[88:91], a[168:171], v[160:175]
    ds_read_b64_tr_b16 v[72:73], v26 offset:24576
    ds_read_b64_tr_b16 v[74:75], v26 offset:25600
    v_mfma_f32_32x32x16_bf16 v[176:191], v[92:95], a[168:171], v[176:191]
    ds_read_b64_tr_b16 v[76:77], v27 offset:24576
    ds_read_b64_tr_b16 v[78:79], v27 offset:25600
    v_mfma_f32_32x32x16_bf16 v[192:207], v[80:83], a[172:175], v[192:207]
    v_mfma_f32_32x32x16_bf16 v[208:223], v[84:87], a[172:175], v[208:223]
    v_mfma_f32_32x32x16_bf16 v[224:239], v[88:91], a[172:175], v[224:239]
    v_mfma_f32_32x32x16_bf16 v[240:255], v[92:95], a[172:175], v[240:255]
    s_waitcnt lgkmcnt(0)
    v_mfma_f32_32x32x16_bf16 v[128:143], v[64:67], a[176:179], v[128:143]
    ds_read_b64_tr_b16 v[80:81], v24 offset:28672
    ds_read_b64_tr_b16 v[82:83], v24 offset:29696
    v_mfma_f32_32x32x16_bf16 v[144:159], v[68:71], a[176:179], v[144:159]
    ds_read_b64_tr_b16 v[84:85], v25 offset:28672
    ds_read_b64_tr_b16 v[86:87], v25 offset:29696
    v_mfma_f32_32x32x16_bf16 v[160:175], v[72:75], a[176:179], v[160:175]
    ds_read_b64_tr_b16 v[88:89], v26 offset:28672
    ds_read_b64_tr_b16 v[90:91], v26 offset:29696
    v_mfma_f32_32x32x16_bf16 v[176:191], v[76:79], a[176:179], v[176:191]
    ds_read_b64_tr_b16 v[92:93], v27 offset:28672
    ds_read_b64_tr_b16 v[94:95], v27 offset:29696
    v_mfma_f32_32x32x16_bf16 v[192:207], v[64:67], a[180:183], v[192:207]
    v_mfma_f32_32x32x16_bf16 v[208:223], v[68:71], a[180:183], v[208:223]
    v_mfma_f32_32x32x16_bf16 v[224:239], v[72:75], a[180:183], v[224:239]
    v_mfma_f32_32x32x16_bf16 v[240:255], v[76:79], a[180:183], v[240:255]
    s_waitcnt lgkmcnt(0)
    v_mfma_f32_32x32x16_bf16 v[128:143], v[80:83], a[184:187], v[128:143]
    v_mfma_f32_32x32x16_bf16 v[144:159], v[84:87], a[184:187], v[144:159]
    v_mfma_f32_32x32x16_bf16 v[160:175], v[88:91], a[184:187], v[160:175]
    v_mfma_f32_32x32x16_bf16 v[176:191], v[92:95], a[184:187], v[176:191]
    v_mfma_f32_32x32x16_bf16 v[192:207], v[80:83], a[188:191], v[192:207]
    v_mfma_f32_32x32x16_bf16 v[208:223], v[84:87], a[188:191], v[208:223]
    v_mfma_f32_32x32x16_bf16 v[224:239], v[88:91], a[188:191], v[224:239]
    v_mfma_f32_32x32x16_bf16 v[240:255], v[92:95], a[188:191], v[240:255]
    s_waitcnt vmcnt(16)
    s_barrier
    v_add_u32 v24, 32768, v8
    v_add_u32 v25, 32768, v9
    v_add_u32 v26, 32768, v10
    v_add_u32 v27, 32768, v11
    ds_read_b64_tr_b16 v[64:65], v24 offset:0
    ds_read_b64_tr_b16 v[66:67], v24 offset:1024
    ds_read_b64_tr_b16 v[68:69], v25 offset:0
    ds_read_b64_tr_b16 v[70:71], v25 offset:1024
    ds_read_b64_tr_b16 v[72:73], v26 offset:0
    ds_read_b64_tr_b16 v[74:75], v26 offset:1024
    ds_read_b64_tr_b16 v[76:77], v27 offset:0
    ds_read_b64_tr_b16 v[78:79], v27 offset:1024
    s_waitcnt lgkmcnt(0)
    v_mfma_f32_32x32x16_bf16 v[128:143], v[64:67], a[192:195], v[128:143]
    ds_read_b64_tr_b16 v[80:81], v24 offset:4096
    ds_read_b64_tr_b16 v[82:83], v24 offset:5120
    v_mfma_f32_32x32x16_bf16 v[144:159], v[68:71], a[192:195], v[144:159]
    ds_read_b64_tr_b16 v[84:85], v25 offset:4096
    ds_read_b64_tr_b16 v[86:87], v25 offset:5120
    v_mfma_f32_32x32x16_bf16 v[160:175], v[72:75], a[192:195], v[160:175]
    ds_read_b64_tr_b16 v[88:89], v26 offset:4096
    ds_read_b64_tr_b16 v[90:91], v26 offset:5120
    v_mfma_f32_32x32x16_bf16 v[176:191], v[76:79], a[192:195], v[176:191]
    ds_read_b64_tr_b16 v[92:93], v27 offset:4096
    ds_read_b64_tr_b16 v[94:95], v27 offset:5120
    v_mfma_f32_32x32x16_bf16 v[192:207], v[64:67], a[196:199], v[192:207]
    v_mfma_f32_32x32x16_bf16 v[208:223], v[68:71], a[196:199], v[208:223]
    v_mfma_f32_32x32x16_bf16 v[224:239], v[72:75], a[196:199], v[224:239]
    v_mfma_f32_32x32x16_bf16 v[240:255], v[76:79], a[196:199], v[240:255]
    s_waitcnt lgkmcnt(0)
    v_mfma_f32_32x32x16_bf16 v[128:143], v[80:83], a[200:203], v[128:143]
    ds_read_b64_tr_b16 v[64:65], v24 offset:8192
    ds_read_b64_tr_b16 v[66:67], v24 offset:9216
    v_mfma_f32_32x32x16_bf16 v[144:159], v[84:87], a[200:203], v[144:159]
    ds_read_b64_tr_b16 v[68:69], v25 offset:8192
    ds_read_b64_tr_b16 v[70:71], v25 offset:9216
    v_mfma_f32_32x32x16_bf16 v[160:175], v[88:91], a[200:203], v[160:175]
    ds_read_b64_tr_b16 v[72:73], v26 offset:8192
    ds_read_b64_tr_b16 v[74:75], v26 offset:9216
    v_mfma_f32_32x32x16_bf16 v[176:191], v[92:95], a[200:203], v[176:191]
    ds_read_b64_tr_b16 v[76:77], v27 offset:8192
    ds_read_b64_tr_b16 v[78:79], v27 offset:9216
    v_mfma_f32_32x32x16_bf16 v[192:207], v[80:83], a[204:207], v[192:207]
    v_mfma_f32_32x32x16_bf16 v[208:223], v[84:87], a[204:207], v[208:223]
    v_mfma_f32_32x32x16_bf16 v[224:239], v[88:91], a[204:207], v[224:239]
    v_mfma_f32_32x32x16_bf16 v[240:255], v[92:95], a[204:207], v[240:255]
    s_waitcnt lgkmcnt(0)
    v_mfma_f32_32x32x16_bf16 v[128:143], v[64:67], a[208:211], v[128:143]
    ds_read_b64_tr_b16 v[80:81], v24 offset:12288
    ds_read_b64_tr_b16 v[82:83], v24 offset:13312
    v_mfma_f32_32x32x16_bf16 v[144:159], v[68:71], a[208:211], v[144:159]
    ds_read_b64_tr_b16 v[84:85], v25 offset:12288
    ds_read_b64_tr_b16 v[86:87], v25 offset:13312
    v_mfma_f32_32x32x16_bf16 v[160:175], v[72:75], a[208:211], v[160:175]
    ds_read_b64_tr_b16 v[88:89], v26 offset:12288
    ds_read_b64_tr_b16 v[90:91], v26 offset:13312
    v_mfma_f32_32x32x16_bf16 v[176:191], v[76:79], a[208:211], v[176:191]
    ds_read_b64_tr_b16 v[92:93], v27 offset:12288
    ds_read_b64_tr_b16 v[94:95], v27 offset:13312
    v_mfma_f32_32x32x16_bf16 v[192:207], v[64:67], a[212:215], v[192:207]
    v_mfma_f32_32x32x16_bf16 v[208:223], v[68:71], a[212:215], v[208:223]
    v_mfma_f32_32x32x16_bf16 v[224:239], v[72:75], a[212:215], v[224:239]
    v_mfma_f32_32x32x16_bf16 v[240:255], v[76:79], a[212:215], v[240:255]
    s_waitcnt lgkmcnt(0)
    v_mfma_f32_32x32x16_bf16 v[128:143], v[80:83], a[216:219], v[128:143]
    ds_read_b64_tr_b16 v[64:65], v24 offset:16384
    ds_read_b64_tr_b16 v[66:67], v24 offset:17408
    v_mfma_f32_32x32x16_bf16 v[144:159], v[84:87], a[216:219], v[144:159]
    ds_read_b64_tr_b16 v[68:69], v25 offset:16384
    ds_read_b64_tr_b16 v[70:71], v25 offset:17408
    v_mfma_f32_32x32x16_bf16 v[160:175], v[88:91], a[216:219], v[160:175]
    ds_read_b64_tr_b16 v[72:73], v26 offset:16384
    ds_read_b64_tr_b16 v[74:75], v26 offset:17408
    v_mfma_f32_32x32x16_bf16 v[176:191], v[92:95], a[216:219], v[176:191]
    ds_read_b64_tr_b16 v[76:77], v27 offset:16384
    ds_read_b64_tr_b16 v[78:79], v27 offset:17408
    v_mfma_f32_32x32x16_bf16 v[192:207], v[80:83], a[220:223], v[192:207]
    v_mfma_f32_32x32x16_bf16 v[208:223], v[84:87], a[220:223], v[208:223]
    v_mfma_f32_32x32x16_bf16 v[224:239], v[88:91], a[220:223], v[224:239]
    v_mfma_f32_32x32x16_bf16 v[240:255], v[92:95], a[220:223], v[240:255]
    s_waitcnt lgkmcnt(0)
    v_mfma_f32_32x32x16_bf16 v[128:143], v[64:67], a[224:227], v[128:143]
    ds_read_b64_tr_b16 v[80:81], v24 offset:20480
    ds_read_b64_tr_b16 v[82:83], v24 offset:21504
    v_mfma_f32_32x32x16_bf16 v[144:159], v[68:71], a[224:227], v[144:159]
    ds_read_b64_tr_b16 v[84:85], v25 offset:20480
    ds_read_b64_tr_b16 v[86:87], v25 offset:21504
    v_mfma_f32_32x32x16_bf16 v[160:175], v[72:75], a[224:227], v[160:175]
    ds_read_b64_tr_b16 v[88:89], v26 offset:20480
    ds_read_b64_tr_b16 v[90:91], v26 offset:21504
    v_mfma_f32_32x32x16_bf16 v[176:191], v[76:79], a[224:227], v[176:191]
    ds_read_b64_tr_b16 v[92:93], v27 offset:20480
    ds_read_b64_tr_b16 v[94:95], v27 offset:21504
    v_mfma_f32_32x32x16_bf16 v[192:207], v[64:67], a[228:231], v[192:207]
    v_mfma_f32_32x32x16_bf16 v[208:223], v[68:71], a[228:231], v[208:223]
    v_mfma_f32_32x32x16_bf16 v[224:239], v[72:75], a[228:231], v[224:239]
    v_mfma_f32_32x32x16_bf16 v[240:255], v[76:79], a[228:231], v[240:255]
    s_waitcnt lgkmcnt(0)
    v_mfma_f32_32x32x16_bf16 v[128:143], v[80:83], a[232:235], v[128:143]
    ds_read_b64_tr_b16 v[64:65], v24 offset:24576
    ds_read_b64_tr_b16 v[66:67], v24 offset:25600
    v_mfma_f32_32x32x16_bf16 v[144:159], v[84:87], a[232:235], v[144:159]
    ds_read_b64_tr_b16 v[68:69], v25 offset:24576
    ds_read_b64_tr_b16 v[70:71], v25 offset:25600
    v_mfma_f32_32x32x16_bf16 v[160:175], v[88:91], a[232:235], v[160:175]
    ds_read_b64_tr_b16 v[72:73], v26 offset:24576
    ds_read_b64_tr_b16 v[74:75], v26 offset:25600
    v_mfma_f32_32x32x16_bf16 v[176:191], v[92:95], a[232:235], v[176:191]
    ds_read_b64_tr_b16 v[76:77], v27 offset:24576
    ds_read_b64_tr_b16 v[78:79], v27 offset:25600
    v_mfma_f32_32x32x16_bf16 v[192:207], v[80:83], a[236:239], v[192:207]
    v_mfma_f32_32x32x16_bf16 v[208:223], v[84:87], a[236:239], v[208:223]
    v_mfma_f32_32x32x16_bf16 v[224:239], v[88:91], a[236:239], v[224:239]
    v_mfma_f32_32x32x16_bf16 v[240:255], v[92:95], a[236:239], v[240:255]
    s_waitcnt lgkmcnt(0)
    v_mfma_f32_32x32x16_bf16 v[128:143], v[64:67], a[240:243], v[128:143]
    ds_read_b64_tr_b16 v[80:81], v24 offset:28672
    ds_read_b64_tr_b16 v[82:83], v24 offset:29696
    v_mfma_f32_32x32x16_bf16 v[144:159], v[68:71], a[240:243], v[144:159]
    ds_read_b64_tr_b16 v[84:85], v25 offset:28672
    ds_read_b64_tr_b16 v[86:87], v25 offset:29696
    v_mfma_f32_32x32x16_bf16 v[160:175], v[72:75], a[240:243], v[160:175]
    ds_read_b64_tr_b16 v[88:89], v26 offset:28672
    ds_read_b64_tr_b16 v[90:91], v26 offset:29696
    v_mfma_f32_32x32x16_bf16 v[176:191], v[76:79], a[240:243], v[176:191]
    ds_read_b64_tr_b16 v[92:93], v27 offset:28672
    ds_read_b64_tr_b16 v[94:95], v27 offset:29696
    v_mfma_f32_32x32x16_bf16 v[192:207], v[64:67], a[244:247], v[192:207]
    v_mfma_f32_32x32x16_bf16 v[208:223], v[68:71], a[244:247], v[208:223]
    v_mfma_f32_32x32x16_bf16 v[224:239], v[72:75], a[244:247], v[224:239]
    v_mfma_f32_32x32x16_bf16 v[240:255], v[76:79], a[244:247], v[240:255]
    s_waitcnt lgkmcnt(0)
    v_mfma_f32_32x32x16_bf16 v[128:143], v[80:83], a[248:251], v[128:143]
    v_mfma_f32_32x32x16_bf16 v[144:159], v[84:87], a[248:251], v[144:159]
    v_mfma_f32_32x32x16_bf16 v[160:175], v[88:91], a[248:251], v[160:175]
    v_mfma_f32_32x32x16_bf16 v[176:191], v[92:95], a[248:251], v[176:191]
    v_mfma_f32_32x32x16_bf16 v[192:207], v[80:83], a[252:255], v[192:207]
    v_mfma_f32_32x32x16_bf16 v[208:223], v[84:87], a[252:255], v[208:223]
    v_mfma_f32_32x32x16_bf16 v[224:239], v[88:91], a[252:255], v[224:239]
    v_mfma_f32_32x32x16_bf16 v[240:255], v[92:95], a[252:255], v[240:255]
    v_lshl_add_u32 v28, v16, 12, v15
    v_add_u32 v28, 16384, v28
    v_add_u32 v29, 131072, v28
    s_nop 1
    v_cvt_pk_bf16_f32 v32, v128, v129
    v_cvt_pk_bf16_f32 v33, v130, v131
    v_cvt_pk_bf16_f32 v34, v132, v133
    v_cvt_pk_bf16_f32 v35, v134, v135
    v_cvt_pk_bf16_f32 v36, v136, v137
    v_cvt_pk_bf16_f32 v37, v138, v139
    v_cvt_pk_bf16_f32 v38, v140, v141
    v_cvt_pk_bf16_f32 v39, v142, v143
    global_store_dwordx4 v28, v[32:35], s[68:69] offset:0 sc1
    global_store_dwordx4 v28, v[36:39], s[68:69] offset:512 sc1
    v_cvt_pk_bf16_f32 v40, v144, v145
    v_cvt_pk_bf16_f32 v41, v146, v147
    v_cvt_pk_bf16_f32 v42, v148, v149
    v_cvt_pk_bf16_f32 v43, v150, v151
    v_cvt_pk_bf16_f32 v44, v152, v153
    v_cvt_pk_bf16_f32 v45, v154, v155
    v_cvt_pk_bf16_f32 v46, v156, v157
    v_cvt_pk_bf16_f32 v47, v158, v159
    global_store_dwordx4 v28, v[40:43], s[68:69] offset:1024 sc1
    global_store_dwordx4 v28, v[44:47], s[68:69] offset:1536 sc1
    v_cvt_pk_bf16_f32 v32, v160, v161
    v_cvt_pk_bf16_f32 v33, v162, v163
    v_cvt_pk_bf16_f32 v34, v164, v165
    v_cvt_pk_bf16_f32 v35, v166, v167
    v_cvt_pk_bf16_f32 v36, v168, v169
    v_cvt_pk_bf16_f32 v37, v170, v171
    v_cvt_pk_bf16_f32 v38, v172, v173
    v_cvt_pk_bf16_f32 v39, v174, v175
    global_store_dwordx4 v28, v[32:35], s[68:69] offset:2048 sc1
    global_store_dwordx4 v28, v[36:39], s[68:69] offset:2560 sc1
    v_cvt_pk_bf16_f32 v40, v176, v177
    v_cvt_pk_bf16_f32 v41, v178, v179
    v_cvt_pk_bf16_f32 v42, v180, v181
    v_cvt_pk_bf16_f32 v43, v182, v183
    v_cvt_pk_bf16_f32 v44, v184, v185
    v_cvt_pk_bf16_f32 v45, v186, v187
    v_cvt_pk_bf16_f32 v46, v188, v189
    v_cvt_pk_bf16_f32 v47, v190, v191
    global_store_dwordx4 v28, v[40:43], s[68:69] offset:3072 sc1
    global_store_dwordx4 v28, v[44:47], s[68:69] offset:3584 sc1
    v_cvt_pk_bf16_f32 v32, v192, v193
    v_cvt_pk_bf16_f32 v33, v194, v195
    v_cvt_pk_bf16_f32 v34, v196, v197
    v_cvt_pk_bf16_f32 v35, v198, v199
    v_cvt_pk_bf16_f32 v36, v200, v201
    v_cvt_pk_bf16_f32 v37, v202, v203
    v_cvt_pk_bf16_f32 v38, v204, v205
    v_cvt_pk_bf16_f32 v39, v206, v207
    global_store_dwordx4 v29, v[32:35], s[68:69] offset:0 sc1
    global_store_dwordx4 v29, v[36:39], s[68:69] offset:512 sc1
    v_cvt_pk_bf16_f32 v40, v208, v209
    v_cvt_pk_bf16_f32 v41, v210, v211
    v_cvt_pk_bf16_f32 v42, v212, v213
    v_cvt_pk_bf16_f32 v43, v214, v215
    v_cvt_pk_bf16_f32 v44, v216, v217
    v_cvt_pk_bf16_f32 v45, v218, v219
    v_cvt_pk_bf16_f32 v46, v220, v221
    v_cvt_pk_bf16_f32 v47, v222, v223
    global_store_dwordx4 v29, v[40:43], s[68:69] offset:1024 sc1
    global_store_dwordx4 v29, v[44:47], s[68:69] offset:1536 sc1
    v_cvt_pk_bf16_f32 v32, v224, v225
    v_cvt_pk_bf16_f32 v33, v226, v227
    v_cvt_pk_bf16_f32 v34, v228, v229
    v_cvt_pk_bf16_f32 v35, v230, v231
    v_cvt_pk_bf16_f32 v36, v232, v233
    v_cvt_pk_bf16_f32 v37, v234, v235
    v_cvt_pk_bf16_f32 v38, v236, v237
    v_cvt_pk_bf16_f32 v39, v238, v239
    global_store_dwordx4 v29, v[32:35], s[68:69] offset:2048 sc1
    global_store_dwordx4 v29, v[36:39], s[68:69] offset:2560 sc1
    v_cvt_pk_bf16_f32 v40, v240, v241
    v_cvt_pk_bf16_f32 v41, v242, v243
    v_cvt_pk_bf16_f32 v42, v244, v245
    v_cvt_pk_bf16_f32 v43, v246, v247
    v_cvt_pk_bf16_f32 v44, v248, v249
    v_cvt_pk_bf16_f32 v45, v250, v251
    v_cvt_pk_bf16_f32 v46, v252, v253
    v_cvt_pk_bf16_f32 v47, v254, v255
    global_store_dwordx4 v29, v[40:43], s[68:69] offset:3072 sc1
    global_store_dwordx4 v29, v[44:47], s[68:69] offset:3584 sc1
    v_mov_b32 v18, s97
    s_waitcnt vmcnt(0)
    s_mov_b64 exec, 0x3
    global_store_dword v17, v18, s[74:75] offset:512 sc1
    s_mov_b64 exec, -1
Lp4:
    s_getpc_b64 s[62:63]
Lpc_75:
    s_sub_u32 s62, s62, Lpc_75-Lp4
    s_subb_u32 s63, s63, 0
    v_lshlrev_b32 v250, 6, v0
    global_load_dword v251, v250, s[62:63]
    v_add_u32 v250, 16384, v250
    global_load_dword v251, v250, s[62:63]
    s_cmp_eq_u32 s96, 2
    s_cselect_b32 s40, 3, s96
    s_cmp_eq_u32 s96, 3
    s_cselect_b32 s40, 2, s40
    s_cmp_lt_u32 s40, 3
    s_cbranch_scc1 Llate
    s_lshl_b32 s96, s8, 2
    s_add_u32 s96, s96, s40
    s_sub_u32 s96, s96, 3
    s_cmp_lt_u32 s96, 64
    s_cbranch_scc0 Lnota
    s_lshr_b32 s8, s96, 2
    s_and_b32 s3, s96, 3
    s_load_dwordx2 s[40:41], s[0:1], 40
    s_lshl_b32 s42, s8, 18
    s_lshl_b32 s43, s9, 8
    s_add_u32 s42, s42, s43
    s_lshl_b32 s44, s9, 15
    s_waitcnt lgkmcnt(0)
    s_add_u32 s40, s40, s42
    s_addc_u32 s41, s41, 0
    s_barrier
    v_and_b32 v16, 63, v0
    v_lshrrev_b32 v17, 5, v16
    v_lshlrev_b32 v17, 11, v17
    v_bfe_u32 v18, v16, 2, 2
    v_lshl_add_u32 v17, v18, 8, v17
    v_bfe_u32 v19, v16, 4, 1
    v_lshl_add_u32 v17, v19, 5, v17
    v_and_b32 v19, 3, v16
    v_lshl_add_u32 v17, v19, 3, v17
    v_add_u32 v17, s44, v17
    v_xor_b32 v19, 0, v18
    v_lshl_add_u32 v20, v19, 6, v17
    v_xor_b32 v19, 1, v18
    v_lshl_add_u32 v21, v19, 6, v17
    v_xor_b32 v19, 2, v18
    v_lshl_add_u32 v22, v19, 6, v17
    v_xor_b32 v19, 3, v18
    v_lshl_add_u32 v23, v19, 6, v17
    v_lshrrev_b32 v17, 4, v16
    v_xor_b32 v18, v18, v17
    v_lshlrev_b32 v17, 10, v17
    v_lshl_add_u32 v17, v18, 6, v17
    v_and_b32 v18, 3, v16
    v_lshl_add_u32 v19, v18, 4, v17
    s_add_u32 m0, s44, 0
    v_add_u32 v17, 0, v19
    global_load_lds_dwordx4 v17, s[40:41]
    s_add_u32 m0, s44, 1024
    v_add_u32 v18, 4096, v19
    global_load_lds_dwordx4 v18, s[40:41]
    s_add_u32 m0, s44, 2048
    v_add_u32 v17, 8192, v19
    global_load_lds_dwordx4 v17, s[40:41]
    s_add_u32 m0, s44, 3072
    v_add_u32 v18, 12288, v19
    global_load_lds_dwordx4 v18, s[40:41]
    s_add_u32 m0, s44, 4096
    v_add_u32 v17, 16384, v19
    global_load_lds_dwordx4 v17, s[40:41]
    s_add_u32 m0, s44, 5120
    v_add_u32 v18, 20480, v19
    global_load_lds_dwordx4 v18, s[40:41]
    s_add_u32 m0, s44, 6144
    v_add_u32 v17, 24576, v19
    global_load_lds_dwordx4 v17, s[40:41]
    s_add_u32 m0, s44, 7168
    v_add_u32 v18, 28672, v19
    global_load_lds_dwordx4 v18, s[40:41]
    s_add_u32 m0, s44, 8192
    v_add_u32 v17, 32768, v19
    global_load_lds_dwordx4 v17, s[40:41]
    s_add_u32 m0, s44, 9216
    v_add_u32 v18, 36864, v19
    global_load_lds_dwordx4 v18, s[40:41]
    s_add_u32 m0, s44, 10240
    v_add_u32 v17, 40960, v19
    global_load_lds_dwordx4 v17, s[40:41]
    s_add_u32 m0, s44, 11264
    v_add_u32 v18, 45056, v19
    global_load_lds_dwordx4 v18, s[40:41]
    s_add_u32 m0, s44, 12288
    v_add_u32 v17, 49152, v19
    global_load_lds_dwordx4 v17, s[40:41]
    s_add_u32 m0, s44, 13312
    v_add_u32 v18, 53248, v19
    global_load_lds_dwordx4 v18, s[40:41]
    s_add_u32 m0, s44, 14336
    v_add_u32 v17, 57344, v19
    global_load_lds_dwordx4 v17, s[40:41]
    s_add_u32 m0, s44, 15360
    v_add_u32 v18, 61440, v19
    global_load_lds_dwordx4 v18, s[40:41]
    s_add_u32 m0, s44, 16384
    v_add_u32 v17, 65536, v19
    global_load_lds_dwordx4 v17, s[40:41]
    s_add_u32 m0, s44, 17408
    v_add_u32 v18, 69632, v19
    global_load_lds_dwordx4 v18, s[40:41]
    s_add_u32 m0, s44, 18432
    v_add_u32 v17, 73728, v19
    global_load_lds_dwordx4 v17, s[40:41]
    s_add_u32 m0, s44, 19456
    v_add_u32 v18, 77824, v19
    global_load_lds_dwordx4 v18, s[40:41]
    s_add_u32 m0, s44, 20480
    v_add_u32 v17, 81920, v19
    global_load_lds_dwordx4 v17, s[40:41]
    s_add_u32 m0, s44, 21504
    v_add_u32 v18, 86016, v19
    global_load_lds_dwordx4 v18, s[40:41]
    s_add_u32 m0, s44, 22528
    v_add_u32 v17, 90112, v19
    global_load_lds_dwordx4 v17, s[40:41]
    s_add_u32 m0, s44, 23552
    v_add_u32 v18, 94208, v19
    global_load_lds_dwordx4 v18, s[40:41]
    s_add_u32 m0, s44, 24576
    v_add_u32 v17, 98304, v19
    global_load_lds_dwordx4 v17, s[40:41]
    s_add_u32 m0, s44, 25600
    v_add_u32 v18, 102400, v19
    global_load_lds_dwordx4 v18, s[40:41]
    s_add_u32 m0, s44, 26624
    v_add_u32 v17, 106496, v19
    global_load_lds_dwordx4 v17, s[40:41]
    s_add_u32 m0, s44, 27648
    v_add_u32 v18, 110592, v19
    global_load_lds_dwordx4 v18, s[40:41]
    s_add_u32 m0, s44, 28672
    v_add_u32 v17, 114688, v19
    global_load_lds_dwordx4 v17, s[40:41]
    s_add_u32 m0, s44, 29696
    v_add_u32 v18, 118784, v19
    global_load_lds_dwordx4 v18, s[40:41]
    s_add_u32 m0, s44, 30720
    v_add_u32 v17, 122880, v19
    global_load_lds_dwordx4 v17, s[40:41]
    s_add_u32 m0, s44, 31744
    v_add_u32 v18, 126976, v19
    global_load_lds_dwordx4 v18, s[40:41]
    s_waitcnt vmcnt(28)
    ds_read_b64_tr_b16 a[0:1], v20 offset:0
    ds_read_b64_tr_b16 a[2:3], v20 offset:1024
    ds_read_b64_tr_b16 a[4:5], v21 offset:0
    ds_read_b64_tr_b16 a[6:7], v21 offset:1024
    ds_read_b64_tr_b16 a[8:9], v22 offset:0
    ds_read_b64_tr_b16 a[10:11], v22 offset:1024
    ds_read_b64_tr_b16 a[12:13], v23 offset:0
    ds_read_b64_tr_b16 a[14:15], v23 offset:1024
    s_waitcnt vmcnt(24)
    ds_read_b64_tr_b16 a[16:17], v20 offset:4096
    ds_read_b64_tr_b16 a[18:19], v20 offset:5120
    ds_read_b64_tr_b16 a[20:21], v21 offset:4096
    ds_read_b64_tr_b16 a[22:23], v21 offset:5120
    ds_read_b64_tr_b16 a[24:25], v22 offset:4096
    ds_read_b64_tr_b16 a[26:27], v22 offset:5120
    ds_read_b64_tr_b16 a[28:29], v23 offset:4096
    ds_read_b64_tr_b16 a[30:31], v23 offset:5120
    s_waitcnt vmcnt(20)
    ds_read_b64_tr_b16 a[32:33], v20 offset:8192
    ds_read_b64_tr_b16 a[34:35], v20 offset:9216
    ds_read_b64_tr_b16 a[36:37], v21 offset:8192
    ds_read_b64_tr_b16 a[38:39], v21 offset:9216
    ds_read_b64_tr_b16 a[40:41], v22 offset:8192
    ds_read_b64_tr_b16 a[42:43], v22 offset:9216
    ds_read_b64_tr_b16 a[44:45], v23 offset:8192
    ds_read_b64_tr_b16 a[46:47], v23 offset:9216
    s_waitcnt vmcnt(16)
    ds_read_b64_tr_b16 a[48:49], v20 offset:12288
    ds_read_b64_tr_b16 a[50:51], v20 offset:13312
    ds_read_b64_tr_b16 a[52:53], v21 offset:12288
    ds_read_b64_tr_b16 a[54:55], v21 offset:13312
    ds_read_b64_tr_b16 a[56:57], v22 offset:12288
    ds_read_b64_tr_b16 a[58:59], v22 offset:13312
    ds_read_b64_tr_b16 a[60:61], v23 offset:12288
    ds_read_b64_tr_b16 a[62:63], v23 offset:13312
    s_waitcnt vmcnt(12)
    ds_read_b64_tr_b16 a[64:65], v20 offset:16384
    ds_read_b64_tr_b16 a[66:67], v20 offset:17408
    ds_read_b64_tr_b16 a[68:69], v21 offset:16384
    ds_read_b64_tr_b16 a[70:71], v21 offset:17408
    ds_read_b64_tr_b16 a[72:73], v22 offset:16384
    ds_read_b64_tr_b16 a[74:75], v22 offset:17408
    ds_read_b64_tr_b16 a[76:77], v23 offset:16384
    ds_read_b64_tr_b16 a[78:79], v23 offset:17408
    s_waitcnt vmcnt(8)
    ds_read_b64_tr_b16 a[80:81], v20 offset:20480
    ds_read_b64_tr_b16 a[82:83], v20 offset:21504
    ds_read_b64_tr_b16 a[84:85], v21 offset:20480
    ds_read_b64_tr_b16 a[86:87], v21 offset:21504
    ds_read_b64_tr_b16 a[88:89], v22 offset:20480
    ds_read_b64_tr_b16 a[90:91], v22 offset:21504
    ds_read_b64_tr_b16 a[92:93], v23 offset:20480
    ds_read_b64_tr_b16 a[94:95], v23 offset:21504
    s_waitcnt vmcnt(4)
    ds_read_b64_tr_b16 a[96:97], v20 offset:24576
    ds_read_b64_tr_b16 a[98:99], v20 offset:25600
    ds_read_b64_tr_b16 a[100:101], v21 offset:24576
    ds_read_b64_tr_b16 a[102:103], v21 offset:25600
    ds_read_b64_tr_b16 a[104:105], v22 offset:24576
    ds_read_b64_tr_b16 a[106:107], v22 offset:25600
    ds_read_b64_tr_b16 a[108:109], v23 offset:24576
    ds_read_b64_tr_b16 a[110:111], v23 offset:25600
    s_waitcnt vmcnt(0)
    ds_read_b64_tr_b16 a[112:113], v20 offset:28672
    ds_read_b64_tr_b16 a[114:115], v20 offset:29696
    ds_read_b64_tr_b16 a[116:117], v21 offset:28672
    ds_read_b64_tr_b16 a[118:119], v21 offset:29696
    ds_read_b64_tr_b16 a[120:121], v22 offset:28672
    ds_read_b64_tr_b16 a[122:123], v22 offset:29696
    ds_read_b64_tr_b16 a[124:125], v23 offset:28672
    ds_read_b64_tr_b16 a[126:127], v23 offset:29696
    s_waitcnt lgkmcnt(0)
    s_add_u32 m0, s44, 0
    v_add_u32 v17, 131072, v19
    global_load_lds_dwordx4 v17, s[40:41]
    s_add_u32 m0, s44, 1024
    v_add_u32 v18, 135168, v19
    global_load_lds_dwordx4 v18, s[40:41]
    s_add_u32 m0, s44, 2048
    v_add_u32 v17, 139264, v19
    global_load_lds_dwordx4 v17, s[40:41]
    s_add_u32 m0, s44, 3072
    v_add_u32 v18, 143360, v19
    global_load_lds_dwordx4 v18, s[40:41]
    s_add_u32 m0, s44, 4096
    v_add_u32 v17, 147456, v19
    global_load_lds_dwordx4 v17, s[40:41]
    s_add_u32 m0, s44, 5120
    v_add_u32 v18, 151552, v19
    global_load_lds_dwordx4 v18, s[40:41]
    s_add_u32 m0, s44, 6144
    v_add_u32 v17, 155648, v19
    global_load_lds_dwordx4 v17, s[40:41]
    s_add_u32 m0, s44, 7168
    v_add_u32 v18, 159744, v19
    global_load_lds_dwordx4 v18, s[40:41]
    s_add_u32 m0, s44, 8192
    v_add_u32 v17, 163840, v19
    global_load_lds_dwordx4 v17, s[40:41]
    s_add_u32 m0, s44, 9216
    v_add_u32 v18, 167936, v19
    global_load_lds_dwordx4 v18, s[40:41]
    s_add_u32 m0, s44, 10240
    v_add_u32 v17, 172032, v19
    global_load_lds_dwordx4 v17, s[40:41]
    s_add_u32 m0, s44, 11264
    v_add_u32 v18, 176128, v19
    global_load_lds_dwordx4 v18, s[40:41]
    s_add_u32 m0, s44, 12288
    v_add_u32 v17, 180224, v19
    global_load_lds_dwordx4 v17, s[40:41]
    s_add_u32 m0, s44, 13312
    v_add_u32 v18, 184320, v19
    global_load_lds_dwordx4 v18, s[40:41]
    s_add_u32 m0, s44, 14336
    v_add_u32 v17, 188416, v19
    global_load_lds_dwordx4 v17, s[40:41]
    s_add_u32 m0, s44, 15360
    v_add_u32 v18, 192512, v19
    global_load_lds_dwordx4 v18, s[40:41]
    s_add_u32 m0, s44, 16384
    v_add_u32 v17, 196608, v19
    global_load_lds_dwordx4 v17, s[40:41]
    s_add_u32 m0, s44, 17408
    v_add_u32 v18, 200704, v19
    global_load_lds_dwordx4 v18, s[40:41]
    s_add_u32 m0, s44, 18432
    v_add_u32 v17, 204800, v19
    global_load_lds_dwordx4 v17, s[40:41]
    s_add_u32 m0, s44, 19456
    v_add_u32 v18, 208896, v19
    global_load_lds_dwordx4 v18, s[40:41]
    s_add_u32 m0, s44, 20480
    v_add_u32 v17, 212992, v19
    global_load_lds_dwordx4 v17, s[40:41]
    s_add_u32 m0, s44, 21504
    v_add_u32 v18, 217088, v19
    global_load_lds_dwordx4 v18, s[40:41]
    s_add_u32 m0, s44, 22528
    v_add_u32 v17, 221184, v19
    global_load_lds_dwordx4 v17, s[40:41]
    s_add_u32 m0, s44, 23552
    v_add_u32 v18, 225280, v19
    global_load_lds_dwordx4 v18, s[40:41]
    s_add_u32 m0, s44, 24576
    v_add_u32 v17, 229376, v19
    global_load_lds_dwordx4 v17, s[40:41]
    s_add_u32 m0, s44, 25600
    v_add_u32 v18, 233472, v19
    global_load_lds_dwordx4 v18, s[40:41]
    s_add_u32 m0, s44, 26624
    v_add_u32 v17, 237568, v19
    global_load_lds_dwordx4 v17, s[40:41]
    s_add_u32 m0, s44, 27648
    v_add_u32 v18, 241664, v19
    global_load_lds_dwordx4 v18, s[40:41]
    s_add_u32 m0, s44, 28672
    v_add_u32 v17, 245760, v19
    global_load_lds_dwordx4 v17, s[40:41]
    s_add_u32 m0, s44, 29696
    v_add_u32 v18, 249856, v19
    global_load_lds_dwordx4 v18, s[40:41]
    s_add_u32 m0, s44, 30720
    v_add_u32 v17, 253952, v19
    global_load_lds_dwordx4 v17, s[40:41]
    s_add_u32 m0, s44, 31744
    v_add_u32 v18, 258048, v19
    global_load_lds_dwordx4 v18, s[40:41]
    s_waitcnt vmcnt(28)
    ds_read_b64_tr_b16 a[128:129], v20 offset:0
    ds_read_b64_tr_b16 a[130:131], v20 offset:1024
    ds_read_b64_tr_b16 a[132:133], v21 offset:0
    ds_read_b64_tr_b16 a[134:135], v21 offset:1024
    ds_read_b64_tr_b16 a[136:137], v22 offset:0
    ds_read_b64_tr_b16 a[138:139], v22 offset:1024
    ds_read_b64_tr_b16 a[140:141], v23 offset:0
    ds_read_b64_tr_b16 a[142:143], v23 offset:1024
    s_waitcnt vmcnt(24)
    ds_read_b64_tr_b16 a[144:145], v20 offset:4096
    ds_read_b64_tr_b16 a[146:147], v20 offset:5120
    ds_read_b64_tr_b16 a[148:149], v21 offset:4096
    ds_read_b64_tr_b16 a[150:151], v21 offset:5120
    ds_read_b64_tr_b16 a[152:153], v22 offset:4096
    ds_read_b64_tr_b16 a[154:155], v22 offset:5120
    ds_read_b64_tr_b16 a[156:157], v23 offset:4096
    ds_read_b64_tr_b16 a[158:159], v23 offset:5120
    s_waitcnt vmcnt(20)
    ds_read_b64_tr_b16 a[160:161], v20 offset:8192
    ds_read_b64_tr_b16 a[162:163], v20 offset:9216
    ds_read_b64_tr_b16 a[164:165], v21 offset:8192
    ds_read_b64_tr_b16 a[166:167], v21 offset:9216
    ds_read_b64_tr_b16 a[168:169], v22 offset:8192
    ds_read_b64_tr_b16 a[170:171], v22 offset:9216
    ds_read_b64_tr_b16 a[172:173], v23 offset:8192
    ds_read_b64_tr_b16 a[174:175], v23 offset:9216
    s_waitcnt vmcnt(16)
    ds_read_b64_tr_b16 a[176:177], v20 offset:12288
    ds_read_b64_tr_b16 a[178:179], v20 offset:13312
    ds_read_b64_tr_b16 a[180:181], v21 offset:12288
    ds_read_b64_tr_b16 a[182:183], v21 offset:13312
    ds_read_b64_tr_b16 a[184:185], v22 offset:12288
    ds_read_b64_tr_b16 a[186:187], v22 offset:13312
    ds_read_b64_tr_b16 a[188:189], v23 offset:12288
    ds_read_b64_tr_b16 a[190:191], v23 offset:13312
    s_waitcnt vmcnt(12)
    ds_read_b64_tr_b16 a[192:193], v20 offset:16384
    ds_read_b64_tr_b16 a[194:195], v20 offset:17408
    ds_read_b64_tr_b16 a[196:197], v21 offset:16384
    ds_read_b64_tr_b16 a[198:199], v21 offset:17408
    ds_read_b64_tr_b16 a[200:201], v22 offset:16384
    ds_read_b64_tr_b16 a[202:203], v22 offset:17408
    ds_read_b64_tr_b16 a[204:205], v23 offset:16384
    ds_read_b64_tr_b16 a[206:207], v23 offset:17408
    s_waitcnt vmcnt(8)
    ds_read_b64_tr_b16 a[208:209], v20 offset:20480
    ds_read_b64_tr_b16 a[210:211], v20 offset:21504
    ds_read_b64_tr_b16 a[212:213], v21 offset:20480
    ds_read_b64_tr_b16 a[214:215], v21 offset:21504
    ds_read_b64_tr_b16 a[216:217], v22 offset:20480
    ds_read_b64_tr_b16 a[218:219], v22 offset:21504
    ds_read_b64_tr_b16 a[220:221], v23 offset:20480
    ds_read_b64_tr_b16 a[222:223], v23 offset:21504
    s_waitcnt vmcnt(4)
    ds_read_b64_tr_b16 a[224:225], v20 offset:24576
    ds_read_b64_tr_b16 a[226:227], v20 offset:25600
    ds_read_b64_tr_b16 a[228:229], v21 offset:24576
    ds_read_b64_tr_b16 a[230:231], v21 offset:25600
    ds_read_b64_tr_b16 a[232:233], v22 offset:24576
    ds_read_b64_tr_b16 a[234:235], v22 offset:25600
    ds_read_b64_tr_b16 a[236:237], v23 offset:24576
    ds_read_b64_tr_b16 a[238:239], v23 offset:25600
    s_waitcnt vmcnt(0)
    ds_read_b64_tr_b16 a[240:241], v20 offset:28672
    ds_read_b64_tr_b16 a[242:243], v20 offset:29696
    ds_read_b64_tr_b16 a[244:245], v21 offset:28672
    ds_read_b64_tr_b16 a[246:247], v21 offset:29696
    ds_read_b64_tr_b16 a[248:249], v22 offset:28672
    ds_read_b64_tr_b16 a[250:251], v22 offset:29696
    ds_read_b64_tr_b16 a[252:253], v23 offset:28672
    ds_read_b64_tr_b16 a[254:255], v23 offset:29696
    s_waitcnt lgkmcnt(0)
    s_barrier
    v_and_b32 v16, 63, v0
    v_and_b32 v17, 15, v16
    v_lshrrev_b32 v18, 4, v16
    v_lshlrev_b32 v1, 4, v16
    s_lshl_b32 s45, s9, 12
    v_lshrrev_b32 v19, 2, v17
    v_xor_b32 v19, v19, v18
    v_lshlrev_b32 v19, 3, v19
    v_lshl_add_u32 v19, v17, 5, v19
    v_add_u32 v2, s45, v19
    v_bfe_u32 v19, v16, 5, 1
    v_lshlrev_b32 v19, 4, v19
    v_bfe_u32 v20, v16, 4, 1
    v_lshl_add_u32 v19, v20, 2, v19
    v_mov_b32 v7, v19
    v_lshrrev_b32 v21, 2, v17
    v_add_u32 v19, v19, v21
    v_and_b32 v21, 3, v16
    v_xor_b32 v21, v21, v20
    v_lshlrev_b32 v21, 3, v21
    v_lshl_add_u32 v19, v19, 5, v21
    v_add_u32 v3, s45, v19
    v_xor_b32 v19, 16, v19
    v_add_u32 v19, 256, v19
    v_add_u32 v4, s45, v19
    s_and_b32 s46, s9, 1
    s_lshl_b32 s47, s46, 4
    v_add_u32 v19, s47, v17
    v_sub_u32 v19, v19, v7
    v_mov_b32 v20, 0xf149f2ca
    v_cmp_gt_i32 vcc, 0, v19
    s_nop 1
    v_cndmask_b32 v8, 0, v20, vcc
    v_cmp_gt_i32 vcc, 1, v19
    s_nop 1
    v_cndmask_b32 v9, 0, v20, vcc
    v_cmp_gt_i32 vcc, 2, v19
    s_nop 1
    v_cndmask_b32 v10, 0, v20, vcc
    v_cmp_gt_i32 vcc, 3, v19
    s_nop 1
    v_cndmask_b32 v11, 0, v20, vcc
    v_cmp_gt_i32 vcc, 8, v19
    s_nop 1
    v_cndmask_b32 v12, 0, v20, vcc
    v_cmp_gt_i32 vcc, 9, v19
    s_nop 1
    v_cndmask_b32 v13, 0, v20, vcc
    v_cmp_gt_i32 vcc, 10, v19
    s_nop 1
    v_cndmask_b32 v14, 0, v20, vcc
    v_cmp_gt_i32 vcc, 11, v19
    s_nop 1
    v_cndmask_b32 v15, 0, v20, vcc
    v_add_u32 v19, s47, v17
    v_mul_u32_u24 v19, 528, v19
    v_lshl_add_u32 v19, v18, 3, v19
    s_lshr_b32 s48, s9, 1
    s_lshl_b32 s49, s48, 8
    s_add_u32 s49, s49, 16384
    v_add_u32 v5, s49, v19
    v_and_b32 v19, 31, v16
    v_mul_u32_u24 v19, 528, v19
    v_lshrrev_b32 v20, 5, v16
    v_lshl_add_u32 v19, v20, 4, v19
    v_add_u32 v6, 16384, v19
    v_lshlrev_b32 v7, 2, v16
    s_lshl_b32 s50, s8, 1
    s_add_u32 s50, s50, s48
    s_add_u32 s64, s4, 4194304
    s_addc_u32 s65, s5, 0
    s_lshl_b32 s51, s50, 21
    s_add_u32 s64, s64, s51
    s_addc_u32 s65, s65, 0
    s_lshl_b32 s51, s3, 15
    s_add_u32 s64, s64, s51
    s_addc_u32 s65, s65, 0
    s_mul_i32 s53, s8, 33024
    s_mul_i32 s54, s3, 528384
    s_add_u32 s66, s4, 75497472
    s_addc_u32 s67, s5, 0
    s_lshl_b32 s51, s53, 0
    s_add_u32 s66, s66, s51
    s_addc_u32 s67, s67, 0
    s_lshl_b32 s51, s9, 13
    s_add_u32 s66, s66, s51
    s_addc_u32 s67, s67, 0
    s_lshl_b32 s51, s54, 0
    s_add_u32 s66, s66, s51
    s_addc_u32 s67, s67, 0
    s_add_u32 s72, s4, 127926272
    s_addc_u32 s73, s5, 0
    s_lshl_b32 s51, s8, 8
    s_add_u32 s72, s72, s51
    s_addc_u32 s73, s73, 0
    s_lshl_b32 s51, s9, 12
    s_add_u32 s72, s72, s51
    s_addc_u32 s73, s73, 0
    s_lshl_b32 s51, s3, 14
    s_add_u32 s72, s72, s51
    s_addc_u32 s73, s73, 0
    s_add_u32 s74, s4, 327696
    s_addc_u32 s75, s5, 0
    s_lshl_b32 s51, s50, 11
    s_add_u32 s74, s74, s51
    s_addc_u32 s75, s75, 0
    s_lshl_b32 s51, s3, 4
    s_add_u32 s74, s74, s51
    s_addc_u32 s75, s75, 0
    s_add_u32 s76, s4, 127533056
    s_addc_u32 s77, s5, 0
    s_lshl_b32 s51, s50, 10
    s_add_u32 s76, s76, s51
    s_addc_u32 s77, s77, 0
    s_lshl_b32 s52, s46, 12
    s_mov_b32 s70, 0x3e0293ee
    s_mov_b32 s71, 0x3e0293ee
    s_mov_b32 s68, s3
    s_lshr_b32 s40, s68, 3
    s_lshl_b32 s40, s40, 5
    v_and_b32 v22, 28, v7
    v_lshrrev_b32 v23, 5, v7
    v_lshl_add_u32 v22, v23, 8, v22
    v_add_u32 v22, s40, v22
    s_mov_b32 s60, 0
    s_mov_b64 exec, 0xffffff
    global_load_dword v23, v22, s[76:77] sc1
    s_waitcnt vmcnt(0)
    v_cmp_ne_u32 vcc, s97, v23
    s_cbranch_vccz Lwf_79
    global_load_dword v23, v22, s[76:77] sc1
    s_sleep 2
Lwf_78:
    global_load_dword v23, v22, s[76:77] sc1
    s_add_u32 s60, s60, 1
    s_cmp_gt_u32 s60, 1000000
    s_cbranch_scc1 Lfail
    s_waitcnt vmcnt(1)
    v_cmp_ne_u32 vcc, s97, v23
    s_cbranch_vccz Lwf_79
    s_sleep 1
    s_branch Lwf_78
Lwf_79:
    s_mov_b64 exec, -1
    v_add_u32 v168, 0, v1
    v_add_u32 v169, 4096, v1
    v_add_u32 v170, 8192, v1
    v_add_u32 v171, 12288, v1
    v_add_u32 v172, 16384, v1
    v_add_u32 v173, 20480, v1
    v_add_u32 v174, 24576, v1
    v_add_u32 v172, s52, v172
    global_load_dwordx4 v[16:19], v172, s[64:65] offset:0 sc1
    global_load_dwordx4 v[20:23], v172, s[64:65] offset:1024 sc1
    global_load_dwordx4 v[24:27], v172, s[64:65] offset:2048 sc1
    global_load_dwordx4 v[28:31], v172, s[64:65] offset:3072 sc1
    global_load_dwordx4 v[32:35], v168, s[64:65] offset:0 sc1
    global_load_dwordx4 v[36:39], v168, s[64:65] offset:1024 sc1
    global_load_dwordx4 v[40:43], v168, s[64:65] offset:2048 sc1
    global_load_dwordx4 v[44:47], v168, s[64:65] offset:3072 sc1
    global_load_dwordx4 v[48:51], v169, s[64:65] offset:0 sc1
    global_load_dwordx4 v[52:55], v169, s[64:65] offset:1024 sc1
    global_load_dwordx4 v[56:59], v169, s[64:65] offset:2048 sc1
    global_load_dwordx4 v[60:63], v169, s[64:65] offset:3072 sc1
    global_load_dwordx4 v[64:67], v170, s[64:65] offset:0 sc1
    global_load_dwordx4 v[68:71], v170, s[64:65] offset:1024 sc1
    global_load_dwordx4 v[72:75], v170, s[64:65] offset:2048 sc1
    global_load_dwordx4 v[76:79], v170, s[64:65] offset:3072 sc1
    global_load_dwordx4 v[80:83], v171, s[64:65] offset:0 sc1
    global_load_dwordx4 v[84:87], v171, s[64:65] offset:1024 sc1
    global_load_dwordx4 v[88:91], v171, s[64:65] offset:2048 sc1
    global_load_dwordx4 v[92:95], v171, s[64:65] offset:3072 sc1
    v_add_u32 v173, 28672, v1
Lat_76:
    s_mov_b32 s60, 0
    s_mov_b64 exec, 0x1
    global_load_dword v175, v7, s[74:75] sc1
    s_waitcnt vmcnt(0)
    v_cmp_ne_u32 vcc, s97, v175
    s_cbranch_vccz Lwf_81
    global_load_dword v175, v7, s[74:75] sc1
    s_sleep 2
Lwf_80:
    global_load_dword v175, v7, s[74:75] sc1
    s_add_u32 s60, s60, 1
    s_cmp_gt_u32 s60, 1000000
    s_cbranch_scc1 Lfail
    s_waitcnt vmcnt(1)
    v_cmp_ne_u32 vcc, s97, v175
    s_cbranch_vccz Lwf_81
    s_sleep 1
    s_cmp_ge_u32 s68, 52
    s_cbranch_scc1 Lwf_80
    s_sleep 12
    s_branch Lwf_80
Lwf_81:
    s_mov_b64 exec, -1
    global_load_dwordx4 v[96:99], v174, s[64:65] offset:2048 sc1
    global_load_dwordx4 v[100:103], v174, s[64:65] offset:3072 sc1
    global_load_dwordx4 v[112:115], v173, s[64:65] offset:0 sc1
    global_load_dwordx4 v[116:119], v173, s[64:65] offset:1024 sc1
    global_load_dwordx4 v[120:123], v173, s[64:65] offset:2048 sc1
    global_load_dwordx4 v[124:127], v173, s[64:65] offset:3072 sc1
    s_waitcnt vmcnt(14)
    v_mfma_f32_16x16x32_bf16 v[148:151], v[32:35], v[16:19], v[8:11]
    v_mfma_f32_16x16x32_bf16 v[148:151], v[36:39], v[20:23], v[148:151]
    v_mfma_f32_16x16x32_bf16 v[148:151], v[40:43], v[24:27], v[148:151]
    v_mfma_f32_16x16x32_bf16 v[148:151], v[44:47], v[28:31], v[148:151]
    v_mfma_f32_16x16x32_bf16 v[152:155], v[48:51], v[16:19], v[12:15]
    v_mfma_f32_16x16x32_bf16 v[152:155], v[52:55], v[20:23], v[152:155]
    v_mfma_f32_16x16x32_bf16 v[152:155], v[56:59], v[24:27], v[152:155]
    v_mfma_f32_16x16x32_bf16 v[152:155], v[60:63], v[28:31], v[152:155]
    s_waitcnt vmcnt(5)
    ds_write2st64_b32 v2, v96, v97 offset0:0 offset1:2
    ds_write2st64_b32 v2, v98, v99 offset0:4 offset1:6
    s_waitcnt vmcnt(4)
    ds_write2st64_b32 v2, v100, v101 offset0:8 offset1:10
    ds_write2st64_b32 v2, v102, v103 offset0:12 offset1:14
    s_waitcnt lgkmcnt(0)
    ds_read_b64_tr_b16 v[128:129], v3 offset:0
    ds_read_b64_tr_b16 v[130:131], v4 offset:0
    ds_read_b64_tr_b16 v[132:133], v3 offset:1024
    ds_read_b64_tr_b16 v[134:135], v4 offset:1024
    ds_read_b64_tr_b16 v[136:137], v3 offset:2048
    ds_read_b64_tr_b16 v[138:139], v4 offset:2048
    ds_read_b64_tr_b16 v[140:141], v3 offset:3072
    ds_read_b64_tr_b16 v[142:143], v4 offset:3072
    v_max3_f32 v156, v148, v149, v150
    v_max3_f32 v156, v156, v151, v152
    v_max3_f32 v156, v156, v153, v154
    v_max_f32 v156, v156, v155
    s_waitcnt lgkmcnt(6)
    v_mfma_f32_16x16x32_bf16 v[144:147], v[128:131], v[16:19], 0
    s_waitcnt lgkmcnt(4)
    v_mfma_f32_16x16x32_bf16 v[144:147], v[132:135], v[20:23], v[144:147]
    s_waitcnt lgkmcnt(2)
    v_mfma_f32_16x16x32_bf16 v[144:147], v[136:139], v[24:27], v[144:147]
    s_waitcnt lgkmcnt(0)
    v_mfma_f32_16x16x32_bf16 v[144:147], v[140:143], v[28:31], v[144:147]
    s_nop 7
    v_max3_f32 v157, v156, v144, v145
    v_max3_f32 v156, v156, v144, v145
    s_nop 1
    v_permlane32_swap_b32 v156, v157
    v_max_f32 v158, v156, v157
    v_max_f32 v156, v156, v157
    s_nop 1
    v_permlane16_swap_b32 v156, v158
    v_max_f32 v156, v156, v158
    v_mul_f32 v156, s70, v156
    v_pk_fma_f32 v[148:149], v[148:149], s[70:71], v[156:157] op_sel_hi:[1,0,0] neg_lo:[0,0,1] neg_hi:[0,0,1]
    v_pk_fma_f32 v[150:151], v[150:151], s[70:71], v[156:157] op_sel_hi:[1,0,0] neg_lo:[0,0,1] neg_hi:[0,0,1]
    v_pk_fma_f32 v[152:153], v[152:153], s[70:71], v[156:157] op_sel_hi:[1,0,0] neg_lo:[0,0,1] neg_hi:[0,0,1]
    v_pk_fma_f32 v[154:155], v[154:155], s[70:71], v[156:157] op_sel_hi:[1,0,0] neg_lo:[0,0,1] neg_hi:[0,0,1]
    v_pk_fma_f32 v[144:145], v[144:145], s[70:71], v[156:157] op_sel_hi:[1,0,0] neg_lo:[0,0,1] neg_hi:[0,0,1]
    v_exp_f32 v148, v148
    v_exp_f32 v149, v149
    v_exp_f32 v150, v150
    v_exp_f32 v151, v151
    v_exp_f32 v152, v152
    v_exp_f32 v153, v153
    v_exp_f32 v154, v154
    v_exp_f32 v155, v155
    v_exp_f32 v144, v144
    v_exp_f32 v145, v145
    v_pk_add_f32 v[160:161], v[148:149], v[150:151]
    v_pk_add_f32 v[162:163], v[152:153], v[154:155]
    v_pk_add_f32 v[160:161], v[160:161], v[144:145]
    v_pk_add_f32 v[160:161], v[160:161], v[162:163]
    v_add_f32 v156, v160, v161
    v_add_f32 v157, v160, v161
    s_nop 1
    v_permlane32_swap_b32 v156, v157
    v_add_f32 v158, v156, v157
    v_add_f32 v156, v156, v157
    s_nop 1
    v_permlane16_swap_b32 v156, v158
    v_add_f32 v156, v156, v158
    v_rcp_f32 v156, v156
    s_nop 0
    v_pk_mul_f32 v[148:149], v[148:149], v[156:157] op_sel_hi:[1,0]
    v_pk_mul_f32 v[150:151], v[150:151], v[156:157] op_sel_hi:[1,0]
    v_pk_mul_f32 v[152:153], v[152:153], v[156:157] op_sel_hi:[1,0]
    v_pk_mul_f32 v[154:155], v[154:155], v[156:157] op_sel_hi:[1,0]
    v_pk_mul_f32 v[144:145], v[144:145], v[156:157] op_sel_hi:[1,0]
    v_cvt_pk_bf16_f32 v160, v148, v149
    v_cvt_pk_bf16_f32 v161, v150, v151
    v_cvt_pk_bf16_f32 v162, v152, v153
    v_cvt_pk_bf16_f32 v163, v154, v155
    v_cvt_pk_bf16_f32 v164, v144, v145
    v_cvt_pk_bf16_f32 v165, v144, v145
    s_waitcnt vmcnt(0)
    v_mfma_f32_16x16x32_bf16 v[168:171], v[64:67], v[160:163], 0
    v_mfma_f32_16x16x32_bf16 v[172:175], v[68:71], v[160:163], 0
    v_mfma_f32_16x16x32_bf16 v[176:179], v[72:75], v[160:163], 0
    v_mfma_f32_16x16x32_bf16 v[180:183], v[76:79], v[160:163], 0
    v_mfma_f32_16x16x32_bf16 v[184:187], v[80:83], v[160:163], 0
    v_mfma_f32_16x16x32_bf16 v[188:191], v[84:87], v[160:163], 0
    v_mfma_f32_16x16x32_bf16 v[192:195], v[88:91], v[160:163], 0
    v_mfma_f32_16x16x32_bf16 v[196:199], v[92:95], v[160:163], 0
    s_barrier
    v_mfma_f32_16x16x16_bf16 v[168:171], v[112:113], v[164:165], v[168:171]
    v_mfma_f32_16x16x16_bf16 v[172:175], v[114:115], v[164:165], v[172:175]
    v_mfma_f32_16x16x16_bf16 v[176:179], v[116:117], v[164:165], v[176:179]
    v_mfma_f32_16x16x16_bf16 v[180:183], v[118:119], v[164:165], v[180:183]
    s_nop 4
    v_cvt_pk_bf16_f32 v216, v168, v169
    v_cvt_pk_bf16_f32 v217, v170, v171
    ds_write_b64 v5, v[216:217] offset:0
    v_mfma_f32_16x16x16_bf16 v[184:187], v[120:121], v[164:165], v[184:187]
    v_cvt_pk_bf16_f32 v218, v172, v173
    v_cvt_pk_bf16_f32 v219, v174, v175
    ds_write_b64 v5, v[218:219] offset:32
    v_mfma_f32_16x16x16_bf16 v[188:191], v[122:123], v[164:165], v[188:191]
    v_cvt_pk_bf16_f32 v216, v176, v177
    v_cvt_pk_bf16_f32 v217, v178, v179
    ds_write_b64 v5, v[216:217] offset:64
    v_mfma_f32_16x16x16_bf16 v[192:195], v[124:125], v[164:165], v[192:195]
    v_cvt_pk_bf16_f32 v218, v180, v181
    v_cvt_pk_bf16_f32 v219, v182, v183
    ds_write_b64 v5, v[218:219] offset:96
    v_mfma_f32_16x16x16_bf16 v[196:199], v[126:127], v[164:165], v[196:199]
    v_cvt_pk_bf16_f32 v216, v184, v185
    v_cvt_pk_bf16_f32 v217, v186, v187
    ds_write_b64 v5, v[216:217] offset:128
    v_cvt_pk_bf16_f32 v218, v188, v189
    v_cvt_pk_bf16_f32 v219, v190, v191
    ds_write_b64 v5, v[218:219] offset:160
    v_cvt_pk_bf16_f32 v216, v192, v193
    v_cvt_pk_bf16_f32 v217, v194, v195
    ds_write_b64 v5, v[216:217] offset:192
    v_cvt_pk_bf16_f32 v218, v196, v197
    v_cvt_pk_bf16_f32 v219, v198, v199
    ds_write_b64 v5, v[218:219] offset:224
    s_waitcnt lgkmcnt(0)
    s_barrier
    ds_read_b128 v[200:203], v6 offset:0
    ds_read_b128 v[204:207], v6 offset:32
    ds_read_b128 v[208:211], v6 offset:64
    v_add_u32 v168, 4096, v1
    s_cmp_ge_u32 s68, 56
    s_cbranch_scc1 Lan_82
    s_waitcnt lgkmcnt(2)
    v_mfma_f32_32x32x16_bf16 v[64:79], a[0:3], v[200:203], 0
    ds_read_b128 v[212:215], v6 offset:96
    v_mfma_f32_32x32x16_bf16 v[80:95], a[4:7], v[200:203], 0
    v_mfma_f32_32x32x16_bf16 v[96:111], a[8:11], v[200:203], 0
    v_mfma_f32_32x32x16_bf16 v[112:127], a[12:15], v[200:203], 0
    s_waitcnt lgkmcnt(2)
    v_mfma_f32_32x32x16_bf16 v[64:79], a[16:19], v[204:207], v[64:79]
    ds_read_b128 v[200:203], v6 offset:128
    v_mfma_f32_32x32x16_bf16 v[80:95], a[20:23], v[204:207], v[80:95]
    v_mfma_f32_32x32x16_bf16 v[96:111], a[24:27], v[204:207], v[96:111]
    v_mfma_f32_32x32x16_bf16 v[112:127], a[28:31], v[204:207], v[112:127]
    s_waitcnt lgkmcnt(2)
    v_mfma_f32_32x32x16_bf16 v[64:79], a[32:35], v[208:211], v[64:79]
    ds_read_b128 v[204:207], v6 offset:160
    v_mfma_f32_32x32x16_bf16 v[80:95], a[36:39], v[208:211], v[80:95]
    v_mfma_f32_32x32x16_bf16 v[96:111], a[40:43], v[208:211], v[96:111]
    v_mfma_f32_32x32x16_bf16 v[112:127], a[44:47], v[208:211], v[112:127]
    s_waitcnt lgkmcnt(2)
    v_mfma_f32_32x32x16_bf16 v[64:79], a[48:51], v[212:215], v[64:79]
    ds_read_b128 v[208:211], v6 offset:192
    v_mfma_f32_32x32x16_bf16 v[80:95], a[52:55], v[212:215], v[80:95]
    v_mfma_f32_32x32x16_bf16 v[96:111], a[56:59], v[212:215], v[96:111]
    v_mfma_f32_32x32x16_bf16 v[112:127], a[60:63], v[212:215], v[112:127]
    s_waitcnt lgkmcnt(2)
    v_mfma_f32_32x32x16_bf16 v[64:79], a[64:67], v[200:203], v[64:79]
    ds_read_b128 v[212:215], v6 offset:224
    v_mfma_f32_32x32x16_bf16 v[80:95], a[68:71], v[200:203], v[80:95]
    v_mfma_f32_32x32x16_bf16 v[96:111], a[72:75], v[200:203], v[96:111]
    v_mfma_f32_32x32x16_bf16 v[112:127], a[76:79], v[200:203], v[112:127]
    s_waitcnt lgkmcnt(2)
    v_mfma_f32_32x32x16_bf16 v[64:79], a[80:83], v[204:207], v[64:79]
    ds_read_b128 v[200:203], v6 offset:256
    v_mfma_f32_32x32x16_bf16 v[80:95], a[84:87], v[204:207], v[80:95]
    v_mfma_f32_32x32x16_bf16 v[96:111], a[88:91], v[204:207], v[96:111]
    v_mfma_f32_32x32x16_bf16 v[112:127], a[92:95], v[204:207], v[112:127]
    s_waitcnt lgkmcnt(2)
    v_mfma_f32_32x32x16_bf16 v[64:79], a[96:99], v[208:211], v[64:79]
    ds_read_b128 v[204:207], v6 offset:288
    v_mfma_f32_32x32x16_bf16 v[80:95], a[100:103], v[208:211], v[80:95]
    v_mfma_f32_32x32x16_bf16 v[96:111], a[104:107], v[208:211], v[96:111]
    v_mfma_f32_32x32x16_bf16 v[112:127], a[108:111], v[208:211], v[112:127]
    s_waitcnt lgkmcnt(2)
    v_mfma_f32_32x32x16_bf16 v[64:79], a[112:115], v[212:215], v[64:79]
    ds_read_b128 v[208:211], v6 offset:320
    v_mfma_f32_32x32x16_bf16 v[80:95], a[116:119], v[212:215], v[80:95]
    v_mfma_f32_32x32x16_bf16 v[96:111], a[120:123], v[212:215], v[96:111]
    v_mfma_f32_32x32x16_bf16 v[112:127], a[124:127], v[212:215], v[112:127]
    s_waitcnt lgkmcnt(2)
    v_mfma_f32_32x32x16_bf16 v[64:79], a[128:131], v[200:203], v[64:79]
    ds_read_b128 v[212:215], v6 offset:352
    v_mfma_f32_32x32x16_bf16 v[80:95], a[132:135], v[200:203], v[80:95]
    v_mfma_f32_32x32x16_bf16 v[96:111], a[136:139], v[200:203], v[96:111]
    v_mfma_f32_32x32x16_bf16 v[112:127], a[140:143], v[200:203], v[112:127]
    s_waitcnt lgkmcnt(2)
    v_mfma_f32_32x32x16_bf16 v[64:79], a[144:147], v[204:207], v[64:79]
    ds_read_b128 v[200:203], v6 offset:384
    v_mfma_f32_32x32x16_bf16 v[80:95], a[148:151], v[204:207], v[80:95]
    v_mfma_f32_32x32x16_bf16 v[96:111], a[152:155], v[204:207], v[96:111]
    v_mfma_f32_32x32x16_bf16 v[112:127], a[156:159], v[204:207], v[112:127]
    s_waitcnt lgkmcnt(2)
    v_mfma_f32_32x32x16_bf16 v[64:79], a[160:163], v[208:211], v[64:79]
    ds_read_b128 v[204:207], v6 offset:416
    v_mfma_f32_32x32x16_bf16 v[80:95], a[164:167], v[208:211], v[80:95]
    v_mfma_f32_32x32x16_bf16 v[96:111], a[168:171], v[208:211], v[96:111]
    v_mfma_f32_32x32x16_bf16 v[112:127], a[172:175], v[208:211], v[112:127]
    s_waitcnt lgkmcnt(2)
    v_mfma_f32_32x32x16_bf16 v[64:79], a[176:179], v[212:215], v[64:79]
    ds_read_b128 v[208:211], v6 offset:448
    v_mfma_f32_32x32x16_bf16 v[80:95], a[180:183], v[212:215], v[80:95]
    v_mfma_f32_32x32x16_bf16 v[96:111], a[184:187], v[212:215], v[96:111]
    v_mfma_f32_32x32x16_bf16 v[112:127], a[188:191], v[212:215], v[112:127]
    s_waitcnt lgkmcnt(2)
    v_mfma_f32_32x32x16_bf16 v[64:79], a[192:195], v[200:203], v[64:79]
    ds_read_b128 v[212:215], v6 offset:480
    v_mfma_f32_32x32x16_bf16 v[80:95], a[196:199], v[200:203], v[80:95]
    v_mfma_f32_32x32x16_bf16 v[96:111], a[200:203], v[200:203], v[96:111]
    v_mfma_f32_32x32x16_bf16 v[112:127], a[204:207], v[200:203], v[112:127]
    s_waitcnt lgkmcnt(2)
    v_mfma_f32_32x32x16_bf16 v[64:79], a[208:211], v[204:207], v[64:79]
    v_mfma_f32_32x32x16_bf16 v[80:95], a[212:215], v[204:207], v[80:95]
    v_mfma_f32_32x32x16_bf16 v[96:111], a[216:219], v[204:207], v[96:111]
    v_mfma_f32_32x32x16_bf16 v[112:127], a[220:223], v[204:207], v[112:127]
    s_waitcnt lgkmcnt(1)
    v_mfma_f32_32x32x16_bf16 v[64:79], a[224:227], v[208:211], v[64:79]
    v_mfma_f32_32x32x16_bf16 v[80:95], a[228:231], v[208:211], v[80:95]
    v_mfma_f32_32x32x16_bf16 v[96:111], a[232:235], v[208:211], v[96:111]
    v_mfma_f32_32x32x16_bf16 v[112:127], a[236:239], v[208:211], v[112:127]
    s_waitcnt lgkmcnt(0)
    v_mfma_f32_32x32x16_bf16 v[64:79], a[240:243], v[212:215], v[64:79]
    v_mfma_f32_32x32x16_bf16 v[80:95], a[244:247], v[212:215], v[80:95]
    v_mfma_f32_32x32x16_bf16 v[96:111], a[248:251], v[212:215], v[96:111]
    v_mfma_f32_32x32x16_bf16 v[112:127], a[252:255], v[212:215], v[112:127]
    s_nop 8
    v_cvt_pk_bf16_f32 v216, v64, v65
    v_cvt_pk_bf16_f32 v217, v66, v67
    v_cvt_pk_bf16_f32 v218, v68, v69
    v_cvt_pk_bf16_f32 v219, v70, v71
    v_cvt_pk_bf16_f32 v220, v72, v73
    v_cvt_pk_bf16_f32 v221, v74, v75
    v_cvt_pk_bf16_f32 v222, v76, v77
    v_cvt_pk_bf16_f32 v223, v78, v79
    global_store_dwordx4 v1, v[216:219], s[66:67] offset:0 sc1
    global_store_dwordx4 v1, v[220:223], s[66:67] offset:1024 sc1
    v_cvt_pk_bf16_f32 v224, v80, v81
    v_cvt_pk_bf16_f32 v225, v82, v83
    v_cvt_pk_bf16_f32 v226, v84, v85
    v_cvt_pk_bf16_f32 v227, v86, v87
    v_cvt_pk_bf16_f32 v228, v88, v89
    v_cvt_pk_bf16_f32 v229, v90, v91
    v_cvt_pk_bf16_f32 v230, v92, v93
    v_cvt_pk_bf16_f32 v231, v94, v95
    global_store_dwordx4 v1, v[224:227], s[66:67] offset:2048 sc1
    global_store_dwordx4 v1, v[228:231], s[66:67] offset:3072 sc1
    v_cvt_pk_bf16_f32 v216, v96, v97
    v_cvt_pk_bf16_f32 v217, v98, v99
    v_cvt_pk_bf16_f32 v218, v100, v101
    v_cvt_pk_bf16_f32 v219, v102, v103
    v_cvt_pk_bf16_f32 v220, v104, v105
    v_cvt_pk_bf16_f32 v221, v106, v107
    v_cvt_pk_bf16_f32 v222, v108, v109
    v_cvt_pk_bf16_f32 v223, v110, v111
    global_store_dwordx4 v168, v[216:219], s[66:67] offset:0 sc1
    global_store_dwordx4 v168, v[220:223], s[66:67] offset:1024 sc1
    v_cvt_pk_bf16_f32 v224, v112, v113
    v_cvt_pk_bf16_f32 v225, v114, v115
    v_cvt_pk_bf16_f32 v226, v116, v117
    v_cvt_pk_bf16_f32 v227, v118, v119
    v_cvt_pk_bf16_f32 v228, v120, v121
    v_cvt_pk_bf16_f32 v229, v122, v123
    v_cvt_pk_bf16_f32 v230, v124, v125
    v_cvt_pk_bf16_f32 v231, v126, v127
    global_store_dwordx4 v168, v[224:227], s[66:67] offset:2048 sc1
    global_store_dwordx4 v168, v[228:231], s[66:67] offset:3072 sc1
    v_lshlrev_b32 v233, 3, v1
    v_mov_b32 v232, s97
    s_waitcnt vmcnt(0)
    s_mov_b64 exec, 0x3
    global_store_dword v233, v232, s[72:73] offset:0 sc1
    s_mov_b64 exec, -1
    s_lshr_b32 s41, s3, 1
    s_add_u32 s41, s41, 56
    s_add_u32 s40, s68, 4
    s_cmp_ge_u32 s40, 56
    s_cselect_b32 s40, s41, s40
    s_sub_u32 s40, s40, s68
    s_lshl_b32 s41, s40, 15
    s_add_u32 s64, s64, s41
    s_addc_u32 s65, s65, 0
    s_mul_i32 s41, s40, 528384
    s_add_u32 s66, s66, s41
    s_addc_u32 s67, s67, 0
    s_lshl_b32 s41, s40, 14
    s_add_u32 s72, s72, s41
    s_addc_u32 s73, s73, 0
    s_lshl_b32 s41, s40, 4
    s_add_u32 s74, s74, s41
    s_addc_u32 s75, s75, 0
    s_add_u32 s68, s68, s40
    s_lshr_b32 s40, s68, 3
    s_lshl_b32 s40, s40, 5
    v_and_b32 v22, 28, v7
    v_lshrrev_b32 v23, 5, v7
    v_lshl_add_u32 v22, v23, 8, v22
    v_add_u32 v22, s40, v22
    s_mov_b32 s60, 0
    s_mov_b64 exec, 0xffffff
    global_load_dword v23, v22, s[76:77] sc1
    s_waitcnt vmcnt(0)
    v_cmp_ne_u32 vcc, s97, v23
    s_cbranch_vccz Lwf_85
    global_load_dword v23, v22, s[76:77] sc1
    s_sleep 2
Lwf_84:
    global_load_dword v23, v22, s[76:77] sc1
    s_add_u32 s60, s60, 1
    s_cmp_gt_u32 s60, 1000000
    s_cbranch_scc1 Lfail
    s_waitcnt vmcnt(1)
    v_cmp_ne_u32 vcc, s97, v23
    s_cbranch_vccz Lwf_85
    s_sleep 1
    s_branch Lwf_84
Lwf_85:
    s_mov_b64 exec, -1
    v_add_u32 v168, 0, v1
    v_add_u32 v169, 4096, v1
    v_add_u32 v170, 8192, v1
    v_add_u32 v171, 12288, v1
    v_add_u32 v172, 16384, v1
    v_add_u32 v173, 20480, v1
    v_add_u32 v174, 24576, v1
    v_add_u32 v172, s52, v172
    global_load_dwordx4 v[16:19], v172, s[64:65] offset:0 sc1
    global_load_dwordx4 v[20:23], v172, s[64:65] offset:1024 sc1
    global_load_dwordx4 v[24:27], v172, s[64:65] offset:2048 sc1
    global_load_dwordx4 v[28:31], v172, s[64:65] offset:3072 sc1
    global_load_dwordx4 v[32:35], v168, s[64:65] offset:0 sc1
    global_load_dwordx4 v[36:39], v168, s[64:65] offset:1024 sc1
    global_load_dwordx4 v[40:43], v168, s[64:65] offset:2048 sc1
    global_load_dwordx4 v[44:47], v168, s[64:65] offset:3072 sc1
    global_load_dwordx4 v[48:51], v169, s[64:65] offset:0 sc1
    global_load_dwordx4 v[52:55], v169, s[64:65] offset:1024 sc1
    global_load_dwordx4 v[56:59], v169, s[64:65] offset:2048 sc1
    global_load_dwordx4 v[60:63], v169, s[64:65] offset:3072 sc1
    global_load_dwordx4 v[64:67], v170, s[64:65] offset:0 sc1
    global_load_dwordx4 v[68:71], v170, s[64:65] offset:1024 sc1
    global_load_dwordx4 v[72:75], v170, s[64:65] offset:2048 sc1
    global_load_dwordx4 v[76:79], v170, s[64:65] offset:3072 sc1
    global_load_dwordx4 v[80:83], v171, s[64:65] offset:0 sc1
    global_load_dwordx4 v[84:87], v171, s[64:65] offset:1024 sc1
    global_load_dwordx4 v[88:91], v171, s[64:65] offset:2048 sc1
    global_load_dwordx4 v[92:95], v171, s[64:65] offset:3072 sc1
    v_add_u32 v173, 28672, v1
    s_branch Lat_76
Lan_82:
    s_mov_b32 s40, 2
    s_bitcmp1_b32 s3, 0
    s_cbranch_scc1 Lax_87
    s_waitcnt lgkmcnt(2)
    v_mfma_f32_32x32x16_bf16 v[64:79], a[0:3], v[200:203], 0
    ds_read_b128 v[212:215], v6 offset:96
    v_mfma_f32_32x32x16_bf16 v[80:95], a[4:7], v[200:203], 0
    s_waitcnt lgkmcnt(2)
    v_mfma_f32_32x32x16_bf16 v[64:79], a[16:19], v[204:207], v[64:79]
    ds_read_b128 v[200:203], v6 offset:128
    v_mfma_f32_32x32x16_bf16 v[80:95], a[20:23], v[204:207], v[80:95]
    s_waitcnt lgkmcnt(2)
    v_mfma_f32_32x32x16_bf16 v[64:79], a[32:35], v[208:211], v[64:79]
    ds_read_b128 v[204:207], v6 offset:160
    v_mfma_f32_32x32x16_bf16 v[80:95], a[36:39], v[208:211], v[80:95]
    s_waitcnt lgkmcnt(2)
    v_mfma_f32_32x32x16_bf16 v[64:79], a[48:51], v[212:215], v[64:79]
    ds_read_b128 v[208:211], v6 offset:192
    v_mfma_f32_32x32x16_bf16 v[80:95], a[52:55], v[212:215], v[80:95]
    s_waitcnt lgkmcnt(2)
    v_mfma_f32_32x32x16_bf16 v[64:79], a[64:67], v[200:203], v[64:79]
    ds_read_b128 v[212:215], v6 offset:224
    v_mfma_f32_32x32x16_bf16 v[80:95], a[68:71], v[200:203], v[80:95]
    s_waitcnt lgkmcnt(2)
    v_mfma_f32_32x32x16_bf16 v[64:79], a[80:83], v[204:207], v[64:79]
    ds_read_b128 v[200:203], v6 offset:256
    v_mfma_f32_32x32x16_bf16 v[80:95], a[84:87], v[204:207], v[80:95]
    s_waitcnt lgkmcnt(2)
    v_mfma_f32_32x32x16_bf16 v[64:79], a[96:99], v[208:211], v[64:79]
    ds_read_b128 v[204:207], v6 offset:288
    v_mfma_f32_32x32x16_bf16 v[80:95], a[100:103], v[208:211], v[80:95]
    s_waitcnt lgkmcnt(2)
    v_mfma_f32_32x32x16_bf16 v[64:79], a[112:115], v[212:215], v[64:79]
    ds_read_b128 v[208:211], v6 offset:320
    v_mfma_f32_32x32x16_bf16 v[80:95], a[116:119], v[212:215], v[80:95]
    s_waitcnt lgkmcnt(2)
    v_mfma_f32_32x32x16_bf16 v[64:79], a[128:131], v[200:203], v[64:79]
    ds_read_b128 v[212:215], v6 offset:352
    v_mfma_f32_32x32x16_bf16 v[80:95], a[132:135], v[200:203], v[80:95]
    s_waitcnt lgkmcnt(2)
    v_mfma_f32_32x32x16_bf16 v[64:79], a[144:147], v[204:207], v[64:79]
    ds_read_b128 v[200:203], v6 offset:384
    v_mfma_f32_32x32x16_bf16 v[80:95], a[148:151], v[204:207], v[80:95]
    s_waitcnt lgkmcnt(2)
    v_mfma_f32_32x32x16_bf16 v[64:79], a[160:163], v[208:211], v[64:79]
    ds_read_b128 v[204:207], v6 offset:416
    v_mfma_f32_32x32x16_bf16 v[80:95], a[164:167], v[208:211], v[80:95]
    s_waitcnt lgkmcnt(2)
    v_mfma_f32_32x32x16_bf16 v[64:79], a[176:179], v[212:215], v[64:79]
    ds_read_b128 v[208:211], v6 offset:448
    v_mfma_f32_32x32x16_bf16 v[80:95], a[180:183], v[212:215], v[80:95]
    s_waitcnt lgkmcnt(2)
    v_mfma_f32_32x32x16_bf16 v[64:79], a[192:195], v[200:203], v[64:79]
    ds_read_b128 v[212:215], v6 offset:480
    v_mfma_f32_32x32x16_bf16 v[80:95], a[196:199], v[200:203], v[80:95]
    s_waitcnt lgkmcnt(2)
    v_mfma_f32_32x32x16_bf16 v[64:79], a[208:211], v[204:207], v[64:79]
    v_mfma_f32_32x32x16_bf16 v[80:95], a[212:215], v[204:207], v[80:95]
    s_waitcnt lgkmcnt(1)
    v_mfma_f32_32x32x16_bf16 v[64:79], a[224:227], v[208:211], v[64:79]
    v_mfma_f32_32x32x16_bf16 v[80:95], a[228:231], v[208:211], v[80:95]
    s_waitcnt lgkmcnt(0)
    v_mfma_f32_32x32x16_bf16 v[64:79], a[240:243], v[212:215], v[64:79]
    v_mfma_f32_32x32x16_bf16 v[80:95], a[244:247], v[212:215], v[80:95]
    s_nop 10
    v_cvt_pk_bf16_f32 v216, v64, v65
    v_cvt_pk_bf16_f32 v217, v66, v67
    v_cvt_pk_bf16_f32 v218, v68, v69
    v_cvt_pk_bf16_f32 v219, v70, v71
    v_cvt_pk_bf16_f32 v220, v72, v73
    v_cvt_pk_bf16_f32 v221, v74, v75
    v_cvt_pk_bf16_f32 v222, v76, v77
    v_cvt_pk_bf16_f32 v223, v78, v79
    global_store_dwordx4 v1, v[216:219], s[66:67] offset:0 sc1
    global_store_dwordx4 v1, v[220:223], s[66:67] offset:1024 sc1
    v_cvt_pk_bf16_f32 v224, v80, v81
    v_cvt_pk_bf16_f32 v225, v82, v83
    v_cvt_pk_bf16_f32 v226, v84, v85
    v_cvt_pk_bf16_f32 v227, v86, v87
    v_cvt_pk_bf16_f32 v228, v88, v89
    v_cvt_pk_bf16_f32 v229, v90, v91
    v_cvt_pk_bf16_f32 v230, v92, v93
    v_cvt_pk_bf16_f32 v231, v94, v95
    global_store_dwordx4 v1, v[224:227], s[66:67] offset:2048 sc1
    global_store_dwordx4 v1, v[228:231], s[66:67] offset:3072 sc1
    s_cmp_ge_u32 s68, 62
    s_cbranch_scc1 Lal_88
    s_lshl_b32 s41, s40, 15
    s_add_u32 s64, s64, s41
    s_addc_u32 s65, s65, 0
    v_add_u32 v168, 0, v1
    v_add_u32 v169, 4096, v1
    v_add_u32 v170, 8192, v1
    v_add_u32 v171, 12288, v1
    v_add_u32 v172, 16384, v1
    v_add_u32 v173, 20480, v1
    v_add_u32 v174, 24576, v1
    v_add_u32 v172, s52, v172
    global_load_dwordx4 v[16:19], v172, s[64:65] offset:0 sc1
    global_load_dwordx4 v[20:23], v172, s[64:65] offset:1024 sc1
    global_load_dwordx4 v[24:27], v172, s[64:65] offset:2048 sc1
    global_load_dwordx4 v[28:31], v172, s[64:65] offset:3072 sc1
    global_load_dwordx4 v[32:35], v168, s[64:65] offset:0 sc1
    global_load_dwordx4 v[36:39], v168, s[64:65] offset:1024 sc1
    global_load_dwordx4 v[40:43], v168, s[64:65] offset:2048 sc1
    global_load_dwordx4 v[44:47], v168, s[64:65] offset:3072 sc1
    global_load_dwordx4 v[48:51], v169, s[64:65] offset:0 sc1
    global_load_dwordx4 v[52:55], v169, s[64:65] offset:1024 sc1
    global_load_dwordx4 v[56:59], v169, s[64:65] offset:2048 sc1
    global_load_dwordx4 v[60:63], v169, s[64:65] offset:3072 sc1
    global_load_dwordx4 v[64:67], v170, s[64:65] offset:0 sc1
    global_load_dwordx4 v[68:71], v170, s[64:65] offset:1024 sc1
    global_load_dwordx4 v[72:75], v170, s[64:65] offset:2048 sc1
    global_load_dwordx4 v[76:79], v170, s[64:65] offset:3072 sc1
    global_load_dwordx4 v[80:83], v171, s[64:65] offset:0 sc1
    global_load_dwordx4 v[84:87], v171, s[64:65] offset:1024 sc1
    global_load_dwordx4 v[88:91], v171, s[64:65] offset:2048 sc1
    global_load_dwordx4 v[92:95], v171, s[64:65] offset:3072 sc1
    v_add_u32 v173, 28672, v1
    v_mov_b32 v232, s97
    s_waitcnt vmcnt(20)
    s_mov_b64 exec, 0x1
    global_store_dword v1, v232, s[72:73] offset:0 sc1
    s_mov_b64 exec, -1
    s_branch Lam_89
Lal_88:
    v_mov_b32 v232, s97
    s_waitcnt vmcnt(0)
    s_mov_b64 exec, 0x1
    global_store_dword v1, v232, s[72:73] offset:0 sc1
    s_mov_b64 exec, -1
Lam_89:
    s_branch Lad_86
Lax_87:
    s_waitcnt lgkmcnt(2)
    v_mfma_f32_32x32x16_bf16 v[96:111], a[8:11], v[200:203], 0
    ds_read_b128 v[212:215], v6 offset:96
    v_mfma_f32_32x32x16_bf16 v[112:127], a[12:15], v[200:203], 0
    s_waitcnt lgkmcnt(2)
    v_mfma_f32_32x32x16_bf16 v[96:111], a[24:27], v[204:207], v[96:111]
    ds_read_b128 v[200:203], v6 offset:128
    v_mfma_f32_32x32x16_bf16 v[112:127], a[28:31], v[204:207], v[112:127]
    s_waitcnt lgkmcnt(2)
    v_mfma_f32_32x32x16_bf16 v[96:111], a[40:43], v[208:211], v[96:111]
    ds_read_b128 v[204:207], v6 offset:160
    v_mfma_f32_32x32x16_bf16 v[112:127], a[44:47], v[208:211], v[112:127]
    s_waitcnt lgkmcnt(2)
    v_mfma_f32_32x32x16_bf16 v[96:111], a[56:59], v[212:215], v[96:111]
    ds_read_b128 v[208:211], v6 offset:192
    v_mfma_f32_32x32x16_bf16 v[112:127], a[60:63], v[212:215], v[112:127]
    s_waitcnt lgkmcnt(2)
    v_mfma_f32_32x32x16_bf16 v[96:111], a[72:75], v[200:203], v[96:111]
    ds_read_b128 v[212:215], v6 offset:224
    v_mfma_f32_32x32x16_bf16 v[112:127], a[76:79], v[200:203], v[112:127]
    s_waitcnt lgkmcnt(2)
    v_mfma_f32_32x32x16_bf16 v[96:111], a[88:91], v[204:207], v[96:111]
    ds_read_b128 v[200:203], v6 offset:256
    v_mfma_f32_32x32x16_bf16 v[112:127], a[92:95], v[204:207], v[112:127]
    s_waitcnt lgkmcnt(2)
    v_mfma_f32_32x32x16_bf16 v[96:111], a[104:107], v[208:211], v[96:111]
    ds_read_b128 v[204:207], v6 offset:288
    v_mfma_f32_32x32x16_bf16 v[112:127], a[108:111], v[208:211], v[112:127]
    s_waitcnt lgkmcnt(2)
    v_mfma_f32_32x32x16_bf16 v[96:111], a[120:123], v[212:215], v[96:111]
    ds_read_b128 v[208:211], v6 offset:320
    v_mfma_f32_32x32x16_bf16 v[112:127], a[124:127], v[212:215], v[112:127]
    s_waitcnt lgkmcnt(2)
    v_mfma_f32_32x32x16_bf16 v[96:111], a[136:139], v[200:203], v[96:111]
    ds_read_b128 v[212:215], v6 offset:352
    v_mfma_f32_32x32x16_bf16 v[112:127], a[140:143], v[200:203], v[112:127]
    s_waitcnt lgkmcnt(2)
    v_mfma_f32_32x32x16_bf16 v[96:111], a[152:155], v[204:207], v[96:111]
    ds_read_b128 v[200:203], v6 offset:384
    v_mfma_f32_32x32x16_bf16 v[112:127], a[156:159], v[204:207], v[112:127]
    s_waitcnt lgkmcnt(2)
    v_mfma_f32_32x32x16_bf16 v[96:111], a[168:171], v[208:211], v[96:111]
    ds_read_b128 v[204:207], v6 offset:416
    v_mfma_f32_32x32x16_bf16 v[112:127], a[172:175], v[208:211], v[112:127]
    s_waitcnt lgkmcnt(2)
    v_mfma_f32_32x32x16_bf16 v[96:111], a[184:187], v[212:215], v[96:111]
    ds_read_b128 v[208:211], v6 offset:448
    v_mfma_f32_32x32x16_bf16 v[112:127], a[188:191], v[212:215], v[112:127]
    s_waitcnt lgkmcnt(2)
    v_mfma_f32_32x32x16_bf16 v[96:111], a[200:203], v[200:203], v[96:111]
    ds_read_b128 v[212:215], v6 offset:480
    v_mfma_f32_32x32x16_bf16 v[112:127], a[204:207], v[200:203], v[112:127]
    s_waitcnt lgkmcnt(2)
    v_mfma_f32_32x32x16_bf16 v[96:111], a[216:219], v[204:207], v[96:111]
    v_mfma_f32_32x32x16_bf16 v[112:127], a[220:223], v[204:207], v[112:127]
    s_waitcnt lgkmcnt(1)
    v_mfma_f32_32x32x16_bf16 v[96:111], a[232:235], v[208:211], v[96:111]
    v_mfma_f32_32x32x16_bf16 v[112:127], a[236:239], v[208:211], v[112:127]
    s_waitcnt lgkmcnt(0)
    v_mfma_f32_32x32x16_bf16 v[96:111], a[248:251], v[212:215], v[96:111]
    v_mfma_f32_32x32x16_bf16 v[112:127], a[252:255], v[212:215], v[112:127]
    s_nop 10
    v_cvt_pk_bf16_f32 v216, v96, v97
    v_cvt_pk_bf16_f32 v217, v98, v99
    v_cvt_pk_bf16_f32 v218, v100, v101
    v_cvt_pk_bf16_f32 v219, v102, v103
    v_cvt_pk_bf16_f32 v220, v104, v105
    v_cvt_pk_bf16_f32 v221, v106, v107
    v_cvt_pk_bf16_f32 v222, v108, v109
    v_cvt_pk_bf16_f32 v223, v110, v111
    global_store_dwordx4 v168, v[216:219], s[66:67] offset:0 sc1
    global_store_dwordx4 v168, v[220:223], s[66:67] offset:1024 sc1
    v_cvt_pk_bf16_f32 v224, v112, v113
    v_cvt_pk_bf16_f32 v225, v114, v115
    v_cvt_pk_bf16_f32 v226, v116, v117
    v_cvt_pk_bf16_f32 v227, v118, v119
    v_cvt_pk_bf16_f32 v228, v120, v121
    v_cvt_pk_bf16_f32 v229, v122, v123
    v_cvt_pk_bf16_f32 v230, v124, v125
    v_cvt_pk_bf16_f32 v231, v126, v127
    global_store_dwordx4 v168, v[224:227], s[66:67] offset:2048 sc1
    global_store_dwordx4 v168, v[228:231], s[66:67] offset:3072 sc1
    s_cmp_ge_u32 s68, 62
    s_cbranch_scc1 Lal_91
    s_lshl_b32 s41, s40, 15
    s_add_u32 s64, s64, s41
    s_addc_u32 s65, s65, 0
    v_add_u32 v168, 0, v1
    v_add_u32 v169, 4096, v1
    v_add_u32 v170, 8192, v1
    v_add_u32 v171, 12288, v1
    v_add_u32 v172, 16384, v1
    v_add_u32 v173, 20480, v1
    v_add_u32 v174, 24576, v1
    v_add_u32 v172, s52, v172
    global_load_dwordx4 v[16:19], v172, s[64:65] offset:0 sc1
    global_load_dwordx4 v[20:23], v172, s[64:65] offset:1024 sc1
    global_load_dwordx4 v[24:27], v172, s[64:65] offset:2048 sc1
    global_load_dwordx4 v[28:31], v172, s[64:65] offset:3072 sc1
    global_load_dwordx4 v[32:35], v168, s[64:65] offset:0 sc1
    global_load_dwordx4 v[36:39], v168, s[64:65] offset:1024 sc1
    global_load_dwordx4 v[40:43], v168, s[64:65] offset:2048 sc1
    global_load_dwordx4 v[44:47], v168, s[64:65] offset:3072 sc1
    global_load_dwordx4 v[48:51], v169, s[64:65] offset:0 sc1
    global_load_dwordx4 v[52:55], v169, s[64:65] offset:1024 sc1
    global_load_dwordx4 v[56:59], v169, s[64:65] offset:2048 sc1
    global_load_dwordx4 v[60:63], v169, s[64:65] offset:3072 sc1
    global_load_dwordx4 v[64:67], v170, s[64:65] offset:0 sc1
    global_load_dwordx4 v[68:71], v170, s[64:65] offset:1024 sc1
    global_load_dwordx4 v[72:75], v170, s[64:65] offset:2048 sc1
    global_load_dwordx4 v[76:79], v170, s[64:65] offset:3072 sc1
    global_load_dwordx4 v[80:83], v171, s[64:65] offset:0 sc1
    global_load_dwordx4 v[84:87], v171, s[64:65] offset:1024 sc1
    global_load_dwordx4 v[88:91], v171, s[64:65] offset:2048 sc1
    global_load_dwordx4 v[92:95], v171, s[64:65] offset:3072 sc1
    v_add_u32 v173, 28672, v1
    v_mov_b32 v232, s97
    s_waitcnt vmcnt(20)
    s_mov_b64 exec, 0x1
    global_store_dword v1, v232, s[72:73] offset:128 sc1
    s_mov_b64 exec, -1
    s_branch Lam_92
Lal_91:
    v_mov_b32 v232, s97
    s_waitcnt vmcnt(0)
    s_mov_b64 exec, 0x1
    global_store_dword v1, v232, s[72:73] offset:128 sc1
    s_mov_b64 exec, -1
Lam_92:
Lad_86:
    s_mul_i32 s41, s40, 528384
    s_add_u32 s66, s66, s41
    s_addc_u32 s67, s67, 0
    s_lshl_b32 s41, s40, 14
    s_add_u32 s72, s72, s41
    s_addc_u32 s73, s73, 0
    s_lshl_b32 s41, s40, 4
    s_add_u32 s74, s74, s41
    s_addc_u32 s75, s75, 0
    s_add_u32 s68, s68, 2
    s_cmp_lt_u32 s68, 64
    s_cbranch_scc1 Lat_76
    s_waitcnt vmcnt(0)
    s_lshr_b32 s94, s96, 2
    s_add_u32 s94, s94, 8
    s_and_b32 s95, s96, 3
Low:
    s_load_dwordx2 s[40:41], s[0:1], 88
    s_lshl_b32 s46, s95, 8
    s_lshl_b32 s47, s9, 6
    s_add_u32 s46, s46, s47
    s_lshl_b32 s48, s9, 15
    s_waitcnt lgkmcnt(0)
    s_add_u32 s40, s40, s46
    s_addc_u32 s41, s41, 0
    s_barrier
    v_and_b32 v16, 63, v0
    v_bfe_u32 v17, v16, 4, 1
    v_mul_u32_u24 v17, 4, v17
    v_bfe_u32 v18, v16, 5, 1
    v_mul_u32_u24 v18, 8, v18
    v_add_u32 v17, v17, v18
    v_bfe_u32 v18, v16, 2, 2
    v_add_u32 v17, v17, v18
    v_mul_u32_u24 v17, 64, v17
    v_and_b32 v18, 3, v16
    v_lshl_add_u32 v17, v18, 4, v17
    v_add_u32 v20, s48, v17
    v_lshrrev_b32 v17, 2, v16
    v_and_b32 v18, 3, v16
    v_lshlrev_b32 v19, 4, v18
    s_mov_b32 s52, 1024
    s_add_u32 m0, s48, 0
    v_add_u32 v18, 0, v17
    v_min_u32 v18, 687, v18
    v_mad_u32_u24 v18, v18, s52, v19
    global_load_lds_dwordx4 v18, s[40:41]
    s_add_u32 m0, s48, 1024
    v_add_u32 v18, 16, v17
    v_min_u32 v18, 687, v18
    v_mad_u32_u24 v18, v18, s52, v19
    global_load_lds_dwordx4 v18, s[40:41]
    s_add_u32 m0, s48, 2048
    v_add_u32 v18, 32, v17
    v_min_u32 v18, 687, v18
    v_mad_u32_u24 v18, v18, s52, v19
    global_load_lds_dwordx4 v18, s[40:41]
    s_add_u32 m0, s48, 3072
    v_add_u32 v18, 48, v17
    v_min_u32 v18, 687, v18
    v_mad_u32_u24 v18, v18, s52, v19
    global_load_lds_dwordx4 v18, s[40:41]
    s_add_u32 m0, s48, 4096
    v_add_u32 v18, 64, v17
    v_min_u32 v18, 687, v18
    v_mad_u32_u24 v18, v18, s52, v19
    global_load_lds_dwordx4 v18, s[40:41]
    s_add_u32 m0, s48, 5120
    v_add_u32 v18, 80, v17
    v_min_u32 v18, 687, v18
    v_mad_u32_u24 v18, v18, s52, v19
    global_load_lds_dwordx4 v18, s[40:41]
    s_add_u32 m0, s48, 6144
    v_add_u32 v18, 96, v17
    v_min_u32 v18, 687, v18
    v_mad_u32_u24 v18, v18, s52, v19
    global_load_lds_dwordx4 v18, s[40:41]
    s_add_u32 m0, s48, 7168
    v_add_u32 v18, 112, v17
    v_min_u32 v18, 687, v18
    v_mad_u32_u24 v18, v18, s52, v19
    global_load_lds_dwordx4 v18, s[40:41]
    s_add_u32 m0, s48, 8192
    v_add_u32 v18, 128, v17
    v_min_u32 v18, 687, v18
    v_mad_u32_u24 v18, v18, s52, v19
    global_load_lds_dwordx4 v18, s[40:41]
    s_add_u32 m0, s48, 9216
    v_add_u32 v18, 144, v17
    v_min_u32 v18, 687, v18
    v_mad_u32_u24 v18, v18, s52, v19
    global_load_lds_dwordx4 v18, s[40:41]
    s_add_u32 m0, s48, 10240
    v_add_u32 v18, 160, v17
    v_min_u32 v18, 687, v18
    v_mad_u32_u24 v18, v18, s52, v19
    global_load_lds_dwordx4 v18, s[40:41]
    s_add_u32 m0, s48, 11264
    v_add_u32 v18, 176, v17
    v_min_u32 v18, 687, v18
    v_mad_u32_u24 v18, v18, s52, v19
    global_load_lds_dwordx4 v18, s[40:41]
    s_add_u32 m0, s48, 12288
    v_add_u32 v18, 192, v17
    v_min_u32 v18, 687, v18
    v_mad_u32_u24 v18, v18, s52, v19
    global_load_lds_dwordx4 v18, s[40:41]
    s_add_u32 m0, s48, 13312
    v_add_u32 v18, 208, v17
    v_min_u32 v18, 687, v18
    v_mad_u32_u24 v18, v18, s52, v19
    global_load_lds_dwordx4 v18, s[40:41]
    s_add_u32 m0, s48, 14336
    v_add_u32 v18, 224, v17
    v_min_u32 v18, 687, v18
    v_mad_u32_u24 v18, v18, s52, v19
    global_load_lds_dwordx4 v18, s[40:41]
    s_add_u32 m0, s48, 15360
    v_add_u32 v18, 240, v17
    v_min_u32 v18, 687, v18
    v_mad_u32_u24 v18, v18, s52, v19
    global_load_lds_dwordx4 v18, s[40:41]
    s_add_u32 m0, s48, 16384
    v_add_u32 v18, 256, v17
    v_min_u32 v18, 687, v18
    v_mad_u32_u24 v18, v18, s52, v19
    global_load_lds_dwordx4 v18, s[40:41]
    s_add_u32 m0, s48, 17408
    v_add_u32 v18, 272, v17
    v_min_u32 v18, 687, v18
    v_mad_u32_u24 v18, v18, s52, v19
    global_load_lds_dwordx4 v18, s[40:41]
    s_add_u32 m0, s48, 18432
    v_add_u32 v18, 288, v17
    v_min_u32 v18, 687, v18
    v_mad_u32_u24 v18, v18, s52, v19
    global_load_lds_dwordx4 v18, s[40:41]
    s_add_u32 m0, s48, 19456
    v_add_u32 v18, 304, v17
    v_min_u32 v18, 687, v18
    v_mad_u32_u24 v18, v18, s52, v19
    global_load_lds_dwordx4 v18, s[40:41]
    s_add_u32 m0, s48, 20480
    v_add_u32 v18, 320, v17
    v_min_u32 v18, 687, v18
    v_mad_u32_u24 v18, v18, s52, v19
    global_load_lds_dwordx4 v18, s[40:41]
    s_add_u32 m0, s48, 21504
    v_add_u32 v18, 336, v17
    v_min_u32 v18, 687, v18
    v_mad_u32_u24 v18, v18, s52, v19
    global_load_lds_dwordx4 v18, s[40:41]
    s_add_u32 m0, s48, 22528
    v_add_u32 v18, 352, v17
    v_min_u32 v18, 687, v18
    v_mad_u32_u24 v18, v18, s52, v19
    global_load_lds_dwordx4 v18, s[40:41]
    s_add_u32 m0, s48, 23552
    v_add_u32 v18, 368, v17
    v_min_u32 v18, 687, v18
    v_mad_u32_u24 v18, v18, s52, v19
    global_load_lds_dwordx4 v18, s[40:41]
    s_add_u32 m0, s48, 24576
    v_add_u32 v18, 384, v17
    v_min_u32 v18, 687, v18
    v_mad_u32_u24 v18, v18, s52, v19
    global_load_lds_dwordx4 v18, s[40:41]
    s_add_u32 m0, s48, 25600
    v_add_u32 v18, 400, v17
    v_min_u32 v18, 687, v18
    v_mad_u32_u24 v18, v18, s52, v19
    global_load_lds_dwordx4 v18, s[40:41]
    s_add_u32 m0, s48, 26624
    v_add_u32 v18, 416, v17
    v_min_u32 v18, 687, v18
    v_mad_u32_u24 v18, v18, s52, v19
    global_load_lds_dwordx4 v18, s[40:41]
    s_add_u32 m0, s48, 27648
    v_add_u32 v18, 432, v17
    v_min_u32 v18, 687, v18
    v_mad_u32_u24 v18, v18, s52, v19
    global_load_lds_dwordx4 v18, s[40:41]
    s_add_u32 m0, s48, 28672
    v_add_u32 v18, 448, v17
    v_min_u32 v18, 687, v18
    v_mad_u32_u24 v18, v18, s52, v19
    global_load_lds_dwordx4 v18, s[40:41]
    s_add_u32 m0, s48, 29696
    v_add_u32 v18, 464, v17
    v_min_u32 v18, 687, v18
    v_mad_u32_u24 v18, v18, s52, v19
    global_load_lds_dwordx4 v18, s[40:41]
    s_add_u32 m0, s48, 30720
    v_add_u32 v18, 480, v17
    v_min_u32 v18, 687, v18
    v_mad_u32_u24 v18, v18, s52, v19
    global_load_lds_dwordx4 v18, s[40:41]
    s_add_u32 m0, s48, 31744
    v_add_u32 v18, 496, v17
    v_min_u32 v18, 687, v18
    v_mad_u32_u24 v18, v18, s52, v19
    global_load_lds_dwordx4 v18, s[40:41]
    s_waitcnt vmcnt(0)
    ds_read_b64_tr_b16 a[0:1], v20 offset:0
    ds_read_b64_tr_b16 a[2:3], v20 offset:1024
    ds_read_b64_tr_b16 a[4:5], v20 offset:8
    ds_read_b64_tr_b16 a[6:7], v20 offset:1032
    ds_read_b64_tr_b16 a[8:9], v20 offset:2048
    ds_read_b64_tr_b16 a[10:11], v20 offset:3072
    ds_read_b64_tr_b16 a[12:13], v20 offset:2056
    ds_read_b64_tr_b16 a[14:15], v20 offset:3080
    ds_read_b64_tr_b16 a[16:17], v20 offset:4096
    ds_read_b64_tr_b16 a[18:19], v20 offset:5120
    ds_read_b64_tr_b16 a[20:21], v20 offset:4104
    ds_read_b64_tr_b16 a[22:23], v20 offset:5128
    ds_read_b64_tr_b16 a[24:25], v20 offset:6144
    ds_read_b64_tr_b16 a[26:27], v20 offset:7168
    ds_read_b64_tr_b16 a[28:29], v20 offset:6152
    ds_read_b64_tr_b16 a[30:31], v20 offset:7176
    ds_read_b64_tr_b16 a[32:33], v20 offset:8192
    ds_read_b64_tr_b16 a[34:35], v20 offset:9216
    ds_read_b64_tr_b16 a[36:37], v20 offset:8200
    ds_read_b64_tr_b16 a[38:39], v20 offset:9224
    ds_read_b64_tr_b16 a[40:41], v20 offset:10240
    ds_read_b64_tr_b16 a[42:43], v20 offset:11264
    ds_read_b64_tr_b16 a[44:45], v20 offset:10248
    ds_read_b64_tr_b16 a[46:47], v20 offset:11272
    ds_read_b64_tr_b16 a[48:49], v20 offset:12288
    ds_read_b64_tr_b16 a[50:51], v20 offset:13312
    ds_read_b64_tr_b16 a[52:53], v20 offset:12296
    ds_read_b64_tr_b16 a[54:55], v20 offset:13320
    ds_read_b64_tr_b16 a[56:57], v20 offset:14336
    ds_read_b64_tr_b16 a[58:59], v20 offset:15360
    ds_read_b64_tr_b16 a[60:61], v20 offset:14344
    ds_read_b64_tr_b16 a[62:63], v20 offset:15368
    ds_read_b64_tr_b16 a[64:65], v20 offset:16384
    ds_read_b64_tr_b16 a[66:67], v20 offset:17408
    ds_read_b64_tr_b16 a[68:69], v20 offset:16392
    ds_read_b64_tr_b16 a[70:71], v20 offset:17416
    ds_read_b64_tr_b16 a[72:73], v20 offset:18432
    ds_read_b64_tr_b16 a[74:75], v20 offset:19456
    ds_read_b64_tr_b16 a[76:77], v20 offset:18440
    ds_read_b64_tr_b16 a[78:79], v20 offset:19464
    ds_read_b64_tr_b16 a[80:81], v20 offset:20480
    ds_read_b64_tr_b16 a[82:83], v20 offset:21504
    ds_read_b64_tr_b16 a[84:85], v20 offset:20488
    ds_read_b64_tr_b16 a[86:87], v20 offset:21512
    ds_read_b64_tr_b16 a[88:89], v20 offset:22528
    ds_read_b64_tr_b16 a[90:91], v20 offset:23552
    ds_read_b64_tr_b16 a[92:93], v20 offset:22536
    ds_read_b64_tr_b16 a[94:95], v20 offset:23560
    ds_read_b64_tr_b16 a[96:97], v20 offset:24576
    ds_read_b64_tr_b16 a[98:99], v20 offset:25600
    ds_read_b64_tr_b16 a[100:101], v20 offset:24584
    ds_read_b64_tr_b16 a[102:103], v20 offset:25608
    ds_read_b64_tr_b16 a[104:105], v20 offset:26624
    ds_read_b64_tr_b16 a[106:107], v20 offset:27648
    ds_read_b64_tr_b16 a[108:109], v20 offset:26632
    ds_read_b64_tr_b16 a[110:111], v20 offset:27656
    ds_read_b64_tr_b16 a[112:113], v20 offset:28672
    ds_read_b64_tr_b16 a[114:115], v20 offset:29696
    ds_read_b64_tr_b16 a[116:117], v20 offset:28680
    ds_read_b64_tr_b16 a[118:119], v20 offset:29704
    ds_read_b64_tr_b16 a[120:121], v20 offset:30720
    ds_read_b64_tr_b16 a[122:123], v20 offset:31744
    ds_read_b64_tr_b16 a[124:125], v20 offset:30728
    ds_read_b64_tr_b16 a[126:127], v20 offset:31752
    s_waitcnt lgkmcnt(0)
    s_add_u32 m0, s48, 0
    v_add_u32 v18, 512, v17
    v_min_u32 v18, 687, v18
    v_mad_u32_u24 v18, v18, s52, v19
    global_load_lds_dwordx4 v18, s[40:41]
    s_add_u32 m0, s48, 1024
    v_add_u32 v18, 528, v17
    v_min_u32 v18, 687, v18
    v_mad_u32_u24 v18, v18, s52, v19
    global_load_lds_dwordx4 v18, s[40:41]
    s_add_u32 m0, s48, 2048
    v_add_u32 v18, 544, v17
    v_min_u32 v18, 687, v18
    v_mad_u32_u24 v18, v18, s52, v19
    global_load_lds_dwordx4 v18, s[40:41]
    s_add_u32 m0, s48, 3072
    v_add_u32 v18, 560, v17
    v_min_u32 v18, 687, v18
    v_mad_u32_u24 v18, v18, s52, v19
    global_load_lds_dwordx4 v18, s[40:41]
    s_add_u32 m0, s48, 4096
    v_add_u32 v18, 576, v17
    v_min_u32 v18, 687, v18
    v_mad_u32_u24 v18, v18, s52, v19
    global_load_lds_dwordx4 v18, s[40:41]
    s_add_u32 m0, s48, 5120
    v_add_u32 v18, 592, v17
    v_min_u32 v18, 687, v18
    v_mad_u32_u24 v18, v18, s52, v19
    global_load_lds_dwordx4 v18, s[40:41]
    s_add_u32 m0, s48, 6144
    v_add_u32 v18, 608, v17
    v_min_u32 v18, 687, v18
    v_mad_u32_u24 v18, v18, s52, v19
    global_load_lds_dwordx4 v18, s[40:41]
    s_add_u32 m0, s48, 7168
    v_add_u32 v18, 624, v17
    v_min_u32 v18, 687, v18
    v_mad_u32_u24 v18, v18, s52, v19
    global_load_lds_dwordx4 v18, s[40:41]
    s_add_u32 m0, s48, 8192
    v_add_u32 v18, 640, v17
    v_min_u32 v18, 687, v18
    v_mad_u32_u24 v18, v18, s52, v19
    global_load_lds_dwordx4 v18, s[40:41]
    s_add_u32 m0, s48, 9216
    v_add_u32 v18, 656, v17
    v_min_u32 v18, 687, v18
    v_mad_u32_u24 v18, v18, s52, v19
    global_load_lds_dwordx4 v18, s[40:41]
    s_add_u32 m0, s48, 10240
    v_add_u32 v18, 672, v17
    v_min_u32 v18, 687, v18
    v_mad_u32_u24 v18, v18, s52, v19
    global_load_lds_dwordx4 v18, s[40:41]
    s_add_u32 m0, s48, 11264
    v_add_u32 v18, 688, v17
    v_min_u32 v18, 687, v18
    v_mad_u32_u24 v18, v18, s52, v19
    global_load_lds_dwordx4 v18, s[40:41]
    s_waitcnt vmcnt(0)
    ds_read_b64_tr_b16 a[128:129], v20 offset:0
    ds_read_b64_tr_b16 a[130:131], v20 offset:1024
    ds_read_b64_tr_b16 a[132:133], v20 offset:8
    ds_read_b64_tr_b16 a[134:135], v20 offset:1032
    ds_read_b64_tr_b16 a[136:137], v20 offset:2048
    ds_read_b64_tr_b16 a[138:139], v20 offset:3072
    ds_read_b64_tr_b16 a[140:141], v20 offset:2056
    ds_read_b64_tr_b16 a[142:143], v20 offset:3080
    ds_read_b64_tr_b16 a[144:145], v20 offset:4096
    ds_read_b64_tr_b16 a[146:147], v20 offset:5120
    ds_read_b64_tr_b16 a[148:149], v20 offset:4104
    ds_read_b64_tr_b16 a[150:151], v20 offset:5128
    ds_read_b64_tr_b16 a[152:153], v20 offset:6144
    ds_read_b64_tr_b16 a[154:155], v20 offset:7168
    ds_read_b64_tr_b16 a[156:157], v20 offset:6152
    ds_read_b64_tr_b16 a[158:159], v20 offset:7176
    ds_read_b64_tr_b16 a[160:161], v20 offset:8192
    ds_read_b64_tr_b16 a[162:163], v20 offset:9216
    ds_read_b64_tr_b16 a[164:165], v20 offset:8200
    ds_read_b64_tr_b16 a[166:167], v20 offset:9224
    ds_read_b64_tr_b16 a[168:169], v20 offset:10240
    ds_read_b64_tr_b16 a[170:171], v20 offset:11264
    ds_read_b64_tr_b16 a[172:173], v20 offset:10248
    ds_read_b64_tr_b16 a[174:175], v20 offset:11272
    s_waitcnt lgkmcnt(0)
    s_barrier
    s_branch Lout
Lidle:
    v_mov_b32 v2, 127401984
    s_mov_b32 s60, 0
    s_mov_b64 exec, 0x1
    global_load_dword v3, v2, s[4:5] sc1
    s_waitcnt vmcnt(0)
    v_cmp_ne_u32 vcc, s97, v3
    s_cbranch_vccz Lwf_94
    global_load_dword v3, v2, s[4:5] sc1
    s_sleep 2
Lwf_93:
    global_load_dword v3, v2, s[4:5] sc1
    s_add_u32 s60, s60, 1
    s_cmp_gt_u32 s60, 1000000
    s_cbranch_scc1 Lfail
    s_waitcnt vmcnt(1)
    v_cmp_ne_u32 vcc, s97, v3
    s_cbranch_vccz Lwf_94
    s_sleep 16
    s_branch Lwf_93
Lwf_94:
    s_waitcnt vmcnt(0)
    s_mov_b64 exec, -1
    s_branch Lend
Llate:
    s_mul_i32 s96, s8, 3
    s_add_u32 s96, s96, s40
    s_add_u32 s96, s96, 128
Lnota:
    s_and_b32 s95, s96, 3
    s_sub_u32 s94, s96, 64
    s_sub_u32 s40, s96, 128
    s_cmp_ge_u32 s96, 204
    s_cselect_b32 s94, s40, s94
    s_lshr_b32 s94, s94, 2
    s_add_u32 s94, s94, 24
    s_load_dwordx2 s[40:41], s[0:1], 88
    s_lshl_b32 s46, s95, 8
    s_lshl_b32 s47, s9, 6
    s_add_u32 s46, s46, s47
    s_lshl_b32 s48, s9, 15
    s_waitcnt lgkmcnt(0)
    s_add_u32 s40, s40, s46
    s_addc_u32 s41, s41, 0
    s_barrier
    v_and_b32 v16, 63, v0
    v_bfe_u32 v17, v16, 4, 1
    v_mul_u32_u24 v17, 4, v17
    v_bfe_u32 v18, v16, 5, 1
    v_mul_u32_u24 v18, 8, v18
    v_add_u32 v17, v17, v18
    v_bfe_u32 v18, v16, 2, 2
    v_add_u32 v17, v17, v18
    v_mul_u32_u24 v17, 64, v17
    v_and_b32 v18, 3, v16
    v_lshl_add_u32 v17, v18, 4, v17
    v_add_u32 v20, s48, v17
    v_lshrrev_b32 v17, 2, v16
    v_and_b32 v18, 3, v16
    v_lshlrev_b32 v19, 4, v18
    s_mov_b32 s52, 1024
    s_add_u32 m0, s48, 0
    v_add_u32 v18, 0, v17
    v_min_u32 v18, 687, v18
    v_mad_u32_u24 v18, v18, s52, v19
    global_load_lds_dwordx4 v18, s[40:41]
    s_add_u32 m0, s48, 1024
    v_add_u32 v18, 16, v17
    v_min_u32 v18, 687, v18
    v_mad_u32_u24 v18, v18, s52, v19
    global_load_lds_dwordx4 v18, s[40:41]
    s_add_u32 m0, s48, 2048
    v_add_u32 v18, 32, v17
    v_min_u32 v18, 687, v18
    v_mad_u32_u24 v18, v18, s52, v19
    global_load_lds_dwordx4 v18, s[40:41]
    s_add_u32 m0, s48, 3072
    v_add_u32 v18, 48, v17
    v_min_u32 v18, 687, v18
    v_mad_u32_u24 v18, v18, s52, v19
    global_load_lds_dwordx4 v18, s[40:41]
    s_add_u32 m0, s48, 4096
    v_add_u32 v18, 64, v17
    v_min_u32 v18, 687, v18
    v_mad_u32_u24 v18, v18, s52, v19
    global_load_lds_dwordx4 v18, s[40:41]
    s_add_u32 m0, s48, 5120
    v_add_u32 v18, 80, v17
    v_min_u32 v18, 687, v18
    v_mad_u32_u24 v18, v18, s52, v19
    global_load_lds_dwordx4 v18, s[40:41]
    s_add_u32 m0, s48, 6144
    v_add_u32 v18, 96, v17
    v_min_u32 v18, 687, v18
    v_mad_u32_u24 v18, v18, s52, v19
    global_load_lds_dwordx4 v18, s[40:41]
    s_add_u32 m0, s48, 7168
    v_add_u32 v18, 112, v17
    v_min_u32 v18, 687, v18
    v_mad_u32_u24 v18, v18, s52, v19
    global_load_lds_dwordx4 v18, s[40:41]
    s_add_u32 m0, s48, 8192
    v_add_u32 v18, 128, v17
    v_min_u32 v18, 687, v18
    v_mad_u32_u24 v18, v18, s52, v19
    global_load_lds_dwordx4 v18, s[40:41]
    s_add_u32 m0, s48, 9216
    v_add_u32 v18, 144, v17
    v_min_u32 v18, 687, v18
    v_mad_u32_u24 v18, v18, s52, v19
    global_load_lds_dwordx4 v18, s[40:41]
    s_add_u32 m0, s48, 10240
    v_add_u32 v18, 160, v17
    v_min_u32 v18, 687, v18
    v_mad_u32_u24 v18, v18, s52, v19
    global_load_lds_dwordx4 v18, s[40:41]
    s_add_u32 m0, s48, 11264
    v_add_u32 v18, 176, v17
    v_min_u32 v18, 687, v18
    v_mad_u32_u24 v18, v18, s52, v19
    global_load_lds_dwordx4 v18, s[40:41]
    s_add_u32 m0, s48, 12288
    v_add_u32 v18, 192, v17
    v_min_u32 v18, 687, v18
    v_mad_u32_u24 v18, v18, s52, v19
    global_load_lds_dwordx4 v18, s[40:41]
    s_add_u32 m0, s48, 13312
    v_add_u32 v18, 208, v17
    v_min_u32 v18, 687, v18
    v_mad_u32_u24 v18, v18, s52, v19
    global_load_lds_dwordx4 v18, s[40:41]
    s_add_u32 m0, s48, 14336
    v_add_u32 v18, 224, v17
    v_min_u32 v18, 687, v18
    v_mad_u32_u24 v18, v18, s52, v19
    global_load_lds_dwordx4 v18, s[40:41]
    s_add_u32 m0, s48, 15360
    v_add_u32 v18, 240, v17
    v_min_u32 v18, 687, v18
    v_mad_u32_u24 v18, v18, s52, v19
    global_load_lds_dwordx4 v18, s[40:41]
    s_add_u32 m0, s48, 16384
    v_add_u32 v18, 256, v17
    v_min_u32 v18, 687, v18
    v_mad_u32_u24 v18, v18, s52, v19
    global_load_lds_dwordx4 v18, s[40:41]
    s_add_u32 m0, s48, 17408
    v_add_u32 v18, 272, v17
    v_min_u32 v18, 687, v18
    v_mad_u32_u24 v18, v18, s52, v19
    global_load_lds_dwordx4 v18, s[40:41]
    s_add_u32 m0, s48, 18432
    v_add_u32 v18, 288, v17
    v_min_u32 v18, 687, v18
    v_mad_u32_u24 v18, v18, s52, v19
    global_load_lds_dwordx4 v18, s[40:41]
    s_add_u32 m0, s48, 19456
    v_add_u32 v18, 304, v17
    v_min_u32 v18, 687, v18
    v_mad_u32_u24 v18, v18, s52, v19
    global_load_lds_dwordx4 v18, s[40:41]
    s_add_u32 m0, s48, 20480
    v_add_u32 v18, 320, v17
    v_min_u32 v18, 687, v18
    v_mad_u32_u24 v18, v18, s52, v19
    global_load_lds_dwordx4 v18, s[40:41]
    s_add_u32 m0, s48, 21504
    v_add_u32 v18, 336, v17
    v_min_u32 v18, 687, v18
    v_mad_u32_u24 v18, v18, s52, v19
    global_load_lds_dwordx4 v18, s[40:41]
    s_add_u32 m0, s48, 22528
    v_add_u32 v18, 352, v17
    v_min_u32 v18, 687, v18
    v_mad_u32_u24 v18, v18, s52, v19
    global_load_lds_dwordx4 v18, s[40:41]
    s_add_u32 m0, s48, 23552
    v_add_u32 v18, 368, v17
    v_min_u32 v18, 687, v18
    v_mad_u32_u24 v18, v18, s52, v19
    global_load_lds_dwordx4 v18, s[40:41]
    s_add_u32 m0, s48, 24576
    v_add_u32 v18, 384, v17
    v_min_u32 v18, 687, v18
    v_mad_u32_u24 v18, v18, s52, v19
    global_load_lds_dwordx4 v18, s[40:41]
    s_add_u32 m0, s48, 25600
    v_add_u32 v18, 400, v17
    v_min_u32 v18, 687, v18
    v_mad_u32_u24 v18, v18, s52, v19
    global_load_lds_dwordx4 v18, s[40:41]
    s_add_u32 m0, s48, 26624
    v_add_u32 v18, 416, v17
    v_min_u32 v18, 687, v18
    v_mad_u32_u24 v18, v18, s52, v19
    global_load_lds_dwordx4 v18, s[40:41]
    s_add_u32 m0, s48, 27648
    v_add_u32 v18, 432, v17
    v_min_u32 v18, 687, v18
    v_mad_u32_u24 v18, v18, s52, v19
    global_load_lds_dwordx4 v18, s[40:41]
    s_add_u32 m0, s48, 28672
    v_add_u32 v18, 448, v17
    v_min_u32 v18, 687, v18
    v_mad_u32_u24 v18, v18, s52, v19
    global_load_lds_dwordx4 v18, s[40:41]
    s_add_u32 m0, s48, 29696
    v_add_u32 v18, 464, v17
    v_min_u32 v18, 687, v18
    v_mad_u32_u24 v18, v18, s52, v19
    global_load_lds_dwordx4 v18, s[40:41]
    s_add_u32 m0, s48, 30720
    v_add_u32 v18, 480, v17
    v_min_u32 v18, 687, v18
    v_mad_u32_u24 v18, v18, s52, v19
    global_load_lds_dwordx4 v18, s[40:41]
    s_add_u32 m0, s48, 31744
    v_add_u32 v18, 496, v17
    v_min_u32 v18, 687, v18
    v_mad_u32_u24 v18, v18, s52, v19
    global_load_lds_dwordx4 v18, s[40:41]
    s_waitcnt vmcnt(0)
    ds_read_b64_tr_b16 a[0:1], v20 offset:0
    ds_read_b64_tr_b16 a[2:3], v20 offset:1024
    ds_read_b64_tr_b16 a[4:5], v20 offset:8
    ds_read_b64_tr_b16 a[6:7], v20 offset:1032
    ds_read_b64_tr_b16 a[8:9], v20 offset:2048
    ds_read_b64_tr_b16 a[10:11], v20 offset:3072
    ds_read_b64_tr_b16 a[12:13], v20 offset:2056
    ds_read_b64_tr_b16 a[14:15], v20 offset:3080
    ds_read_b64_tr_b16 a[16:17], v20 offset:4096
    ds_read_b64_tr_b16 a[18:19], v20 offset:5120
    ds_read_b64_tr_b16 a[20:21], v20 offset:4104
    ds_read_b64_tr_b16 a[22:23], v20 offset:5128
    ds_read_b64_tr_b16 a[24:25], v20 offset:6144
    ds_read_b64_tr_b16 a[26:27], v20 offset:7168
    ds_read_b64_tr_b16 a[28:29], v20 offset:6152
    ds_read_b64_tr_b16 a[30:31], v20 offset:7176
    ds_read_b64_tr_b16 a[32:33], v20 offset:8192
    ds_read_b64_tr_b16 a[34:35], v20 offset:9216
    ds_read_b64_tr_b16 a[36:37], v20 offset:8200
    ds_read_b64_tr_b16 a[38:39], v20 offset:9224
    ds_read_b64_tr_b16 a[40:41], v20 offset:10240
    ds_read_b64_tr_b16 a[42:43], v20 offset:11264
    ds_read_b64_tr_b16 a[44:45], v20 offset:10248
    ds_read_b64_tr_b16 a[46:47], v20 offset:11272
    ds_read_b64_tr_b16 a[48:49], v20 offset:12288
    ds_read_b64_tr_b16 a[50:51], v20 offset:13312
    ds_read_b64_tr_b16 a[52:53], v20 offset:12296
    ds_read_b64_tr_b16 a[54:55], v20 offset:13320
    ds_read_b64_tr_b16 a[56:57], v20 offset:14336
    ds_read_b64_tr_b16 a[58:59], v20 offset:15360
    ds_read_b64_tr_b16 a[60:61], v20 offset:14344
    ds_read_b64_tr_b16 a[62:63], v20 offset:15368
    ds_read_b64_tr_b16 a[64:65], v20 offset:16384
    ds_read_b64_tr_b16 a[66:67], v20 offset:17408
    ds_read_b64_tr_b16 a[68:69], v20 offset:16392
    ds_read_b64_tr_b16 a[70:71], v20 offset:17416
    ds_read_b64_tr_b16 a[72:73], v20 offset:18432
    ds_read_b64_tr_b16 a[74:75], v20 offset:19456
    ds_read_b64_tr_b16 a[76:77], v20 offset:18440
    ds_read_b64_tr_b16 a[78:79], v20 offset:19464
    ds_read_b64_tr_b16 a[80:81], v20 offset:20480
    ds_read_b64_tr_b16 a[82:83], v20 offset:21504
    ds_read_b64_tr_b16 a[84:85], v20 offset:20488
    ds_read_b64_tr_b16 a[86:87], v20 offset:21512
    ds_read_b64_tr_b16 a[88:89], v20 offset:22528
    ds_read_b64_tr_b16 a[90:91], v20 offset:23552
    ds_read_b64_tr_b16 a[92:93], v20 offset:22536
    ds_read_b64_tr_b16 a[94:95], v20 offset:23560
    ds_read_b64_tr_b16 a[96:97], v20 offset:24576
    ds_read_b64_tr_b16 a[98:99], v20 offset:25600
    ds_read_b64_tr_b16 a[100:101], v20 offset:24584
    ds_read_b64_tr_b16 a[102:103], v20 offset:25608
    ds_read_b64_tr_b16 a[104:105], v20 offset:26624
    ds_read_b64_tr_b16 a[106:107], v20 offset:27648
    ds_read_b64_tr_b16 a[108:109], v20 offset:26632
    ds_read_b64_tr_b16 a[110:111], v20 offset:27656
    ds_read_b64_tr_b16 a[112:113], v20 offset:28672
    ds_read_b64_tr_b16 a[114:115], v20 offset:29696
    ds_read_b64_tr_b16 a[116:117], v20 offset:28680
    ds_read_b64_tr_b16 a[118:119], v20 offset:29704
    ds_read_b64_tr_b16 a[120:121], v20 offset:30720
    ds_read_b64_tr_b16 a[122:123], v20 offset:31744
    ds_read_b64_tr_b16 a[124:125], v20 offset:30728
    ds_read_b64_tr_b16 a[126:127], v20 offset:31752
    s_waitcnt lgkmcnt(0)
    s_add_u32 m0, s48, 0
    v_add_u32 v18, 512, v17
    v_min_u32 v18, 687, v18
    v_mad_u32_u24 v18, v18, s52, v19
    global_load_lds_dwordx4 v18, s[40:41]
    s_add_u32 m0, s48, 1024
    v_add_u32 v18, 528, v17
    v_min_u32 v18, 687, v18
    v_mad_u32_u24 v18, v18, s52, v19
    global_load_lds_dwordx4 v18, s[40:41]
    s_add_u32 m0, s48, 2048
    v_add_u32 v18, 544, v17
    v_min_u32 v18, 687, v18
    v_mad_u32_u24 v18, v18, s52, v19
    global_load_lds_dwordx4 v18, s[40:41]
    s_add_u32 m0, s48, 3072
    v_add_u32 v18, 560, v17
    v_min_u32 v18, 687, v18
    v_mad_u32_u24 v18, v18, s52, v19
    global_load_lds_dwordx4 v18, s[40:41]
    s_add_u32 m0, s48, 4096
    v_add_u32 v18, 576, v17
    v_min_u32 v18, 687, v18
    v_mad_u32_u24 v18, v18, s52, v19
    global_load_lds_dwordx4 v18, s[40:41]
    s_add_u32 m0, s48, 5120
    v_add_u32 v18, 592, v17
    v_min_u32 v18, 687, v18
    v_mad_u32_u24 v18, v18, s52, v19
    global_load_lds_dwordx4 v18, s[40:41]
    s_add_u32 m0, s48, 6144
    v_add_u32 v18, 608, v17
    v_min_u32 v18, 687, v18
    v_mad_u32_u24 v18, v18, s52, v19
    global_load_lds_dwordx4 v18, s[40:41]
    s_add_u32 m0, s48, 7168
    v_add_u32 v18, 624, v17
    v_min_u32 v18, 687, v18
    v_mad_u32_u24 v18, v18, s52, v19
    global_load_lds_dwordx4 v18, s[40:41]
    s_add_u32 m0, s48, 8192
    v_add_u32 v18, 640, v17
    v_min_u32 v18, 687, v18
    v_mad_u32_u24 v18, v18, s52, v19
    global_load_lds_dwordx4 v18, s[40:41]
    s_add_u32 m0, s48, 9216
    v_add_u32 v18, 656, v17
    v_min_u32 v18, 687, v18
    v_mad_u32_u24 v18, v18, s52, v19
    global_load_lds_dwordx4 v18, s[40:41]
    s_add_u32 m0, s48, 10240
    v_add_u32 v18, 672, v17
    v_min_u32 v18, 687, v18
    v_mad_u32_u24 v18, v18, s52, v19
    global_load_lds_dwordx4 v18, s[40:41]
    s_add_u32 m0, s48, 11264
    v_add_u32 v18, 688, v17
    v_min_u32 v18, 687, v18
    v_mad_u32_u24 v18, v18, s52, v19
    global_load_lds_dwordx4 v18, s[40:41]
    s_waitcnt vmcnt(0)
    ds_read_b64_tr_b16 a[128:129], v20 offset:0
    ds_read_b64_tr_b16 a[130:131], v20 offset:1024
    ds_read_b64_tr_b16 a[132:133], v20 offset:8
    ds_read_b64_tr_b16 a[134:135], v20 offset:1032
    ds_read_b64_tr_b16 a[136:137], v20 offset:2048
    ds_read_b64_tr_b16 a[138:139], v20 offset:3072
    ds_read_b64_tr_b16 a[140:141], v20 offset:2056
    ds_read_b64_tr_b16 a[142:143], v20 offset:3080
    ds_read_b64_tr_b16 a[144:145], v20 offset:4096
    ds_read_b64_tr_b16 a[146:147], v20 offset:5120
    ds_read_b64_tr_b16 a[148:149], v20 offset:4104
    ds_read_b64_tr_b16 a[150:151], v20 offset:5128
    ds_read_b64_tr_b16 a[152:153], v20 offset:6144
    ds_read_b64_tr_b16 a[154:155], v20 offset:7168
    ds_read_b64_tr_b16 a[156:157], v20 offset:6152
    ds_read_b64_tr_b16 a[158:159], v20 offset:7176
    ds_read_b64_tr_b16 a[160:161], v20 offset:8192
    ds_read_b64_tr_b16 a[162:163], v20 offset:9216
    ds_read_b64_tr_b16 a[164:165], v20 offset:8200
    ds_read_b64_tr_b16 a[166:167], v20 offset:9224
    ds_read_b64_tr_b16 a[168:169], v20 offset:10240
    ds_read_b64_tr_b16 a[170:171], v20 offset:11264
    ds_read_b64_tr_b16 a[172:173], v20 offset:10248
    ds_read_b64_tr_b16 a[174:175], v20 offset:11272
    s_waitcnt lgkmcnt(0)
    s_barrier
    s_cmp_lt_u32 s96, 204
    s_cbranch_scc1 Lnosp
    v_mov_b32 v2, 328640
    s_mov_b32 s60, 0
    s_mov_b64 exec, 0x1
    global_load_dword v3, v2, s[4:5] sc1
    s_waitcnt vmcnt(0)
    v_cmp_ne_u32 vcc, s97, v3
    s_cbranch_vccz Lwf_96
    global_load_dword v3, v2, s[4:5] sc1
    s_sleep 2
Lwf_95:
    global_load_dword v3, v2, s[4:5] sc1
    s_add_u32 s60, s60, 1
    s_cmp_gt_u32 s60, 1000000
    s_cbranch_scc1 Lfail
    s_waitcnt vmcnt(1)
    v_cmp_ne_u32 vcc, s97, v3
    s_cbranch_vccz Lwf_96
    s_sleep 32
    s_branch Lwf_95
Lwf_96:
    s_waitcnt vmcnt(0)
    s_mov_b64 exec, -1
    s_branch Lout
Lnosp:
    s_cmp_lt_u32 s96, 108
    s_cbranch_scc1 Lnotr
    s_cmp_ge_u32 s96, 140
    s_cbranch_scc1 Lg1
    s_sub_u32 s3, s96, 108
    s_and_b32 s8, s3, 7
    s_lshr_b32 s3, s3, 3
    s_load_dwordx2 s[40:41], s[0:1], 0
    v_and_b32 v96, 63, v0
    v_and_b32 v97, 3, v96
    v_lshrrev_b32 v98, 2, v96
    v_lshlrev_b32 v1, 9, v98
    v_lshl_add_u32 v1, v97, 4, v1
    v_lshrrev_b32 v99, 2, v98
    v_lshlrev_b32 v99, 6, v99
    v_bfe_u32 v100, v98, 1, 1
    v_lshl_add_u32 v99, v100, 5, v99
    v_and_b32 v100, 1, v98
    v_lshl_add_u32 v99, v100, 3, v99
    s_lshl_b32 s42, s9, 8
    v_add_u32 v99, s42, v99
    v_lshl_add_u32 v2, v97, 10, v99
    v_and_b32 v100, 0xffe0, v99
    v_add_u32 v99, v99, v100
    v_add_u32 v99, 495616, v99
    v_and_b32 v100, 63, v0
    v_lshlrev_b32 v100, 6, v100
    v_add_u32 v100, 495648, v100
    s_mov_b32 s60, 0
    s_mov_b64 exec, -1
    global_load_dword v101, v100, s[4:5] sc1
    s_waitcnt vmcnt(0)
    v_cmp_ne_u32 vcc, s97, v101
    s_cbranch_vccz Lwf_98
    global_load_dword v101, v100, s[4:5] sc1
    s_sleep 2
Lwf_97:
    global_load_dword v101, v100, s[4:5] sc1
    s_add_u32 s60, s60, 1
    s_cmp_gt_u32 s60, 1000000
    s_cbranch_scc1 Lfail
    s_waitcnt vmcnt(1)
    v_cmp_ne_u32 vcc, s97, v101
    s_cbranch_vccz Lwf_98
    s_sleep 1
    s_branch Lwf_97
Lwf_98:
    s_waitcnt vmcnt(0)
    s_mov_b64 exec, -1
    v_add_u32 v100, 4096, v100
    s_mov_b32 s60, 0
    s_mov_b64 exec, 0xffffffff
    global_load_dword v101, v100, s[4:5] sc1
    s_waitcnt vmcnt(0)
    v_cmp_ne_u32 vcc, s97, v101
    s_cbranch_vccz Lwf_100
    global_load_dword v101, v100, s[4:5] sc1
    s_sleep 2
Lwf_99:
    global_load_dword v101, v100, s[4:5] sc1
    s_add_u32 s60, s60, 1
    s_cmp_gt_u32 s60, 1000000
    s_cbranch_scc1 Lfail
    s_waitcnt vmcnt(1)
    v_cmp_ne_u32 vcc, s97, v101
    s_cbranch_vccz Lwf_100
    s_sleep 1
    s_branch Lwf_99
Lwf_100:
    s_waitcnt vmcnt(0)
    s_mov_b64 exec, -1
    v_add_u32 v100, 4096, v99
    global_load_dwordx2 v[104:105], v99, s[4:5] offset:0 sc1
    global_load_dwordx2 v[106:107], v99, s[4:5] offset:16 sc1
    global_load_dwordx2 v[108:109], v99, s[4:5] offset:2048 sc1
    global_load_dwordx2 v[110:111], v99, s[4:5] offset:2064 sc1
    global_load_dwordx2 v[112:113], v100, s[4:5] offset:0 sc1
    global_load_dwordx2 v[114:115], v100, s[4:5] offset:16 sc1
    v_lshrrev_b32 v100, 2, v98
    v_lshlrev_b32 v3, 10, v100
    v_and_b32 v100, 3, v98
    v_lshl_add_u32 v3, v100, 8, v3
    v_lshl_add_u32 v3, v97, 4, v3
    v_lshlrev_b32 v4, 2, v96
    v_lshlrev_b32 v7, 7, v96
    v_lshlrev_b32 v6, 4, v97
    s_lshl_b32 s43, s9, 2
    v_lshl_add_u32 v5, v97, 4, s43
    v_mov_b32 v12, 0x3f80
    v_mov_b32 v13, 0x3f800000
    s_and_b32 s44, s8, 1
    s_lshr_b32 s45, s8, 1
    s_waitcnt lgkmcnt(0)
    s_mul_i32 s46, s3, 528384
    s_add_u32 s64, s4, 75497472
    s_addc_u32 s65, s5, 0
    s_lshl_b32 s51, s46, 0
    s_add_u32 s64, s64, s51
    s_addc_u32 s65, s65, 0
    s_lshl_b32 s51, s9, 13
    s_add_u32 s64, s64, s51
    s_addc_u32 s65, s65, 0
    s_lshl_b32 s51, s8, 6
    s_add_u32 s64, s64, s51
    s_addc_u32 s65, s65, 0
    s_add_u32 s66, s40, 0
    s_addc_u32 s67, s41, 0
    s_lshl_b32 s51, s3, 15
    s_add_u32 s66, s66, s51
    s_addc_u32 s67, s67, 0
    s_lshl_b32 s51, s8, 12
    s_add_u32 s66, s66, s51
    s_addc_u32 s67, s67, 0
    s_add_u32 s68, s4, 109576192
    s_addc_u32 s69, s5, 0
    s_lshl_b32 s51, s3, 15
    s_add_u32 s68, s68, s51
    s_addc_u32 s69, s69, 0
    s_lshl_b32 s51, s9, 12
    s_add_u32 s68, s68, s51
    s_addc_u32 s69, s69, 0
    s_lshl_b32 s51, s44, 14
    s_add_u32 s68, s68, s51
    s_addc_u32 s69, s69, 0
    s_lshl_b32 s51, s45, 6
    s_add_u32 s68, s68, s51
    s_addc_u32 s69, s69, 0
    s_add_u32 s70, s4, 111673344
    s_addc_u32 s71, s5, 0
    s_lshl_b32 s51, s3, 15
    s_add_u32 s70, s70, s51
    s_addc_u32 s71, s71, 0
    s_lshl_b32 s51, s9, 12
    s_add_u32 s70, s70, s51
    s_addc_u32 s71, s71, 0
    s_lshl_b32 s51, s44, 14
    s_add_u32 s70, s70, s51
    s_addc_u32 s71, s71, 0
    s_lshl_b32 s51, s45, 6
    s_add_u32 s70, s70, s51
    s_addc_u32 s71, s71, 0
    s_add_u32 s72, s4, 127926272
    s_addc_u32 s73, s5, 0
    s_lshl_b32 s51, s3, 14
    s_add_u32 s72, s72, s51
    s_addc_u32 s73, s73, 0
    s_lshl_b32 s51, s9, 12
    s_add_u32 s72, s72, s51
    s_addc_u32 s73, s73, 0
    s_add_u32 s74, s4, 128974848
    s_addc_u32 s75, s5, 0
    s_lshl_b32 s51, s3, 11
    s_add_u32 s74, s74, s51
    s_addc_u32 s75, s75, 0
    s_lshl_b32 s51, s8, 7
    s_add_u32 s74, s74, s51
    s_addc_u32 s75, s75, 0
    v_lshlrev_b32 v14, 10, v96
    s_waitcnt vmcnt(0)
    v_lshlrev_b32 v16, 16, v104
    v_and_b32 v17, 0xffff0000, v104
    v_lshlrev_b32 v18, 16, v105
    v_and_b32 v19, 0xffff0000, v105
    v_lshlrev_b32 v20, 16, v106
    v_and_b32 v21, 0xffff0000, v106
    v_lshlrev_b32 v22, 16, v107
    v_and_b32 v23, 0xffff0000, v107
    v_lshlrev_b32 v24, 16, v108
    v_and_b32 v25, 0xffff0000, v108
    v_lshlrev_b32 v26, 16, v109
    v_and_b32 v27, 0xffff0000, v109
    v_lshlrev_b32 v28, 16, v110
    v_and_b32 v29, 0xffff0000, v110
    v_lshlrev_b32 v30, 16, v111
    v_and_b32 v31, 0xffff0000, v111
    v_lshlrev_b32 v32, 16, v112
    v_and_b32 v33, 0xffff0000, v112
    v_lshlrev_b32 v34, 16, v113
    v_and_b32 v35, 0xffff0000, v113
    v_lshlrev_b32 v36, 16, v114
    v_and_b32 v37, 0xffff0000, v114
    v_lshlrev_b32 v38, 16, v115
    v_and_b32 v39, 0xffff0000, v115
    s_mov_b32 s76, s3
Lr_101:
    global_load_dwordx2 v[56:57], v2, s[66:67] offset:0
    global_load_dwordx2 v[58:59], v2, s[66:67] offset:16
    v_mov_b32 v48, 0
    v_mov_b32 v49, 0
    v_mov_b32 v50, 0
    v_mov_b32 v51, 0
    v_mov_b32 v52, 0
    v_mov_b32 v53, 0
    v_mov_b32 v54, 0
    v_mov_b32 v55, 0
    s_mov_b32 s60, 0
    s_mov_b64 exec, 0xffffffff
    global_load_dword v11, v7, s[72:73] sc1
    s_waitcnt vmcnt(0)
    v_cmp_ne_u32 vcc, s97, v11
    s_cbranch_vccz Lwf_103
    global_load_dword v11, v7, s[72:73] sc1
    s_sleep 2
Lwf_102:
    global_load_dword v11, v7, s[72:73] sc1
    s_add_u32 s60, s60, 1
    s_cmp_gt_u32 s60, 1000000
    s_cbranch_scc1 Lfail
    s_waitcnt vmcnt(1)
    v_cmp_ne_u32 vcc, s97, v11
    s_cbranch_vccz Lwf_103
    s_sleep 1
    s_cmp_ge_u32 s76, 52
    s_cbranch_scc1 Lwf_102
    s_sleep 12
    s_branch Lwf_102
Lwf_103:
    s_mov_b64 exec, -1
    v_mov_b32 v8, v1
    global_load_dwordx4 v[96:99], v8, s[64:65] sc1
    v_add_u32 v9, 33024, v1
    global_load_dwordx4 v[100:103], v9, s[64:65] sc1
    v_add_u32 v8, 66048, v1
    global_load_dwordx4 v[104:107], v8, s[64:65] sc1
    v_add_u32 v9, 99072, v1
    global_load_dwordx4 v[108:111], v9, s[64:65] sc1
    v_add_u32 v8, 132096, v1
    global_load_dwordx4 v[112:115], v8, s[64:65] sc1
    v_add_u32 v9, 165120, v1
    global_load_dwordx4 v[116:119], v9, s[64:65] sc1
    v_add_u32 v8, 198144, v1
    global_load_dwordx4 v[120:123], v8, s[64:65] sc1
    v_add_u32 v9, 231168, v1
    global_load_dwordx4 v[124:127], v9, s[64:65] sc1
    v_add_u32 v8, 264192, v1
    global_load_dwordx4 v[128:131], v8, s[64:65] sc1
    v_add_u32 v9, 297216, v1
    global_load_dwordx4 v[132:135], v9, s[64:65] sc1
    v_add_u32 v8, 330240, v1
    global_load_dwordx4 v[136:139], v8, s[64:65] sc1
    v_add_u32 v9, 363264, v1
    global_load_dwordx4 v[140:143], v9, s[64:65] sc1
    v_add_u32 v8, 396288, v1
    global_load_dwordx4 v[144:147], v8, s[64:65] sc1
    v_add_u32 v9, 429312, v1
    global_load_dwordx4 v[148:151], v9, s[64:65] sc1
    v_add_u32 v8, 462336, v1
    global_load_dwordx4 v[152:155], v8, s[64:65] sc1
    v_add_u32 v9, 495360, v1
    global_load_dwordx4 v[156:159], v9, s[64:65] sc1
    s_waitcnt vmcnt(16)
    v_lshlrev_b32 v40, 16, v56
    v_and_b32 v41, 0xffff0000, v56
    v_lshlrev_b32 v42, 16, v57
    v_and_b32 v43, 0xffff0000, v57
    v_lshlrev_b32 v44, 16, v58
    v_and_b32 v45, 0xffff0000, v58
    v_lshlrev_b32 v46, 16, v59
    v_and_b32 v47, 0xffff0000, v59
    s_waitcnt vmcnt(15)
    v_dot2c_f32_bf16 v48, v96, v12
    v_dot2c_f32_bf16 v49, v96, v13
    v_dot2c_f32_bf16 v50, v97, v12
    v_dot2c_f32_bf16 v51, v97, v13
    v_dot2c_f32_bf16 v52, v98, v12
    v_dot2c_f32_bf16 v53, v98, v13
    v_dot2c_f32_bf16 v54, v99, v12
    v_dot2c_f32_bf16 v55, v99, v13
    s_waitcnt vmcnt(14)
    v_dot2c_f32_bf16 v48, v100, v12
    v_dot2c_f32_bf16 v49, v100, v13
    v_dot2c_f32_bf16 v50, v101, v12
    v_dot2c_f32_bf16 v51, v101, v13
    v_dot2c_f32_bf16 v52, v102, v12
    v_dot2c_f32_bf16 v53, v102, v13
    v_dot2c_f32_bf16 v54, v103, v12
    v_dot2c_f32_bf16 v55, v103, v13
    s_waitcnt vmcnt(13)
    v_dot2c_f32_bf16 v48, v104, v12
    v_dot2c_f32_bf16 v49, v104, v13
    v_dot2c_f32_bf16 v50, v105, v12
    v_dot2c_f32_bf16 v51, v105, v13
    v_dot2c_f32_bf16 v52, v106, v12
    v_dot2c_f32_bf16 v53, v106, v13
    v_dot2c_f32_bf16 v54, v107, v12
    v_dot2c_f32_bf16 v55, v107, v13
    s_waitcnt vmcnt(12)
    v_dot2c_f32_bf16 v48, v108, v12
    v_dot2c_f32_bf16 v49, v108, v13
    v_dot2c_f32_bf16 v50, v109, v12
    v_dot2c_f32_bf16 v51, v109, v13
    v_dot2c_f32_bf16 v52, v110, v12
    v_dot2c_f32_bf16 v53, v110, v13
    v_dot2c_f32_bf16 v54, v111, v12
    v_dot2c_f32_bf16 v55, v111, v13
    s_waitcnt vmcnt(11)
    v_dot2c_f32_bf16 v48, v112, v12
    v_dot2c_f32_bf16 v49, v112, v13
    v_dot2c_f32_bf16 v50, v113, v12
    v_dot2c_f32_bf16 v51, v113, v13
    v_dot2c_f32_bf16 v52, v114, v12
    v_dot2c_f32_bf16 v53, v114, v13
    v_dot2c_f32_bf16 v54, v115, v12
    v_dot2c_f32_bf16 v55, v115, v13
    s_waitcnt vmcnt(10)
    v_dot2c_f32_bf16 v48, v116, v12
    v_dot2c_f32_bf16 v49, v116, v13
    v_dot2c_f32_bf16 v50, v117, v12
    v_dot2c_f32_bf16 v51, v117, v13
    v_dot2c_f32_bf16 v52, v118, v12
    v_dot2c_f32_bf16 v53, v118, v13
    v_dot2c_f32_bf16 v54, v119, v12
    v_dot2c_f32_bf16 v55, v119, v13
    s_waitcnt vmcnt(9)
    v_dot2c_f32_bf16 v48, v120, v12
    v_dot2c_f32_bf16 v49, v120, v13
    v_dot2c_f32_bf16 v50, v121, v12
    v_dot2c_f32_bf16 v51, v121, v13
    v_dot2c_f32_bf16 v52, v122, v12
    v_dot2c_f32_bf16 v53, v122, v13
    v_dot2c_f32_bf16 v54, v123, v12
    v_dot2c_f32_bf16 v55, v123, v13
    s_waitcnt vmcnt(8)
    v_dot2c_f32_bf16 v48, v124, v12
    v_dot2c_f32_bf16 v49, v124, v13
    v_dot2c_f32_bf16 v50, v125, v12
    v_dot2c_f32_bf16 v51, v125, v13
    v_dot2c_f32_bf16 v52, v126, v12
    v_dot2c_f32_bf16 v53, v126, v13
    v_dot2c_f32_bf16 v54, v127, v12
    v_dot2c_f32_bf16 v55, v127, v13
    s_waitcnt vmcnt(7)
    v_dot2c_f32_bf16 v48, v128, v12
    v_dot2c_f32_bf16 v49, v128, v13
    v_dot2c_f32_bf16 v50, v129, v12
    v_dot2c_f32_bf16 v51, v129, v13
    v_dot2c_f32_bf16 v52, v130, v12
    v_dot2c_f32_bf16 v53, v130, v13
    v_dot2c_f32_bf16 v54, v131, v12
    v_dot2c_f32_bf16 v55, v131, v13
    s_waitcnt vmcnt(6)
    v_dot2c_f32_bf16 v48, v132, v12
    v_dot2c_f32_bf16 v49, v132, v13
    v_dot2c_f32_bf16 v50, v133, v12
    v_dot2c_f32_bf16 v51, v133, v13
    v_dot2c_f32_bf16 v52, v134, v12
    v_dot2c_f32_bf16 v53, v134, v13
    v_dot2c_f32_bf16 v54, v135, v12
    v_dot2c_f32_bf16 v55, v135, v13
    s_waitcnt vmcnt(5)
    v_dot2c_f32_bf16 v48, v136, v12
    v_dot2c_f32_bf16 v49, v136, v13
    v_dot2c_f32_bf16 v50, v137, v12
    v_dot2c_f32_bf16 v51, v137, v13
    v_dot2c_f32_bf16 v52, v138, v12
    v_dot2c_f32_bf16 v53, v138, v13
    v_dot2c_f32_bf16 v54, v139, v12
    v_dot2c_f32_bf16 v55, v139, v13
    s_waitcnt vmcnt(4)
    v_dot2c_f32_bf16 v48, v140, v12
    v_dot2c_f32_bf16 v49, v140, v13
    v_dot2c_f32_bf16 v50, v141, v12
    v_dot2c_f32_bf16 v51, v141, v13
    v_dot2c_f32_bf16 v52, v142, v12
    v_dot2c_f32_bf16 v53, v142, v13
    v_dot2c_f32_bf16 v54, v143, v12
    v_dot2c_f32_bf16 v55, v143, v13
    s_waitcnt vmcnt(3)
    v_dot2c_f32_bf16 v48, v144, v12
    v_dot2c_f32_bf16 v49, v144, v13
    v_dot2c_f32_bf16 v50, v145, v12
    v_dot2c_f32_bf16 v51, v145, v13
    v_dot2c_f32_bf16 v52, v146, v12
    v_dot2c_f32_bf16 v53, v146, v13
    v_dot2c_f32_bf16 v54, v147, v12
    v_dot2c_f32_bf16 v55, v147, v13
    s_waitcnt vmcnt(2)
    v_dot2c_f32_bf16 v48, v148, v12
    v_dot2c_f32_bf16 v49, v148, v13
    v_dot2c_f32_bf16 v50, v149, v12
    v_dot2c_f32_bf16 v51, v149, v13
    v_dot2c_f32_bf16 v52, v150, v12
    v_dot2c_f32_bf16 v53, v150, v13
    v_dot2c_f32_bf16 v54, v151, v12
    v_dot2c_f32_bf16 v55, v151, v13
    s_waitcnt vmcnt(1)
    v_dot2c_f32_bf16 v48, v152, v12
    v_dot2c_f32_bf16 v49, v152, v13
    v_dot2c_f32_bf16 v50, v153, v12
    v_dot2c_f32_bf16 v51, v153, v13
    v_dot2c_f32_bf16 v52, v154, v12
    v_dot2c_f32_bf16 v53, v154, v13
    v_dot2c_f32_bf16 v54, v155, v12
    v_dot2c_f32_bf16 v55, v155, v13
    s_waitcnt vmcnt(0)
    v_dot2c_f32_bf16 v48, v156, v12
    v_dot2c_f32_bf16 v49, v156, v13
    v_dot2c_f32_bf16 v50, v157, v12
    v_dot2c_f32_bf16 v51, v157, v13
    v_dot2c_f32_bf16 v52, v158, v12
    v_dot2c_f32_bf16 v53, v158, v13
    v_dot2c_f32_bf16 v54, v159, v12
    v_dot2c_f32_bf16 v55, v159, v13
    v_fmac_f32 v40, v48, v16
    v_fmac_f32 v41, v49, v17
    v_fmac_f32 v42, v50, v18
    v_fmac_f32 v43, v51, v19
    v_fmac_f32 v44, v52, v20
    v_fmac_f32 v45, v53, v21
    v_fmac_f32 v46, v54, v22
    v_fmac_f32 v47, v55, v23
    v_cvt_pk_bf16_f32 v56, v40, v41
    v_cvt_pk_bf16_f32 v57, v42, v43
    v_cvt_pk_bf16_f32 v58, v44, v45
    v_cvt_pk_bf16_f32 v59, v46, v47
    v_lshlrev_b32 v40, 16, v56
    v_and_b32 v41, 0xffff0000, v56
    v_lshlrev_b32 v42, 16, v57
    v_and_b32 v43, 0xffff0000, v57
    v_lshlrev_b32 v44, 16, v58
    v_and_b32 v45, 0xffff0000, v58
    v_lshlrev_b32 v46, 16, v59
    v_and_b32 v47, 0xffff0000, v59
    global_store_dwordx4 v3, v[56:59], s[68:69] sc1
    v_add_f32 v8, v40, v41
    v_add_f32 v9, v42, v43
    v_add_f32 v8, v8, v44
    v_add_f32 v9, v9, v45
    v_add_f32 v8, v8, v46
    v_add_f32 v9, v9, v47
    v_add_f32 v8, v8, v9
    s_nop 1
    v_add_f32_dpp v8, v8, v8 row_ror:4 row_mask:0xf bank_mask:0xf
    s_nop 1
    v_add_f32_dpp v8, v8, v8 row_ror:8 row_mask:0xf bank_mask:0xf
    v_mov_b32 v9, v8
    s_nop 1
    v_permlane16_swap_b32 v8, v9
    v_add_f32 v8, v8, v9
    v_mov_b32 v9, v8
    s_nop 1
    v_permlane32_swap_b32 v8, v9
    v_add_f32 v8, v8, v9
    ds_write_b32 v5, v8 offset:0
    s_waitcnt lgkmcnt(0)
    s_barrier
    ds_read_b128 v[48:51], v6 offset:0
    s_waitcnt lgkmcnt(0)
    v_add_f32 v8, v48, v49
    v_add_f32 v9, v50, v51
    v_add_f32 v8, v8, v9
    v_mul_f32 v8, 0x3b000000, v8
    v_sub_f32 v40, v40, v8
    v_sub_f32 v41, v41, v8
    v_sub_f32 v42, v42, v8
    v_sub_f32 v43, v43, v8
    v_sub_f32 v44, v44, v8
    v_sub_f32 v45, v45, v8
    v_sub_f32 v46, v46, v8
    v_sub_f32 v47, v47, v8
    v_mul_f32 v8, v40, v40
    v_mul_f32 v9, v41, v41
    v_fmac_f32 v8, v42, v42
    v_fmac_f32 v9, v43, v43
    v_fmac_f32 v8, v44, v44
    v_fmac_f32 v9, v45, v45
    v_fmac_f32 v8, v46, v46
    v_fmac_f32 v9, v47, v47
    v_add_f32 v8, v8, v9
    s_nop 1
    v_add_f32_dpp v8, v8, v8 row_ror:4 row_mask:0xf bank_mask:0xf
    s_nop 1
    v_add_f32_dpp v8, v8, v8 row_ror:8 row_mask:0xf bank_mask:0xf
    v_mov_b32 v9, v8
    s_nop 1
    v_permlane16_swap_b32 v8, v9
    v_add_f32 v8, v8, v9
    v_mov_b32 v9, v8
    s_nop 1
    v_permlane32_swap_b32 v8, v9
    v_add_f32 v8, v8, v9
    ds_write_b32 v5, v8 offset:128
    s_waitcnt lgkmcnt(0)
    s_barrier
    ds_read_b128 v[48:51], v6 offset:128
    s_waitcnt lgkmcnt(0)
    v_add_f32 v8, v48, v49
    v_add_f32 v9, v50, v51
    v_add_f32 v8, v8, v9
    v_mov_b32 v9, 0x3727c5ac
    v_fmac_f32 v9, 0x3b000000, v8
    v_rsq_f32 v8, v9
    s_nop 0
    v_mul_f32 v40, v40, v8
    v_mul_f32 v41, v41, v8
    v_mul_f32 v42, v42, v8
    v_mul_f32 v43, v43, v8
    v_mul_f32 v44, v44, v8
    v_mul_f32 v45, v45, v8
    v_mul_f32 v46, v46, v8
    v_mul_f32 v47, v47, v8
    v_fma_f32 v40, v40, v32, v24
    v_fma_f32 v41, v41, v33, v25
    v_fma_f32 v42, v42, v34, v26
    v_fma_f32 v43, v43, v35, v27
    v_fma_f32 v44, v44, v36, v28
    v_fma_f32 v45, v45, v37, v29
    v_fma_f32 v46, v46, v38, v30
    v_fma_f32 v47, v47, v39, v31
    v_cvt_pk_bf16_f32 v48, v40, v41
    v_cvt_pk_bf16_f32 v49, v42, v43
    v_cvt_pk_bf16_f32 v50, v44, v45
    v_cvt_pk_bf16_f32 v51, v46, v47
    global_store_dwordx4 v3, v[48:51], s[70:71] sc1
    s_waitcnt vmcnt(0)
    s_barrier
    s_cmp_lg_u32 s9, 0
    s_cbranch_scc1 Lrw_104
    v_mov_b32 v8, s97
    s_nop 0
    s_mov_b64 exec, 0x3
    global_store_dword v14, v8, s[74:75] offset:0 sc1
    s_mov_b64 exec, -1
Lrw_104:
    s_add_u32 s64, s64, 2113536
    s_addc_u32 s65, s65, 0
    s_add_u32 s66, s66, 131072
    s_addc_u32 s67, s67, 0
    s_add_u32 s68, s68, 131072
    s_addc_u32 s69, s69, 0
    s_add_u32 s70, s70, 131072
    s_addc_u32 s71, s71, 0
    s_add_u32 s72, s72, 65536
    s_addc_u32 s73, s73, 0
    s_add_u32 s74, s74, 8192
    s_addc_u32 s75, s75, 0
    s_add_u32 s76, s76, 4
    s_cmp_lt_u32 s76, 64
    s_cbranch_scc1 Lr_101
    s_branch Lout
Lnotr:
    s_sub_u32 s8, s96, 64
    s_cmp_ge_u32 s8, 22
    s_cselect_b32 s3, 1, 0
    s_cselect_b32 s40, 22, 0
    s_sub_u32 s8, s8, s40
    s_load_dwordx2 s[40:41], s[0:1], 64
    s_lshl_b32 s42, s8, 2
    s_add_u32 s42, s42, s9
    s_min_u32 s43, s42, 85
    s_lshl_b32 s43, s43, 5
    s_lshl_b32 s44, s9, 15
    s_waitcnt lgkmcnt(0)
    s_add_u32 s40, s40, s43
    s_addc_u32 s41, s41, 0
    s_barrier
    v_and_b32 v16, 63, v0
    v_bfe_u32 v17, v16, 4, 1
    v_mul_u32_u24 v17, 4, v17
    v_bfe_u32 v18, v16, 5, 1
    v_mul_u32_u24 v18, 16, v18
    v_add_u32 v17, v17, v18
    v_bfe_u32 v18, v16, 2, 2
    v_add_u32 v17, v17, v18
    v_mul_u32_u24 v17, 32, v17
    v_and_b32 v18, 3, v16
    v_lshl_add_u32 v17, v18, 3, v17
    v_add_u32 v20, s44, v17
    v_lshrrev_b32 v17, 1, v16
    v_and_b32 v18, 1, v16
    v_lshlrev_b32 v19, 4, v18
    s_mov_b32 s52, 2752
    s_add_u32 m0, s44, 0
    v_add_u32 v18, 0, v17
    v_mad_u32_u24 v18, v18, s52, v19
    global_load_lds_dwordx4 v18, s[40:41]
    s_add_u32 m0, s44, 1024
    v_add_u32 v18, 32, v17
    v_mad_u32_u24 v18, v18, s52, v19
    global_load_lds_dwordx4 v18, s[40:41]
    s_add_u32 m0, s44, 2048
    v_add_u32 v18, 64, v17
    v_mad_u32_u24 v18, v18, s52, v19
    global_load_lds_dwordx4 v18, s[40:41]
    s_add_u32 m0, s44, 3072
    v_add_u32 v18, 96, v17
    v_mad_u32_u24 v18, v18, s52, v19
    global_load_lds_dwordx4 v18, s[40:41]
    s_add_u32 m0, s44, 4096
    v_add_u32 v18, 128, v17
    v_mad_u32_u24 v18, v18, s52, v19
    global_load_lds_dwordx4 v18, s[40:41]
    s_add_u32 m0, s44, 5120
    v_add_u32 v18, 160, v17
    v_mad_u32_u24 v18, v18, s52, v19
    global_load_lds_dwordx4 v18, s[40:41]
    s_add_u32 m0, s44, 6144
    v_add_u32 v18, 192, v17
    v_mad_u32_u24 v18, v18, s52, v19
    global_load_lds_dwordx4 v18, s[40:41]
    s_add_u32 m0, s44, 7168
    v_add_u32 v18, 224, v17
    v_mad_u32_u24 v18, v18, s52, v19
    global_load_lds_dwordx4 v18, s[40:41]
    s_add_u32 m0, s44, 8192
    v_add_u32 v18, 256, v17
    v_mad_u32_u24 v18, v18, s52, v19
    global_load_lds_dwordx4 v18, s[40:41]
    s_add_u32 m0, s44, 9216
    v_add_u32 v18, 288, v17
    v_mad_u32_u24 v18, v18, s52, v19
    global_load_lds_dwordx4 v18, s[40:41]
    s_add_u32 m0, s44, 10240
    v_add_u32 v18, 320, v17
    v_mad_u32_u24 v18, v18, s52, v19
    global_load_lds_dwordx4 v18, s[40:41]
    s_add_u32 m0, s44, 11264
    v_add_u32 v18, 352, v17
    v_mad_u32_u24 v18, v18, s52, v19
    global_load_lds_dwordx4 v18, s[40:41]
    s_add_u32 m0, s44, 12288
    v_add_u32 v18, 384, v17
    v_mad_u32_u24 v18, v18, s52, v19
    global_load_lds_dwordx4 v18, s[40:41]
    s_add_u32 m0, s44, 13312
    v_add_u32 v18, 416, v17
    v_mad_u32_u24 v18, v18, s52, v19
    global_load_lds_dwordx4 v18, s[40:41]
    s_add_u32 m0, s44, 14336
    v_add_u32 v18, 448, v17
    v_mad_u32_u24 v18, v18, s52, v19
    global_load_lds_dwordx4 v18, s[40:41]
    s_add_u32 m0, s44, 15360
    v_add_u32 v18, 480, v17
    v_mad_u32_u24 v18, v18, s52, v19
    global_load_lds_dwordx4 v18, s[40:41]
    s_waitcnt vmcnt(0)
    ds_read_b64_tr_b16 v[64:65], v20 offset:0
    ds_read_b64_tr_b16 v[66:67], v20 offset:256
    ds_read_b64_tr_b16 v[68:69], v20 offset:1024
    ds_read_b64_tr_b16 v[70:71], v20 offset:1280
    ds_read_b64_tr_b16 v[72:73], v20 offset:2048
    ds_read_b64_tr_b16 v[74:75], v20 offset:2304
    ds_read_b64_tr_b16 v[76:77], v20 offset:3072
    ds_read_b64_tr_b16 v[78:79], v20 offset:3328
    ds_read_b64_tr_b16 v[80:81], v20 offset:4096
    ds_read_b64_tr_b16 v[82:83], v20 offset:4352
    ds_read_b64_tr_b16 v[84:85], v20 offset:5120
    ds_read_b64_tr_b16 v[86:87], v20 offset:5376
    ds_read_b64_tr_b16 v[88:89], v20 offset:6144
    ds_read_b64_tr_b16 v[90:91], v20 offset:6400
    ds_read_b64_tr_b16 v[92:93], v20 offset:7168
    ds_read_b64_tr_b16 v[94:95], v20 offset:7424
    ds_read_b64_tr_b16 v[96:97], v20 offset:8192
    ds_read_b64_tr_b16 v[98:99], v20 offset:8448
    ds_read_b64_tr_b16 v[100:101], v20 offset:9216
    ds_read_b64_tr_b16 v[102:103], v20 offset:9472
    ds_read_b64_tr_b16 v[104:105], v20 offset:10240
    ds_read_b64_tr_b16 v[106:107], v20 offset:10496
    ds_read_b64_tr_b16 v[108:109], v20 offset:11264
    ds_read_b64_tr_b16 v[110:111], v20 offset:11520
    ds_read_b64_tr_b16 v[112:113], v20 offset:12288
    ds_read_b64_tr_b16 v[114:115], v20 offset:12544
    ds_read_b64_tr_b16 v[116:117], v20 offset:13312
    ds_read_b64_tr_b16 v[118:119], v20 offset:13568
    ds_read_b64_tr_b16 v[120:121], v20 offset:14336
    ds_read_b64_tr_b16 v[122:123], v20 offset:14592
    ds_read_b64_tr_b16 v[124:125], v20 offset:15360
    ds_read_b64_tr_b16 v[126:127], v20 offset:15616
    s_waitcnt lgkmcnt(0)
    s_barrier
    v_and_b32 v16, 63, v0
    v_lshlrev_b32 v1, 4, v16
    v_lshlrev_b32 v2, 2, v16
    s_lshl_b32 s45, s9, 13
    v_add_u32 v3, s45, v1
    v_lshrrev_b32 v17, 4, v16
    v_lshlrev_b32 v17, 6, v17
    s_lshl_b32 s46, s9, 8
    s_add_u32 s46, s46, 32768
    v_add_u32 v4, s46, v17
    v_add_u32 v5, 32768, v2
    s_add_u32 s64, s4, 111673344
    s_addc_u32 s65, s5, 0
    s_lshl_b32 s51, s3, 15
    s_add_u32 s64, s64, s51
    s_addc_u32 s65, s65, 0
    s_mov_b32 s47, 117396480
    s_cmp_lt_u32 s42, 43
    s_cselect_b32 s47, 113770496, s47
    s_cselect_b32 s53, 1, 0
    s_min_u32 s48, s42, 86
    s_lshl_b32 s48, s48, 10
    s_add_u32 s47, s47, s48
    s_mul_i32 s48, s3, 45056
    s_add_u32 s47, s47, s48
    s_add_u32 s66, s4, s47
    s_addc_u32 s67, s5, 0
    s_add_u32 s68, s4, 121632256
    s_addc_u32 s69, s5, 0
    s_lshl_b32 s51, s3, 12
    s_add_u32 s68, s68, s51
    s_addc_u32 s69, s69, 0
    s_lshl_b32 s51, s8, 8
    s_add_u32 s68, s68, s51
    s_addc_u32 s69, s69, 0
    s_and_b32 s49, s8, 1
    s_add_u32 s72, s4, 128974848
    s_addc_u32 s73, s5, 0
    s_lshl_b32 s51, s3, 11
    s_add_u32 s72, s72, s51
    s_addc_u32 s73, s73, 0
    s_lshl_b32 s51, s49, 10
    s_add_u32 s72, s72, s51
    s_addc_u32 s73, s73, 0
    s_add_u32 s74, s4, 130023424
    s_addc_u32 s75, s5, 0
    s_lshl_b32 s51, s3, 14
    s_add_u32 s74, s74, s51
    s_addc_u32 s75, s75, 0
    s_lshl_b32 s51, s8, 7
    s_add_u32 s74, s74, s51
    s_addc_u32 s75, s75, 0
    v_lshlrev_b32 v6, 12, v16
    v_lshlrev_b32 v7, 7, v16
    s_mov_b32 s54, 0x3dd2d3e8
    v_mov_b32 v32, 0x40135761
    s_cmp_lt_u32 s42, 86
    s_cselect_b32 s55, 0, 1
    s_or_b32 s55, s55, s53
    s_mov_b32 s76, s3
Lz_105:
    s_mov_b32 s60, 0
    s_mov_b64 exec, 0xff
    global_load_dword v25, v7, s[72:73] sc1
    s_waitcnt vmcnt(0)
    v_cmp_ne_u32 vcc, s97, v25
    s_cbranch_vccz Lwf_107
    global_load_dword v25, v7, s[72:73] sc1
    s_sleep 2
Lwf_106:
    global_load_dword v25, v7, s[72:73] sc1
    s_add_u32 s60, s60, 1
    s_cmp_gt_u32 s60, 1000000
    s_cbranch_scc1 Lfail
    s_waitcnt vmcnt(1)
    v_cmp_ne_u32 vcc, s97, v25
    s_cbranch_vccz Lwf_107
    s_sleep 1
    s_cmp_ge_u32 s76, 52
    s_cbranch_scc1 Lwf_106
    s_sleep 12
    s_branch Lwf_106
Lwf_107:
    s_mov_b64 exec, -1
    v_add_u32 v24, 4096, v3
    global_load_dwordx4 v[160:163], v3, s[64:65] offset:0 sc1
    global_load_dwordx4 v[164:167], v3, s[64:65] offset:1024 sc1
    global_load_dwordx4 v[168:171], v3, s[64:65] offset:2048 sc1
    global_load_dwordx4 v[172:175], v3, s[64:65] offset:3072 sc1
    global_load_dwordx4 v[176:179], v24, s[64:65] offset:0 sc1
    global_load_dwordx4 v[180:183], v24, s[64:65] offset:1024 sc1
    global_load_dwordx4 v[184:187], v24, s[64:65] offset:2048 sc1
    global_load_dwordx4 v[188:191], v24, s[64:65] offset:3072 sc1
    s_waitcnt vmcnt(7)
    ds_write_b128 v3, v[160:163] offset:0
    s_waitcnt vmcnt(6)
    ds_write_b128 v3, v[164:167] offset:1024
    s_waitcnt vmcnt(5)
    ds_write_b128 v3, v[168:171] offset:2048
    s_waitcnt vmcnt(4)
    ds_write_b128 v3, v[172:175] offset:3072
    s_waitcnt vmcnt(3)
    ds_write_b128 v3, v[176:179] offset:4096
    s_waitcnt vmcnt(2)
    ds_write_b128 v3, v[180:183] offset:5120
    s_waitcnt vmcnt(1)
    ds_write_b128 v3, v[184:187] offset:6144
    s_waitcnt vmcnt(0)
    ds_write_b128 v3, v[188:191] offset:7168
    s_waitcnt lgkmcnt(0)
    s_barrier
    s_cmp_eq_u32 s53, 0
    s_cbranch_scc1 Lz2_108
    ds_read_b128 v[128:131], v1 offset:0
    ds_read_b128 v[132:135], v1 offset:16384
    ds_read_b128 v[136:139], v1 offset:1024
    ds_read_b128 v[140:143], v1 offset:17408
    ds_read_b128 v[144:147], v1 offset:2048
    ds_read_b128 v[148:151], v1 offset:18432
    ds_read_b128 v[152:155], v1 offset:3072
    s_waitcnt lgkmcnt(6)
    v_mfma_f32_16x16x32_bf16 v[16:19], v[64:67], v[128:131], 0
    ds_read_b128 v[156:159], v1 offset:19456
    s_waitcnt lgkmcnt(6)
    v_mfma_f32_16x16x32_bf16 v[20:23], v[64:67], v[132:135], 0
    ds_read_b128 v[128:131], v1 offset:4096
    s_waitcnt lgkmcnt(6)
    v_mfma_f32_16x16x32_bf16 v[16:19], v[68:71], v[136:139], v[16:19]
    ds_read_b128 v[132:135], v1 offset:20480
    s_waitcnt lgkmcnt(6)
    v_mfma_f32_16x16x32_bf16 v[20:23], v[68:71], v[140:143], v[20:23]
    ds_read_b128 v[136:139], v1 offset:5120
    s_waitcnt lgkmcnt(6)
    v_mfma_f32_16x16x32_bf16 v[16:19], v[72:75], v[144:147], v[16:19]
    ds_read_b128 v[140:143], v1 offset:21504
    s_waitcnt lgkmcnt(6)
    v_mfma_f32_16x16x32_bf16 v[20:23], v[72:75], v[148:151], v[20:23]
    ds_read_b128 v[144:147], v1 offset:6144
    s_waitcnt lgkmcnt(6)
    v_mfma_f32_16x16x32_bf16 v[16:19], v[76:79], v[152:155], v[16:19]
    ds_read_b128 v[148:151], v1 offset:22528
    s_waitcnt lgkmcnt(6)
    v_mfma_f32_16x16x32_bf16 v[20:23], v[76:79], v[156:159], v[20:23]
    ds_read_b128 v[152:155], v1 offset:7168
    s_waitcnt lgkmcnt(6)
    v_mfma_f32_16x16x32_bf16 v[16:19], v[80:83], v[128:131], v[16:19]
    ds_read_b128 v[156:159], v1 offset:23552
    s_waitcnt lgkmcnt(6)
    v_mfma_f32_16x16x32_bf16 v[20:23], v[80:83], v[132:135], v[20:23]
    ds_read_b128 v[128:131], v1 offset:8192
    s_waitcnt lgkmcnt(6)
    v_mfma_f32_16x16x32_bf16 v[16:19], v[84:87], v[136:139], v[16:19]
    ds_read_b128 v[132:135], v1 offset:24576
    s_waitcnt lgkmcnt(6)
    v_mfma_f32_16x16x32_bf16 v[20:23], v[84:87], v[140:143], v[20:23]
    ds_read_b128 v[136:139], v1 offset:9216
    s_waitcnt lgkmcnt(6)
    v_mfma_f32_16x16x32_bf16 v[16:19], v[88:91], v[144:147], v[16:19]
    ds_read_b128 v[140:143], v1 offset:25600
    s_waitcnt lgkmcnt(6)
    v_mfma_f32_16x16x32_bf16 v[20:23], v[88:91], v[148:151], v[20:23]
    ds_read_b128 v[144:147], v1 offset:10240
    s_waitcnt lgkmcnt(6)
    v_mfma_f32_16x16x32_bf16 v[16:19], v[92:95], v[152:155], v[16:19]
    ds_read_b128 v[148:151], v1 offset:26624
    s_waitcnt lgkmcnt(6)
    v_mfma_f32_16x16x32_bf16 v[20:23], v[92:95], v[156:159], v[20:23]
    ds_read_b128 v[152:155], v1 offset:11264
    s_waitcnt lgkmcnt(6)
    v_mfma_f32_16x16x32_bf16 v[16:19], v[96:99], v[128:131], v[16:19]
    ds_read_b128 v[156:159], v1 offset:27648
    s_waitcnt lgkmcnt(6)
    v_mfma_f32_16x16x32_bf16 v[20:23], v[96:99], v[132:135], v[20:23]
    ds_read_b128 v[128:131], v1 offset:12288
    s_waitcnt lgkmcnt(6)
    v_mfma_f32_16x16x32_bf16 v[16:19], v[100:103], v[136:139], v[16:19]
    ds_read_b128 v[132:135], v1 offset:28672
    s_waitcnt lgkmcnt(6)
    v_mfma_f32_16x16x32_bf16 v[20:23], v[100:103], v[140:143], v[20:23]
    ds_read_b128 v[136:139], v1 offset:13312
    s_waitcnt lgkmcnt(6)
    v_mfma_f32_16x16x32_bf16 v[16:19], v[104:107], v[144:147], v[16:19]
    ds_read_b128 v[140:143], v1 offset:29696
    s_waitcnt lgkmcnt(6)
    v_mfma_f32_16x16x32_bf16 v[20:23], v[104:107], v[148:151], v[20:23]
    ds_read_b128 v[144:147], v1 offset:14336
    s_waitcnt lgkmcnt(6)
    v_mfma_f32_16x16x32_bf16 v[16:19], v[108:111], v[152:155], v[16:19]
    ds_read_b128 v[148:151], v1 offset:30720
    s_waitcnt lgkmcnt(6)
    v_mfma_f32_16x16x32_bf16 v[20:23], v[108:111], v[156:159], v[20:23]
    ds_read_b128 v[152:155], v1 offset:15360
    s_waitcnt lgkmcnt(6)
    v_mfma_f32_16x16x32_bf16 v[16:19], v[112:115], v[128:131], v[16:19]
    ds_read_b128 v[156:159], v1 offset:31744
    s_waitcnt lgkmcnt(6)
    v_mfma_f32_16x16x32_bf16 v[20:23], v[112:115], v[132:135], v[20:23]
    s_waitcnt lgkmcnt(5)
    v_mfma_f32_16x16x32_bf16 v[16:19], v[116:119], v[136:139], v[16:19]
    s_waitcnt lgkmcnt(4)
    v_mfma_f32_16x16x32_bf16 v[20:23], v[116:119], v[140:143], v[20:23]
    s_waitcnt lgkmcnt(3)
    v_mfma_f32_16x16x32_bf16 v[16:19], v[120:123], v[144:147], v[16:19]
    s_waitcnt lgkmcnt(2)
    v_mfma_f32_16x16x32_bf16 v[20:23], v[120:123], v[148:151], v[20:23]
    s_waitcnt lgkmcnt(1)
    v_mfma_f32_16x16x32_bf16 v[16:19], v[124:127], v[152:155], v[16:19]
    s_waitcnt lgkmcnt(0)
    v_mfma_f32_16x16x32_bf16 v[20:23], v[124:127], v[156:159], v[20:23]
    s_branch Lzg_109
Lz2_108:
    ds_read_b128 v[128:131], v1 offset:0
    ds_read_b128 v[132:135], v1 offset:16384
    ds_read_b128 v[136:139], v1 offset:1024
    ds_read_b128 v[140:143], v1 offset:17408
    ds_read_b128 v[144:147], v1 offset:2048
    ds_read_b128 v[148:151], v1 offset:18432
    ds_read_b128 v[152:155], v1 offset:3072
    s_waitcnt lgkmcnt(6)
    v_mfma_f32_16x16x32_bf16 v[16:19], v[128:131], v[64:67], 0
    ds_read_b128 v[156:159], v1 offset:19456
    s_waitcnt lgkmcnt(6)
    v_mfma_f32_16x16x32_bf16 v[20:23], v[132:135], v[64:67], 0
    ds_read_b128 v[128:131], v1 offset:4096
    s_waitcnt lgkmcnt(6)
    v_mfma_f32_16x16x32_bf16 v[16:19], v[136:139], v[68:71], v[16:19]
    ds_read_b128 v[132:135], v1 offset:20480
    s_waitcnt lgkmcnt(6)
    v_mfma_f32_16x16x32_bf16 v[20:23], v[140:143], v[68:71], v[20:23]
    ds_read_b128 v[136:139], v1 offset:5120
    s_waitcnt lgkmcnt(6)
    v_mfma_f32_16x16x32_bf16 v[16:19], v[144:147], v[72:75], v[16:19]
    ds_read_b128 v[140:143], v1 offset:21504
    s_waitcnt lgkmcnt(6)
    v_mfma_f32_16x16x32_bf16 v[20:23], v[148:151], v[72:75], v[20:23]
    ds_read_b128 v[144:147], v1 offset:6144
    s_waitcnt lgkmcnt(6)
    v_mfma_f32_16x16x32_bf16 v[16:19], v[152:155], v[76:79], v[16:19]
    ds_read_b128 v[148:151], v1 offset:22528
    s_waitcnt lgkmcnt(6)
    v_mfma_f32_16x16x32_bf16 v[20:23], v[156:159], v[76:79], v[20:23]
    ds_read_b128 v[152:155], v1 offset:7168
    s_waitcnt lgkmcnt(6)
    v_mfma_f32_16x16x32_bf16 v[16:19], v[128:131], v[80:83], v[16:19]
    ds_read_b128 v[156:159], v1 offset:23552
    s_waitcnt lgkmcnt(6)
    v_mfma_f32_16x16x32_bf16 v[20:23], v[132:135], v[80:83], v[20:23]
    ds_read_b128 v[128:131], v1 offset:8192
    s_waitcnt lgkmcnt(6)
    v_mfma_f32_16x16x32_bf16 v[16:19], v[136:139], v[84:87], v[16:19]
    ds_read_b128 v[132:135], v1 offset:24576
    s_waitcnt lgkmcnt(6)
    v_mfma_f32_16x16x32_bf16 v[20:23], v[140:143], v[84:87], v[20:23]
    ds_read_b128 v[136:139], v1 offset:9216
    s_waitcnt lgkmcnt(6)
    v_mfma_f32_16x16x32_bf16 v[16:19], v[144:147], v[88:91], v[16:19]
    ds_read_b128 v[140:143], v1 offset:25600
    s_waitcnt lgkmcnt(6)
    v_mfma_f32_16x16x32_bf16 v[20:23], v[148:151], v[88:91], v[20:23]
    ds_read_b128 v[144:147], v1 offset:10240
    s_waitcnt lgkmcnt(6)
    v_mfma_f32_16x16x32_bf16 v[16:19], v[152:155], v[92:95], v[16:19]
    ds_read_b128 v[148:151], v1 offset:26624
    s_waitcnt lgkmcnt(6)
    v_mfma_f32_16x16x32_bf16 v[20:23], v[156:159], v[92:95], v[20:23]
    ds_read_b128 v[152:155], v1 offset:11264
    s_waitcnt lgkmcnt(6)
    v_mfma_f32_16x16x32_bf16 v[16:19], v[128:131], v[96:99], v[16:19]
    ds_read_b128 v[156:159], v1 offset:27648
    s_waitcnt lgkmcnt(6)
    v_mfma_f32_16x16x32_bf16 v[20:23], v[132:135], v[96:99], v[20:23]
    ds_read_b128 v[128:131], v1 offset:12288
    s_waitcnt lgkmcnt(6)
    v_mfma_f32_16x16x32_bf16 v[16:19], v[136:139], v[100:103], v[16:19]
    ds_read_b128 v[132:135], v1 offset:28672
    s_waitcnt lgkmcnt(6)
    v_mfma_f32_16x16x32_bf16 v[20:23], v[140:143], v[100:103], v[20:23]
    ds_read_b128 v[136:139], v1 offset:13312
    s_waitcnt lgkmcnt(6)
    v_mfma_f32_16x16x32_bf16 v[16:19], v[144:147], v[104:107], v[16:19]
    ds_read_b128 v[140:143], v1 offset:29696
    s_waitcnt lgkmcnt(6)
    v_mfma_f32_16x16x32_bf16 v[20:23], v[148:151], v[104:107], v[20:23]
    ds_read_b128 v[144:147], v1 offset:14336
    s_waitcnt lgkmcnt(6)
    v_mfma_f32_16x16x32_bf16 v[16:19], v[152:155], v[108:111], v[16:19]
    ds_read_b128 v[148:151], v1 offset:30720
    s_waitcnt lgkmcnt(6)
    v_mfma_f32_16x16x32_bf16 v[20:23], v[156:159], v[108:111], v[20:23]
    ds_read_b128 v[152:155], v1 offset:15360
    s_waitcnt lgkmcnt(6)
    v_mfma_f32_16x16x32_bf16 v[16:19], v[128:131], v[112:115], v[16:19]
    ds_read_b128 v[156:159], v1 offset:31744
    s_waitcnt lgkmcnt(6)
    v_mfma_f32_16x16x32_bf16 v[20:23], v[132:135], v[112:115], v[20:23]
    s_waitcnt lgkmcnt(5)
    v_mfma_f32_16x16x32_bf16 v[16:19], v[136:139], v[116:119], v[16:19]
    s_waitcnt lgkmcnt(4)
    v_mfma_f32_16x16x32_bf16 v[20:23], v[140:143], v[116:119], v[20:23]
    s_waitcnt lgkmcnt(3)
    v_mfma_f32_16x16x32_bf16 v[16:19], v[144:147], v[120:123], v[16:19]
    s_waitcnt lgkmcnt(2)
    v_mfma_f32_16x16x32_bf16 v[20:23], v[148:151], v[120:123], v[20:23]
    s_waitcnt lgkmcnt(1)
    v_mfma_f32_16x16x32_bf16 v[16:19], v[152:155], v[124:127], v[16:19]
    s_waitcnt lgkmcnt(0)
    v_mfma_f32_16x16x32_bf16 v[20:23], v[156:159], v[124:127], v[20:23]
Lzg_109:
    s_nop 7
    v_cvt_pk_bf16_f32 v40, v16, v17
    v_cvt_pk_bf16_f32 v41, v18, v19
    v_cvt_pk_bf16_f32 v42, v20, v21
    v_cvt_pk_bf16_f32 v43, v22, v23
    v_lshlrev_b32 v16, 16, v40
    v_and_b32 v17, 0xffff0000, v40
    v_lshlrev_b32 v18, 16, v41
    v_and_b32 v19, 0xffff0000, v41
    v_lshlrev_b32 v20, 16, v42
    v_and_b32 v21, 0xffff0000, v42
    v_lshlrev_b32 v22, 16, v43
    v_and_b32 v23, 0xffff0000, v43
    v_mul_f32 v24, v16, v16
    v_mul_f32 v25, v17, v17
    v_mul_f32 v26, v18, v18
    v_mul_f32 v27, v19, v19
    v_mul_f32 v28, v20, v20
    v_mul_f32 v29, v21, v21
    v_mul_f32 v30, v22, v22
    v_mul_f32 v31, v23, v23
    v_fma_f32 v24, v24, s54, v32
    v_fma_f32 v25, v25, s54, v32
    v_fma_f32 v26, v26, s54, v32
    v_fma_f32 v27, v27, s54, v32
    v_fma_f32 v28, v28, s54, v32
    v_fma_f32 v29, v29, s54, v32
    v_fma_f32 v30, v30, s54, v32
    v_fma_f32 v31, v31, s54, v32
    v_mul_f32 v24, v24, v16
    v_mul_f32 v25, v25, v17
    v_mul_f32 v26, v26, v18
    v_mul_f32 v27, v27, v19
    v_mul_f32 v28, v28, v20
    v_mul_f32 v29, v29, v21
    v_mul_f32 v30, v30, v22
    v_mul_f32 v31, v31, v23
    v_exp_f32 v24, -v24
    v_exp_f32 v25, -v25
    v_exp_f32 v26, -v26
    v_exp_f32 v27, -v27
    v_exp_f32 v28, -v28
    v_exp_f32 v29, -v29
    v_exp_f32 v30, -v30
    v_exp_f32 v31, -v31
    v_add_f32 v24, 1.0, v24
    v_add_f32 v25, 1.0, v25
    v_add_f32 v26, 1.0, v26
    v_add_f32 v27, 1.0, v27
    v_add_f32 v28, 1.0, v28
    v_add_f32 v29, 1.0, v29
    v_add_f32 v30, 1.0, v30
    v_add_f32 v31, 1.0, v31
    v_rcp_f32 v24, v24
    v_rcp_f32 v25, v25
    v_rcp_f32 v26, v26
    v_rcp_f32 v27, v27
    v_rcp_f32 v28, v28
    v_rcp_f32 v29, v29
    v_rcp_f32 v30, v30
    v_rcp_f32 v31, v31
    v_mul_f32 v16, v16, v24
    v_mul_f32 v17, v17, v25
    v_mul_f32 v18, v18, v26
    v_mul_f32 v19, v19, v27
    v_mul_f32 v20, v20, v28
    v_mul_f32 v21, v21, v29
    v_mul_f32 v22, v22, v30
    v_mul_f32 v23, v23, v31
    v_cvt_pk_bf16_f32 v160, v16, v17
    v_cvt_pk_bf16_f32 v161, v18, v19
    v_cvt_pk_bf16_f32 v162, v20, v21
    v_cvt_pk_bf16_f32 v163, v22, v23
    global_store_dwordx4 v1, v[160:163], s[66:67] sc1
    v_mov_b32 v40, v16
    v_mul_f32 v41, v16, v16
    v_mov_b32 v42, v17
    v_mul_f32 v43, v17, v17
    v_mov_b32 v44, v18
    v_mul_f32 v45, v18, v18
    v_mov_b32 v46, v19
    v_mul_f32 v47, v19, v19
    v_mov_b32 v48, v20
    v_mul_f32 v49, v20, v20
    v_mov_b32 v50, v21
    v_mul_f32 v51, v21, v21
    v_mov_b32 v52, v22
    v_mul_f32 v53, v22, v22
    v_mov_b32 v54, v23
    v_mul_f32 v55, v23, v23
    v_add_f32_dpp v40, v40, v40 row_ror:8 row_mask:0xf bank_mask:0xf
    v_add_f32_dpp v41, v41, v41 row_ror:8 row_mask:0xf bank_mask:0xf
    v_add_f32_dpp v42, v42, v42 row_ror:8 row_mask:0xf bank_mask:0xf
    v_add_f32_dpp v43, v43, v43 row_ror:8 row_mask:0xf bank_mask:0xf
    v_add_f32_dpp v44, v44, v44 row_ror:8 row_mask:0xf bank_mask:0xf
    v_add_f32_dpp v45, v45, v45 row_ror:8 row_mask:0xf bank_mask:0xf
    v_add_f32_dpp v46, v46, v46 row_ror:8 row_mask:0xf bank_mask:0xf
    v_add_f32_dpp v47, v47, v47 row_ror:8 row_mask:0xf bank_mask:0xf
    v_add_f32_dpp v48, v48, v48 row_ror:8 row_mask:0xf bank_mask:0xf
    v_add_f32_dpp v49, v49, v49 row_ror:8 row_mask:0xf bank_mask:0xf
    v_add_f32_dpp v50, v50, v50 row_ror:8 row_mask:0xf bank_mask:0xf
    v_add_f32_dpp v51, v51, v51 row_ror:8 row_mask:0xf bank_mask:0xf
    v_add_f32_dpp v52, v52, v52 row_ror:8 row_mask:0xf bank_mask:0xf
    v_add_f32_dpp v53, v53, v53 row_ror:8 row_mask:0xf bank_mask:0xf
    v_add_f32_dpp v54, v54, v54 row_ror:8 row_mask:0xf bank_mask:0xf
    v_add_f32_dpp v55, v55, v55 row_ror:8 row_mask:0xf bank_mask:0xf
    v_add_f32_dpp v40, v40, v40 row_ror:4 row_mask:0xf bank_mask:0xf
    v_add_f32_dpp v41, v41, v41 row_ror:4 row_mask:0xf bank_mask:0xf
    v_add_f32_dpp v42, v42, v42 row_ror:4 row_mask:0xf bank_mask:0xf
    v_add_f32_dpp v43, v43, v43 row_ror:4 row_mask:0xf bank_mask:0xf
    v_add_f32_dpp v44, v44, v44 row_ror:4 row_mask:0xf bank_mask:0xf
    v_add_f32_dpp v45, v45, v45 row_ror:4 row_mask:0xf bank_mask:0xf
    v_add_f32_dpp v46, v46, v46 row_ror:4 row_mask:0xf bank_mask:0xf
    v_add_f32_dpp v47, v47, v47 row_ror:4 row_mask:0xf bank_mask:0xf
    v_add_f32_dpp v48, v48, v48 row_ror:4 row_mask:0xf bank_mask:0xf
    v_add_f32_dpp v49, v49, v49 row_ror:4 row_mask:0xf bank_mask:0xf
    v_add_f32_dpp v50, v50, v50 row_ror:4 row_mask:0xf bank_mask:0xf
    v_add_f32_dpp v51, v51, v51 row_ror:4 row_mask:0xf bank_mask:0xf
    v_add_f32_dpp v52, v52, v52 row_ror:4 row_mask:0xf bank_mask:0xf
    v_add_f32_dpp v53, v53, v53 row_ror:4 row_mask:0xf bank_mask:0xf
    v_add_f32_dpp v54, v54, v54 row_ror:4 row_mask:0xf bank_mask:0xf
    v_add_f32_dpp v55, v55, v55 row_ror:4 row_mask:0xf bank_mask:0xf
    v_add_f32_dpp v40, v40, v40 row_ror:2 row_mask:0xf bank_mask:0xf
    v_add_f32_dpp v41, v41, v41 row_ror:2 row_mask:0xf bank_mask:0xf
    v_add_f32_dpp v42, v42, v42 row_ror:2 row_mask:0xf bank_mask:0xf
    v_add_f32_dpp v43, v43, v43 row_ror:2 row_mask:0xf bank_mask:0xf
    v_add_f32_dpp v44, v44, v44 row_ror:2 row_mask:0xf bank_mask:0xf
    v_add_f32_dpp v45, v45, v45 row_ror:2 row_mask:0xf bank_mask:0xf
    v_add_f32_dpp v46, v46, v46 row_ror:2 row_mask:0xf bank_mask:0xf
    v_add_f32_dpp v47, v47, v47 row_ror:2 row_mask:0xf bank_mask:0xf
    v_add_f32_dpp v48, v48, v48 row_ror:2 row_mask:0xf bank_mask:0xf
    v_add_f32_dpp v49, v49, v49 row_ror:2 row_mask:0xf bank_mask:0xf
    v_add_f32_dpp v50, v50, v50 row_ror:2 row_mask:0xf bank_mask:0xf
    v_add_f32_dpp v51, v51, v51 row_ror:2 row_mask:0xf bank_mask:0xf
    v_add_f32_dpp v52, v52, v52 row_ror:2 row_mask:0xf bank_mask:0xf
    v_add_f32_dpp v53, v53, v53 row_ror:2 row_mask:0xf bank_mask:0xf
    v_add_f32_dpp v54, v54, v54 row_ror:2 row_mask:0xf bank_mask:0xf
    v_add_f32_dpp v55, v55, v55 row_ror:2 row_mask:0xf bank_mask:0xf
    v_add_f32_dpp v40, v40, v40 row_ror:1 row_mask:0xf bank_mask:0xf
    v_add_f32_dpp v41, v41, v41 row_ror:1 row_mask:0xf bank_mask:0xf
    v_add_f32_dpp v42, v42, v42 row_ror:1 row_mask:0xf bank_mask:0xf
    v_add_f32_dpp v43, v43, v43 row_ror:1 row_mask:0xf bank_mask:0xf
    v_add_f32_dpp v44, v44, v44 row_ror:1 row_mask:0xf bank_mask:0xf
    v_add_f32_dpp v45, v45, v45 row_ror:1 row_mask:0xf bank_mask:0xf
    v_add_f32_dpp v46, v46, v46 row_ror:1 row_mask:0xf bank_mask:0xf
    v_add_f32_dpp v47, v47, v47 row_ror:1 row_mask:0xf bank_mask:0xf
    v_add_f32_dpp v48, v48, v48 row_ror:1 row_mask:0xf bank_mask:0xf
    v_add_f32_dpp v49, v49, v49 row_ror:1 row_mask:0xf bank_mask:0xf
    v_add_f32_dpp v50, v50, v50 row_ror:1 row_mask:0xf bank_mask:0xf
    v_add_f32_dpp v51, v51, v51 row_ror:1 row_mask:0xf bank_mask:0xf
    v_add_f32_dpp v52, v52, v52 row_ror:1 row_mask:0xf bank_mask:0xf
    v_add_f32_dpp v53, v53, v53 row_ror:1 row_mask:0xf bank_mask:0xf
    v_add_f32_dpp v54, v54, v54 row_ror:1 row_mask:0xf bank_mask:0xf
    v_add_f32_dpp v55, v55, v55 row_ror:1 row_mask:0xf bank_mask:0xf
    s_cmp_eq_u32 s55, 0
    s_cbranch_scc1 Lzn_110
    v_mov_b64 v[40:41], 0
    v_mov_b64 v[42:43], 0
    v_mov_b64 v[44:45], 0
    v_mov_b64 v[46:47], 0
    v_mov_b64 v[48:49], 0
    v_mov_b64 v[50:51], 0
    v_mov_b64 v[52:53], 0
    v_mov_b64 v[54:55], 0
Lzn_110:
    ds_write_b128 v4, v[40:43] offset:0
    ds_write_b128 v4, v[44:47] offset:16
    ds_write_b128 v4, v[48:51] offset:32
    ds_write_b128 v4, v[52:55] offset:48
    s_waitcnt lgkmcnt(0)
    s_barrier
    s_cmp_lg_u32 s9, 0
    s_cbranch_scc1 Lzf_112
    s_cmp_lt_u32 s8, 10
    s_cbranch_scc1 Lzf_112
    ds_read_b32 v40, v5 offset:0
    ds_read_b32 v41, v5 offset:256
    ds_read_b32 v42, v5 offset:512
    ds_read_b32 v43, v5 offset:768
    s_waitcnt lgkmcnt(0)
    v_add_f32 v40, v40, v41
    v_add_f32 v42, v42, v43
    v_add_f32 v40, v40, v42
    global_store_dword v2, v40, s[68:69] sc1
Lzf_112:
    s_waitcnt vmcnt(0)
    s_barrier
    s_cmp_lg_u32 s9, 0
    s_cbranch_scc1 Lze_111
    v_mov_b32 v24, s97
    s_nop 0
    s_mov_b64 exec, 0xf
    global_store_dword v6, v24, s[74:75] offset:0 sc1
    s_mov_b64 exec, -1
Lze_111:
    s_add_u32 s64, s64, 65536
    s_addc_u32 s65, s65, 0
    s_add_u32 s66, s66, 90112
    s_addc_u32 s67, s67, 0
    s_add_u32 s68, s68, 8192
    s_addc_u32 s69, s69, 0
    s_add_u32 s72, s72, 4096
    s_addc_u32 s73, s73, 0
    s_add_u32 s74, s74, 32768
    s_addc_u32 s75, s75, 0
    s_add_u32 s76, s76, 2
    s_cmp_lt_u32 s76, 64
    s_cbranch_scc1 Lz_105
    s_branch Lout
Lg1:
    s_sub_u32 s96, s96, 140
    s_and_b32 s8, s96, 3
    s_lshr_b32 s3, s96, 2
    s_load_dwordx4 s[40:43], s[0:1], 72
    v_and_b32 v16, 63, v0
    v_and_b32 v17, 15, v16
    v_lshrrev_b32 v18, 4, v16
    v_lshlrev_b32 v1, 4, v16
    v_min_u32 v2, 11, v16
    v_lshlrev_b32 v2, 7, v2
    v_lshrrev_b32 v19, 2, v17
    v_lshlrev_b32 v19, 3, v19
    v_and_b32 v20, 3, v17
    v_add_u32 v19, v19, v20
    v_lshlrev_b32 v14, 1, v19
    v_lshlrev_b32 v3, 12, v19
    v_lshl_add_u32 v3, v18, 4, v3
    v_add_u32 v4, 16384, v3
    v_and_b32 v19, 31, v16
    v_lshlrev_b32 v19, 3, v19
    v_lshrrev_b32 v20, 5, v16
    v_mul_u32_u24 v20, 1536, v20
    v_add_u32 v5, v19, v20
    s_mul_i32 s44, s9, 3072
    v_add_u32 v6, s44, v1
    s_lshl_b32 s45, s9, 8
    s_add_u32 s45, s45, 24576
    v_add_u32 v7, s45, v19
    v_lshlrev_b32 v20, 6, v18
    v_add_u32 v8, s45, v20
    s_lshl_b32 s46, s3, 2
    s_add_u32 s46, s46, s9
    s_mul_i32 s47, s8, 12
    s_cmp_eq_u32 s8, 3
    s_cselect_b32 s47, 34, s47
    s_waitcnt lgkmcnt(0)
    s_add_u32 s64, s40, 0
    s_addc_u32 s65, s41, 0
    s_lshl_b32 s51, s46, 17
    s_add_u32 s64, s64, s51
    s_addc_u32 s65, s65, 0
    s_add_u32 s66, s4, 117440512
    s_addc_u32 s67, s5, 0
    s_lshl_b32 s51, s47, 10
    s_add_u32 s66, s66, s51
    s_addc_u32 s67, s67, 0
    s_add_u32 s68, s4, 121634816
    s_addc_u32 s69, s5, 0
    s_add_u32 s72, s4, 130024704
    s_addc_u32 s73, s5, 0
    s_lshl_b32 s51, s9, 12
    s_add_u32 s72, s72, s51
    s_addc_u32 s73, s73, 0
    s_add_u32 s78, s42, 0
    s_addc_u32 s79, s43, 0
    s_lshl_b32 s51, s46, 6
    s_add_u32 s78, s78, s51
    s_addc_u32 s79, s79, 0
    global_load_ushort v12, v14, s[78:79]
    global_load_ushort v13, v14, s[78:79] offset:8
    s_waitcnt vmcnt(0)
    v_lshlrev_b32 v12, 16, v12
    v_lshlrev_b32 v13, 16, v13
    v_mov_b32 v128, v12
    v_mov_b32 v129, v12
    v_mov_b32 v130, v12
    v_mov_b32 v131, v12
    v_mov_b32 v132, v13
    v_mov_b32 v133, v13
    v_mov_b32 v134, v13
    v_mov_b32 v135, v13
    v_mov_b32 v136, v12
    v_mov_b32 v137, v12
    v_mov_b32 v138, v12
    v_mov_b32 v139, v12
    v_mov_b32 v140, v13
    v_mov_b32 v141, v13
    v_mov_b32 v142, v13
    v_mov_b32 v143, v13
    v_mov_b32 v144, v12
    v_mov_b32 v145, v12
    v_mov_b32 v146, v12
    v_mov_b32 v147, v12
    v_mov_b32 v148, v13
    v_mov_b32 v149, v13
    v_mov_b32 v150, v13
    v_mov_b32 v151, v13
    v_mov_b32 v152, v12
    v_mov_b32 v153, v12
    v_mov_b32 v154, v12
    v_mov_b32 v155, v12
    v_mov_b32 v156, v13
    v_mov_b32 v157, v13
    v_mov_b32 v158, v13
    v_mov_b32 v159, v13
    v_mov_b32 v160, v12
    v_mov_b32 v161, v12
    v_mov_b32 v162, v12
    v_mov_b32 v163, v12
    v_mov_b32 v164, v13
    v_mov_b32 v165, v13
    v_mov_b32 v166, v13
    v_mov_b32 v167, v13
    v_mov_b32 v168, v12
    v_mov_b32 v169, v12
    v_mov_b32 v170, v12
    v_mov_b32 v171, v12
    v_mov_b32 v172, v13
    v_mov_b32 v173, v13
    v_mov_b32 v174, v13
    v_mov_b32 v175, v13
    v_mov_b32 v176, v12
    v_mov_b32 v177, v12
    v_mov_b32 v178, v12
    v_mov_b32 v179, v12
    v_mov_b32 v180, v13
    v_mov_b32 v181, v13
    v_mov_b32 v182, v13
    v_mov_b32 v183, v13
    v_mov_b32 v184, v12
    v_mov_b32 v185, v12
    v_mov_b32 v186, v12
    v_mov_b32 v187, v12
    v_mov_b32 v188, v13
    v_mov_b32 v189, v13
    v_mov_b32 v190, v13
    v_mov_b32 v191, v13
    v_mov_b32 v192, v12
    v_mov_b32 v193, v12
    v_mov_b32 v194, v12
    v_mov_b32 v195, v12
    v_mov_b32 v196, v13
    v_mov_b32 v197, v13
    v_mov_b32 v198, v13
    v_mov_b32 v199, v13
    v_mov_b32 v200, v12
    v_mov_b32 v201, v12
    v_mov_b32 v202, v12
    v_mov_b32 v203, v12
    v_mov_b32 v204, v13
    v_mov_b32 v205, v13
    v_mov_b32 v206, v13
    v_mov_b32 v207, v13
    v_mov_b32 v208, v12
    v_mov_b32 v209, v12
    v_mov_b32 v210, v12
    v_mov_b32 v211, v12
    v_mov_b32 v212, v13
    v_mov_b32 v213, v13
    v_mov_b32 v214, v13
    v_mov_b32 v215, v13
    v_mov_b32 v216, v12
    v_mov_b32 v217, v12
    v_mov_b32 v218, v12
    v_mov_b32 v219, v12
    v_mov_b32 v220, v13
    v_mov_b32 v221, v13
    v_mov_b32 v222, v13
    v_mov_b32 v223, v13
    global_load_dwordx4 v[56:59], v3, s[64:65]
    global_load_dwordx4 v[60:63], v4, s[64:65]
    s_mov_b32 s76, 0
    s_mul_i32 s48, s46, 45056
    s_add_u32 s70, s4, 113770496
    s_addc_u32 s71, s5, 0
    s_lshl_b32 s51, s47, 10
    s_add_u32 s70, s70, s51
    s_addc_u32 s71, s71, 0
    s_lshl_b32 s51, s48, 0
    s_add_u32 s70, s70, s51
    s_addc_u32 s71, s71, 0
    s_add_u32 s74, s4, 130023424
    s_addc_u32 s75, s5, 0
    s_lshl_b32 s51, s46, 14
    s_add_u32 s74, s74, s51
    s_addc_u32 s75, s75, 0
    s_lshl_b32 s51, s9, 12
    s_add_u32 s74, s74, s51
    s_addc_u32 s75, s75, 0
    s_barrier
    s_mov_b32 s60, 0
    s_mov_b64 exec, 0xfff
    global_load_dword v9, v2, s[72:73] sc1
    s_waitcnt vmcnt(0)
    v_cmp_ne_u32 vcc, s97, v9
    s_cbranch_vccz Lwf_114
    global_load_dword v9, v2, s[72:73] sc1
    s_sleep 2
Lwf_113:
    global_load_dword v9, v2, s[72:73] sc1
    s_add_u32 s60, s60, 1
    s_cmp_gt_u32 s60, 1000000
    s_cbranch_scc1 Lfail
    s_waitcnt vmcnt(1)
    v_cmp_ne_u32 vcc, s97, v9
    s_cbranch_vccz Lwf_114
    s_sleep 1
    s_cmp_ge_u32 s76, 52
    s_cbranch_scc1 Lwf_113
    s_sleep 12
    s_branch Lwf_113
Lwf_114:
    s_mov_b64 exec, -1
    global_load_dwordx2 v[28:29], v5, s[68:69] offset:0 sc1
    global_load_dwordx2 v[30:31], v5, s[68:69] offset:256 sc1
    global_load_dwordx2 v[32:33], v5, s[68:69] offset:512 sc1
    global_load_dwordx2 v[34:35], v5, s[68:69] offset:768 sc1
    global_load_dwordx2 v[36:37], v5, s[68:69] offset:1024 sc1
    global_load_dwordx2 v[38:39], v5, s[68:69] offset:1280 sc1
    global_load_dwordx4 v[16:19], v6, s[66:67] offset:0 sc1
    global_load_dwordx4 v[20:23], v6, s[66:67] offset:1024 sc1
    global_load_dwordx4 v[24:27], v6, s[66:67] offset:2048 sc1
Lg_115:
    s_add_u32 s66, s66, 45056
    s_addc_u32 s67, s67, 0
    s_add_u32 s68, s68, 4096
    s_addc_u32 s69, s69, 0
    s_add_u32 s72, s72, 16384
    s_addc_u32 s73, s73, 0
    global_load_dword v15, v2, s[72:73] sc1
    s_add_u32 s40, s76, 1
    s_and_b32 s40, s40, 63
    s_lshl_b32 s40, s40, 6
    v_add_u32 v10, s40, v3
    v_add_u32 v11, s40, v4
    global_load_dwordx4 v[64:67], v10, s[64:65]
    global_load_dwordx4 v[68:71], v11, s[64:65]
    s_waitcnt vmcnt(6)
    v_add_f32 v28, v28, v30
    v_add_f32 v29, v29, v31
    v_add_f32 v28, v28, v32
    v_add_f32 v29, v29, v33
    v_add_f32 v28, v28, v34
    v_add_f32 v29, v29, v35
    v_add_f32 v28, v28, v36
    v_add_f32 v29, v29, v37
    v_add_f32 v28, v28, v38
    v_add_f32 v29, v29, v39
    v_mov_b32 v30, v28
    v_mov_b32 v31, v29
    s_nop 0
    v_permlane32_swap_b32 v28, v30
    v_permlane32_swap_b32 v29, v31
    v_add_f32 v28, v28, v30
    v_add_f32 v29, v29, v31
    v_mul_f32 v28, 0x3abe82fa, v28
    v_mul_f32 v29, 0x3abe82fa, v29
    v_fma_f32 v29, -v28, v28, v29
    v_max_f32 v29, 0, v29
    v_add_f32 v29, 0x3727c5ac, v29
    v_rsq_f32 v30, v29
    s_nop 0
    v_mul_f32_e64 v31, -v28, v30
    ds_write_b64 v7, v[30:31]
    s_waitcnt lgkmcnt(0)
    ds_read_b128 v[40:43], v8 offset:0
    ds_read_b128 v[44:47], v8 offset:16
    ds_read_b128 v[48:51], v8 offset:32
    ds_read_b128 v[52:55], v8 offset:48
    s_waitcnt vmcnt(3)
    v_lshlrev_b32 v120, 16, v16
    v_and_b32 v121, 0xffff0000, v16
    v_lshlrev_b32 v122, 16, v17
    v_and_b32 v123, 0xffff0000, v17
    v_lshlrev_b32 v124, 16, v18
    v_and_b32 v125, 0xffff0000, v18
    v_lshlrev_b32 v126, 16, v19
    v_and_b32 v127, 0xffff0000, v19
    s_waitcnt lgkmcnt(0)
    v_fma_f32 v120, v120, v40, v41
    v_fma_f32 v121, v121, v42, v43
    v_fma_f32 v122, v122, v44, v45
    v_fma_f32 v123, v123, v46, v47
    v_fma_f32 v124, v124, v48, v49
    v_fma_f32 v125, v125, v50, v51
    v_fma_f32 v126, v126, v52, v53
    v_fma_f32 v127, v127, v54, v55
    v_cvt_pk_bf16_f32 v16, v120, v121
    v_cvt_pk_bf16_f32 v17, v122, v123
    v_cvt_pk_bf16_f32 v18, v124, v125
    v_cvt_pk_bf16_f32 v19, v126, v127
    ds_write_b128 v6, v[16:19] offset:0
    v_lshlrev_b32 v120, 16, v20
    v_and_b32 v121, 0xffff0000, v20
    v_lshlrev_b32 v122, 16, v21
    v_and_b32 v123, 0xffff0000, v21
    v_lshlrev_b32 v124, 16, v22
    v_and_b32 v125, 0xffff0000, v22
    v_lshlrev_b32 v126, 16, v23
    v_and_b32 v127, 0xffff0000, v23
    v_fma_f32 v120, v120, v40, v41
    v_fma_f32 v121, v121, v42, v43
    v_fma_f32 v122, v122, v44, v45
    v_fma_f32 v123, v123, v46, v47
    v_fma_f32 v124, v124, v48, v49
    v_fma_f32 v125, v125, v50, v51
    v_fma_f32 v126, v126, v52, v53
    v_fma_f32 v127, v127, v54, v55
    v_cvt_pk_bf16_f32 v20, v120, v121
    v_cvt_pk_bf16_f32 v21, v122, v123
    v_cvt_pk_bf16_f32 v22, v124, v125
    v_cvt_pk_bf16_f32 v23, v126, v127
    ds_write_b128 v6, v[20:23] offset:1024
    v_lshlrev_b32 v120, 16, v24
    v_and_b32 v121, 0xffff0000, v24
    v_lshlrev_b32 v122, 16, v25
    v_and_b32 v123, 0xffff0000, v25
    v_lshlrev_b32 v124, 16, v26
    v_and_b32 v125, 0xffff0000, v26
    v_lshlrev_b32 v126, 16, v27
    v_and_b32 v127, 0xffff0000, v27
    v_fma_f32 v120, v120, v40, v41
    v_fma_f32 v121, v121, v42, v43
    v_fma_f32 v122, v122, v44, v45
    v_fma_f32 v123, v123, v46, v47
    v_fma_f32 v124, v124, v48, v49
    v_fma_f32 v125, v125, v50, v51
    v_fma_f32 v126, v126, v52, v53
    v_fma_f32 v127, v127, v54, v55
    v_cvt_pk_bf16_f32 v24, v120, v121
    v_cvt_pk_bf16_f32 v25, v122, v123
    v_cvt_pk_bf16_f32 v26, v124, v125
    v_cvt_pk_bf16_f32 v27, v126, v127
    ds_write_b128 v6, v[24:27] offset:2048
    s_waitcnt vmcnt(2) lgkmcnt(0)
    v_cmp_ne_u32 vcc, s97, v15
    s_nop 0
    s_and_b32 s41, vcc_lo, 0xfff
    s_cmp_lg_u32 s41, 0
    s_cbranch_scc1 Lgn_116
    global_load_dwordx2 v[28:29], v5, s[68:69] offset:0 sc1
    global_load_dwordx2 v[30:31], v5, s[68:69] offset:256 sc1
    global_load_dwordx2 v[32:33], v5, s[68:69] offset:512 sc1
    global_load_dwordx2 v[34:35], v5, s[68:69] offset:768 sc1
    global_load_dwordx2 v[36:37], v5, s[68:69] offset:1024 sc1
    global_load_dwordx2 v[38:39], v5, s[68:69] offset:1280 sc1
    global_load_dwordx4 v[16:19], v6, s[66:67] offset:0 sc1
    global_load_dwordx4 v[20:23], v6, s[66:67] offset:1024 sc1
    global_load_dwordx4 v[24:27], v6, s[66:67] offset:2048 sc1
Lgn_116:
    s_barrier
    ds_read_b128 v[72:75], v1 offset:0
    ds_read_b128 v[76:79], v1 offset:1024
    ds_read_b128 v[80:83], v1 offset:2048
    ds_read_b128 v[84:87], v1 offset:3072
    ds_read_b128 v[88:91], v1 offset:4096
    ds_read_b128 v[92:95], v1 offset:5120
    ds_read_b128 v[96:99], v1 offset:6144
    ds_read_b128 v[100:103], v1 offset:7168
    ds_read_b128 v[104:107], v1 offset:8192
    ds_read_b128 v[108:111], v1 offset:9216
    ds_read_b128 v[112:115], v1 offset:10240
    ds_read_b128 v[116:119], v1 offset:11264
    s_waitcnt lgkmcnt(11)
    v_mfma_f32_16x16x32_bf16 v[128:131], v[72:75], v[56:59], v[128:131]
    v_mfma_f32_16x16x32_bf16 v[132:135], v[72:75], v[60:63], v[132:135]
    s_waitcnt lgkmcnt(10)
    v_mfma_f32_16x16x32_bf16 v[136:139], v[76:79], v[56:59], v[136:139]
    v_mfma_f32_16x16x32_bf16 v[140:143], v[76:79], v[60:63], v[140:143]
    s_waitcnt lgkmcnt(9)
    v_mfma_f32_16x16x32_bf16 v[144:147], v[80:83], v[56:59], v[144:147]
    v_mfma_f32_16x16x32_bf16 v[148:151], v[80:83], v[60:63], v[148:151]
    s_waitcnt lgkmcnt(8)
    v_mfma_f32_16x16x32_bf16 v[152:155], v[84:87], v[56:59], v[152:155]
    v_mfma_f32_16x16x32_bf16 v[156:159], v[84:87], v[60:63], v[156:159]
    s_waitcnt lgkmcnt(7)
    v_mfma_f32_16x16x32_bf16 v[160:163], v[88:91], v[56:59], v[160:163]
    v_mfma_f32_16x16x32_bf16 v[164:167], v[88:91], v[60:63], v[164:167]
    s_waitcnt lgkmcnt(6)
    v_mfma_f32_16x16x32_bf16 v[168:171], v[92:95], v[56:59], v[168:171]
    v_mfma_f32_16x16x32_bf16 v[172:175], v[92:95], v[60:63], v[172:175]
    s_waitcnt lgkmcnt(5)
    v_mfma_f32_16x16x32_bf16 v[176:179], v[96:99], v[56:59], v[176:179]
    v_mfma_f32_16x16x32_bf16 v[180:183], v[96:99], v[60:63], v[180:183]
    s_waitcnt lgkmcnt(4)
    v_mfma_f32_16x16x32_bf16 v[184:187], v[100:103], v[56:59], v[184:187]
    v_mfma_f32_16x16x32_bf16 v[188:191], v[100:103], v[60:63], v[188:191]
    s_waitcnt lgkmcnt(3)
    v_mfma_f32_16x16x32_bf16 v[192:195], v[104:107], v[56:59], v[192:195]
    v_mfma_f32_16x16x32_bf16 v[196:199], v[104:107], v[60:63], v[196:199]
    s_waitcnt lgkmcnt(2)
    v_mfma_f32_16x16x32_bf16 v[200:203], v[108:111], v[56:59], v[200:203]
    v_mfma_f32_16x16x32_bf16 v[204:207], v[108:111], v[60:63], v[204:207]
    s_waitcnt lgkmcnt(1)
    v_mfma_f32_16x16x32_bf16 v[208:211], v[112:115], v[56:59], v[208:211]
    v_mfma_f32_16x16x32_bf16 v[212:215], v[112:115], v[60:63], v[212:215]
    s_waitcnt lgkmcnt(0)
    v_mfma_f32_16x16x32_bf16 v[216:219], v[116:119], v[56:59], v[216:219]
    v_mfma_f32_16x16x32_bf16 v[220:223], v[116:119], v[60:63], v[220:223]
    s_cmp_eq_u32 s41, 0
    s_cbranch_scc1 Lgb_117
    s_mov_b32 s60, 0
    s_mov_b64 exec, 0xfff
    global_load_dword v9, v2, s[72:73] sc1
    s_waitcnt vmcnt(0)
    v_cmp_ne_u32 vcc, s97, v9
    s_cbranch_vccz Lwf_119
    global_load_dword v9, v2, s[72:73] sc1
    s_sleep 2
Lwf_118:
    global_load_dword v9, v2, s[72:73] sc1
    s_add_u32 s60, s60, 1
    s_cmp_gt_u32 s60, 1000000
    s_cbranch_scc1 Lfail
    s_waitcnt vmcnt(1)
    v_cmp_ne_u32 vcc, s97, v9
    s_cbranch_vccz Lwf_119
    s_sleep 1
    s_cmp_ge_u32 s76, 52
    s_cbranch_scc1 Lwf_118
    s_sleep 12
    s_branch Lwf_118
Lwf_119:
    s_mov_b64 exec, -1
    global_load_dwordx2 v[28:29], v5, s[68:69] offset:0 sc1
    global_load_dwordx2 v[30:31], v5, s[68:69] offset:256 sc1
    global_load_dwordx2 v[32:33], v5, s[68:69] offset:512 sc1
    global_load_dwordx2 v[34:35], v5, s[68:69] offset:768 sc1
    global_load_dwordx2 v[36:37], v5, s[68:69] offset:1024 sc1
    global_load_dwordx2 v[38:39], v5, s[68:69] offset:1280 sc1
    global_load_dwordx4 v[16:19], v6, s[66:67] offset:0 sc1
    global_load_dwordx4 v[20:23], v6, s[66:67] offset:1024 sc1
    global_load_dwordx4 v[24:27], v6, s[66:67] offset:2048 sc1
Lgb_117:
    s_cmp_lg_u32 s76, 62
    s_cbranch_scc1 Lgz3_120
    s_cmp_lg_u32 s3, 15
    s_cbranch_scc1 Lgz3_120
    s_mov_b32 s60, 0
    s_mov_b64 exec, 0x7ff
    global_load_dword v9, v2, s[74:75] sc1
    s_waitcnt vmcnt(0)
    v_cmp_ne_u32 vcc, s97, v9
    s_cbranch_vccz Lwf_122
    global_load_dword v9, v2, s[74:75] sc1
    s_sleep 2
Lwf_121:
    global_load_dword v9, v2, s[74:75] sc1
    s_add_u32 s60, s60, 1
    s_cmp_gt_u32 s60, 1000000
    s_cbranch_scc1 Lfail
    s_waitcnt vmcnt(1)
    v_cmp_ne_u32 vcc, s97, v9
    s_cbranch_vccz Lwf_122
    s_sleep 1
    s_branch Lwf_121
Lwf_122:
    s_mov_b64 exec, -1
    v_add_u32 v10, 4096, v1
    v_add_u32 v11, 8192, v1
    global_load_dwordx4 a[176:179], v1, s[70:71] offset:0 sc1
    global_load_dwordx4 a[180:183], v1, s[70:71] offset:1024 sc1
    global_load_dwordx4 a[184:187], v1, s[70:71] offset:2048 sc1
    global_load_dwordx4 a[188:191], v1, s[70:71] offset:3072 sc1
    global_load_dwordx4 a[192:195], v10, s[70:71] offset:0 sc1
    global_load_dwordx4 a[196:199], v10, s[70:71] offset:1024 sc1
    global_load_dwordx4 a[200:203], v10, s[70:71] offset:2048 sc1
    global_load_dwordx4 a[204:207], v10, s[70:71] offset:3072 sc1
    global_load_dwordx4 a[208:211], v11, s[70:71] offset:0 sc1
    global_load_dwordx4 a[212:215], v11, s[70:71] offset:1024 sc1
    global_load_dwordx4 a[216:219], v11, s[70:71] offset:2048 sc1
    global_load_dwordx4 a[220:223], v11, s[70:71] offset:3072 sc1
Lgz3_120:
    s_add_u32 s66, s66, 45056
    s_addc_u32 s67, s67, 0
    s_add_u32 s68, s68, 4096
    s_addc_u32 s69, s69, 0
    s_add_u32 s72, s72, 16384
    s_addc_u32 s73, s73, 0
    global_load_dword v15, v2, s[72:73] sc1
    s_add_u32 s40, s76, 2
    s_and_b32 s40, s40, 63
    s_lshl_b32 s40, s40, 6
    v_add_u32 v10, s40, v3
    v_add_u32 v11, s40, v4
    global_load_dwordx4 v[56:59], v10, s[64:65]
    global_load_dwordx4 v[60:63], v11, s[64:65]
    s_waitcnt vmcnt(6)
    v_add_f32 v28, v28, v30
    v_add_f32 v29, v29, v31
    v_add_f32 v28, v28, v32
    v_add_f32 v29, v29, v33
    v_add_f32 v28, v28, v34
    v_add_f32 v29, v29, v35
    v_add_f32 v28, v28, v36
    v_add_f32 v29, v29, v37
    v_add_f32 v28, v28, v38
    v_add_f32 v29, v29, v39
    v_mov_b32 v30, v28
    v_mov_b32 v31, v29
    s_nop 0
    v_permlane32_swap_b32 v28, v30
    v_permlane32_swap_b32 v29, v31
    v_add_f32 v28, v28, v30
    v_add_f32 v29, v29, v31
    v_mul_f32 v28, 0x3abe82fa, v28
    v_mul_f32 v29, 0x3abe82fa, v29
    v_fma_f32 v29, -v28, v28, v29
    v_max_f32 v29, 0, v29
    v_add_f32 v29, 0x3727c5ac, v29
    v_rsq_f32 v30, v29
    s_nop 0
    v_mul_f32_e64 v31, -v28, v30
    ds_write_b64 v7, v[30:31]
    s_waitcnt lgkmcnt(0)
    ds_read_b128 v[40:43], v8 offset:0
    ds_read_b128 v[44:47], v8 offset:16
    ds_read_b128 v[48:51], v8 offset:32
    ds_read_b128 v[52:55], v8 offset:48
    s_waitcnt vmcnt(3)
    v_lshlrev_b32 v120, 16, v16
    v_and_b32 v121, 0xffff0000, v16
    v_lshlrev_b32 v122, 16, v17
    v_and_b32 v123, 0xffff0000, v17
    v_lshlrev_b32 v124, 16, v18
    v_and_b32 v125, 0xffff0000, v18
    v_lshlrev_b32 v126, 16, v19
    v_and_b32 v127, 0xffff0000, v19
    s_waitcnt lgkmcnt(0)
    v_fma_f32 v120, v120, v40, v41
    v_fma_f32 v121, v121, v42, v43
    v_fma_f32 v122, v122, v44, v45
    v_fma_f32 v123, v123, v46, v47
    v_fma_f32 v124, v124, v48, v49
    v_fma_f32 v125, v125, v50, v51
    v_fma_f32 v126, v126, v52, v53
    v_fma_f32 v127, v127, v54, v55
    v_cvt_pk_bf16_f32 v16, v120, v121
    v_cvt_pk_bf16_f32 v17, v122, v123
    v_cvt_pk_bf16_f32 v18, v124, v125
    v_cvt_pk_bf16_f32 v19, v126, v127
    ds_write_b128 v6, v[16:19] offset:12288
    v_lshlrev_b32 v120, 16, v20
    v_and_b32 v121, 0xffff0000, v20
    v_lshlrev_b32 v122, 16, v21
    v_and_b32 v123, 0xffff0000, v21
    v_lshlrev_b32 v124, 16, v22
    v_and_b32 v125, 0xffff0000, v22
    v_lshlrev_b32 v126, 16, v23
    v_and_b32 v127, 0xffff0000, v23
    v_fma_f32 v120, v120, v40, v41
    v_fma_f32 v121, v121, v42, v43
    v_fma_f32 v122, v122, v44, v45
    v_fma_f32 v123, v123, v46, v47
    v_fma_f32 v124, v124, v48, v49
    v_fma_f32 v125, v125, v50, v51
    v_fma_f32 v126, v126, v52, v53
    v_fma_f32 v127, v127, v54, v55
    v_cvt_pk_bf16_f32 v20, v120, v121
    v_cvt_pk_bf16_f32 v21, v122, v123
    v_cvt_pk_bf16_f32 v22, v124, v125
    v_cvt_pk_bf16_f32 v23, v126, v127
    ds_write_b128 v6, v[20:23] offset:13312
    v_lshlrev_b32 v120, 16, v24
    v_and_b32 v121, 0xffff0000, v24
    v_lshlrev_b32 v122, 16, v25
    v_and_b32 v123, 0xffff0000, v25
    v_lshlrev_b32 v124, 16, v26
    v_and_b32 v125, 0xffff0000, v26
    v_lshlrev_b32 v126, 16, v27
    v_and_b32 v127, 0xffff0000, v27
    v_fma_f32 v120, v120, v40, v41
    v_fma_f32 v121, v121, v42, v43
    v_fma_f32 v122, v122, v44, v45
    v_fma_f32 v123, v123, v46, v47
    v_fma_f32 v124, v124, v48, v49
    v_fma_f32 v125, v125, v50, v51
    v_fma_f32 v126, v126, v52, v53
    v_fma_f32 v127, v127, v54, v55
    v_cvt_pk_bf16_f32 v24, v120, v121
    v_cvt_pk_bf16_f32 v25, v122, v123
    v_cvt_pk_bf16_f32 v26, v124, v125
    v_cvt_pk_bf16_f32 v27, v126, v127
    ds_write_b128 v6, v[24:27] offset:14336
    s_waitcnt vmcnt(2) lgkmcnt(0)
    v_cmp_ne_u32 vcc, s97, v15
    s_nop 0
    s_and_b32 s41, vcc_lo, 0xfff
    s_cmp_eq_u32 s76, 62
    s_cselect_b32 s41, 0, s41
    s_cbranch_scc1 Lgn_123
    s_cmp_lg_u32 s41, 0
    s_cbranch_scc1 Lgn_123
    global_load_dwordx2 v[28:29], v5, s[68:69] offset:0 sc1
    global_load_dwordx2 v[30:31], v5, s[68:69] offset:256 sc1
    global_load_dwordx2 v[32:33], v5, s[68:69] offset:512 sc1
    global_load_dwordx2 v[34:35], v5, s[68:69] offset:768 sc1
    global_load_dwordx2 v[36:37], v5, s[68:69] offset:1024 sc1
    global_load_dwordx2 v[38:39], v5, s[68:69] offset:1280 sc1
    global_load_dwordx4 v[16:19], v6, s[66:67] offset:0 sc1
    global_load_dwordx4 v[20:23], v6, s[66:67] offset:1024 sc1
    global_load_dwordx4 v[24:27], v6, s[66:67] offset:2048 sc1
Lgn_123:
    s_barrier
    ds_read_b128 v[72:75], v1 offset:12288
    ds_read_b128 v[76:79], v1 offset:13312
    ds_read_b128 v[80:83], v1 offset:14336
    ds_read_b128 v[84:87], v1 offset:15360
    ds_read_b128 v[88:91], v1 offset:16384
    ds_read_b128 v[92:95], v1 offset:17408
    ds_read_b128 v[96:99], v1 offset:18432
    ds_read_b128 v[100:103], v1 offset:19456
    ds_read_b128 v[104:107], v1 offset:20480
    ds_read_b128 v[108:111], v1 offset:21504
    ds_read_b128 v[112:115], v1 offset:22528
    ds_read_b128 v[116:119], v1 offset:23552
    s_waitcnt lgkmcnt(11)
    v_mfma_f32_16x16x32_bf16 v[128:131], v[72:75], v[64:67], v[128:131]
    v_mfma_f32_16x16x32_bf16 v[132:135], v[72:75], v[68:71], v[132:135]
    s_waitcnt lgkmcnt(10)
    v_mfma_f32_16x16x32_bf16 v[136:139], v[76:79], v[64:67], v[136:139]
    v_mfma_f32_16x16x32_bf16 v[140:143], v[76:79], v[68:71], v[140:143]
    s_waitcnt lgkmcnt(9)
    v_mfma_f32_16x16x32_bf16 v[144:147], v[80:83], v[64:67], v[144:147]
    v_mfma_f32_16x16x32_bf16 v[148:151], v[80:83], v[68:71], v[148:151]
    s_waitcnt lgkmcnt(8)
    v_mfma_f32_16x16x32_bf16 v[152:155], v[84:87], v[64:67], v[152:155]
    v_mfma_f32_16x16x32_bf16 v[156:159], v[84:87], v[68:71], v[156:159]
    s_waitcnt lgkmcnt(7)
    v_mfma_f32_16x16x32_bf16 v[160:163], v[88:91], v[64:67], v[160:163]
    v_mfma_f32_16x16x32_bf16 v[164:167], v[88:91], v[68:71], v[164:167]
    s_waitcnt lgkmcnt(6)
    v_mfma_f32_16x16x32_bf16 v[168:171], v[92:95], v[64:67], v[168:171]
    v_mfma_f32_16x16x32_bf16 v[172:175], v[92:95], v[68:71], v[172:175]
    s_waitcnt lgkmcnt(5)
    v_mfma_f32_16x16x32_bf16 v[176:179], v[96:99], v[64:67], v[176:179]
    v_mfma_f32_16x16x32_bf16 v[180:183], v[96:99], v[68:71], v[180:183]
    s_waitcnt lgkmcnt(4)
    v_mfma_f32_16x16x32_bf16 v[184:187], v[100:103], v[64:67], v[184:187]
    v_mfma_f32_16x16x32_bf16 v[188:191], v[100:103], v[68:71], v[188:191]
    s_waitcnt lgkmcnt(3)
    v_mfma_f32_16x16x32_bf16 v[192:195], v[104:107], v[64:67], v[192:195]
    v_mfma_f32_16x16x32_bf16 v[196:199], v[104:107], v[68:71], v[196:199]
    s_waitcnt lgkmcnt(2)
    v_mfma_f32_16x16x32_bf16 v[200:203], v[108:111], v[64:67], v[200:203]
    v_mfma_f32_16x16x32_bf16 v[204:207], v[108:111], v[68:71], v[204:207]
    s_waitcnt lgkmcnt(1)
    v_mfma_f32_16x16x32_bf16 v[208:211], v[112:115], v[64:67], v[208:211]
    v_mfma_f32_16x16x32_bf16 v[212:215], v[112:115], v[68:71], v[212:215]
    s_waitcnt lgkmcnt(0)
    v_mfma_f32_16x16x32_bf16 v[216:219], v[116:119], v[64:67], v[216:219]
    v_mfma_f32_16x16x32_bf16 v[220:223], v[116:119], v[68:71], v[220:223]
    s_cmp_lg_u32 s76, 60
    s_cbranch_scc1 Lgz1_125
    s_cmp_eq_u32 s3, 15
    s_cbranch_scc1 Lgz1_125
    s_mov_b32 s60, 0
    s_mov_b64 exec, 0x7ff
    global_load_dword v9, v2, s[74:75] sc1
    s_waitcnt vmcnt(0)
    v_cmp_ne_u32 vcc, s97, v9
    s_cbranch_vccz Lwf_127
    global_load_dword v9, v2, s[74:75] sc1
    s_sleep 2
Lwf_126:
    global_load_dword v9, v2, s[74:75] sc1
    s_add_u32 s60, s60, 1
    s_cmp_gt_u32 s60, 1000000
    s_cbranch_scc1 Lfail
    s_waitcnt vmcnt(1)
    v_cmp_ne_u32 vcc, s97, v9
    s_cbranch_vccz Lwf_127
    s_sleep 1
    s_branch Lwf_126
Lwf_127:
    s_mov_b64 exec, -1
    v_add_u32 v10, 4096, v1
    v_add_u32 v11, 8192, v1
    global_load_dwordx4 a[176:179], v1, s[70:71] offset:0 sc1
    global_load_dwordx4 a[180:183], v1, s[70:71] offset:1024 sc1
    global_load_dwordx4 a[184:187], v1, s[70:71] offset:2048 sc1
    global_load_dwordx4 a[188:191], v1, s[70:71] offset:3072 sc1
    global_load_dwordx4 a[192:195], v10, s[70:71] offset:0 sc1
    global_load_dwordx4 a[196:199], v10, s[70:71] offset:1024 sc1
    global_load_dwordx4 a[200:203], v10, s[70:71] offset:2048 sc1
    global_load_dwordx4 a[204:207], v10, s[70:71] offset:3072 sc1
    global_load_dwordx4 a[208:211], v11, s[70:71] offset:0 sc1
    global_load_dwordx4 a[212:215], v11, s[70:71] offset:1024 sc1
    global_load_dwordx4 a[216:219], v11, s[70:71] offset:2048 sc1
    global_load_dwordx4 a[220:223], v11, s[70:71] offset:3072 sc1
Lgz1_125:
    s_cmp_eq_u32 s41, 0
    s_cbranch_scc1 Lgb_124
    s_mov_b32 s60, 0
    s_mov_b64 exec, 0xfff
    global_load_dword v9, v2, s[72:73] sc1
    s_waitcnt vmcnt(0)
    v_cmp_ne_u32 vcc, s97, v9
    s_cbranch_vccz Lwf_129
    global_load_dword v9, v2, s[72:73] sc1
    s_sleep 2
Lwf_128:
    global_load_dword v9, v2, s[72:73] sc1
    s_add_u32 s60, s60, 1
    s_cmp_gt_u32 s60, 1000000
    s_cbranch_scc1 Lfail
    s_waitcnt vmcnt(1)
    v_cmp_ne_u32 vcc, s97, v9
    s_cbranch_vccz Lwf_129
    s_sleep 1
    s_cmp_ge_u32 s76, 52
    s_cbranch_scc1 Lwf_128
    s_sleep 12
    s_branch Lwf_128
Lwf_129:
    s_mov_b64 exec, -1
    global_load_dwordx2 v[28:29], v5, s[68:69] offset:0 sc1
    global_load_dwordx2 v[30:31], v5, s[68:69] offset:256 sc1
    global_load_dwordx2 v[32:33], v5, s[68:69] offset:512 sc1
    global_load_dwordx2 v[34:35], v5, s[68:69] offset:768 sc1
    global_load_dwordx2 v[36:37], v5, s[68:69] offset:1024 sc1
    global_load_dwordx2 v[38:39], v5, s[68:69] offset:1280 sc1
    global_load_dwordx4 v[16:19], v6, s[66:67] offset:0 sc1
    global_load_dwordx4 v[20:23], v6, s[66:67] offset:1024 sc1
    global_load_dwordx4 v[24:27], v6, s[66:67] offset:2048 sc1
Lgb_124:
    s_add_u32 s76, s76, 2
    s_cmp_lt_u32 s76, 64
    s_cbranch_scc1 Lg_115
    v_add_u32 v10, 4096, v1
    s_mov_b32 s40, s48
    s_lshr_b32 s41, s47, 1
    s_add_u32 s80, s4, 122683392
    s_addc_u32 s81, s5, 0
    s_lshl_b32 s51, s40, 0
    s_add_u32 s80, s80, s51
    s_addc_u32 s81, s81, 0
    s_lshl_b32 s51, s41, 10
    s_add_u32 s80, s80, s51
    s_addc_u32 s81, s81, 0
    s_add_u32 s74, s4, 127401984
    s_addc_u32 s75, s5, 0
    s_lshl_b32 s51, s46, 9
    s_add_u32 s74, s74, s51
    s_addc_u32 s75, s75, 0
    s_lshl_b32 s51, s8, 7
    s_add_u32 s74, s74, s51
    s_addc_u32 s75, s75, 0
    v_add_u32 v3, 22528, v1
    v_add_u32 v4, 26624, v1
    s_waitcnt vmcnt(0)
    v_accvgpr_read_b32 v16, a176
    v_accvgpr_read_b32 v17, a177
    v_accvgpr_read_b32 v18, a178
    v_accvgpr_read_b32 v19, a179
    v_lshlrev_b32 v120, 16, v16
    v_and_b32 v121, 0xffff0000, v16
    v_lshlrev_b32 v122, 16, v17
    v_and_b32 v123, 0xffff0000, v17
    v_lshlrev_b32 v124, 16, v18
    v_and_b32 v125, 0xffff0000, v18
    v_lshlrev_b32 v126, 16, v19
    v_and_b32 v127, 0xffff0000, v19
    v_pk_mul_f32 v[128:129], v[128:129], v[120:121]
    v_pk_mul_f32 v[130:131], v[130:131], v[122:123]
    v_cvt_pk_bf16_f32 v72, v128, v129
    v_cvt_pk_bf16_f32 v73, v130, v131
    v_pk_mul_f32 v[132:133], v[132:133], v[124:125]
    v_pk_mul_f32 v[134:135], v[134:135], v[126:127]
    v_cvt_pk_bf16_f32 v76, v132, v133
    v_cvt_pk_bf16_f32 v77, v134, v135
    v_accvgpr_read_b32 v16, a180
    v_accvgpr_read_b32 v17, a181
    v_accvgpr_read_b32 v18, a182
    v_accvgpr_read_b32 v19, a183
    v_lshlrev_b32 v120, 16, v16
    v_and_b32 v121, 0xffff0000, v16
    v_lshlrev_b32 v122, 16, v17
    v_and_b32 v123, 0xffff0000, v17
    v_lshlrev_b32 v124, 16, v18
    v_and_b32 v125, 0xffff0000, v18
    v_lshlrev_b32 v126, 16, v19
    v_and_b32 v127, 0xffff0000, v19
    v_pk_mul_f32 v[136:137], v[136:137], v[120:121]
    v_pk_mul_f32 v[138:139], v[138:139], v[122:123]
    v_cvt_pk_bf16_f32 v74, v136, v137
    v_cvt_pk_bf16_f32 v75, v138, v139
    v_pk_mul_f32 v[140:141], v[140:141], v[124:125]
    v_pk_mul_f32 v[142:143], v[142:143], v[126:127]
    v_cvt_pk_bf16_f32 v78, v140, v141
    v_cvt_pk_bf16_f32 v79, v142, v143
    global_store_dwordx4 v1, v[72:75], s[80:81] offset:0 sc1
    global_store_dwordx4 v3, v[76:79], s[80:81] offset:0 sc1
    v_accvgpr_read_b32 v16, a184
    v_accvgpr_read_b32 v17, a185
    v_accvgpr_read_b32 v18, a186
    v_accvgpr_read_b32 v19, a187
    v_lshlrev_b32 v120, 16, v16
    v_and_b32 v121, 0xffff0000, v16
    v_lshlrev_b32 v122, 16, v17
    v_and_b32 v123, 0xffff0000, v17
    v_lshlrev_b32 v124, 16, v18
    v_and_b32 v125, 0xffff0000, v18
    v_lshlrev_b32 v126, 16, v19
    v_and_b32 v127, 0xffff0000, v19
    v_pk_mul_f32 v[144:145], v[144:145], v[120:121]
    v_pk_mul_f32 v[146:147], v[146:147], v[122:123]
    v_cvt_pk_bf16_f32 v80, v144, v145
    v_cvt_pk_bf16_f32 v81, v146, v147
    v_pk_mul_f32 v[148:149], v[148:149], v[124:125]
    v_pk_mul_f32 v[150:151], v[150:151], v[126:127]
    v_cvt_pk_bf16_f32 v84, v148, v149
    v_cvt_pk_bf16_f32 v85, v150, v151
    v_accvgpr_read_b32 v16, a188
    v_accvgpr_read_b32 v17, a189
    v_accvgpr_read_b32 v18, a190
    v_accvgpr_read_b32 v19, a191
    v_lshlrev_b32 v120, 16, v16
    v_and_b32 v121, 0xffff0000, v16
    v_lshlrev_b32 v122, 16, v17
    v_and_b32 v123, 0xffff0000, v17
    v_lshlrev_b32 v124, 16, v18
    v_and_b32 v125, 0xffff0000, v18
    v_lshlrev_b32 v126, 16, v19
    v_and_b32 v127, 0xffff0000, v19
    v_pk_mul_f32 v[152:153], v[152:153], v[120:121]
    v_pk_mul_f32 v[154:155], v[154:155], v[122:123]
    v_cvt_pk_bf16_f32 v82, v152, v153
    v_cvt_pk_bf16_f32 v83, v154, v155
    v_pk_mul_f32 v[156:157], v[156:157], v[124:125]
    v_pk_mul_f32 v[158:159], v[158:159], v[126:127]
    v_cvt_pk_bf16_f32 v86, v156, v157
    v_cvt_pk_bf16_f32 v87, v158, v159
    global_store_dwordx4 v1, v[80:83], s[80:81] offset:1024 sc1
    global_store_dwordx4 v3, v[84:87], s[80:81] offset:1024 sc1
    v_accvgpr_read_b32 v16, a192
    v_accvgpr_read_b32 v17, a193
    v_accvgpr_read_b32 v18, a194
    v_accvgpr_read_b32 v19, a195
    v_lshlrev_b32 v120, 16, v16
    v_and_b32 v121, 0xffff0000, v16
    v_lshlrev_b32 v122, 16, v17
    v_and_b32 v123, 0xffff0000, v17
    v_lshlrev_b32 v124, 16, v18
    v_and_b32 v125, 0xffff0000, v18
    v_lshlrev_b32 v126, 16, v19
    v_and_b32 v127, 0xffff0000, v19
    v_pk_mul_f32 v[160:161], v[160:161], v[120:121]
    v_pk_mul_f32 v[162:163], v[162:163], v[122:123]
    v_cvt_pk_bf16_f32 v72, v160, v161
    v_cvt_pk_bf16_f32 v73, v162, v163
    v_pk_mul_f32 v[164:165], v[164:165], v[124:125]
    v_pk_mul_f32 v[166:167], v[166:167], v[126:127]
    v_cvt_pk_bf16_f32 v76, v164, v165
    v_cvt_pk_bf16_f32 v77, v166, v167
    v_accvgpr_read_b32 v16, a196
    v_accvgpr_read_b32 v17, a197
    v_accvgpr_read_b32 v18, a198
    v_accvgpr_read_b32 v19, a199
    v_lshlrev_b32 v120, 16, v16
    v_and_b32 v121, 0xffff0000, v16
    v_lshlrev_b32 v122, 16, v17
    v_and_b32 v123, 0xffff0000, v17
    v_lshlrev_b32 v124, 16, v18
    v_and_b32 v125, 0xffff0000, v18
    v_lshlrev_b32 v126, 16, v19
    v_and_b32 v127, 0xffff0000, v19
    v_pk_mul_f32 v[168:169], v[168:169], v[120:121]
    v_pk_mul_f32 v[170:171], v[170:171], v[122:123]
    v_cvt_pk_bf16_f32 v74, v168, v169
    v_cvt_pk_bf16_f32 v75, v170, v171
    v_pk_mul_f32 v[172:173], v[172:173], v[124:125]
    v_pk_mul_f32 v[174:175], v[174:175], v[126:127]
    v_cvt_pk_bf16_f32 v78, v172, v173
    v_cvt_pk_bf16_f32 v79, v174, v175
    global_store_dwordx4 v1, v[72:75], s[80:81] offset:2048 sc1
    global_store_dwordx4 v3, v[76:79], s[80:81] offset:2048 sc1
    v_accvgpr_read_b32 v16, a200
    v_accvgpr_read_b32 v17, a201
    v_accvgpr_read_b32 v18, a202
    v_accvgpr_read_b32 v19, a203
    v_lshlrev_b32 v120, 16, v16
    v_and_b32 v121, 0xffff0000, v16
    v_lshlrev_b32 v122, 16, v17
    v_and_b32 v123, 0xffff0000, v17
    v_lshlrev_b32 v124, 16, v18
    v_and_b32 v125, 0xffff0000, v18
    v_lshlrev_b32 v126, 16, v19
    v_and_b32 v127, 0xffff0000, v19
    v_pk_mul_f32 v[176:177], v[176:177], v[120:121]
    v_pk_mul_f32 v[178:179], v[178:179], v[122:123]
    v_cvt_pk_bf16_f32 v80, v176, v177
    v_cvt_pk_bf16_f32 v81, v178, v179
    v_pk_mul_f32 v[180:181], v[180:181], v[124:125]
    v_pk_mul_f32 v[182:183], v[182:183], v[126:127]
    v_cvt_pk_bf16_f32 v84, v180, v181
    v_cvt_pk_bf16_f32 v85, v182, v183
    v_accvgpr_read_b32 v16, a204
    v_accvgpr_read_b32 v17, a205
    v_accvgpr_read_b32 v18, a206
    v_accvgpr_read_b32 v19, a207
    v_lshlrev_b32 v120, 16, v16
    v_and_b32 v121, 0xffff0000, v16
    v_lshlrev_b32 v122, 16, v17
    v_and_b32 v123, 0xffff0000, v17
    v_lshlrev_b32 v124, 16, v18
    v_and_b32 v125, 0xffff0000, v18
    v_lshlrev_b32 v126, 16, v19
    v_and_b32 v127, 0xffff0000, v19
    v_pk_mul_f32 v[184:185], v[184:185], v[120:121]
    v_pk_mul_f32 v[186:187], v[186:187], v[122:123]
    v_cvt_pk_bf16_f32 v82, v184, v185
    v_cvt_pk_bf16_f32 v83, v186, v187
    v_pk_mul_f32 v[188:189], v[188:189], v[124:125]
    v_pk_mul_f32 v[190:191], v[190:191], v[126:127]
    v_cvt_pk_bf16_f32 v86, v188, v189
    v_cvt_pk_bf16_f32 v87, v190, v191
    global_store_dwordx4 v1, v[80:83], s[80:81] offset:3072 sc1
    global_store_dwordx4 v3, v[84:87], s[80:81] offset:3072 sc1
    v_accvgpr_read_b32 v16, a208
    v_accvgpr_read_b32 v17, a209
    v_accvgpr_read_b32 v18, a210
    v_accvgpr_read_b32 v19, a211
    v_lshlrev_b32 v120, 16, v16
    v_and_b32 v121, 0xffff0000, v16
    v_lshlrev_b32 v122, 16, v17
    v_and_b32 v123, 0xffff0000, v17
    v_lshlrev_b32 v124, 16, v18
    v_and_b32 v125, 0xffff0000, v18
    v_lshlrev_b32 v126, 16, v19
    v_and_b32 v127, 0xffff0000, v19
    v_pk_mul_f32 v[192:193], v[192:193], v[120:121]
    v_pk_mul_f32 v[194:195], v[194:195], v[122:123]
    v_cvt_pk_bf16_f32 v72, v192, v193
    v_cvt_pk_bf16_f32 v73, v194, v195
    v_pk_mul_f32 v[196:197], v[196:197], v[124:125]
    v_pk_mul_f32 v[198:199], v[198:199], v[126:127]
    v_cvt_pk_bf16_f32 v76, v196, v197
    v_cvt_pk_bf16_f32 v77, v198, v199
    v_accvgpr_read_b32 v16, a212
    v_accvgpr_read_b32 v17, a213
    v_accvgpr_read_b32 v18, a214
    v_accvgpr_read_b32 v19, a215
    v_lshlrev_b32 v120, 16, v16
    v_and_b32 v121, 0xffff0000, v16
    v_lshlrev_b32 v122, 16, v17
    v_and_b32 v123, 0xffff0000, v17
    v_lshlrev_b32 v124, 16, v18
    v_and_b32 v125, 0xffff0000, v18
    v_lshlrev_b32 v126, 16, v19
    v_and_b32 v127, 0xffff0000, v19
    v_pk_mul_f32 v[200:201], v[200:201], v[120:121]
    v_pk_mul_f32 v[202:203], v[202:203], v[122:123]
    v_cvt_pk_bf16_f32 v74, v200, v201
    v_cvt_pk_bf16_f32 v75, v202, v203
    v_pk_mul_f32 v[204:205], v[204:205], v[124:125]
    v_pk_mul_f32 v[206:207], v[206:207], v[126:127]
    v_cvt_pk_bf16_f32 v78, v204, v205
    v_cvt_pk_bf16_f32 v79, v206, v207
    s_cmp_lg_u32 s8, 3
    s_cbranch_scc1 Lgz_131
    v_mov_b64 v[74:75], 0
    v_mov_b64 v[78:79], 0
Lgz_131:
    global_store_dwordx4 v10, v[72:75], s[80:81] offset:0 sc1
    global_store_dwordx4 v4, v[76:79], s[80:81] offset:0 sc1
    s_cmp_ge_u32 s8, 2
    s_cbranch_scc1 Lgs_130
    v_accvgpr_read_b32 v16, a216
    v_accvgpr_read_b32 v17, a217
    v_accvgpr_read_b32 v18, a218
    v_accvgpr_read_b32 v19, a219
    v_lshlrev_b32 v120, 16, v16
    v_and_b32 v121, 0xffff0000, v16
    v_lshlrev_b32 v122, 16, v17
    v_and_b32 v123, 0xffff0000, v17
    v_lshlrev_b32 v124, 16, v18
    v_and_b32 v125, 0xffff0000, v18
    v_lshlrev_b32 v126, 16, v19
    v_and_b32 v127, 0xffff0000, v19
    v_pk_mul_f32 v[208:209], v[208:209], v[120:121]
    v_pk_mul_f32 v[210:211], v[210:211], v[122:123]
    v_cvt_pk_bf16_f32 v80, v208, v209
    v_cvt_pk_bf16_f32 v81, v210, v211
    v_pk_mul_f32 v[212:213], v[212:213], v[124:125]
    v_pk_mul_f32 v[214:215], v[214:215], v[126:127]
    v_cvt_pk_bf16_f32 v84, v212, v213
    v_cvt_pk_bf16_f32 v85, v214, v215
    v_accvgpr_read_b32 v16, a220
    v_accvgpr_read_b32 v17, a221
    v_accvgpr_read_b32 v18, a222
    v_accvgpr_read_b32 v19, a223
    v_lshlrev_b32 v120, 16, v16
    v_and_b32 v121, 0xffff0000, v16
    v_lshlrev_b32 v122, 16, v17
    v_and_b32 v123, 0xffff0000, v17
    v_lshlrev_b32 v124, 16, v18
    v_and_b32 v125, 0xffff0000, v18
    v_lshlrev_b32 v126, 16, v19
    v_and_b32 v127, 0xffff0000, v19
    v_pk_mul_f32 v[216:217], v[216:217], v[120:121]
    v_pk_mul_f32 v[218:219], v[218:219], v[122:123]
    v_cvt_pk_bf16_f32 v82, v216, v217
    v_cvt_pk_bf16_f32 v83, v218, v219
    v_pk_mul_f32 v[220:221], v[220:221], v[124:125]
    v_pk_mul_f32 v[222:223], v[222:223], v[126:127]
    v_cvt_pk_bf16_f32 v86, v220, v221
    v_cvt_pk_bf16_f32 v87, v222, v223
    global_store_dwordx4 v10, v[80:83], s[80:81] offset:1024 sc1
    global_store_dwordx4 v4, v[84:87], s[80:81] offset:1024 sc1
Lgs_130:
    v_mov_b32 v10, s97
    s_waitcnt vmcnt(0)
    s_mov_b64 exec, 0x1
    global_store_dword v1, v10, s[74:75] offset:0 sc1
    s_mov_b64 exec, -1
    s_sub_u32 s94, 63, s3
Lout:
    s_load_dwordx2 s[42:43], s[0:1], 112
    s_lshl_b32 s46, s95, 8
    s_lshl_b32 s47, s9, 6
    s_add_u32 s46, s46, s47
    s_waitcnt lgkmcnt(0)
    s_barrier
    v_and_b32 v16, 63, v0
    v_lshlrev_b32 v16, 6, v16
    v_add_u32 v16, 501792, v16
    s_mov_b32 s60, 0
    s_mov_b64 exec, 0xffffffff
    global_load_dword v17, v16, s[4:5] sc1
    s_waitcnt vmcnt(0)
    v_cmp_ne_u32 vcc, s97, v17
    s_cbranch_vccz Lwf_133
    global_load_dword v17, v16, s[4:5] sc1
    s_sleep 2
Lwf_132:
    global_load_dword v17, v16, s[4:5] sc1
    s_add_u32 s60, s60, 1
    s_cmp_gt_u32 s60, 1000000
    s_cbranch_scc1 Lfail
    s_waitcnt vmcnt(1)
    v_cmp_ne_u32 vcc, s97, v17
    s_cbranch_vccz Lwf_133
    s_sleep 1
    s_branch Lwf_132
Lwf_133:
    s_waitcnt vmcnt(0)
    s_mov_b64 exec, -1
    v_and_b32 v16, 63, v0
    v_and_b32 v17, 15, v16
    v_lshrrev_b32 v18, 4, v16
    v_lshlrev_b32 v1, 4, v16
    v_lshlrev_b32 v2, 2, v16
    s_mul_i32 s49, s9, 11264
    v_add_u32 v3, s49, v1
    v_lshrrev_b32 v19, 2, v17
    v_lshlrev_b32 v19, 3, v19
    v_and_b32 v20, 3, v17
    v_add_u32 v19, v19, v20
    v_lshlrev_b32 v4, 10, v19
    v_lshl_add_u32 v4, v18, 4, v4
    v_add_u32 v4, s46, v4
    v_add_u32 v5, 4096, v4
    v_add_u32 v12, 32768, v4
    v_add_u32 v13, 36864, v4
    v_lshlrev_b32 v19, 4, v18
    v_and_b32 v20, 32, v19
    v_add_u32 v19, v19, v20
    s_lshl_b32 s49, s46, 1
    v_add_u32 v19, s49, v19
    v_add_u32 v19, 501760, v19
    global_load_dwordx4 v[168:171], v19, s[4:5] sc1
    s_mul_i32 s49, s94, 45056
    s_add_u32 s64, s4, 122683392
    s_addc_u32 s65, s5, 0
    s_lshl_b32 s51, s49, 0
    s_add_u32 s64, s64, s51
    s_addc_u32 s65, s65, 0
    s_add_u32 s66, s4, 109576192
    s_addc_u32 s67, s5, 0
    s_lshl_b32 s51, s94, 15
    s_add_u32 s66, s66, s51
    s_addc_u32 s67, s67, 0
    s_add_u32 s68, s42, 0
    s_addc_u32 s69, s43, 0
    s_lshl_b32 s51, s94, 15
    s_add_u32 s68, s68, s51
    s_addc_u32 s69, s69, 0
    s_add_u32 s72, s4, 127401984
    s_addc_u32 s73, s5, 0
    s_lshl_b32 s51, s94, 9
    s_add_u32 s72, s72, s51
    s_addc_u32 s73, s73, 0
    v_lshlrev_b32 v7, 3, v1
    v_lshlrev_b32 v19, 4, v17
    v_lshrrev_b32 v20, 1, v18
    v_lshl_add_u32 v19, v20, 9, v19
    v_and_b32 v20, 1, v18
    v_lshl_add_u32 v19, v20, 3, v19
    s_lshl_b32 s49, s46, 4
    v_add_u32 v224, s49, v19
    v_add_u32 v224, 0, v224
    v_add_u32 v225, s49, v19
    v_add_u32 v225, 16384, v225
    v_add_u32 v201, 4096, v3
    v_add_u32 v202, 8192, v3
    v_mov_b32 v200, v3
    s_mov_b32 s60, 0
    s_mov_b64 exec, 0xf
    global_load_dword v10, v7, s[72:73] sc1
    s_waitcnt vmcnt(0)
    v_cmp_ne_u32 vcc, s97, v10
    s_cbranch_vccz Lwf_135
    global_load_dword v10, v7, s[72:73] sc1
    s_sleep 2
Lwf_134:
    global_load_dword v10, v7, s[72:73] sc1
    s_add_u32 s60, s60, 1
    s_cmp_gt_u32 s60, 1000000
    s_cbranch_scc1 Lfail
    s_waitcnt vmcnt(1)
    v_cmp_ne_u32 vcc, s97, v10
    s_cbranch_vccz Lwf_135
    s_sleep 1
    s_branch Lwf_134
Lwf_135:
    s_mov_b64 exec, -1
    global_load_dwordx4 v[16:19], v200, s[64:65] offset:0 sc1
    global_load_dwordx4 v[20:23], v200, s[64:65] offset:1024 sc1
    global_load_dwordx4 v[24:27], v200, s[64:65] offset:2048 sc1
    global_load_dwordx4 v[28:31], v200, s[64:65] offset:3072 sc1
    global_load_dwordx4 v[32:35], v201, s[64:65] offset:0 sc1
    global_load_dwordx4 v[36:39], v201, s[64:65] offset:1024 sc1
    global_load_dwordx4 v[40:43], v201, s[64:65] offset:2048 sc1
    global_load_dwordx4 v[44:47], v201, s[64:65] offset:3072 sc1
    global_load_dwordx4 v[48:51], v202, s[64:65] offset:0 sc1
    global_load_dwordx4 v[52:55], v202, s[64:65] offset:1024 sc1
    global_load_dwordx4 v[56:59], v202, s[64:65] offset:2048 sc1
    global_load_dwordx2 v[176:177], v224, s[66:67] offset:0 sc1
    global_load_dwordx2 v[178:179], v224, s[66:67] offset:256 sc1
    global_load_dwordx2 v[180:181], v225, s[66:67] offset:0 sc1
    global_load_dwordx2 v[182:183], v225, s[66:67] offset:256 sc1
    v_add_u32 v8, 45056, v1
    v_lshlrev_b32 v160, 16, v168
    v_and_b32 v161, 0xffff0000, v168
    v_lshlrev_b32 v162, 16, v169
    v_and_b32 v163, 0xffff0000, v169
    v_lshlrev_b32 v164, 16, v170
    v_and_b32 v165, 0xffff0000, v170
    v_lshlrev_b32 v166, 16, v171
    v_and_b32 v167, 0xffff0000, v171
    s_waitcnt vmcnt(14)
    ds_write_b128 v200, v[16:19] offset:0
    s_waitcnt vmcnt(13)
    ds_write_b128 v200, v[20:23] offset:1024
    s_waitcnt vmcnt(12)
    ds_write_b128 v200, v[24:27] offset:2048
    s_waitcnt vmcnt(11)
    ds_write_b128 v200, v[28:31] offset:3072
    s_waitcnt vmcnt(10)
    ds_write_b128 v200, v[32:35] offset:4096
    s_waitcnt vmcnt(9)
    ds_write_b128 v200, v[36:39] offset:5120
    s_waitcnt vmcnt(8)
    ds_write_b128 v200, v[40:43] offset:6144
    s_waitcnt vmcnt(7)
    ds_write_b128 v200, v[44:47] offset:7168
    s_waitcnt vmcnt(6)
    ds_write_b128 v200, v[48:51] offset:8192
    s_waitcnt vmcnt(5)
    ds_write_b128 v200, v[52:55] offset:9216
    s_waitcnt vmcnt(4)
    ds_write_b128 v200, v[56:59] offset:10240
    s_waitcnt lgkmcnt(0)
    s_barrier
    ds_read_b128 v[104:107], v1 offset:0
    ds_read_b128 v[108:111], v1 offset:22528
    ds_read_b128 v[112:115], v1 offset:1024
    ds_read_b128 v[116:119], v1 offset:23552
    ds_read_b128 v[120:123], v1 offset:2048
    ds_read_b128 v[124:127], v1 offset:24576
    ds_read_b128 v[128:131], v1 offset:3072
    s_waitcnt lgkmcnt(6)
    v_mfma_f32_16x16x32_bf16 v[136:139], a[0:3], v[104:107], 0
    ds_read_b128 v[132:135], v1 offset:25600
    v_mfma_f32_16x16x32_bf16 v[140:143], a[4:7], v[104:107], 0
    s_waitcnt lgkmcnt(6)
    v_mfma_f32_16x16x32_bf16 v[144:147], a[0:3], v[108:111], 0
    ds_read_b128 v[104:107], v1 offset:4096
    v_mfma_f32_16x16x32_bf16 v[148:151], a[4:7], v[108:111], 0
    s_waitcnt lgkmcnt(6)
    v_mfma_f32_16x16x32_bf16 v[136:139], a[8:11], v[112:115], v[136:139]
    ds_read_b128 v[108:111], v1 offset:26624
    v_mfma_f32_16x16x32_bf16 v[140:143], a[12:15], v[112:115], v[140:143]
    s_waitcnt lgkmcnt(6)
    v_mfma_f32_16x16x32_bf16 v[144:147], a[8:11], v[116:119], v[144:147]
    ds_read_b128 v[112:115], v1 offset:5120
    v_mfma_f32_16x16x32_bf16 v[148:151], a[12:15], v[116:119], v[148:151]
    s_waitcnt lgkmcnt(6)
    v_mfma_f32_16x16x32_bf16 v[136:139], a[16:19], v[120:123], v[136:139]
    ds_read_b128 v[116:119], v1 offset:27648
    v_mfma_f32_16x16x32_bf16 v[140:143], a[20:23], v[120:123], v[140:143]
    s_waitcnt lgkmcnt(6)
    v_mfma_f32_16x16x32_bf16 v[144:147], a[16:19], v[124:127], v[144:147]
    ds_read_b128 v[120:123], v1 offset:6144
    v_mfma_f32_16x16x32_bf16 v[148:151], a[20:23], v[124:127], v[148:151]
    s_waitcnt lgkmcnt(6)
    v_mfma_f32_16x16x32_bf16 v[136:139], a[24:27], v[128:131], v[136:139]
    ds_read_b128 v[124:127], v1 offset:28672
    v_mfma_f32_16x16x32_bf16 v[140:143], a[28:31], v[128:131], v[140:143]
    s_waitcnt lgkmcnt(6)
    v_mfma_f32_16x16x32_bf16 v[144:147], a[24:27], v[132:135], v[144:147]
    ds_read_b128 v[128:131], v1 offset:7168
    v_mfma_f32_16x16x32_bf16 v[148:151], a[28:31], v[132:135], v[148:151]
    s_waitcnt lgkmcnt(6)
    v_mfma_f32_16x16x32_bf16 v[136:139], a[32:35], v[104:107], v[136:139]
    ds_read_b128 v[132:135], v1 offset:29696
    v_mfma_f32_16x16x32_bf16 v[140:143], a[36:39], v[104:107], v[140:143]
    s_waitcnt lgkmcnt(6)
    v_mfma_f32_16x16x32_bf16 v[144:147], a[32:35], v[108:111], v[144:147]
    ds_read_b128 v[104:107], v1 offset:8192
    v_mfma_f32_16x16x32_bf16 v[148:151], a[36:39], v[108:111], v[148:151]
    s_waitcnt lgkmcnt(6)
    v_mfma_f32_16x16x32_bf16 v[136:139], a[40:43], v[112:115], v[136:139]
    ds_read_b128 v[108:111], v1 offset:30720
    v_mfma_f32_16x16x32_bf16 v[140:143], a[44:47], v[112:115], v[140:143]
    s_waitcnt lgkmcnt(6)
    v_mfma_f32_16x16x32_bf16 v[144:147], a[40:43], v[116:119], v[144:147]
    ds_read_b128 v[112:115], v1 offset:9216
    v_mfma_f32_16x16x32_bf16 v[148:151], a[44:47], v[116:119], v[148:151]
    s_waitcnt lgkmcnt(6)
    v_mfma_f32_16x16x32_bf16 v[136:139], a[48:51], v[120:123], v[136:139]
    ds_read_b128 v[116:119], v1 offset:31744
    v_mfma_f32_16x16x32_bf16 v[140:143], a[52:55], v[120:123], v[140:143]
    s_waitcnt lgkmcnt(6)
    v_mfma_f32_16x16x32_bf16 v[144:147], a[48:51], v[124:127], v[144:147]
    ds_read_b128 v[120:123], v1 offset:10240
    v_mfma_f32_16x16x32_bf16 v[148:151], a[52:55], v[124:127], v[148:151]
    s_waitcnt lgkmcnt(6)
    v_mfma_f32_16x16x32_bf16 v[136:139], a[56:59], v[128:131], v[136:139]
    ds_read_b128 v[124:127], v1 offset:32768
    v_mfma_f32_16x16x32_bf16 v[140:143], a[60:63], v[128:131], v[140:143]
    s_waitcnt lgkmcnt(6)
    v_mfma_f32_16x16x32_bf16 v[144:147], a[56:59], v[132:135], v[144:147]
    ds_read_b128 v[128:131], v1 offset:11264
    v_mfma_f32_16x16x32_bf16 v[148:151], a[60:63], v[132:135], v[148:151]
    s_waitcnt lgkmcnt(6)
    v_mfma_f32_16x16x32_bf16 v[136:139], a[64:67], v[104:107], v[136:139]
    ds_read_b128 v[132:135], v1 offset:33792
    v_mfma_f32_16x16x32_bf16 v[140:143], a[68:71], v[104:107], v[140:143]
    s_waitcnt lgkmcnt(6)
    v_mfma_f32_16x16x32_bf16 v[144:147], a[64:67], v[108:111], v[144:147]
    ds_read_b128 v[104:107], v1 offset:12288
    v_mfma_f32_16x16x32_bf16 v[148:151], a[68:71], v[108:111], v[148:151]
    s_waitcnt lgkmcnt(6)
    v_mfma_f32_16x16x32_bf16 v[136:139], a[72:75], v[112:115], v[136:139]
    ds_read_b128 v[108:111], v1 offset:34816
    v_mfma_f32_16x16x32_bf16 v[140:143], a[76:79], v[112:115], v[140:143]
    s_waitcnt lgkmcnt(6)
    v_mfma_f32_16x16x32_bf16 v[144:147], a[72:75], v[116:119], v[144:147]
    ds_read_b128 v[112:115], v1 offset:13312
    v_mfma_f32_16x16x32_bf16 v[148:151], a[76:79], v[116:119], v[148:151]
    s_waitcnt lgkmcnt(6)
    v_mfma_f32_16x16x32_bf16 v[136:139], a[80:83], v[120:123], v[136:139]
    ds_read_b128 v[116:119], v1 offset:35840
    v_mfma_f32_16x16x32_bf16 v[140:143], a[84:87], v[120:123], v[140:143]
    s_waitcnt lgkmcnt(6)
    v_mfma_f32_16x16x32_bf16 v[144:147], a[80:83], v[124:127], v[144:147]
    ds_read_b128 v[120:123], v1 offset:14336
    v_mfma_f32_16x16x32_bf16 v[148:151], a[84:87], v[124:127], v[148:151]
    s_waitcnt lgkmcnt(6)
    v_mfma_f32_16x16x32_bf16 v[136:139], a[88:91], v[128:131], v[136:139]
    ds_read_b128 v[124:127], v1 offset:36864
    v_mfma_f32_16x16x32_bf16 v[140:143], a[92:95], v[128:131], v[140:143]
    s_waitcnt lgkmcnt(6)
    v_mfma_f32_16x16x32_bf16 v[144:147], a[88:91], v[132:135], v[144:147]
    ds_read_b128 v[128:131], v1 offset:15360
    v_mfma_f32_16x16x32_bf16 v[148:151], a[92:95], v[132:135], v[148:151]
    s_waitcnt lgkmcnt(6)
    v_mfma_f32_16x16x32_bf16 v[136:139], a[96:99], v[104:107], v[136:139]
    ds_read_b128 v[132:135], v1 offset:37888
    v_mfma_f32_16x16x32_bf16 v[140:143], a[100:103], v[104:107], v[140:143]
    s_waitcnt lgkmcnt(6)
    v_mfma_f32_16x16x32_bf16 v[144:147], a[96:99], v[108:111], v[144:147]
    ds_read_b128 v[104:107], v1 offset:16384
    v_mfma_f32_16x16x32_bf16 v[148:151], a[100:103], v[108:111], v[148:151]
    s_waitcnt lgkmcnt(6)
    v_mfma_f32_16x16x32_bf16 v[136:139], a[104:107], v[112:115], v[136:139]
    ds_read_b128 v[108:111], v1 offset:38912
    v_mfma_f32_16x16x32_bf16 v[140:143], a[108:111], v[112:115], v[140:143]
    s_waitcnt lgkmcnt(6)
    v_mfma_f32_16x16x32_bf16 v[144:147], a[104:107], v[116:119], v[144:147]
    ds_read_b128 v[112:115], v1 offset:17408
    v_mfma_f32_16x16x32_bf16 v[148:151], a[108:111], v[116:119], v[148:151]
    s_waitcnt lgkmcnt(6)
    v_mfma_f32_16x16x32_bf16 v[136:139], a[112:115], v[120:123], v[136:139]
    ds_read_b128 v[116:119], v1 offset:39936
    v_mfma_f32_16x16x32_bf16 v[140:143], a[116:119], v[120:123], v[140:143]
    s_waitcnt lgkmcnt(6)
    v_mfma_f32_16x16x32_bf16 v[144:147], a[112:115], v[124:127], v[144:147]
    ds_read_b128 v[120:123], v1 offset:18432
    v_mfma_f32_16x16x32_bf16 v[148:151], a[116:119], v[124:127], v[148:151]
    s_waitcnt lgkmcnt(6)
    v_mfma_f32_16x16x32_bf16 v[136:139], a[120:123], v[128:131], v[136:139]
    ds_read_b128 v[124:127], v1 offset:40960
    v_mfma_f32_16x16x32_bf16 v[140:143], a[124:127], v[128:131], v[140:143]
    s_waitcnt lgkmcnt(6)
    v_mfma_f32_16x16x32_bf16 v[144:147], a[120:123], v[132:135], v[144:147]
    ds_read_b128 v[128:131], v1 offset:19456
    v_mfma_f32_16x16x32_bf16 v[148:151], a[124:127], v[132:135], v[148:151]
    s_waitcnt lgkmcnt(6)
    v_mfma_f32_16x16x32_bf16 v[136:139], a[128:131], v[104:107], v[136:139]
    ds_read_b128 v[132:135], v1 offset:41984
    v_mfma_f32_16x16x32_bf16 v[140:143], a[132:135], v[104:107], v[140:143]
    s_waitcnt lgkmcnt(6)
    v_mfma_f32_16x16x32_bf16 v[144:147], a[128:131], v[108:111], v[144:147]
    ds_read_b128 v[104:107], v1 offset:20480
    v_mfma_f32_16x16x32_bf16 v[148:151], a[132:135], v[108:111], v[148:151]
    s_waitcnt lgkmcnt(6)
    v_mfma_f32_16x16x32_bf16 v[136:139], a[136:139], v[112:115], v[136:139]
    ds_read_b128 v[108:111], v1 offset:43008
    v_mfma_f32_16x16x32_bf16 v[140:143], a[140:143], v[112:115], v[140:143]
    s_waitcnt lgkmcnt(6)
    v_mfma_f32_16x16x32_bf16 v[144:147], a[136:139], v[116:119], v[144:147]
    ds_read_b128 v[112:115], v1 offset:21504
    v_mfma_f32_16x16x32_bf16 v[148:151], a[140:143], v[116:119], v[148:151]
    s_waitcnt lgkmcnt(6)
    v_mfma_f32_16x16x32_bf16 v[136:139], a[144:147], v[120:123], v[136:139]
    ds_read_b128 v[116:119], v1 offset:44032
    v_mfma_f32_16x16x32_bf16 v[140:143], a[148:151], v[120:123], v[140:143]
    s_waitcnt lgkmcnt(6)
    v_mfma_f32_16x16x32_bf16 v[144:147], a[144:147], v[124:127], v[144:147]
    v_mfma_f32_16x16x32_bf16 v[148:151], a[148:151], v[124:127], v[148:151]
    s_waitcnt lgkmcnt(5)
    v_mfma_f32_16x16x32_bf16 v[136:139], a[152:155], v[128:131], v[136:139]
    v_mfma_f32_16x16x32_bf16 v[140:143], a[156:159], v[128:131], v[140:143]
    s_waitcnt lgkmcnt(4)
    v_mfma_f32_16x16x32_bf16 v[144:147], a[152:155], v[132:135], v[144:147]
    v_mfma_f32_16x16x32_bf16 v[148:151], a[156:159], v[132:135], v[148:151]
    s_waitcnt lgkmcnt(3)
    v_mfma_f32_16x16x32_bf16 v[136:139], a[160:163], v[104:107], v[136:139]
    v_mfma_f32_16x16x32_bf16 v[140:143], a[164:167], v[104:107], v[140:143]
    s_waitcnt lgkmcnt(2)
    v_mfma_f32_16x16x32_bf16 v[144:147], a[160:163], v[108:111], v[144:147]
    v_mfma_f32_16x16x32_bf16 v[148:151], a[164:167], v[108:111], v[148:151]
    s_waitcnt lgkmcnt(1)
    v_mfma_f32_16x16x32_bf16 v[136:139], a[168:171], v[112:115], v[136:139]
    v_mfma_f32_16x16x32_bf16 v[140:143], a[172:175], v[112:115], v[140:143]
    s_waitcnt lgkmcnt(0)
    v_mfma_f32_16x16x32_bf16 v[144:147], a[168:171], v[116:119], v[144:147]
    v_mfma_f32_16x16x32_bf16 v[148:151], a[172:175], v[116:119], v[148:151]
    s_waitcnt vmcnt(0)
    v_lshlrev_b32 v152, 16, v176
    v_and_b32 v153, 0xffff0000, v176
    v_lshlrev_b32 v154, 16, v177
    v_and_b32 v155, 0xffff0000, v177
    v_lshlrev_b32 v156, 16, v178
    v_and_b32 v157, 0xffff0000, v178
    v_lshlrev_b32 v158, 16, v179
    v_and_b32 v159, 0xffff0000, v179
    v_fmac_f32 v152, v136, v160
    v_fmac_f32 v153, v137, v161
    v_fmac_f32 v154, v138, v162
    v_fmac_f32 v155, v139, v163
    v_fmac_f32 v156, v140, v164
    v_fmac_f32 v157, v141, v165
    v_fmac_f32 v158, v142, v166
    v_fmac_f32 v159, v143, v167
    v_cvt_pk_bf16_f32 v16, v152, v153
    v_cvt_pk_bf16_f32 v17, v154, v155
    v_cvt_pk_bf16_f32 v18, v156, v157
    v_cvt_pk_bf16_f32 v19, v158, v159
    global_store_dwordx4 v4, v[16:19], s[68:69]
    v_lshlrev_b32 v152, 16, v180
    v_and_b32 v153, 0xffff0000, v180
    v_lshlrev_b32 v154, 16, v181
    v_and_b32 v155, 0xffff0000, v181
    v_lshlrev_b32 v156, 16, v182
    v_and_b32 v157, 0xffff0000, v182
    v_lshlrev_b32 v158, 16, v183
    v_and_b32 v159, 0xffff0000, v183
    v_fmac_f32 v152, v144, v160
    v_fmac_f32 v153, v145, v161
    v_fmac_f32 v154, v146, v162
    v_fmac_f32 v155, v147, v163
    v_fmac_f32 v156, v148, v164
    v_fmac_f32 v157, v149, v165
    v_fmac_f32 v158, v150, v166
    v_fmac_f32 v159, v151, v167
    v_cvt_pk_bf16_f32 v20, v152, v153
    v_cvt_pk_bf16_f32 v21, v154, v155
    v_cvt_pk_bf16_f32 v22, v156, v157
    v_cvt_pk_bf16_f32 v23, v158, v159
    global_store_dwordx4 v5, v[20:23], s[68:69]
Lend:
    s_branch Ldone
Lfail:
    s_mov_b64 exec, 1
    v_mov_b32 v2, 437248
    v_mov_b32 v3, s99
    global_store_dword v2, v3, s[4:5]
    s_waitcnt vmcnt(0)
    s_endpgm
Ldone:
    s_waitcnt vmcnt(0)
    s_endpgm
.fill 4096, 4, 0xBF800000
.section .rodata,"a"
.p2align 6
.amdhsa_kernel adaLN_cond__memory_aug_recurrent_mem_tr__mixer_gmlp__prompt_kernel
  .amdhsa_next_free_vgpr 512
  .amdhsa_next_free_sgpr 102
  .amdhsa_accum_offset 256
  .amdhsa_group_segment_fixed_size 0
  .amdhsa_kernarg_size 136
  .amdhsa_user_sgpr_count 2
  .amdhsa_user_sgpr_kernarg_segment_ptr 1
  .amdhsa_system_sgpr_workgroup_id_x 1
.end_amdhsa_kernel
```
